```python
import torch

def _softmax(x, axis=-1):
    return torch.softmax(x, dim=axis)

def _gelu(x):
    return torch.nn.functional.gelu(x, approximate='tanh')

def _silu(x):
    return torch.nn.functional.silu(x)

def _sigmoid(x):
    return torch.sigmoid(x)

def _layernorm(x, axis=-1, eps=1e-05):
    m = x.mean(dim=axis, keepdim=True)
    v = x.var(dim=axis, keepdim=True, unbiased=False)
    return (x - m) / torch.sqrt(v + eps)

def _scatter_add(tgt, idx, src, axis=0):
    return tgt.clone().index_add_(axis, idx, src)

def _segment_sum(src, seg, n):
    out = torch.zeros((n,) + src.shape[1:], dtype=src.dtype)
    return out.index_add_(0, seg, src)

def _pad(x, pw):
    flat = tuple((v for pair in reversed(pw) for v in pair))
    return torch.nn.functional.pad(x, flat)
kernel_name = 'adaLN_cond__gqa_block_cached__mixer_s_mlp__prompt'

def setup_inputs():

    _w = lambda a: (lambda t: t.to(torch.bfloat16) if t.is_floating_point() else t)(torch.as_tensor(a))

    def _A_setup():
        B, Sq, D = (1, 2048, 448)
        Hq, Hkv, Sk, Dh = (16, 8, 2048, 256)
        assert Hq % Hkv == 0, (Hq, Hkv)
        return {'x': _w((lambda *s: torch.randn(*s, dtype=torch.bfloat16) * 0.05)(B, Sq, D)), 'k_cache': _w((lambda *s: torch.randn(*s, dtype=torch.bfloat16) * 3.2)(B, Hkv, Sk, Dh)), 'v_cache': _w((lambda *s: torch.randn(*s, dtype=torch.bfloat16) * 0.4)(B, Hkv, Sk, Dh)), 'wq': _w((lambda *s: torch.randn(*s, dtype=torch.bfloat16) * 3.2)(D, Hq * Dh) * D ** (-0.5)), 'wo': _w((lambda *s: torch.randn(*s, dtype=torch.bfloat16) * 0.4)(Hq * Dh, D) * (Hq * Dh) ** (-0.5))}
    _A_in = _A_setup()

    def _B_setup():
        B, S, D, F = (1, 2048, 448, 1792)
        return {'x': _w((lambda *s: torch.randn(*s, dtype=torch.bfloat16) * 0.05)(B, S, D)), 'w1': _w((lambda *s: torch.randn(*s, dtype=torch.bfloat16) * 3.2)(D, D) * D ** (-0.5)), 'w2': _w((lambda *s: torch.randn(*s, dtype=torch.bfloat16) * 3.2)(D, D) * D ** (-0.5)), 'w3': _w((lambda *s: torch.randn(*s, dtype=torch.bfloat16) * 3.2)(D, F) * D ** (-0.5)), 'w4': _w((lambda *s: torch.randn(*s, dtype=torch.bfloat16) * 3.2)(F, D) * F ** (-0.5))}
    _B_in = _B_setup()
    return {'A_x': _A_in['x'], 'A_k_cache': _A_in['k_cache'], 'A_v_cache': _A_in['v_cache'], 'A_wq': _A_in['wq'], 'A_wo': _A_in['wo'], 'B_x': _B_in['x'], 'B_w1': _B_in['w1'], 'B_w2': _B_in['w2'], 'B_w3': _B_in['w3'], 'B_w4': _B_in['w4'], 'c': _w((lambda *s: torch.randn(*s, dtype=torch.bfloat16) * 0.1)(1, 448) * 8.0), 'w_mod': _w((lambda *s: torch.randn(*s, dtype=torch.bfloat16) * 0.1)(448, 6 * 448) * 448 ** (-0.5) * 8.0)}

def reference(A_x, A_k_cache, A_v_cache, A_wq, A_wo, B_x, B_w1, B_w2, B_w3, B_w4, c, w_mod):

    def _A_ref(x, k_cache, v_cache, wq, wo):
        B, Sq, D = x.shape
        Hq, Dh = (16, 256)
        Hkv = k_cache.shape[1]
        rep = Hq // Hkv
        q = (lambda x, *d: x.permute(*d))((x @ wq).reshape(B, Sq, Hq, Dh), 0, 2, 1, 3)
        k = (lambda x, n, axis: torch.repeat_interleave(x, n, dim=axis))(k_cache, rep, axis=1)
        v = (lambda x, n, axis: torch.repeat_interleave(x, n, dim=axis))(v_cache, rep, axis=1)
        scores = torch.einsum('bhqd,bhkd->bhqk', q, k) * Dh ** (-0.5)
        p = _softmax(scores, axis=-1)
        o = torch.einsum('bhqk,bhkd->bhqd', p, v)
        return (lambda x, *d: x.permute(*d))(o, 0, 2, 1, 3).reshape(B, Sq, Hq * Dh) @ wo

    def _B_ref(x, w1, w2, w3, w4):
        B, S, D = x.shape
        h = _gelu(_layernorm(x, axis=-1) @ w1)
        c = D // 4
        g0 = _pad(h[:, :, 0 * c:1 * c], ((0, 0), (1, 0), (0, 0)))[:, :S, :]
        g1 = _pad(h[:, :, 1 * c:2 * c], ((0, 0), (0, 1), (0, 0)))[:, 1:, :]
        g2 = _pad(h[:, :, 2 * c:3 * c], ((0, 0), (2, 0), (0, 0)))[:, :S, :]
        g3 = _pad(h[:, :, 3 * c:], ((0, 0), (0, 2), (0, 0)))[:, 2:, :]
        hs = torch.concatenate([g0, g1, g2, g3], axis=-1) @ w2
        x1 = x + hs
        h2 = _gelu(_layernorm(x1, axis=-1) @ w3) @ w4
        return x1 + h2
    x = A_x
    mod = (_silu(c) @ w_mod).reshape(c.shape[0], 6, 1, -1)
    sa, ca, ga, sb, cb, gb = (mod[:, 0].clone(), mod[:, 1].clone(), mod[:, 2].clone(), mod[:, 3].clone(), mod[:, 4].clone(), mod[:, 5].clone())
    h = _layernorm(x, axis=-1) * (1 + ca) + sa
    x = x + ga * _A_ref(h, A_k_cache, A_v_cache, A_wq, A_wo)
    h = _layernorm(x, axis=-1) * (1 + cb) + sb
    x = x + gb * _B_ref(h, B_w1, B_w2, B_w3, B_w4)
    return x
```

```asm
; @launch grid=(256,1,1) block=(256,1,1) lds=163840
.amdgcn_target "amdgcn-amd-amdhsa--gfx950"
.text
.globl adaLN_cond__gqa_block_cached__mixer_s_mlp__prompt_kernel
.p2align 8
.type adaLN_cond__gqa_block_cached__mixer_s_mlp__prompt_kernel,@function
adaLN_cond__gqa_block_cached__mixer_s_mlp__prompt_kernel:
    s_cmp_ge_u32 s2, 256
    s_cbranch_scc1 L_k2_done
    s_load_dwordx8 s[76:83], s[0:1], 0
    s_load_dwordx2 s[86:87], s[0:1], 112
    s_load_dwordx2 s[84:85], s[0:1], 32
    s_load_dwordx8 s[88:95], s[0:1], 48
    s_load_dwordx4 s[64:67], s[0:1], 80
    s_load_dwordx2 s[68:69], s[0:1], 104
    v_lshrrev_b32 v1, 6, v0
    v_and_b32 v0, 63, v0
    s_and_b32 s42, s2, 7
    v_readfirstlane_b32 s40, v1
    s_lshr_b32 s41, s2, 3
    v_lshlrev_b32 v211, 4, v0
    v_lshrrev_b32 v6, 2, v0
    v_and_b32 v7, 3, v0
    s_lshl_b32 s62, s41, 6
    s_lshl_b32 s63, s40, 4
    s_add_u32 s62, s62, s63
    v_add_u32 v8, s62, v6
    v_mul_u32_u24 v8, 896, v8
    v_lshl_add_u32 v200, v7, 4, v8
    v_and_b32 v1, 15, v0
    v_lshrrev_b32 v2, 4, v0
    v_lshrrev_b32 v3, 3, v0
    v_and_b32 v4, 7, v0
    v_and_b32 v8, 2, v3
    v_xor_b32 v8, v4, v8
    v_lshlrev_b32 v8, 4, v8
    v_lshl_add_u32 v204, v3, 13, v8
    v_xor_b32 v205, 64, v204
    s_and_b32 s62, s40, 1
    s_lshl_b32 s62, s62, 9
    s_lshl_b32 s63, s42, 10
    s_add_u32 s62, s62, s63
    s_lshr_b32 s63, s40, 1
    s_lshl_b32 s63, s63, 8
    s_add_u32 s56, s62, s63
    s_add_u32 s57, s56, 64512
    s_add_u32 s58, s57, 64512
    s_add_u32 s59, s58, 64512
    s_lshl_b32 s60, s40, 14
    s_add_u32 s60, s60, 90112
    s_lshl_b32 s62, s41, 2
    s_add_u32 s62, s62, s40
    s_mul_i32 s62, s62, 28
    v_min_u32 v8, 27, v0
    v_add_u32 v8, s62, v8
    v_lshrrev_b32 v9, 3, v8
    v_and_b32 v8, 7, v8
    v_lshlrev_b32 v8, 7, v8
    v_lshl_add_u32 v215, v9, 13, v8
    s_lshl_b32 s55, s42, 10
    s_waitcnt lgkmcnt(0)
    s_mov_b32 s20, s76
    s_mov_b32 s21, s77
    s_mov_b32 s22, 1835008
    s_mov_b32 s23, 0x20000
    s_cmp_ge_u32 s2, 84
    s_cbranch_scc1 L_mod_x
L_mod:
    s_mov_b32 s4, s64
    s_mov_b32 s5, s65
    s_mov_b32 s6, 896
    s_mov_b32 s7, 0x20000
    s_mov_b32 s8, s66
    s_mov_b32 s9, s67
    s_mov_b32 s10, 2408448
    s_mov_b32 s11, 0x20000
    s_lshl_b32 s62, s40, 4
    v_add_u32 v10, s62, v6
    v_mul_u32_u24 v11, 5376, v10
    v_lshl_add_u32 v11, v7, 4, v11
    s_lshl_b32 s62, s2, 6
    v_lshlrev_b32 v10, 1, v10
    buffer_load_dwordx4 v[16:19], v11, s[8:11], s62 offen
    s_add_u32 s62, s62, 344064
    buffer_load_dwordx4 v[20:23], v11, s[8:11], s62 offen
    s_add_u32 s62, s62, 344064
    buffer_load_dwordx4 v[24:27], v11, s[8:11], s62 offen
    s_add_u32 s62, s62, 344064
    buffer_load_dwordx4 v[28:31], v11, s[8:11], s62 offen
    s_add_u32 s62, s62, 344064
    buffer_load_dwordx4 v[32:35], v11, s[8:11], s62 offen
    s_add_u32 s62, s62, 344064
    buffer_load_dwordx4 v[36:39], v11, s[8:11], s62 offen
    s_add_u32 s62, s62, 344064
    buffer_load_dwordx4 v[40:43], v11, s[8:11], s62 offen
    s_add_u32 s62, s62, 344064
    buffer_load_ushort v44, v10, s[4:7], 0 offen offset:0
    buffer_load_ushort v45, v10, s[4:7], 0 offen offset:128
    buffer_load_ushort v46, v10, s[4:7], 0 offen offset:256
    buffer_load_ushort v47, v10, s[4:7], 0 offen offset:384
    buffer_load_ushort v48, v10, s[4:7], 0 offen offset:512
    buffer_load_ushort v49, v10, s[4:7], 0 offen offset:640
    buffer_load_ushort v50, v10, s[4:7], 0 offen offset:768
    s_mov_b32 s4, s86
    s_mov_b32 s5, s87
    s_mov_b32 s6, 18432
    s_mov_b32 s7, 0x20000
    s_mov_b32 s8, s68
    s_mov_b32 s9, s69
    s_mov_b32 s10, 256
    s_mov_b32 s11, 0x20000
    v_mov_b32 v52, 0
    v_mov_b32 v53, 0
    v_mov_b32 v54, 0
    v_mov_b32 v55, 0
    v_mov_b32 v56, 0
    v_mov_b32 v57, 0
    v_mov_b32 v58, 0
    v_mov_b32 v59, 0
    v_mov_b32 v12, 0xbfb8aa3b
    s_waitcnt vmcnt(0)
    v_lshlrev_b32 v44, 16, v44
    v_lshlrev_b32 v45, 16, v45
    v_lshlrev_b32 v46, 16, v46
    v_lshlrev_b32 v47, 16, v47
    v_lshlrev_b32 v48, 16, v48
    v_lshlrev_b32 v49, 16, v49
    v_lshlrev_b32 v50, 16, v50
    v_mul_f32 v60, v12, v44
    v_mul_f32 v61, v12, v45
    v_mul_f32 v62, v12, v46
    v_mul_f32 v63, v12, v47
    v_mul_f32 v64, v12, v48
    v_mul_f32 v65, v12, v49
    v_mul_f32 v66, v12, v50
    v_exp_f32 v60, v60
    v_exp_f32 v61, v61
    v_exp_f32 v62, v62
    v_exp_f32 v63, v63
    v_exp_f32 v64, v64
    v_exp_f32 v65, v65
    v_exp_f32 v66, v66
    v_add_f32 v60, 1.0, v60
    v_add_f32 v61, 1.0, v61
    v_add_f32 v62, 1.0, v62
    v_add_f32 v63, 1.0, v63
    v_add_f32 v64, 1.0, v64
    v_add_f32 v65, 1.0, v65
    v_add_f32 v66, 1.0, v66
    v_rcp_f32 v60, v60
    v_rcp_f32 v61, v61
    v_rcp_f32 v62, v62
    v_rcp_f32 v63, v63
    v_rcp_f32 v64, v64
    v_rcp_f32 v65, v65
    v_rcp_f32 v66, v66
    v_mul_f32 v44, v44, v60
    v_mul_f32 v45, v45, v61
    v_mul_f32 v46, v46, v62
    v_mul_f32 v47, v47, v63
    v_mul_f32 v48, v48, v64
    v_mul_f32 v49, v49, v65
    v_mul_f32 v50, v50, v66
    v_cvt_pk_bf16_f32 v44, v44, v44
    v_cvt_pk_bf16_f32 v45, v45, v45
    v_cvt_pk_bf16_f32 v46, v46, v46
    v_cvt_pk_bf16_f32 v47, v47, v47
    v_cvt_pk_bf16_f32 v48, v48, v48
    v_cvt_pk_bf16_f32 v49, v49, v49
    v_cvt_pk_bf16_f32 v50, v50, v50
    v_lshlrev_b32 v60, 16, v44
    v_and_b32 v44, 0xffff, v44
    v_lshlrev_b32 v61, 16, v45
    v_and_b32 v45, 0xffff, v45
    v_lshlrev_b32 v62, 16, v46
    v_and_b32 v46, 0xffff, v46
    v_lshlrev_b32 v63, 16, v47
    v_and_b32 v47, 0xffff, v47
    v_lshlrev_b32 v64, 16, v48
    v_and_b32 v48, 0xffff, v48
    v_lshlrev_b32 v65, 16, v49
    v_and_b32 v49, 0xffff, v49
    v_lshlrev_b32 v66, 16, v50
    v_and_b32 v50, 0xffff, v50
    v_dot2c_f32_bf16 v52, v16, v44
    v_dot2c_f32_bf16 v53, v16, v60
    v_dot2c_f32_bf16 v54, v17, v44
    v_dot2c_f32_bf16 v55, v17, v60
    v_dot2c_f32_bf16 v56, v18, v44
    v_dot2c_f32_bf16 v57, v18, v60
    v_dot2c_f32_bf16 v58, v19, v44
    v_dot2c_f32_bf16 v59, v19, v60
    v_dot2c_f32_bf16 v52, v20, v45
    v_dot2c_f32_bf16 v53, v20, v61
    v_dot2c_f32_bf16 v54, v21, v45
    v_dot2c_f32_bf16 v55, v21, v61
    v_dot2c_f32_bf16 v56, v22, v45
    v_dot2c_f32_bf16 v57, v22, v61
    v_dot2c_f32_bf16 v58, v23, v45
    v_dot2c_f32_bf16 v59, v23, v61
    v_dot2c_f32_bf16 v52, v24, v46
    v_dot2c_f32_bf16 v53, v24, v62
    v_dot2c_f32_bf16 v54, v25, v46
    v_dot2c_f32_bf16 v55, v25, v62
    v_dot2c_f32_bf16 v56, v26, v46
    v_dot2c_f32_bf16 v57, v26, v62
    v_dot2c_f32_bf16 v58, v27, v46
    v_dot2c_f32_bf16 v59, v27, v62
    v_dot2c_f32_bf16 v52, v28, v47
    v_dot2c_f32_bf16 v53, v28, v63
    v_dot2c_f32_bf16 v54, v29, v47
    v_dot2c_f32_bf16 v55, v29, v63
    v_dot2c_f32_bf16 v56, v30, v47
    v_dot2c_f32_bf16 v57, v30, v63
    v_dot2c_f32_bf16 v58, v31, v47
    v_dot2c_f32_bf16 v59, v31, v63
    v_dot2c_f32_bf16 v52, v32, v48
    v_dot2c_f32_bf16 v53, v32, v64
    v_dot2c_f32_bf16 v54, v33, v48
    v_dot2c_f32_bf16 v55, v33, v64
    v_dot2c_f32_bf16 v56, v34, v48
    v_dot2c_f32_bf16 v57, v34, v64
    v_dot2c_f32_bf16 v58, v35, v48
    v_dot2c_f32_bf16 v59, v35, v64
    v_dot2c_f32_bf16 v52, v36, v49
    v_dot2c_f32_bf16 v53, v36, v65
    v_dot2c_f32_bf16 v54, v37, v49
    v_dot2c_f32_bf16 v55, v37, v65
    v_dot2c_f32_bf16 v56, v38, v49
    v_dot2c_f32_bf16 v57, v38, v65
    v_dot2c_f32_bf16 v58, v39, v49
    v_dot2c_f32_bf16 v59, v39, v65
    v_dot2c_f32_bf16 v52, v40, v50
    v_dot2c_f32_bf16 v53, v40, v66
    v_dot2c_f32_bf16 v54, v41, v50
    v_dot2c_f32_bf16 v55, v41, v66
    v_dot2c_f32_bf16 v56, v42, v50
    v_dot2c_f32_bf16 v57, v42, v66
    v_dot2c_f32_bf16 v58, v43, v50
    v_dot2c_f32_bf16 v59, v43, v66
    s_nop 1
    s_nop 1
    v_add_f32_dpp v52, v52, v52 row_ror:4 row_mask:0xf bank_mask:0xf
    v_add_f32_dpp v53, v53, v53 row_ror:4 row_mask:0xf bank_mask:0xf
    v_add_f32_dpp v54, v54, v54 row_ror:4 row_mask:0xf bank_mask:0xf
    v_add_f32_dpp v55, v55, v55 row_ror:4 row_mask:0xf bank_mask:0xf
    v_add_f32_dpp v56, v56, v56 row_ror:4 row_mask:0xf bank_mask:0xf
    v_add_f32_dpp v57, v57, v57 row_ror:4 row_mask:0xf bank_mask:0xf
    v_add_f32_dpp v58, v58, v58 row_ror:4 row_mask:0xf bank_mask:0xf
    v_add_f32_dpp v59, v59, v59 row_ror:4 row_mask:0xf bank_mask:0xf
    s_nop 1
    v_add_f32_dpp v52, v52, v52 row_ror:8 row_mask:0xf bank_mask:0xf
    v_add_f32_dpp v53, v53, v53 row_ror:8 row_mask:0xf bank_mask:0xf
    v_add_f32_dpp v54, v54, v54 row_ror:8 row_mask:0xf bank_mask:0xf
    v_add_f32_dpp v55, v55, v55 row_ror:8 row_mask:0xf bank_mask:0xf
    v_add_f32_dpp v56, v56, v56 row_ror:8 row_mask:0xf bank_mask:0xf
    v_add_f32_dpp v57, v57, v57 row_ror:8 row_mask:0xf bank_mask:0xf
    v_add_f32_dpp v58, v58, v58 row_ror:8 row_mask:0xf bank_mask:0xf
    v_add_f32_dpp v59, v59, v59 row_ror:8 row_mask:0xf bank_mask:0xf
    v_mov_b32 v60, v52
    v_mov_b32 v61, v53
    v_mov_b32 v62, v54
    v_mov_b32 v63, v55
    v_mov_b32 v64, v56
    v_mov_b32 v65, v57
    v_mov_b32 v66, v58
    v_mov_b32 v67, v59
    s_nop 1
    v_permlane32_swap_b32 v52, v60
    v_permlane32_swap_b32 v53, v61
    v_permlane32_swap_b32 v54, v62
    v_permlane32_swap_b32 v55, v63
    v_permlane32_swap_b32 v56, v64
    v_permlane32_swap_b32 v57, v65
    v_permlane32_swap_b32 v58, v66
    v_permlane32_swap_b32 v59, v67
    s_nop 1
    v_add_f32 v52, v52, v60
    v_add_f32 v53, v53, v61
    v_add_f32 v54, v54, v62
    v_add_f32 v55, v55, v63
    v_add_f32 v56, v56, v64
    v_add_f32 v57, v57, v65
    v_add_f32 v58, v58, v66
    v_add_f32 v59, v59, v67
    v_mov_b32 v60, v52
    v_mov_b32 v61, v53
    v_mov_b32 v62, v54
    v_mov_b32 v63, v55
    v_mov_b32 v64, v56
    v_mov_b32 v65, v57
    v_mov_b32 v66, v58
    v_mov_b32 v67, v59
    s_nop 1
    v_permlane16_swap_b32 v52, v60
    v_permlane16_swap_b32 v53, v61
    v_permlane16_swap_b32 v54, v62
    v_permlane16_swap_b32 v55, v63
    v_permlane16_swap_b32 v56, v64
    v_permlane16_swap_b32 v57, v65
    v_permlane16_swap_b32 v58, v66
    v_permlane16_swap_b32 v59, v67
    s_nop 1
    v_add_f32 v52, v52, v60
    v_add_f32 v53, v53, v61
    v_add_f32 v54, v54, v62
    v_add_f32 v55, v55, v63
    v_add_f32 v56, v56, v64
    v_add_f32 v57, v57, v65
    v_add_f32 v58, v58, v66
    v_add_f32 v59, v59, v67
    s_lshl_b32 s62, s40, 7
    s_add_u32 s62, s62, 159232
    v_lshlrev_b32 v10, 5, v7
    v_add_u32 v10, s62, v10
    ds_write_b128 v10, v[52:55]
    ds_write_b128 v10, v[56:59] offset:16
    s_waitcnt lgkmcnt(0)
    s_barrier
    s_cmp_lg_u32 s40, 0
    s_cbranch_scc1 L_mod_x
    v_and_b32 v11, 31, v0
    v_lshlrev_b32 v10, 2, v11
    v_add_u32 v12, 159232, v10
    ds_read_b32 v44, v12 offset:0
    ds_read_b32 v45, v12 offset:128
    ds_read_b32 v46, v12 offset:256
    ds_read_b32 v47, v12 offset:384
    s_mul_hi_u32 s63, s2, 306783379
    s_cmp_eq_u32 s63, 1
    s_cselect_b32 s62, 1.0, 0
    s_cmp_eq_u32 s63, 4
    s_cselect_b32 s62, 1.0, s62
    v_bfe_u32 v13, v0, 2, 2
    v_lshlrev_b32 v13, 3, v13
    v_bfe_u32 v14, v0, 4, 1
    v_lshl_add_u32 v13, v14, 2, v13
    v_add_lshl_u32 v13, v13, v7, 1
    s_waitcnt lgkmcnt(0)
    v_add_f32 v44, v44, v45
    v_add_f32 v46, v46, v47
    v_add_f32 v44, v44, v46
    v_cvt_pk_bf16_f32 v44, v44, v44
    v_lshlrev_b32 v44, 16, v44
    v_add_f32 v44, s62, v44
    v_cvt_pk_bf16_f32 v45, v44, v44
    v_lshlrev_b32 v44, 16, v45
    s_lshl_b32 s62, s2, 7
    s_lshl_b32 s63, s2, 6
    s_add_u32 s63, s63, 12288
    buffer_store_dword v44, v10, s[4:7], s62 offen offset:0 sc1
    buffer_store_short v45, v13, s[4:7], s63 offen sc1
    s_cmp_ge_u32 s2, 28
    s_cbranch_scc1 L_mod_x
    v_mov_b32 v10, 0
    v_mov_b32 v11, 1
    s_mov_b64 exec, 1
    s_waitcnt vmcnt(0)
    buffer_atomic_add v11, v10, s[8:11], 0 offen offset:132 sc0 sc1
    s_mov_b64 exec, -1
    buffer_load_dwordx4 v[112:115], v200, s[20:23], 0 offen offset:0
    buffer_load_dwordx4 v[116:119], v200, s[20:23], 0 offen offset:64
    buffer_load_dwordx4 v[120:123], v200, s[20:23], 0 offen offset:128
    buffer_load_dwordx4 v[124:127], v200, s[20:23], 0 offen offset:192
    buffer_load_dwordx4 v[128:131], v200, s[20:23], 0 offen offset:256
    buffer_load_dwordx4 v[132:135], v200, s[20:23], 0 offen offset:320
    buffer_load_dwordx4 v[136:139], v200, s[20:23], 0 offen offset:384
    buffer_load_dwordx4 v[140:143], v200, s[20:23], 0 offen offset:448
    buffer_load_dwordx4 v[144:147], v200, s[20:23], 0 offen offset:512
    buffer_load_dwordx4 v[148:151], v200, s[20:23], 0 offen offset:576
    buffer_load_dwordx4 v[152:155], v200, s[20:23], 0 offen offset:640
    buffer_load_dwordx4 v[156:159], v200, s[20:23], 0 offen offset:704
    buffer_load_dwordx4 v[160:163], v200, s[20:23], 0 offen offset:768
    buffer_load_dwordx4 v[164:167], v200, s[20:23], 0 offen offset:832
    s_waitcnt vmcnt(14)
    v_readfirstlane_b32 s62, v11
    v_mov_b32 v11, 1
    s_cmp_lg_u32 s62, 27
    s_cbranch_scc1 L_mod_back
    s_mov_b64 exec, 1
    buffer_store_dword v11, v10, s[8:11], 0 offen sc1
    s_mov_b64 exec, -1
    s_branch L_mod_back
L_mod_x:
    buffer_load_dwordx4 v[112:115], v200, s[20:23], 0 offen offset:0
    buffer_load_dwordx4 v[116:119], v200, s[20:23], 0 offen offset:64
    buffer_load_dwordx4 v[120:123], v200, s[20:23], 0 offen offset:128
    buffer_load_dwordx4 v[124:127], v200, s[20:23], 0 offen offset:192
    buffer_load_dwordx4 v[128:131], v200, s[20:23], 0 offen offset:256
    buffer_load_dwordx4 v[132:135], v200, s[20:23], 0 offen offset:320
    buffer_load_dwordx4 v[136:139], v200, s[20:23], 0 offen offset:384
    buffer_load_dwordx4 v[140:143], v200, s[20:23], 0 offen offset:448
    buffer_load_dwordx4 v[144:147], v200, s[20:23], 0 offen offset:512
    buffer_load_dwordx4 v[148:151], v200, s[20:23], 0 offen offset:576
    buffer_load_dwordx4 v[152:155], v200, s[20:23], 0 offen offset:640
    buffer_load_dwordx4 v[156:159], v200, s[20:23], 0 offen offset:704
    buffer_load_dwordx4 v[160:163], v200, s[20:23], 0 offen offset:768
    buffer_load_dwordx4 v[164:167], v200, s[20:23], 0 offen offset:832
L_mod_back:
    s_mov_b32 s20, s68
    s_mov_b32 s21, s69
    s_mov_b32 s22, 256
    s_mov_b32 s23, 0x20000
    s_add_u32 s36, s86, 32768
    s_addc_u32 s37, s87, 0
    s_mov_b32 s38, 32768
    s_mov_b32 s39, 0x20000
    v_mov_b32 v10, 0
    v_mov_b32 v11, 0
    v_mov_b32 v12, 0
    v_mov_b32 v13, 0
    s_lshl_b32 s62, s2, 7
    buffer_store_dwordx4 v[10:13], v10, s[36:39], s62 offen sc1
    s_nop 0
    s_add_u32 s24, s86, 0
    s_addc_u32 s25, s87, 0
    s_mov_b32 s26, 3584
    s_mov_b32 s27, 0x20000
    s_mov_b32 s12, s82
    s_mov_b32 s13, s83
    s_mov_b32 s14, 3670016
    s_mov_b32 s15, 0x20000
    buffer_load_dword v255, v215, s[12:15], s55 offen
    v_and_b32 v5, 6, v3
    v_xor_b32 v5, v4, v5
    v_lshlrev_b32 v5, 4, v5
    s_lshl_b32 s52, s40, 12
    s_lshr_b32 s55, s40, 1
    s_lshl_b32 s61, s55, 14
    v_lshl_add_u32 v222, v3, 9, v5
    v_mov_b32 v223, v222
    v_and_b32 v8, 7, v1
    v_lshrrev_b32 v9, 3, v1
    v_lshlrev_b32 v9, 10, v9
    v_lshl_add_u32 v9, v8, 7, v9
    v_add_u32 v9, s61, v9
    v_and_b32 v8, 6, v8
    v_xor_b32 v8, v2, v8
    s_add_u32 m0, s60, 0
    s_nop 0
    buffer_load_dwordx4 v204, s[12:15], s56 offen offset:0 lds
    v_lshlrev_b32 v8, 4, v8
    v_add_u32 v216, v9, v8
    v_xor_b32 v8, 64, v8
    v_add_u32 v217, v9, v8
    v_and_b32 v8, 1, v2
    v_lshlrev_b32 v8, 2, v8
    v_lshrrev_b32 v9, 2, v1
    v_add_u32 v8, v8, v9
    v_lshrrev_b32 v9, 1, v2
    v_lshlrev_b32 v9, 10, v9
    v_lshl_add_u32 v9, v8, 7, v9
    v_and_b32 v221, 1, v1
    buffer_load_dwordx4 v205, s[12:15], s57 offen offset:1024 lds
    v_lshl_add_u32 v9, v221, 3, v9
    v_add_u32 v9, 65536, v9
    v_and_b32 v8, 6, v8
    v_bfe_u32 v221, v1, 1, 1
    v_xor_b32 v8, v8, v221
    v_xor_b32 v221, 0, v8
    v_lshlrev_b32 v221, 4, v221
    v_add3_u32 v218, v9, v221, s61
    v_xor_b32 v221, 2, v8
    v_lshlrev_b32 v221, 4, v221
    v_add3_u32 v219, v9, v221, s61
    v_xor_b32 v221, 4, v8
    buffer_load_dwordx4 v204, s[12:15], s58 offen offset:2048 lds
    v_lshlrev_b32 v221, 4, v221
    v_add3_u32 v220, v9, v221, s61
    v_xor_b32 v221, 6, v8
    v_lshlrev_b32 v221, 4, v221
    v_add3_u32 v221, v9, v221, s61
    s_lshl_b32 s62, s40, 7
    s_xor_b32 s63, s62, 256
    s_add_u32 s63, s63, 16384
    s_add_u32 s44, s62, 0
    s_add_u32 s48, s63, 0
    s_add_u32 s45, s62, 3072
    s_add_u32 s49, s63, 3072
    s_add_u32 s46, s62, 6144
    s_add_u32 s50, s63, 6144
    s_add_u32 s47, s62, 9216
    s_add_u32 s51, s63, 9216
    s_mov_b32 s53, 0x5d800000
    s_lshl_b32 s62, s42, 20
    s_add_u32 s4, s78, s62
    s_addc_u32 s5, s79, 0
    s_mov_b32 s6, 1048576
    s_mov_b32 s7, 0x20000
    s_add_u32 s8, s80, s62
    s_addc_u32 s9, s81, 0
    s_mov_b32 s10, 1048576
    s_mov_b32 s11, 0x20000
    s_mul_i32 s62, s42, 458752
    s_add_u32 s16, s84, s62
    s_addc_u32 s17, s85, 0
    s_mov_b32 s18, 458752
    s_mov_b32 s19, 0x20000
    s_mul_i32 s62, s42, 1835008
    s_add_u32 s62, s62, 65536
    s_add_u32 s28, s86, s62
    s_addc_u32 s29, s87, 0
    s_mov_b32 s30, 1835008
    s_mov_b32 s31, 0x20000
    s_lshl_b32 s96, s2, 2
    s_add_u32 s96, s96, s40
    s_min_u32 s96, s96, 979
    s_mov_b32 s32, s88
    s_mov_b32 s33, s89
    s_mov_b32 s34, 401408
    s_mov_b32 s35, 0x20000
    s_mov_b32 s99, 896
    s_mov_b32 s100, 14336
    s_mov_b32 s62, 36765696
    s_mov_b32 s63, 613566757
    s_mov_b32 s101, 7
    s_cmp_lt_u32 s96, 98
    s_cbranch_scc1 L_side_sel
    s_mov_b32 s32, s90
    s_mov_b32 s33, s91
    s_mov_b32 s62, 37167104
    s_sub_u32 s96, s96, 98
    s_cmp_lt_u32 s96, 98
    s_cbranch_scc1 L_side_sel
    s_mov_b32 s32, s92
    s_mov_b32 s33, s93
    s_mov_b32 s34, 1605632
    s_mov_b32 s62, 37568512
    s_sub_u32 s96, s96, 98
    s_mov_b32 s99, 3584
    s_mov_b32 s63, 153391690
    s_mov_b32 s101, 28
    s_cmp_lt_u32 s96, 392
    s_cbranch_scc1 L_side_sel
    s_mov_b32 s32, s94
    s_mov_b32 s33, s95
    s_mov_b32 s62, 39174144
    s_sub_u32 s96, s96, 392
    s_mov_b32 s99, 896
    s_mov_b32 s100, 57344
    s_mov_b32 s63, 613566757
    s_mov_b32 s101, 7
L_side_sel:
    s_mul_hi_u32 s97, s96, s63
    s_mul_i32 s98, s97, s101
    s_sub_u32 s98, s96, s98
    s_add_u32 s36, s86, s62
    s_addc_u32 s37, s87, 0
    s_mov_b32 s38, 1605632
    s_mov_b32 s39, 0x20000
    s_mul_i32 s62, s97, s99
    s_lshl_b32 s62, s62, 5
    s_lshl_b32 s63, s98, 7
    s_add_u32 s64, s62, s63
    s_lshl_b32 s62, s99, 3
    s_sub_u32 s62, s62, 1024
    s_add_u32 s65, s64, s62
    s_add_u32 s66, s65, s62
    s_add_u32 s67, s66, s62
    s_mul_i32 s62, s98, s100
    s_lshl_b32 s62, s62, 2
    s_lshl_b32 s63, s97, 10
    s_add_u32 s68, s62, s63
    s_add_u32 s69, s68, s100
    s_add_u32 s70, s69, s100
    s_add_u32 s71, s70, s100
    s_mul_i32 s75, s41, 9
    s_lshr_b32 s75, s75, 5
    s_sub_u32 s75, 14, s75
    s_sub_u32 s100, s75, 1
    s_sub_u32 s54, s75, 2
    s_mov_b32 s101, s99
    v_lshlrev_b32 v201, 5, v7
    v_add_u32 v201, 155648, v201
    s_mul_i32 s62, s40, 14336
    s_add_u32 s62, s62, 32768
    v_lshlrev_b32 v8, 1, v7
    v_xor_b32 v8, v6, v8
    v_lshl_add_u32 v8, v7, 4, v8
    v_lshlrev_b32 v8, 4, v8
    v_add_u32 v202, s62, v8
    buffer_load_dwordx4 v205, s[12:15], s59 offen offset:3072 lds
    v_add_u32 v204, 0x40000, v204
    v_add_u32 v205, 0x40000, v205
    v_lshlrev_b32 v8, 1, v2
    v_xor_b32 v8, v1, v8
    v_lshl_add_u32 v8, v2, 4, v8
    v_lshlrev_b32 v203, 4, v8
    v_add_u32 v203, 32768, v203
    v_lshlrev_b32 v6, 10, v2
    v_lshrrev_b32 v7, 2, v1
    v_lshl_add_u32 v6, v7, 7, v6
    v_and_b32 v7, 1, v1
    v_lshl_add_u32 v6, v7, 3, v6
    v_bfe_u32 v7, v1, 3, 1
    v_and_b32 v8, 1, v2
    s_add_u32 m0, s60, 4096
    s_nop 0
    buffer_load_dwordx4 v204, s[12:15], s56 offen offset:0 lds
    v_lshl_add_u32 v7, v8, 1, v7
    v_lshlrev_b32 v7, 1, v7
    v_bfe_u32 v8, v1, 1, 1
    v_xor_b32 v7, v7, v8
    v_xor_b32 v8, 0, v7
    v_lshlrev_b32 v8, 4, v8
    v_add3_u32 v206, v6, v8, s60
    v_xor_b32 v8, 2, v7
    v_lshlrev_b32 v8, 4, v8
    v_add3_u32 v207, v6, v8, s60
    v_xor_b32 v8, 4, v7
    v_lshlrev_b32 v8, 4, v8
    buffer_load_dwordx4 v205, s[12:15], s57 offen offset:1024 lds
    v_add3_u32 v208, v6, v8, s60
    v_xor_b32 v8, 6, v7
    v_lshlrev_b32 v8, 4, v8
    v_add3_u32 v209, v6, v8, s60
    v_lshrrev_b32 v6, 1, v2
    v_lshl_add_u32 v6, v6, 4, v1
    v_lshlrev_b32 v6, 4, v6
    v_and_b32 v7, 1, v2
    v_lshl_add_u32 v210, v7, 3, v6
    s_lshl_b32 s62, s40, 13
    s_add_u32 s62, s62, 65536
    s_cmp_eq_u32 s40, 3
    s_cselect_b32 s62, 155648, s62
    v_add_u32 v212, s62, v210
    v_add_u32 v213, s60, v210
    v_add_u32 v240, s62, v211
    buffer_load_dwordx4 v204, s[12:15], s58 offen offset:2048 lds
    v_add_u32 v241, s60, v211
    s_xor_b32 s55, s40, 2
    s_lshl_b32 s62, s55, 13
    s_add_u32 s62, s62, 65536
    s_cmp_eq_u32 s55, 3
    s_cselect_b32 s62, 155648, s62
    s_lshl_b32 s63, s55, 14
    s_add_u32 s63, s63, 90112
    v_add_u32 v242, s62, v211
    v_add_u32 v243, s63, v211
    s_lshl_b32 s62, s41, 2
    s_add_u32 s62, s62, s40
    s_mul_i32 s63, s62, 12
    v_min_u32 v215, 11, v1
    v_add_u32 v215, s63, v215
    v_lshlrev_b32 v215, 7, v215
    s_lshl_b32 s62, s62, 2
    v_add_u32 v254, s62, v2
    v_lshlrev_b32 v254, 7, v254
    s_mov_b32 s96, 65536
    v_mov_b32 v244, 0x3db8aa3b
    v_mov_b32 v172, 0x3f803f80
    v_mov_b32 v168, 0
    v_mov_b32 v169, 0
    buffer_load_dwordx4 v205, s[12:15], s59 offen offset:3072 lds
    v_add_u32 v204, 0x40000, v204
    v_add_u32 v205, 0x40000, v205
    v_mov_b32 v170, 0
    v_mov_b32 v171, 0
    s_waitcnt vmcnt(23)
    v_dot2c_f32_bf16 v168, v112, v172
    v_dot2c_f32_bf16 v170, v112, v112
    v_lshlrev_b32 v0, 16, v112
    v_and_b32 v1, 0xffff0000, v112
    v_dot2c_f32_bf16 v169, v113, v172
    v_dot2c_f32_bf16 v171, v113, v113
    v_lshlrev_b32 v2, 16, v113
    v_and_b32 v3, 0xffff0000, v113
    v_dot2c_f32_bf16 v168, v114, v172
    v_dot2c_f32_bf16 v170, v114, v114
    s_add_u32 m0, s60, 8192
    s_nop 0
    buffer_load_dwordx4 v204, s[12:15], s56 offen offset:0 lds
    v_lshlrev_b32 v4, 16, v114
    v_and_b32 v5, 0xffff0000, v114
    v_dot2c_f32_bf16 v169, v115, v172
    v_dot2c_f32_bf16 v171, v115, v115
    v_lshlrev_b32 v6, 16, v115
    v_and_b32 v7, 0xffff0000, v115
    s_waitcnt vmcnt(23)
    v_dot2c_f32_bf16 v168, v116, v172
    v_dot2c_f32_bf16 v170, v116, v116
    v_lshlrev_b32 v8, 16, v116
    v_and_b32 v9, 0xffff0000, v116
    v_dot2c_f32_bf16 v169, v117, v172
    v_dot2c_f32_bf16 v171, v117, v117
    buffer_load_dwordx4 v205, s[12:15], s57 offen offset:1024 lds
    v_lshlrev_b32 v10, 16, v117
    v_and_b32 v11, 0xffff0000, v117
    v_dot2c_f32_bf16 v168, v118, v172
    v_dot2c_f32_bf16 v170, v118, v118
    v_lshlrev_b32 v12, 16, v118
    v_and_b32 v13, 0xffff0000, v118
    v_dot2c_f32_bf16 v169, v119, v172
    v_dot2c_f32_bf16 v171, v119, v119
    v_lshlrev_b32 v14, 16, v119
    v_and_b32 v15, 0xffff0000, v119
    s_waitcnt vmcnt(23)
    v_dot2c_f32_bf16 v168, v120, v172
    v_dot2c_f32_bf16 v170, v120, v120
    buffer_load_dwordx4 v204, s[12:15], s58 offen offset:2048 lds
    v_lshlrev_b32 v16, 16, v120
    v_and_b32 v17, 0xffff0000, v120
    v_dot2c_f32_bf16 v169, v121, v172
    v_dot2c_f32_bf16 v171, v121, v121
    v_lshlrev_b32 v18, 16, v121
    v_and_b32 v19, 0xffff0000, v121
    v_dot2c_f32_bf16 v168, v122, v172
    v_dot2c_f32_bf16 v170, v122, v122
    v_lshlrev_b32 v20, 16, v122
    v_and_b32 v21, 0xffff0000, v122
    v_dot2c_f32_bf16 v169, v123, v172
    v_dot2c_f32_bf16 v171, v123, v123
    buffer_load_dwordx4 v205, s[12:15], s59 offen offset:3072 lds
    v_add_u32 v204, 0x40000, v204
    v_add_u32 v205, 0x40000, v205
    v_lshlrev_b32 v22, 16, v123
    v_and_b32 v23, 0xffff0000, v123
    s_waitcnt vmcnt(24)
    v_dot2c_f32_bf16 v168, v124, v172
    v_dot2c_f32_bf16 v170, v124, v124
    v_lshlrev_b32 v24, 16, v124
    v_and_b32 v25, 0xffff0000, v124
    v_dot2c_f32_bf16 v169, v125, v172
    v_dot2c_f32_bf16 v171, v125, v125
    v_lshlrev_b32 v26, 16, v125
    v_and_b32 v27, 0xffff0000, v125
    v_dot2c_f32_bf16 v168, v126, v172
    v_dot2c_f32_bf16 v170, v126, v126
    s_add_u32 m0, s60, 12288
    s_nop 0
    buffer_load_dwordx4 v204, s[12:15], s56 offen offset:0 lds
    v_lshlrev_b32 v28, 16, v126
    v_and_b32 v29, 0xffff0000, v126
    v_dot2c_f32_bf16 v169, v127, v172
    v_dot2c_f32_bf16 v171, v127, v127
    v_lshlrev_b32 v30, 16, v127
    v_and_b32 v31, 0xffff0000, v127
    s_waitcnt vmcnt(24)
    v_dot2c_f32_bf16 v168, v128, v172
    v_dot2c_f32_bf16 v170, v128, v128
    v_lshlrev_b32 v32, 16, v128
    v_and_b32 v33, 0xffff0000, v128
    v_dot2c_f32_bf16 v169, v129, v172
    v_dot2c_f32_bf16 v171, v129, v129
    buffer_load_dwordx4 v205, s[12:15], s57 offen offset:1024 lds
    v_lshlrev_b32 v34, 16, v129
    v_and_b32 v35, 0xffff0000, v129
    v_dot2c_f32_bf16 v168, v130, v172
    v_dot2c_f32_bf16 v170, v130, v130
    v_lshlrev_b32 v36, 16, v130
    v_and_b32 v37, 0xffff0000, v130
    v_dot2c_f32_bf16 v169, v131, v172
    v_dot2c_f32_bf16 v171, v131, v131
    v_lshlrev_b32 v38, 16, v131
    v_and_b32 v39, 0xffff0000, v131
    s_waitcnt vmcnt(24)
    v_dot2c_f32_bf16 v168, v132, v172
    v_dot2c_f32_bf16 v170, v132, v132
    buffer_load_dwordx4 v204, s[12:15], s58 offen offset:2048 lds
    v_lshlrev_b32 v40, 16, v132
    v_and_b32 v41, 0xffff0000, v132
    v_dot2c_f32_bf16 v169, v133, v172
    v_dot2c_f32_bf16 v171, v133, v133
    v_lshlrev_b32 v42, 16, v133
    v_and_b32 v43, 0xffff0000, v133
    v_dot2c_f32_bf16 v168, v134, v172
    v_dot2c_f32_bf16 v170, v134, v134
    v_lshlrev_b32 v44, 16, v134
    v_and_b32 v45, 0xffff0000, v134
    v_dot2c_f32_bf16 v169, v135, v172
    v_dot2c_f32_bf16 v171, v135, v135
    buffer_load_dwordx4 v205, s[12:15], s59 offen offset:3072 lds
    v_add_u32 v204, 0x40000, v204
    v_add_u32 v205, 0x40000, v205
    v_lshlrev_b32 v46, 16, v135
    v_and_b32 v47, 0xffff0000, v135
    s_waitcnt vmcnt(25)
    v_dot2c_f32_bf16 v168, v136, v172
    v_dot2c_f32_bf16 v170, v136, v136
    v_lshlrev_b32 v48, 16, v136
    v_and_b32 v49, 0xffff0000, v136
    v_dot2c_f32_bf16 v169, v137, v172
    v_dot2c_f32_bf16 v171, v137, v137
    v_lshlrev_b32 v50, 16, v137
    v_and_b32 v51, 0xffff0000, v137
    v_dot2c_f32_bf16 v168, v138, v172
    v_dot2c_f32_bf16 v170, v138, v138
    s_add_u32 m0, s52, 0
    s_nop 0
    buffer_load_dwordx4 v222, s[4:7], s44 offen offset:0 lds
    v_lshlrev_b32 v52, 16, v138
    v_and_b32 v53, 0xffff0000, v138
    v_dot2c_f32_bf16 v169, v139, v172
    v_dot2c_f32_bf16 v171, v139, v139
    v_lshlrev_b32 v54, 16, v139
    v_and_b32 v55, 0xffff0000, v139
    s_waitcnt vmcnt(25)
    v_dot2c_f32_bf16 v168, v140, v172
    v_dot2c_f32_bf16 v170, v140, v140
    v_lshlrev_b32 v56, 16, v140
    v_and_b32 v57, 0xffff0000, v140
    v_dot2c_f32_bf16 v169, v141, v172
    v_dot2c_f32_bf16 v171, v141, v141
    buffer_load_dwordx4 v222, s[4:7], s45 offen offset:1024 lds
    v_lshlrev_b32 v58, 16, v141
    v_and_b32 v59, 0xffff0000, v141
    v_dot2c_f32_bf16 v168, v142, v172
    v_dot2c_f32_bf16 v170, v142, v142
    v_lshlrev_b32 v60, 16, v142
    v_and_b32 v61, 0xffff0000, v142
    v_dot2c_f32_bf16 v169, v143, v172
    v_dot2c_f32_bf16 v171, v143, v143
    v_lshlrev_b32 v62, 16, v143
    v_and_b32 v63, 0xffff0000, v143
    s_waitcnt vmcnt(25)
    v_dot2c_f32_bf16 v168, v144, v172
    v_dot2c_f32_bf16 v170, v144, v144
    buffer_load_dwordx4 v222, s[4:7], s46 offen offset:2048 lds
    v_lshlrev_b32 v64, 16, v144
    v_and_b32 v65, 0xffff0000, v144
    v_dot2c_f32_bf16 v169, v145, v172
    v_dot2c_f32_bf16 v171, v145, v145
    v_lshlrev_b32 v66, 16, v145
    v_and_b32 v67, 0xffff0000, v145
    v_dot2c_f32_bf16 v168, v146, v172
    v_dot2c_f32_bf16 v170, v146, v146
    v_lshlrev_b32 v68, 16, v146
    v_and_b32 v69, 0xffff0000, v146
    v_dot2c_f32_bf16 v169, v147, v172
    v_dot2c_f32_bf16 v171, v147, v147
    buffer_load_dwordx4 v222, s[4:7], s47 offen offset:3072 lds
    v_lshlrev_b32 v70, 16, v147
    v_and_b32 v71, 0xffff0000, v147
    s_waitcnt vmcnt(26)
    v_dot2c_f32_bf16 v168, v148, v172
    v_dot2c_f32_bf16 v170, v148, v148
    v_lshlrev_b32 v72, 16, v148
    v_and_b32 v73, 0xffff0000, v148
    v_dot2c_f32_bf16 v169, v149, v172
    v_dot2c_f32_bf16 v171, v149, v149
    v_lshlrev_b32 v74, 16, v149
    v_and_b32 v75, 0xffff0000, v149
    v_dot2c_f32_bf16 v168, v150, v172
    v_dot2c_f32_bf16 v170, v150, v150
    s_add_u32 m0, s52, 16384
    s_nop 0
    buffer_load_dwordx4 v222, s[4:7], s48 offen offset:0 lds
    v_lshlrev_b32 v76, 16, v150
    v_and_b32 v77, 0xffff0000, v150
    v_dot2c_f32_bf16 v169, v151, v172
    v_dot2c_f32_bf16 v171, v151, v151
    v_lshlrev_b32 v78, 16, v151
    v_and_b32 v79, 0xffff0000, v151
    s_waitcnt vmcnt(26)
    v_dot2c_f32_bf16 v168, v152, v172
    v_dot2c_f32_bf16 v170, v152, v152
    v_lshlrev_b32 v80, 16, v152
    v_and_b32 v81, 0xffff0000, v152
    v_dot2c_f32_bf16 v169, v153, v172
    v_dot2c_f32_bf16 v171, v153, v153
    buffer_load_dwordx4 v222, s[4:7], s49 offen offset:1024 lds
    v_lshlrev_b32 v82, 16, v153
    v_and_b32 v83, 0xffff0000, v153
    v_dot2c_f32_bf16 v168, v154, v172
    v_dot2c_f32_bf16 v170, v154, v154
    v_lshlrev_b32 v84, 16, v154
    v_and_b32 v85, 0xffff0000, v154
    v_dot2c_f32_bf16 v169, v155, v172
    v_dot2c_f32_bf16 v171, v155, v155
    v_lshlrev_b32 v86, 16, v155
    v_and_b32 v87, 0xffff0000, v155
    s_waitcnt vmcnt(26)
    v_dot2c_f32_bf16 v168, v156, v172
    v_dot2c_f32_bf16 v170, v156, v156
    buffer_load_dwordx4 v222, s[4:7], s50 offen offset:2048 lds
    v_lshlrev_b32 v88, 16, v156
    v_and_b32 v89, 0xffff0000, v156
    v_dot2c_f32_bf16 v169, v157, v172
    v_dot2c_f32_bf16 v171, v157, v157
    v_lshlrev_b32 v90, 16, v157
    v_and_b32 v91, 0xffff0000, v157
    v_dot2c_f32_bf16 v168, v158, v172
    v_dot2c_f32_bf16 v170, v158, v158
    v_lshlrev_b32 v92, 16, v158
    v_and_b32 v93, 0xffff0000, v158
    v_dot2c_f32_bf16 v169, v159, v172
    v_dot2c_f32_bf16 v171, v159, v159
    buffer_load_dwordx4 v222, s[4:7], s51 offen offset:3072 lds
    v_add_u32 v222, 0x8000, v222
    v_lshlrev_b32 v94, 16, v159
    v_and_b32 v95, 0xffff0000, v159
    s_waitcnt vmcnt(27)
    v_dot2c_f32_bf16 v168, v160, v172
    v_dot2c_f32_bf16 v170, v160, v160
    v_lshlrev_b32 v96, 16, v160
    v_and_b32 v97, 0xffff0000, v160
    v_dot2c_f32_bf16 v169, v161, v172
    v_dot2c_f32_bf16 v171, v161, v161
    v_lshlrev_b32 v98, 16, v161
    v_and_b32 v99, 0xffff0000, v161
    v_dot2c_f32_bf16 v168, v162, v172
    v_dot2c_f32_bf16 v170, v162, v162
    v_lshlrev_b32 v100, 16, v162
    v_and_b32 v101, 0xffff0000, v162
    v_dot2c_f32_bf16 v169, v163, v172
    v_dot2c_f32_bf16 v171, v163, v163
    v_lshlrev_b32 v102, 16, v163
    v_and_b32 v103, 0xffff0000, v163
    s_waitcnt vmcnt(26)
    v_dot2c_f32_bf16 v168, v164, v172
    v_dot2c_f32_bf16 v170, v164, v164
    v_lshlrev_b32 v104, 16, v164
    v_and_b32 v105, 0xffff0000, v164
    v_dot2c_f32_bf16 v169, v165, v172
    v_dot2c_f32_bf16 v171, v165, v165
    v_lshlrev_b32 v106, 16, v165
    v_and_b32 v107, 0xffff0000, v165
    v_dot2c_f32_bf16 v168, v166, v172
    v_dot2c_f32_bf16 v170, v166, v166
    v_lshlrev_b32 v108, 16, v166
    v_and_b32 v109, 0xffff0000, v166
    v_dot2c_f32_bf16 v169, v167, v172
    v_dot2c_f32_bf16 v171, v167, v167
    v_lshlrev_b32 v110, 16, v167
    v_and_b32 v111, 0xffff0000, v167
    s_nop 1
    v_add_f32 v168, v168, v169
    v_add_f32 v169, v170, v171
    s_nop 0
    v_add_f32_dpp v168, v168, v168 quad_perm:[1,0,3,2] row_mask:0xf bank_mask:0xf
    v_add_f32_dpp v169, v169, v169 quad_perm:[1,0,3,2] row_mask:0xf bank_mask:0xf
    s_nop 0
    v_add_f32_dpp v168, v168, v168 quad_perm:[2,3,0,1] row_mask:0xf bank_mask:0xf
    v_add_f32_dpp v169, v169, v169 quad_perm:[2,3,0,1] row_mask:0xf bank_mask:0xf
    s_nop 0
    v_mul_f32 v170, 0xbb124925, v168
    v_mov_b32 v171, 0x3727c5ac
    v_fmac_f32 v171, 0x3b124925, v169
    v_fma_f32 v171, -v170, v170, v171
    v_max_f32 v171, 0x3727c5ac, v171
    v_rsq_f32 v174, v171
    s_nop 0
    v_mul_f32 v176, v170, v174
    v_pk_fma_f32 v[0:1], v[0:1], v[174:175], v[176:177] op_sel_hi:[1,0,0]
    v_pk_fma_f32 v[2:3], v[2:3], v[174:175], v[176:177] op_sel_hi:[1,0,0]
    v_pk_fma_f32 v[4:5], v[4:5], v[174:175], v[176:177] op_sel_hi:[1,0,0]
    v_pk_fma_f32 v[6:7], v[6:7], v[174:175], v[176:177] op_sel_hi:[1,0,0]
    v_pk_fma_f32 v[8:9], v[8:9], v[174:175], v[176:177] op_sel_hi:[1,0,0]
    v_pk_fma_f32 v[10:11], v[10:11], v[174:175], v[176:177] op_sel_hi:[1,0,0]
    v_pk_fma_f32 v[12:13], v[12:13], v[174:175], v[176:177] op_sel_hi:[1,0,0]
    v_pk_fma_f32 v[14:15], v[14:15], v[174:175], v[176:177] op_sel_hi:[1,0,0]
    v_pk_fma_f32 v[16:17], v[16:17], v[174:175], v[176:177] op_sel_hi:[1,0,0]
    v_pk_fma_f32 v[18:19], v[18:19], v[174:175], v[176:177] op_sel_hi:[1,0,0]
    v_pk_fma_f32 v[20:21], v[20:21], v[174:175], v[176:177] op_sel_hi:[1,0,0]
    v_pk_fma_f32 v[22:23], v[22:23], v[174:175], v[176:177] op_sel_hi:[1,0,0]
    v_pk_fma_f32 v[24:25], v[24:25], v[174:175], v[176:177] op_sel_hi:[1,0,0]
    v_pk_fma_f32 v[26:27], v[26:27], v[174:175], v[176:177] op_sel_hi:[1,0,0]
    v_pk_fma_f32 v[28:29], v[28:29], v[174:175], v[176:177] op_sel_hi:[1,0,0]
    v_pk_fma_f32 v[30:31], v[30:31], v[174:175], v[176:177] op_sel_hi:[1,0,0]
    v_pk_fma_f32 v[32:33], v[32:33], v[174:175], v[176:177] op_sel_hi:[1,0,0]
    v_pk_fma_f32 v[34:35], v[34:35], v[174:175], v[176:177] op_sel_hi:[1,0,0]
    v_pk_fma_f32 v[36:37], v[36:37], v[174:175], v[176:177] op_sel_hi:[1,0,0]
    v_pk_fma_f32 v[38:39], v[38:39], v[174:175], v[176:177] op_sel_hi:[1,0,0]
    v_pk_fma_f32 v[40:41], v[40:41], v[174:175], v[176:177] op_sel_hi:[1,0,0]
    v_pk_fma_f32 v[42:43], v[42:43], v[174:175], v[176:177] op_sel_hi:[1,0,0]
    v_pk_fma_f32 v[44:45], v[44:45], v[174:175], v[176:177] op_sel_hi:[1,0,0]
    v_pk_fma_f32 v[46:47], v[46:47], v[174:175], v[176:177] op_sel_hi:[1,0,0]
    v_pk_fma_f32 v[48:49], v[48:49], v[174:175], v[176:177] op_sel_hi:[1,0,0]
    v_pk_fma_f32 v[50:51], v[50:51], v[174:175], v[176:177] op_sel_hi:[1,0,0]
    v_pk_fma_f32 v[52:53], v[52:53], v[174:175], v[176:177] op_sel_hi:[1,0,0]
    v_pk_fma_f32 v[54:55], v[54:55], v[174:175], v[176:177] op_sel_hi:[1,0,0]
    v_pk_fma_f32 v[56:57], v[56:57], v[174:175], v[176:177] op_sel_hi:[1,0,0]
    v_pk_fma_f32 v[58:59], v[58:59], v[174:175], v[176:177] op_sel_hi:[1,0,0]
    v_pk_fma_f32 v[60:61], v[60:61], v[174:175], v[176:177] op_sel_hi:[1,0,0]
    v_pk_fma_f32 v[62:63], v[62:63], v[174:175], v[176:177] op_sel_hi:[1,0,0]
    v_pk_fma_f32 v[64:65], v[64:65], v[174:175], v[176:177] op_sel_hi:[1,0,0]
    v_pk_fma_f32 v[66:67], v[66:67], v[174:175], v[176:177] op_sel_hi:[1,0,0]
    v_pk_fma_f32 v[68:69], v[68:69], v[174:175], v[176:177] op_sel_hi:[1,0,0]
    v_pk_fma_f32 v[70:71], v[70:71], v[174:175], v[176:177] op_sel_hi:[1,0,0]
    v_pk_fma_f32 v[72:73], v[72:73], v[174:175], v[176:177] op_sel_hi:[1,0,0]
    v_pk_fma_f32 v[74:75], v[74:75], v[174:175], v[176:177] op_sel_hi:[1,0,0]
    v_pk_fma_f32 v[76:77], v[76:77], v[174:175], v[176:177] op_sel_hi:[1,0,0]
    v_pk_fma_f32 v[78:79], v[78:79], v[174:175], v[176:177] op_sel_hi:[1,0,0]
    v_pk_fma_f32 v[80:81], v[80:81], v[174:175], v[176:177] op_sel_hi:[1,0,0]
    v_pk_fma_f32 v[82:83], v[82:83], v[174:175], v[176:177] op_sel_hi:[1,0,0]
    v_pk_fma_f32 v[84:85], v[84:85], v[174:175], v[176:177] op_sel_hi:[1,0,0]
    v_pk_fma_f32 v[86:87], v[86:87], v[174:175], v[176:177] op_sel_hi:[1,0,0]
    v_pk_fma_f32 v[88:89], v[88:89], v[174:175], v[176:177] op_sel_hi:[1,0,0]
    v_pk_fma_f32 v[90:91], v[90:91], v[174:175], v[176:177] op_sel_hi:[1,0,0]
    v_pk_fma_f32 v[92:93], v[92:93], v[174:175], v[176:177] op_sel_hi:[1,0,0]
    v_pk_fma_f32 v[94:95], v[94:95], v[174:175], v[176:177] op_sel_hi:[1,0,0]
    v_pk_fma_f32 v[96:97], v[96:97], v[174:175], v[176:177] op_sel_hi:[1,0,0]
    v_pk_fma_f32 v[98:99], v[98:99], v[174:175], v[176:177] op_sel_hi:[1,0,0]
    v_pk_fma_f32 v[100:101], v[100:101], v[174:175], v[176:177] op_sel_hi:[1,0,0]
    v_pk_fma_f32 v[102:103], v[102:103], v[174:175], v[176:177] op_sel_hi:[1,0,0]
    v_pk_fma_f32 v[104:105], v[104:105], v[174:175], v[176:177] op_sel_hi:[1,0,0]
    v_pk_fma_f32 v[106:107], v[106:107], v[174:175], v[176:177] op_sel_hi:[1,0,0]
    v_pk_fma_f32 v[108:109], v[108:109], v[174:175], v[176:177] op_sel_hi:[1,0,0]
    v_pk_fma_f32 v[110:111], v[110:111], v[174:175], v[176:177] op_sel_hi:[1,0,0]
    s_cmp_lg_u32 s40, 0
    s_cbranch_scc1 L_par_done
    v_mov_b32 v178, 0
    s_mov_b32 s62, 0
L_par_poll:
    buffer_load_dword v179, v178, s[20:23], 0 offen sc1
    s_waitcnt vmcnt(0)
    v_readfirstlane_b32 s63, v179
    s_add_u32 s62, s62, 1
    s_cmp_lg_u32 s63, 0
    s_cbranch_scc1 L_par_go
    s_sleep 2
    s_cmp_lt_u32 s62, 0x100000
    s_cbranch_scc1 L_par_poll
L_par_go:
    s_mov_b32 m0, 155648
    s_nop 0
    buffer_load_dwordx4 v211, s[24:27], 0 offen offset:0 sc1 lds
    buffer_load_dwordx4 v211, s[24:27], 0 offen offset:1024 sc1 lds
    buffer_load_dwordx4 v211, s[24:27], 0 offen offset:2048 sc1 lds
    buffer_load_dwordx4 v211, s[24:27], 0 offen offset:3072 sc1 lds
    s_waitcnt vmcnt(0)
L_par_done:
    s_barrier
    ds_read_b128 v[180:183], v201 offset:0
    ds_read_b128 v[188:191], v201 offset:1792
    ds_read_b128 v[184:187], v201 offset:16
    ds_read_b128 v[192:195], v201 offset:1808
    ds_read_b128 v[224:227], v201 offset:128
    ds_read_b128 v[232:235], v201 offset:1920
    ds_read_b128 v[228:231], v201 offset:144
    ds_read_b128 v[236:239], v201 offset:1936
    s_waitcnt lgkmcnt(4)
    v_pk_fma_f32 v[0:1], v[0:1], v[188:189], v[180:181]
    v_pk_fma_f32 v[2:3], v[2:3], v[190:191], v[182:183]
    v_pk_fma_f32 v[4:5], v[4:5], v[192:193], v[184:185]
    v_pk_fma_f32 v[6:7], v[6:7], v[194:195], v[186:187]
    v_cvt_pk_bf16_f32 v112, v0, v1
    v_cvt_pk_bf16_f32 v113, v2, v3
    v_cvt_pk_bf16_f32 v114, v4, v5
    v_cvt_pk_bf16_f32 v115, v6, v7
    ds_write_b128 v202, v[112:115] offset:0
    ds_read_b128 v[180:183], v201 offset:256
    ds_read_b128 v[188:191], v201 offset:2048
    ds_read_b128 v[184:187], v201 offset:272
    ds_read_b128 v[192:195], v201 offset:2064
    s_waitcnt lgkmcnt(5)
    v_pk_fma_f32 v[8:9], v[8:9], v[232:233], v[224:225]
    v_pk_fma_f32 v[10:11], v[10:11], v[234:235], v[226:227]
    v_pk_fma_f32 v[12:13], v[12:13], v[236:237], v[228:229]
    v_pk_fma_f32 v[14:15], v[14:15], v[238:239], v[230:231]
    v_cvt_pk_bf16_f32 v116, v8, v9
    v_cvt_pk_bf16_f32 v117, v10, v11
    v_cvt_pk_bf16_f32 v118, v12, v13
    v_cvt_pk_bf16_f32 v119, v14, v15
    ds_write_b128 v202, v[116:119] offset:1024
    ds_read_b128 v[224:227], v201 offset:384
    ds_read_b128 v[232:235], v201 offset:2176
    ds_read_b128 v[228:231], v201 offset:400
    ds_read_b128 v[236:239], v201 offset:2192
    s_waitcnt lgkmcnt(5)
    v_pk_fma_f32 v[16:17], v[16:17], v[188:189], v[180:181]
    v_pk_fma_f32 v[18:19], v[18:19], v[190:191], v[182:183]
    v_pk_fma_f32 v[20:21], v[20:21], v[192:193], v[184:185]
    v_pk_fma_f32 v[22:23], v[22:23], v[194:195], v[186:187]
    v_cvt_pk_bf16_f32 v120, v16, v17
    v_cvt_pk_bf16_f32 v121, v18, v19
    v_cvt_pk_bf16_f32 v122, v20, v21
    v_cvt_pk_bf16_f32 v123, v22, v23
    ds_write_b128 v202, v[120:123] offset:2048
    ds_read_b128 v[180:183], v201 offset:512
    ds_read_b128 v[188:191], v201 offset:2304
    ds_read_b128 v[184:187], v201 offset:528
    ds_read_b128 v[192:195], v201 offset:2320
    s_waitcnt lgkmcnt(5)
    v_pk_fma_f32 v[24:25], v[24:25], v[232:233], v[224:225]
    v_pk_fma_f32 v[26:27], v[26:27], v[234:235], v[226:227]
    v_pk_fma_f32 v[28:29], v[28:29], v[236:237], v[228:229]
    v_pk_fma_f32 v[30:31], v[30:31], v[238:239], v[230:231]
    v_cvt_pk_bf16_f32 v124, v24, v25
    v_cvt_pk_bf16_f32 v125, v26, v27
    v_cvt_pk_bf16_f32 v126, v28, v29
    v_cvt_pk_bf16_f32 v127, v30, v31
    ds_write_b128 v202, v[124:127] offset:3072
    ds_read_b128 v[224:227], v201 offset:640
    ds_read_b128 v[232:235], v201 offset:2432
    ds_read_b128 v[228:231], v201 offset:656
    ds_read_b128 v[236:239], v201 offset:2448
    s_waitcnt lgkmcnt(5)
    v_pk_fma_f32 v[32:33], v[32:33], v[188:189], v[180:181]
    v_pk_fma_f32 v[34:35], v[34:35], v[190:191], v[182:183]
    v_pk_fma_f32 v[36:37], v[36:37], v[192:193], v[184:185]
    v_pk_fma_f32 v[38:39], v[38:39], v[194:195], v[186:187]
    v_cvt_pk_bf16_f32 v128, v32, v33
    v_cvt_pk_bf16_f32 v129, v34, v35
    v_cvt_pk_bf16_f32 v130, v36, v37
    v_cvt_pk_bf16_f32 v131, v38, v39
    ds_write_b128 v202, v[128:131] offset:4096
    ds_read_b128 v[180:183], v201 offset:768
    ds_read_b128 v[188:191], v201 offset:2560
    ds_read_b128 v[184:187], v201 offset:784
    ds_read_b128 v[192:195], v201 offset:2576
    s_waitcnt lgkmcnt(5)
    v_pk_fma_f32 v[40:41], v[40:41], v[232:233], v[224:225]
    v_pk_fma_f32 v[42:43], v[42:43], v[234:235], v[226:227]
    v_pk_fma_f32 v[44:45], v[44:45], v[236:237], v[228:229]
    v_pk_fma_f32 v[46:47], v[46:47], v[238:239], v[230:231]
    v_cvt_pk_bf16_f32 v132, v40, v41
    v_cvt_pk_bf16_f32 v133, v42, v43
    v_cvt_pk_bf16_f32 v134, v44, v45
    v_cvt_pk_bf16_f32 v135, v46, v47
    ds_write_b128 v202, v[132:135] offset:5120
    ds_read_b128 v[224:227], v201 offset:896
    ds_read_b128 v[232:235], v201 offset:2688
    ds_read_b128 v[228:231], v201 offset:912
    ds_read_b128 v[236:239], v201 offset:2704
    s_waitcnt lgkmcnt(5)
    v_pk_fma_f32 v[48:49], v[48:49], v[188:189], v[180:181]
    v_pk_fma_f32 v[50:51], v[50:51], v[190:191], v[182:183]
    v_pk_fma_f32 v[52:53], v[52:53], v[192:193], v[184:185]
    v_pk_fma_f32 v[54:55], v[54:55], v[194:195], v[186:187]
    v_cvt_pk_bf16_f32 v136, v48, v49
    v_cvt_pk_bf16_f32 v137, v50, v51
    v_cvt_pk_bf16_f32 v138, v52, v53
    v_cvt_pk_bf16_f32 v139, v54, v55
    ds_write_b128 v202, v[136:139] offset:6144
    ds_read_b128 v[180:183], v201 offset:1024
    ds_read_b128 v[188:191], v201 offset:2816
    ds_read_b128 v[184:187], v201 offset:1040
    ds_read_b128 v[192:195], v201 offset:2832
    s_waitcnt lgkmcnt(5)
    v_pk_fma_f32 v[56:57], v[56:57], v[232:233], v[224:225]
    v_pk_fma_f32 v[58:59], v[58:59], v[234:235], v[226:227]
    v_pk_fma_f32 v[60:61], v[60:61], v[236:237], v[228:229]
    v_pk_fma_f32 v[62:63], v[62:63], v[238:239], v[230:231]
    v_cvt_pk_bf16_f32 v140, v56, v57
    v_cvt_pk_bf16_f32 v141, v58, v59
    v_cvt_pk_bf16_f32 v142, v60, v61
    v_cvt_pk_bf16_f32 v143, v62, v63
    ds_write_b128 v202, v[140:143] offset:7168
    ds_read_b128 v[224:227], v201 offset:1152
    ds_read_b128 v[232:235], v201 offset:2944
    ds_read_b128 v[228:231], v201 offset:1168
    ds_read_b128 v[236:239], v201 offset:2960
    s_waitcnt lgkmcnt(5)
    v_pk_fma_f32 v[64:65], v[64:65], v[188:189], v[180:181]
    v_pk_fma_f32 v[66:67], v[66:67], v[190:191], v[182:183]
    v_pk_fma_f32 v[68:69], v[68:69], v[192:193], v[184:185]
    v_pk_fma_f32 v[70:71], v[70:71], v[194:195], v[186:187]
    v_cvt_pk_bf16_f32 v144, v64, v65
    v_cvt_pk_bf16_f32 v145, v66, v67
    v_cvt_pk_bf16_f32 v146, v68, v69
    v_cvt_pk_bf16_f32 v147, v70, v71
    ds_write_b128 v202, v[144:147] offset:8192
    ds_read_b128 v[180:183], v201 offset:1280
    ds_read_b128 v[188:191], v201 offset:3072
    ds_read_b128 v[184:187], v201 offset:1296
    ds_read_b128 v[192:195], v201 offset:3088
    s_waitcnt lgkmcnt(5)
    v_pk_fma_f32 v[72:73], v[72:73], v[232:233], v[224:225]
    v_pk_fma_f32 v[74:75], v[74:75], v[234:235], v[226:227]
    v_pk_fma_f32 v[76:77], v[76:77], v[236:237], v[228:229]
    v_pk_fma_f32 v[78:79], v[78:79], v[238:239], v[230:231]
    v_cvt_pk_bf16_f32 v148, v72, v73
    v_cvt_pk_bf16_f32 v149, v74, v75
    v_cvt_pk_bf16_f32 v150, v76, v77
    v_cvt_pk_bf16_f32 v151, v78, v79
    ds_write_b128 v202, v[148:151] offset:9216
    ds_read_b128 v[224:227], v201 offset:1408
    ds_read_b128 v[232:235], v201 offset:3200
    ds_read_b128 v[228:231], v201 offset:1424
    ds_read_b128 v[236:239], v201 offset:3216
    s_waitcnt lgkmcnt(5)
    v_pk_fma_f32 v[80:81], v[80:81], v[188:189], v[180:181]
    v_pk_fma_f32 v[82:83], v[82:83], v[190:191], v[182:183]
    v_pk_fma_f32 v[84:85], v[84:85], v[192:193], v[184:185]
    v_pk_fma_f32 v[86:87], v[86:87], v[194:195], v[186:187]
    v_cvt_pk_bf16_f32 v152, v80, v81
    v_cvt_pk_bf16_f32 v153, v82, v83
    v_cvt_pk_bf16_f32 v154, v84, v85
    v_cvt_pk_bf16_f32 v155, v86, v87
    ds_write_b128 v202, v[152:155] offset:10240
    ds_read_b128 v[180:183], v201 offset:1536
    ds_read_b128 v[188:191], v201 offset:3328
    ds_read_b128 v[184:187], v201 offset:1552
    ds_read_b128 v[192:195], v201 offset:3344
    s_waitcnt lgkmcnt(5)
    v_pk_fma_f32 v[88:89], v[88:89], v[232:233], v[224:225]
    v_pk_fma_f32 v[90:91], v[90:91], v[234:235], v[226:227]
    v_pk_fma_f32 v[92:93], v[92:93], v[236:237], v[228:229]
    v_pk_fma_f32 v[94:95], v[94:95], v[238:239], v[230:231]
    v_cvt_pk_bf16_f32 v156, v88, v89
    v_cvt_pk_bf16_f32 v157, v90, v91
    v_cvt_pk_bf16_f32 v158, v92, v93
    v_cvt_pk_bf16_f32 v159, v94, v95
    ds_write_b128 v202, v[156:159] offset:11264
    ds_read_b128 v[224:227], v201 offset:1664
    ds_read_b128 v[232:235], v201 offset:3456
    ds_read_b128 v[228:231], v201 offset:1680
    ds_read_b128 v[236:239], v201 offset:3472
    s_waitcnt lgkmcnt(5)
    v_pk_fma_f32 v[96:97], v[96:97], v[188:189], v[180:181]
    v_pk_fma_f32 v[98:99], v[98:99], v[190:191], v[182:183]
    v_pk_fma_f32 v[100:101], v[100:101], v[192:193], v[184:185]
    v_pk_fma_f32 v[102:103], v[102:103], v[194:195], v[186:187]
    v_cvt_pk_bf16_f32 v160, v96, v97
    v_cvt_pk_bf16_f32 v161, v98, v99
    v_cvt_pk_bf16_f32 v162, v100, v101
    v_cvt_pk_bf16_f32 v163, v102, v103
    ds_write_b128 v202, v[160:163] offset:12288
    s_waitcnt lgkmcnt(1)
    v_pk_fma_f32 v[104:105], v[104:105], v[232:233], v[224:225]
    v_pk_fma_f32 v[106:107], v[106:107], v[234:235], v[226:227]
    v_pk_fma_f32 v[108:109], v[108:109], v[236:237], v[228:229]
    v_pk_fma_f32 v[110:111], v[110:111], v[238:239], v[230:231]
    v_cvt_pk_bf16_f32 v164, v104, v105
    v_cvt_pk_bf16_f32 v165, v106, v107
    v_cvt_pk_bf16_f32 v166, v108, v109
    v_cvt_pk_bf16_f32 v167, v110, v111
    ds_write_b128 v202, v[164:167] offset:13312
    s_waitcnt vmcnt(20)
    s_waitcnt lgkmcnt(0)
    s_barrier
    ds_read_b128 a[0:3], v203 offset:0
    ds_read_b128 a[4:7], v203 offset:14336
    ds_read_b128 a[8:11], v203 offset:28672
    ds_read_b128 a[12:15], v203 offset:43008
    ds_read_b64_tr_b16 v[128:129], v206 offset:0
    ds_read_b64_tr_b16 v[130:131], v206 offset:512
    ds_read_b64_tr_b16 v[132:133], v207 offset:0
    ds_read_b64_tr_b16 v[134:135], v207 offset:512
    ds_read_b64_tr_b16 v[136:137], v208 offset:0
    ds_read_b64_tr_b16 v[138:139], v208 offset:512
    ds_read_b64_tr_b16 v[140:141], v209 offset:0
    ds_read_b64_tr_b16 v[142:143], v209 offset:512
    s_waitcnt lgkmcnt(0)
    v_mfma_f32_16x16x32_bf16 v[0:3], v[128:131], a[0:3], 0
    s_add_u32 m0, s60, 0
    s_waitcnt vmcnt(16)
    v_mfma_f32_16x16x32_bf16 v[4:7], v[128:131], a[4:7], 0
    buffer_load_dwordx4 v204, s[12:15], s56 offen offset:0 lds
    v_mfma_f32_16x16x32_bf16 v[8:11], v[128:131], a[8:11], 0
    ds_read_b64_tr_b16 v[144:145], v206 offset:4096
    ds_read_b64_tr_b16 v[146:147], v206 offset:4608
    v_mfma_f32_16x16x32_bf16 v[12:15], v[128:131], a[12:15], 0
    ds_read_b64_tr_b16 v[148:149], v207 offset:4096
    ds_read_b64_tr_b16 v[150:151], v207 offset:4608
    v_mfma_f32_16x16x32_bf16 v[16:19], v[132:135], a[0:3], 0
    ds_read_b64_tr_b16 v[152:153], v208 offset:4096
    ds_read_b64_tr_b16 v[154:155], v208 offset:4608
    v_mfma_f32_16x16x32_bf16 v[20:23], v[132:135], a[4:7], 0
    buffer_load_dwordx4 v205, s[12:15], s57 offen offset:1024 lds
    v_mfma_f32_16x16x32_bf16 v[24:27], v[132:135], a[8:11], 0
    ds_read_b64_tr_b16 v[156:157], v209 offset:4096
    ds_read_b64_tr_b16 v[158:159], v209 offset:4608
    v_mfma_f32_16x16x32_bf16 v[28:31], v[132:135], a[12:15], 0
    ds_read_b128 a[16:19], v203 offset:1024
    ds_read_b128 a[20:23], v203 offset:15360
    v_mfma_f32_16x16x32_bf16 v[32:35], v[136:139], a[0:3], 0
    ds_read_b128 a[24:27], v203 offset:29696
    ds_read_b128 a[28:31], v203 offset:44032
    v_mfma_f32_16x16x32_bf16 v[36:39], v[136:139], a[4:7], 0
    buffer_load_dwordx4 v204, s[12:15], s58 offen offset:2048 lds
    v_mfma_f32_16x16x32_bf16 v[40:43], v[136:139], a[8:11], 0
    v_mfma_f32_16x16x32_bf16 v[44:47], v[136:139], a[12:15], 0
    v_mfma_f32_16x16x32_bf16 v[48:51], v[140:143], a[0:3], 0
    v_mfma_f32_16x16x32_bf16 v[52:55], v[140:143], a[4:7], 0
    buffer_load_dwordx4 v205, s[12:15], s59 offen offset:3072 lds
    v_mfma_f32_16x16x32_bf16 v[56:59], v[140:143], a[8:11], 0
    v_add_u32 v204, 0x40000, v204
    v_add_u32 v205, 0x40000, v205
    v_mfma_f32_16x16x32_bf16 v[60:63], v[140:143], a[12:15], 0
    s_waitcnt lgkmcnt(0)
    v_mfma_f32_16x16x32_bf16 v[0:3], v[144:147], a[16:19], v[0:3]
    s_add_u32 m0, s60, 4096
    s_waitcnt vmcnt(16)
    v_mfma_f32_16x16x32_bf16 v[4:7], v[144:147], a[20:23], v[4:7]
    buffer_load_dwordx4 v204, s[12:15], s56 offen offset:0 lds
    v_mfma_f32_16x16x32_bf16 v[8:11], v[144:147], a[24:27], v[8:11]
    ds_read_b64_tr_b16 v[128:129], v206 offset:8192
    ds_read_b64_tr_b16 v[130:131], v206 offset:8704
    v_mfma_f32_16x16x32_bf16 v[12:15], v[144:147], a[28:31], v[12:15]
    ds_read_b64_tr_b16 v[132:133], v207 offset:8192
    ds_read_b64_tr_b16 v[134:135], v207 offset:8704
    v_mfma_f32_16x16x32_bf16 v[16:19], v[148:151], a[16:19], v[16:19]
    ds_read_b64_tr_b16 v[136:137], v208 offset:8192
    ds_read_b64_tr_b16 v[138:139], v208 offset:8704
    v_mfma_f32_16x16x32_bf16 v[20:23], v[148:151], a[20:23], v[20:23]
    buffer_load_dwordx4 v205, s[12:15], s57 offen offset:1024 lds
    v_mfma_f32_16x16x32_bf16 v[24:27], v[148:151], a[24:27], v[24:27]
    ds_read_b64_tr_b16 v[140:141], v209 offset:8192
    ds_read_b64_tr_b16 v[142:143], v209 offset:8704
    v_mfma_f32_16x16x32_bf16 v[28:31], v[148:151], a[28:31], v[28:31]
    ds_read_b128 a[32:35], v203 offset:2048
    ds_read_b128 a[36:39], v203 offset:16384
    v_mfma_f32_16x16x32_bf16 v[32:35], v[152:155], a[16:19], v[32:35]
    ds_read_b128 a[40:43], v203 offset:30720
    ds_read_b128 a[44:47], v203 offset:45056
    v_mfma_f32_16x16x32_bf16 v[36:39], v[152:155], a[20:23], v[36:39]
    buffer_load_dwordx4 v204, s[12:15], s58 offen offset:2048 lds
    v_mfma_f32_16x16x32_bf16 v[40:43], v[152:155], a[24:27], v[40:43]
    v_mfma_f32_16x16x32_bf16 v[44:47], v[152:155], a[28:31], v[44:47]
    v_mfma_f32_16x16x32_bf16 v[48:51], v[156:159], a[16:19], v[48:51]
    v_mfma_f32_16x16x32_bf16 v[52:55], v[156:159], a[20:23], v[52:55]
    buffer_load_dwordx4 v205, s[12:15], s59 offen offset:3072 lds
    v_mfma_f32_16x16x32_bf16 v[56:59], v[156:159], a[24:27], v[56:59]
    v_add_u32 v204, 0x40000, v204
    v_add_u32 v205, 0x40000, v205
    v_mfma_f32_16x16x32_bf16 v[60:63], v[156:159], a[28:31], v[60:63]
    s_waitcnt lgkmcnt(0)
    v_mfma_f32_16x16x32_bf16 v[0:3], v[128:131], a[32:35], v[0:3]
    s_add_u32 m0, s60, 8192
    s_waitcnt vmcnt(16)
    v_mfma_f32_16x16x32_bf16 v[4:7], v[128:131], a[36:39], v[4:7]
    buffer_load_dwordx4 v204, s[12:15], s56 offen offset:0 lds
    v_mfma_f32_16x16x32_bf16 v[8:11], v[128:131], a[40:43], v[8:11]
    ds_read_b64_tr_b16 v[144:145], v206 offset:12288
    ds_read_b64_tr_b16 v[146:147], v206 offset:12800
    v_mfma_f32_16x16x32_bf16 v[12:15], v[128:131], a[44:47], v[12:15]
    ds_read_b64_tr_b16 v[148:149], v207 offset:12288
    ds_read_b64_tr_b16 v[150:151], v207 offset:12800
    v_mfma_f32_16x16x32_bf16 v[16:19], v[132:135], a[32:35], v[16:19]
    ds_read_b64_tr_b16 v[152:153], v208 offset:12288
    ds_read_b64_tr_b16 v[154:155], v208 offset:12800
    v_mfma_f32_16x16x32_bf16 v[20:23], v[132:135], a[36:39], v[20:23]
    buffer_load_dwordx4 v205, s[12:15], s57 offen offset:1024 lds
    v_mfma_f32_16x16x32_bf16 v[24:27], v[132:135], a[40:43], v[24:27]
    ds_read_b64_tr_b16 v[156:157], v209 offset:12288
    ds_read_b64_tr_b16 v[158:159], v209 offset:12800
    v_mfma_f32_16x16x32_bf16 v[28:31], v[132:135], a[44:47], v[28:31]
    ds_read_b128 a[48:51], v203 offset:3072
    ds_read_b128 a[52:55], v203 offset:17408
    v_mfma_f32_16x16x32_bf16 v[32:35], v[136:139], a[32:35], v[32:35]
    ds_read_b128 a[56:59], v203 offset:31744
    ds_read_b128 a[60:63], v203 offset:46080
    v_mfma_f32_16x16x32_bf16 v[36:39], v[136:139], a[36:39], v[36:39]
    buffer_load_dwordx4 v204, s[12:15], s58 offen offset:2048 lds
    v_mfma_f32_16x16x32_bf16 v[40:43], v[136:139], a[40:43], v[40:43]
    v_mfma_f32_16x16x32_bf16 v[44:47], v[136:139], a[44:47], v[44:47]
    v_mfma_f32_16x16x32_bf16 v[48:51], v[140:143], a[32:35], v[48:51]
    v_mfma_f32_16x16x32_bf16 v[52:55], v[140:143], a[36:39], v[52:55]
    buffer_load_dwordx4 v205, s[12:15], s59 offen offset:3072 lds
    v_mfma_f32_16x16x32_bf16 v[56:59], v[140:143], a[40:43], v[56:59]
    v_add_u32 v204, 0x40000, v204
    v_add_u32 v205, 0x40000, v205
    v_mfma_f32_16x16x32_bf16 v[60:63], v[140:143], a[44:47], v[60:63]
    s_waitcnt lgkmcnt(0)
    v_mfma_f32_16x16x32_bf16 v[0:3], v[144:147], a[48:51], v[0:3]
    s_add_u32 m0, s60, 12288
    s_waitcnt vmcnt(8)
    v_mfma_f32_16x16x32_bf16 v[4:7], v[144:147], a[52:55], v[4:7]
    buffer_load_dwordx4 v204, s[12:15], s56 offen offset:0 lds
    v_mfma_f32_16x16x32_bf16 v[8:11], v[144:147], a[56:59], v[8:11]
    ds_read_b64_tr_b16 v[128:129], v206 offset:0
    ds_read_b64_tr_b16 v[130:131], v206 offset:512
    v_mfma_f32_16x16x32_bf16 v[12:15], v[144:147], a[60:63], v[12:15]
    ds_read_b64_tr_b16 v[132:133], v207 offset:0
    ds_read_b64_tr_b16 v[134:135], v207 offset:512
    v_mfma_f32_16x16x32_bf16 v[16:19], v[148:151], a[48:51], v[16:19]
    ds_read_b64_tr_b16 v[136:137], v208 offset:0
    ds_read_b64_tr_b16 v[138:139], v208 offset:512
    v_mfma_f32_16x16x32_bf16 v[20:23], v[148:151], a[52:55], v[20:23]
    buffer_load_dwordx4 v205, s[12:15], s57 offen offset:1024 lds
    v_mfma_f32_16x16x32_bf16 v[24:27], v[148:151], a[56:59], v[24:27]
    ds_read_b64_tr_b16 v[140:141], v209 offset:0
    ds_read_b64_tr_b16 v[142:143], v209 offset:512
    v_mfma_f32_16x16x32_bf16 v[28:31], v[148:151], a[60:63], v[28:31]
    ds_read_b128 a[64:67], v203 offset:4096
    ds_read_b128 a[68:71], v203 offset:18432
    v_mfma_f32_16x16x32_bf16 v[32:35], v[152:155], a[48:51], v[32:35]
    ds_read_b128 a[72:75], v203 offset:32768
    ds_read_b128 a[76:79], v203 offset:47104
    v_mfma_f32_16x16x32_bf16 v[36:39], v[152:155], a[52:55], v[36:39]
    buffer_load_dwordx4 v204, s[12:15], s58 offen offset:2048 lds
    v_mfma_f32_16x16x32_bf16 v[40:43], v[152:155], a[56:59], v[40:43]
    v_mfma_f32_16x16x32_bf16 v[44:47], v[152:155], a[60:63], v[44:47]
    v_mfma_f32_16x16x32_bf16 v[48:51], v[156:159], a[48:51], v[48:51]
    v_mfma_f32_16x16x32_bf16 v[52:55], v[156:159], a[52:55], v[52:55]
    buffer_load_dwordx4 v205, s[12:15], s59 offen offset:3072 lds
    v_mfma_f32_16x16x32_bf16 v[56:59], v[156:159], a[56:59], v[56:59]
    v_add_u32 v204, 0x40000, v204
    v_add_u32 v205, 0x40000, v205
    v_mfma_f32_16x16x32_bf16 v[60:63], v[156:159], a[60:63], v[60:63]
    s_waitcnt lgkmcnt(0)
    v_mfma_f32_16x16x32_bf16 v[0:3], v[128:131], a[64:67], v[0:3]
    s_add_u32 m0, s60, 0
    s_waitcnt vmcnt(8)
    v_mfma_f32_16x16x32_bf16 v[4:7], v[128:131], a[68:71], v[4:7]
    buffer_load_dwordx4 v204, s[12:15], s56 offen offset:0 lds
    v_mfma_f32_16x16x32_bf16 v[8:11], v[128:131], a[72:75], v[8:11]
    ds_read_b64_tr_b16 v[144:145], v206 offset:4096
    ds_read_b64_tr_b16 v[146:147], v206 offset:4608
    v_mfma_f32_16x16x32_bf16 v[12:15], v[128:131], a[76:79], v[12:15]
    ds_read_b64_tr_b16 v[148:149], v207 offset:4096
    ds_read_b64_tr_b16 v[150:151], v207 offset:4608
    v_mfma_f32_16x16x32_bf16 v[16:19], v[132:135], a[64:67], v[16:19]
    ds_read_b64_tr_b16 v[152:153], v208 offset:4096
    ds_read_b64_tr_b16 v[154:155], v208 offset:4608
    v_mfma_f32_16x16x32_bf16 v[20:23], v[132:135], a[68:71], v[20:23]
    buffer_load_dwordx4 v205, s[12:15], s57 offen offset:1024 lds
    v_mfma_f32_16x16x32_bf16 v[24:27], v[132:135], a[72:75], v[24:27]
    ds_read_b64_tr_b16 v[156:157], v209 offset:4096
    ds_read_b64_tr_b16 v[158:159], v209 offset:4608
    v_mfma_f32_16x16x32_bf16 v[28:31], v[132:135], a[76:79], v[28:31]
    ds_read_b128 a[80:83], v203 offset:5120
    ds_read_b128 a[84:87], v203 offset:19456
    v_mfma_f32_16x16x32_bf16 v[32:35], v[136:139], a[64:67], v[32:35]
    ds_read_b128 a[88:91], v203 offset:33792
    ds_read_b128 a[92:95], v203 offset:48128
    v_mfma_f32_16x16x32_bf16 v[36:39], v[136:139], a[68:71], v[36:39]
    buffer_load_dwordx4 v204, s[12:15], s58 offen offset:2048 lds
    v_mfma_f32_16x16x32_bf16 v[40:43], v[136:139], a[72:75], v[40:43]
    v_mfma_f32_16x16x32_bf16 v[44:47], v[136:139], a[76:79], v[44:47]
    v_mfma_f32_16x16x32_bf16 v[48:51], v[140:143], a[64:67], v[48:51]
    v_mfma_f32_16x16x32_bf16 v[52:55], v[140:143], a[68:71], v[52:55]
    buffer_load_dwordx4 v205, s[12:15], s59 offen offset:3072 lds
    v_mfma_f32_16x16x32_bf16 v[56:59], v[140:143], a[72:75], v[56:59]
    v_add_u32 v204, 0x40000, v204
    v_add_u32 v205, 0x40000, v205
    v_mfma_f32_16x16x32_bf16 v[60:63], v[140:143], a[76:79], v[60:63]
    s_waitcnt lgkmcnt(0)
    v_mfma_f32_16x16x32_bf16 v[0:3], v[144:147], a[80:83], v[0:3]
    s_add_u32 m0, s60, 4096
    s_waitcnt vmcnt(8)
    v_mfma_f32_16x16x32_bf16 v[4:7], v[144:147], a[84:87], v[4:7]
    buffer_load_dwordx4 v204, s[12:15], s56 offen offset:0 lds
    v_mfma_f32_16x16x32_bf16 v[8:11], v[144:147], a[88:91], v[8:11]
    ds_read_b64_tr_b16 v[128:129], v206 offset:8192
    ds_read_b64_tr_b16 v[130:131], v206 offset:8704
    v_mfma_f32_16x16x32_bf16 v[12:15], v[144:147], a[92:95], v[12:15]
    ds_read_b64_tr_b16 v[132:133], v207 offset:8192
    ds_read_b64_tr_b16 v[134:135], v207 offset:8704
    v_mfma_f32_16x16x32_bf16 v[16:19], v[148:151], a[80:83], v[16:19]
    ds_read_b64_tr_b16 v[136:137], v208 offset:8192
    ds_read_b64_tr_b16 v[138:139], v208 offset:8704
    v_mfma_f32_16x16x32_bf16 v[20:23], v[148:151], a[84:87], v[20:23]
    buffer_load_dwordx4 v205, s[12:15], s57 offen offset:1024 lds
    v_mfma_f32_16x16x32_bf16 v[24:27], v[148:151], a[88:91], v[24:27]
    ds_read_b64_tr_b16 v[140:141], v209 offset:8192
    ds_read_b64_tr_b16 v[142:143], v209 offset:8704
    v_mfma_f32_16x16x32_bf16 v[28:31], v[148:151], a[92:95], v[28:31]
    ds_read_b128 a[96:99], v203 offset:6144
    ds_read_b128 a[100:103], v203 offset:20480
    v_mfma_f32_16x16x32_bf16 v[32:35], v[152:155], a[80:83], v[32:35]
    ds_read_b128 a[104:107], v203 offset:34816
    ds_read_b128 a[108:111], v203 offset:49152
    v_mfma_f32_16x16x32_bf16 v[36:39], v[152:155], a[84:87], v[36:39]
    buffer_load_dwordx4 v204, s[12:15], s58 offen offset:2048 lds
    v_mfma_f32_16x16x32_bf16 v[40:43], v[152:155], a[88:91], v[40:43]
    v_mfma_f32_16x16x32_bf16 v[44:47], v[152:155], a[92:95], v[44:47]
    v_mfma_f32_16x16x32_bf16 v[48:51], v[156:159], a[80:83], v[48:51]
    v_mfma_f32_16x16x32_bf16 v[52:55], v[156:159], a[84:87], v[52:55]
    buffer_load_dwordx4 v205, s[12:15], s59 offen offset:3072 lds
    v_mfma_f32_16x16x32_bf16 v[56:59], v[156:159], a[88:91], v[56:59]
    v_add_u32 v204, 0x40000, v204
    v_add_u32 v205, 0x40000, v205
    v_mfma_f32_16x16x32_bf16 v[60:63], v[156:159], a[92:95], v[60:63]
    s_waitcnt lgkmcnt(0)
    v_mfma_f32_16x16x32_bf16 v[0:3], v[128:131], a[96:99], v[0:3]
    s_add_u32 m0, s60, 8192
    s_waitcnt vmcnt(8)
    v_mfma_f32_16x16x32_bf16 v[4:7], v[128:131], a[100:103], v[4:7]
    buffer_load_dwordx4 v204, s[12:15], s56 offen offset:0 lds
    v_mfma_f32_16x16x32_bf16 v[8:11], v[128:131], a[104:107], v[8:11]
    ds_read_b64_tr_b16 v[144:145], v206 offset:12288
    ds_read_b64_tr_b16 v[146:147], v206 offset:12800
    v_mfma_f32_16x16x32_bf16 v[12:15], v[128:131], a[108:111], v[12:15]
    ds_read_b64_tr_b16 v[148:149], v207 offset:12288
    ds_read_b64_tr_b16 v[150:151], v207 offset:12800
    v_mfma_f32_16x16x32_bf16 v[16:19], v[132:135], a[96:99], v[16:19]
    ds_read_b64_tr_b16 v[152:153], v208 offset:12288
    ds_read_b64_tr_b16 v[154:155], v208 offset:12800
    v_mfma_f32_16x16x32_bf16 v[20:23], v[132:135], a[100:103], v[20:23]
    buffer_load_dwordx4 v205, s[12:15], s57 offen offset:1024 lds
    v_mfma_f32_16x16x32_bf16 v[24:27], v[132:135], a[104:107], v[24:27]
    ds_read_b64_tr_b16 v[156:157], v209 offset:12288
    ds_read_b64_tr_b16 v[158:159], v209 offset:12800
    v_mfma_f32_16x16x32_bf16 v[28:31], v[132:135], a[108:111], v[28:31]
    ds_read_b128 a[112:115], v203 offset:7168
    ds_read_b128 a[116:119], v203 offset:21504
    v_mfma_f32_16x16x32_bf16 v[32:35], v[136:139], a[96:99], v[32:35]
    ds_read_b128 a[120:123], v203 offset:35840
    ds_read_b128 a[124:127], v203 offset:50176
    v_mfma_f32_16x16x32_bf16 v[36:39], v[136:139], a[100:103], v[36:39]
    buffer_load_dwordx4 v204, s[12:15], s58 offen offset:2048 lds
    v_mfma_f32_16x16x32_bf16 v[40:43], v[136:139], a[104:107], v[40:43]
    v_mfma_f32_16x16x32_bf16 v[44:47], v[136:139], a[108:111], v[44:47]
    v_mfma_f32_16x16x32_bf16 v[48:51], v[140:143], a[96:99], v[48:51]
    v_mfma_f32_16x16x32_bf16 v[52:55], v[140:143], a[100:103], v[52:55]
    buffer_load_dwordx4 v205, s[12:15], s59 offen offset:3072 lds
    v_mfma_f32_16x16x32_bf16 v[56:59], v[140:143], a[104:107], v[56:59]
    v_add_u32 v204, 0x40000, v204
    v_add_u32 v205, 0x40000, v205
    v_mfma_f32_16x16x32_bf16 v[60:63], v[140:143], a[108:111], v[60:63]
    s_waitcnt lgkmcnt(0)
    v_mfma_f32_16x16x32_bf16 v[0:3], v[144:147], a[112:115], v[0:3]
    s_add_u32 m0, s60, 12288
    s_waitcnt vmcnt(8)
    v_mfma_f32_16x16x32_bf16 v[4:7], v[144:147], a[116:119], v[4:7]
    buffer_load_dwordx4 v204, s[12:15], s56 offen offset:0 lds
    v_mfma_f32_16x16x32_bf16 v[8:11], v[144:147], a[120:123], v[8:11]
    ds_read_b64_tr_b16 v[128:129], v206 offset:0
    ds_read_b64_tr_b16 v[130:131], v206 offset:512
    v_mfma_f32_16x16x32_bf16 v[12:15], v[144:147], a[124:127], v[12:15]
    ds_read_b64_tr_b16 v[132:133], v207 offset:0
    ds_read_b64_tr_b16 v[134:135], v207 offset:512
    v_mfma_f32_16x16x32_bf16 v[16:19], v[148:151], a[112:115], v[16:19]
    ds_read_b64_tr_b16 v[136:137], v208 offset:0
    ds_read_b64_tr_b16 v[138:139], v208 offset:512
    v_mfma_f32_16x16x32_bf16 v[20:23], v[148:151], a[116:119], v[20:23]
    buffer_load_dwordx4 v205, s[12:15], s57 offen offset:1024 lds
    v_mfma_f32_16x16x32_bf16 v[24:27], v[148:151], a[120:123], v[24:27]
    ds_read_b64_tr_b16 v[140:141], v209 offset:0
    ds_read_b64_tr_b16 v[142:143], v209 offset:512
    v_mfma_f32_16x16x32_bf16 v[28:31], v[148:151], a[124:127], v[28:31]
    ds_read_b128 a[128:131], v203 offset:8192
    ds_read_b128 a[132:135], v203 offset:22528
    v_mfma_f32_16x16x32_bf16 v[32:35], v[152:155], a[112:115], v[32:35]
    ds_read_b128 a[136:139], v203 offset:36864
    ds_read_b128 a[140:143], v203 offset:51200
    v_mfma_f32_16x16x32_bf16 v[36:39], v[152:155], a[116:119], v[36:39]
    buffer_load_dwordx4 v204, s[12:15], s58 offen offset:2048 lds
    v_mfma_f32_16x16x32_bf16 v[40:43], v[152:155], a[120:123], v[40:43]
    v_mfma_f32_16x16x32_bf16 v[44:47], v[152:155], a[124:127], v[44:47]
    v_mfma_f32_16x16x32_bf16 v[48:51], v[156:159], a[112:115], v[48:51]
    v_mfma_f32_16x16x32_bf16 v[52:55], v[156:159], a[116:119], v[52:55]
    buffer_load_dwordx4 v205, s[12:15], s59 offen offset:3072 lds
    v_mfma_f32_16x16x32_bf16 v[56:59], v[156:159], a[120:123], v[56:59]
    v_add_u32 v204, 0x40000, v204
    v_add_u32 v205, 0x40000, v205
    v_mfma_f32_16x16x32_bf16 v[60:63], v[156:159], a[124:127], v[60:63]
    s_waitcnt lgkmcnt(0)
    v_mfma_f32_16x16x32_bf16 v[0:3], v[128:131], a[128:131], v[0:3]
    s_add_u32 m0, s60, 0
    s_waitcnt vmcnt(8)
    v_mfma_f32_16x16x32_bf16 v[4:7], v[128:131], a[132:135], v[4:7]
    buffer_load_dwordx4 v204, s[12:15], s56 offen offset:0 lds
    v_mfma_f32_16x16x32_bf16 v[8:11], v[128:131], a[136:139], v[8:11]
    ds_read_b64_tr_b16 v[144:145], v206 offset:4096
    ds_read_b64_tr_b16 v[146:147], v206 offset:4608
    v_mfma_f32_16x16x32_bf16 v[12:15], v[128:131], a[140:143], v[12:15]
    ds_read_b64_tr_b16 v[148:149], v207 offset:4096
    ds_read_b64_tr_b16 v[150:151], v207 offset:4608
    v_mfma_f32_16x16x32_bf16 v[16:19], v[132:135], a[128:131], v[16:19]
    ds_read_b64_tr_b16 v[152:153], v208 offset:4096
    ds_read_b64_tr_b16 v[154:155], v208 offset:4608
    v_mfma_f32_16x16x32_bf16 v[20:23], v[132:135], a[132:135], v[20:23]
    buffer_load_dwordx4 v205, s[12:15], s57 offen offset:1024 lds
    v_mfma_f32_16x16x32_bf16 v[24:27], v[132:135], a[136:139], v[24:27]
    ds_read_b64_tr_b16 v[156:157], v209 offset:4096
    ds_read_b64_tr_b16 v[158:159], v209 offset:4608
    v_mfma_f32_16x16x32_bf16 v[28:31], v[132:135], a[140:143], v[28:31]
    ds_read_b128 a[144:147], v203 offset:9216
    ds_read_b128 a[148:151], v203 offset:23552
    v_mfma_f32_16x16x32_bf16 v[32:35], v[136:139], a[128:131], v[32:35]
    ds_read_b128 a[152:155], v203 offset:37888
    ds_read_b128 a[156:159], v203 offset:52224
    v_mfma_f32_16x16x32_bf16 v[36:39], v[136:139], a[132:135], v[36:39]
    buffer_load_dwordx4 v204, s[12:15], s58 offen offset:2048 lds
    v_mfma_f32_16x16x32_bf16 v[40:43], v[136:139], a[136:139], v[40:43]
    v_mfma_f32_16x16x32_bf16 v[44:47], v[136:139], a[140:143], v[44:47]
    v_mfma_f32_16x16x32_bf16 v[48:51], v[140:143], a[128:131], v[48:51]
    v_mfma_f32_16x16x32_bf16 v[52:55], v[140:143], a[132:135], v[52:55]
    buffer_load_dwordx4 v205, s[12:15], s59 offen offset:3072 lds
    v_mfma_f32_16x16x32_bf16 v[56:59], v[140:143], a[136:139], v[56:59]
    v_add_u32 v204, 0x40000, v204
    v_add_u32 v205, 0x40000, v205
    v_mfma_f32_16x16x32_bf16 v[60:63], v[140:143], a[140:143], v[60:63]
    s_waitcnt lgkmcnt(0)
    v_mfma_f32_16x16x32_bf16 v[0:3], v[144:147], a[144:147], v[0:3]
    s_add_u32 m0, s60, 4096
    s_waitcnt vmcnt(8)
    v_mfma_f32_16x16x32_bf16 v[4:7], v[144:147], a[148:151], v[4:7]
    buffer_load_dwordx4 v204, s[12:15], s56 offen offset:0 lds
    v_mfma_f32_16x16x32_bf16 v[8:11], v[144:147], a[152:155], v[8:11]
    ds_read_b64_tr_b16 v[128:129], v206 offset:8192
    ds_read_b64_tr_b16 v[130:131], v206 offset:8704
    v_mfma_f32_16x16x32_bf16 v[12:15], v[144:147], a[156:159], v[12:15]
    ds_read_b64_tr_b16 v[132:133], v207 offset:8192
    ds_read_b64_tr_b16 v[134:135], v207 offset:8704
    v_mfma_f32_16x16x32_bf16 v[16:19], v[148:151], a[144:147], v[16:19]
    ds_read_b64_tr_b16 v[136:137], v208 offset:8192
    ds_read_b64_tr_b16 v[138:139], v208 offset:8704
    v_mfma_f32_16x16x32_bf16 v[20:23], v[148:151], a[148:151], v[20:23]
    buffer_load_dwordx4 v205, s[12:15], s57 offen offset:1024 lds
    v_mfma_f32_16x16x32_bf16 v[24:27], v[148:151], a[152:155], v[24:27]
    ds_read_b64_tr_b16 v[140:141], v209 offset:8192
    ds_read_b64_tr_b16 v[142:143], v209 offset:8704
    v_mfma_f32_16x16x32_bf16 v[28:31], v[148:151], a[156:159], v[28:31]
    ds_read_b128 a[160:163], v203 offset:10240
    ds_read_b128 a[164:167], v203 offset:24576
    v_mfma_f32_16x16x32_bf16 v[32:35], v[152:155], a[144:147], v[32:35]
    ds_read_b128 a[168:171], v203 offset:38912
    ds_read_b128 a[172:175], v203 offset:53248
    v_mfma_f32_16x16x32_bf16 v[36:39], v[152:155], a[148:151], v[36:39]
    buffer_load_dwordx4 v204, s[12:15], s58 offen offset:2048 lds
    v_mfma_f32_16x16x32_bf16 v[40:43], v[152:155], a[152:155], v[40:43]
    v_mfma_f32_16x16x32_bf16 v[44:47], v[152:155], a[156:159], v[44:47]
    v_mfma_f32_16x16x32_bf16 v[48:51], v[156:159], a[144:147], v[48:51]
    v_mfma_f32_16x16x32_bf16 v[52:55], v[156:159], a[148:151], v[52:55]
    buffer_load_dwordx4 v205, s[12:15], s59 offen offset:3072 lds
    v_mfma_f32_16x16x32_bf16 v[56:59], v[156:159], a[152:155], v[56:59]
    v_add_u32 v204, 0xffcc0080, v204
    v_add_u32 v205, 0xffcc0080, v205
    v_mfma_f32_16x16x32_bf16 v[60:63], v[156:159], a[156:159], v[60:63]
    s_waitcnt lgkmcnt(0)
    v_mfma_f32_16x16x32_bf16 v[0:3], v[128:131], a[160:163], v[0:3]
    s_add_u32 m0, s60, 8192
    s_waitcnt vmcnt(8)
    v_mfma_f32_16x16x32_bf16 v[4:7], v[128:131], a[164:167], v[4:7]
    buffer_load_dwordx4 v204, s[12:15], s56 offen offset:0 lds
    v_mfma_f32_16x16x32_bf16 v[8:11], v[128:131], a[168:171], v[8:11]
    ds_read_b64_tr_b16 v[144:145], v206 offset:12288
    ds_read_b64_tr_b16 v[146:147], v206 offset:12800
    v_mfma_f32_16x16x32_bf16 v[12:15], v[128:131], a[172:175], v[12:15]
    ds_read_b64_tr_b16 v[148:149], v207 offset:12288
    ds_read_b64_tr_b16 v[150:151], v207 offset:12800
    v_mfma_f32_16x16x32_bf16 v[16:19], v[132:135], a[160:163], v[16:19]
    ds_read_b64_tr_b16 v[152:153], v208 offset:12288
    ds_read_b64_tr_b16 v[154:155], v208 offset:12800
    v_mfma_f32_16x16x32_bf16 v[20:23], v[132:135], a[164:167], v[20:23]
    buffer_load_dwordx4 v205, s[12:15], s57 offen offset:1024 lds
    v_mfma_f32_16x16x32_bf16 v[24:27], v[132:135], a[168:171], v[24:27]
    ds_read_b64_tr_b16 v[156:157], v209 offset:12288
    ds_read_b64_tr_b16 v[158:159], v209 offset:12800
    v_mfma_f32_16x16x32_bf16 v[28:31], v[132:135], a[172:175], v[28:31]
    ds_read_b128 a[176:179], v203 offset:11264
    ds_read_b128 a[180:183], v203 offset:25600
    v_mfma_f32_16x16x32_bf16 v[32:35], v[136:139], a[160:163], v[32:35]
    ds_read_b128 a[184:187], v203 offset:39936
    ds_read_b128 a[188:191], v203 offset:54272
    v_mfma_f32_16x16x32_bf16 v[36:39], v[136:139], a[164:167], v[36:39]
    buffer_load_dwordx4 v204, s[12:15], s58 offen offset:2048 lds
    v_mfma_f32_16x16x32_bf16 v[40:43], v[136:139], a[168:171], v[40:43]
    v_mfma_f32_16x16x32_bf16 v[44:47], v[136:139], a[172:175], v[44:47]
    v_mfma_f32_16x16x32_bf16 v[48:51], v[140:143], a[160:163], v[48:51]
    v_mfma_f32_16x16x32_bf16 v[52:55], v[140:143], a[164:167], v[52:55]
    buffer_load_dwordx4 v205, s[12:15], s59 offen offset:3072 lds
    v_mfma_f32_16x16x32_bf16 v[56:59], v[140:143], a[168:171], v[56:59]
    v_add_u32 v204, 0x40000, v204
    v_add_u32 v205, 0x40000, v205
    v_mfma_f32_16x16x32_bf16 v[60:63], v[140:143], a[172:175], v[60:63]
    s_waitcnt lgkmcnt(0)
    v_mfma_f32_16x16x32_bf16 v[0:3], v[144:147], a[176:179], v[0:3]
    s_add_u32 m0, s60, 12288
    s_waitcnt vmcnt(8)
    v_mfma_f32_16x16x32_bf16 v[4:7], v[144:147], a[180:183], v[4:7]
    buffer_load_dwordx4 v204, s[12:15], s56 offen offset:0 lds
    v_mfma_f32_16x16x32_bf16 v[8:11], v[144:147], a[184:187], v[8:11]
    ds_read_b64_tr_b16 v[128:129], v206 offset:0
    ds_read_b64_tr_b16 v[130:131], v206 offset:512
    v_mfma_f32_16x16x32_bf16 v[12:15], v[144:147], a[188:191], v[12:15]
    ds_read_b64_tr_b16 v[132:133], v207 offset:0
    ds_read_b64_tr_b16 v[134:135], v207 offset:512
    v_mfma_f32_16x16x32_bf16 v[16:19], v[148:151], a[176:179], v[16:19]
    ds_read_b64_tr_b16 v[136:137], v208 offset:0
    ds_read_b64_tr_b16 v[138:139], v208 offset:512
    v_mfma_f32_16x16x32_bf16 v[20:23], v[148:151], a[180:183], v[20:23]
    buffer_load_dwordx4 v205, s[12:15], s57 offen offset:1024 lds
    v_mfma_f32_16x16x32_bf16 v[24:27], v[148:151], a[184:187], v[24:27]
    ds_read_b64_tr_b16 v[140:141], v209 offset:0
    ds_read_b64_tr_b16 v[142:143], v209 offset:512
    v_mfma_f32_16x16x32_bf16 v[28:31], v[148:151], a[188:191], v[28:31]
    ds_read_b128 a[192:195], v203 offset:12288
    ds_read_b128 a[196:199], v203 offset:26624
    v_mfma_f32_16x16x32_bf16 v[32:35], v[152:155], a[176:179], v[32:35]
    ds_read_b128 a[200:203], v203 offset:40960
    ds_read_b128 a[204:207], v203 offset:55296
    v_mfma_f32_16x16x32_bf16 v[36:39], v[152:155], a[180:183], v[36:39]
    buffer_load_dwordx4 v204, s[12:15], s58 offen offset:2048 lds
    v_mfma_f32_16x16x32_bf16 v[40:43], v[152:155], a[184:187], v[40:43]
    v_mfma_f32_16x16x32_bf16 v[44:47], v[152:155], a[188:191], v[44:47]
    v_mfma_f32_16x16x32_bf16 v[48:51], v[156:159], a[176:179], v[48:51]
    v_mfma_f32_16x16x32_bf16 v[52:55], v[156:159], a[180:183], v[52:55]
    buffer_load_dwordx4 v205, s[12:15], s59 offen offset:3072 lds
    v_mfma_f32_16x16x32_bf16 v[56:59], v[156:159], a[184:187], v[56:59]
    v_add_u32 v204, 0x40000, v204
    v_add_u32 v205, 0x40000, v205
    v_mfma_f32_16x16x32_bf16 v[60:63], v[156:159], a[188:191], v[60:63]
    s_waitcnt lgkmcnt(0)
    v_mfma_f32_16x16x32_bf16 v[0:3], v[128:131], a[192:195], v[0:3]
    s_add_u32 m0, s60, 0
    s_waitcnt vmcnt(8)
    v_mfma_f32_16x16x32_bf16 v[4:7], v[128:131], a[196:199], v[4:7]
    buffer_load_dwordx4 v204, s[12:15], s56 offen offset:0 lds
    v_mfma_f32_16x16x32_bf16 v[8:11], v[128:131], a[200:203], v[8:11]
    ds_read_b64_tr_b16 v[144:145], v206 offset:4096
    ds_read_b64_tr_b16 v[146:147], v206 offset:4608
    v_mfma_f32_16x16x32_bf16 v[12:15], v[128:131], a[204:207], v[12:15]
    ds_read_b64_tr_b16 v[148:149], v207 offset:4096
    ds_read_b64_tr_b16 v[150:151], v207 offset:4608
    v_mfma_f32_16x16x32_bf16 v[16:19], v[132:135], a[192:195], v[16:19]
    ds_read_b64_tr_b16 v[152:153], v208 offset:4096
    ds_read_b64_tr_b16 v[154:155], v208 offset:4608
    v_mfma_f32_16x16x32_bf16 v[20:23], v[132:135], a[196:199], v[20:23]
    buffer_load_dwordx4 v205, s[12:15], s57 offen offset:1024 lds
    v_mfma_f32_16x16x32_bf16 v[24:27], v[132:135], a[200:203], v[24:27]
    ds_read_b64_tr_b16 v[156:157], v209 offset:4096
    ds_read_b64_tr_b16 v[158:159], v209 offset:4608
    v_mfma_f32_16x16x32_bf16 v[28:31], v[132:135], a[204:207], v[28:31]
    ds_read_b128 a[208:211], v203 offset:13312
    ds_read_b128 a[212:215], v203 offset:27648
    v_mfma_f32_16x16x32_bf16 v[32:35], v[136:139], a[192:195], v[32:35]
    ds_read_b128 a[216:219], v203 offset:41984
    ds_read_b128 a[220:223], v203 offset:56320
    v_mfma_f32_16x16x32_bf16 v[36:39], v[136:139], a[196:199], v[36:39]
    buffer_load_dwordx4 v204, s[12:15], s58 offen offset:2048 lds
    v_mfma_f32_16x16x32_bf16 v[40:43], v[136:139], a[200:203], v[40:43]
    v_mfma_f32_16x16x32_bf16 v[44:47], v[136:139], a[204:207], v[44:47]
    v_mfma_f32_16x16x32_bf16 v[48:51], v[140:143], a[192:195], v[48:51]
    v_mfma_f32_16x16x32_bf16 v[52:55], v[140:143], a[196:199], v[52:55]
    buffer_load_dwordx4 v205, s[12:15], s59 offen offset:3072 lds
    v_mfma_f32_16x16x32_bf16 v[56:59], v[140:143], a[200:203], v[56:59]
    v_add_u32 v204, 0x40000, v204
    v_add_u32 v205, 0x40000, v205
    v_mfma_f32_16x16x32_bf16 v[60:63], v[140:143], a[204:207], v[60:63]
    s_waitcnt lgkmcnt(0)
    v_mfma_f32_16x16x32_bf16 v[0:3], v[144:147], a[208:211], v[0:3]
    s_add_u32 m0, s60, 4096
    s_waitcnt vmcnt(8)
    v_mfma_f32_16x16x32_bf16 v[4:7], v[144:147], a[212:215], v[4:7]
    buffer_load_dwordx4 v204, s[12:15], s56 offen offset:0 lds
    v_mfma_f32_16x16x32_bf16 v[8:11], v[144:147], a[216:219], v[8:11]
    ds_read_b64_tr_b16 v[128:129], v206 offset:8192
    ds_read_b64_tr_b16 v[130:131], v206 offset:8704
    v_mfma_f32_16x16x32_bf16 v[12:15], v[144:147], a[220:223], v[12:15]
    ds_read_b64_tr_b16 v[132:133], v207 offset:8192
    ds_read_b64_tr_b16 v[134:135], v207 offset:8704
    v_mfma_f32_16x16x32_bf16 v[16:19], v[148:151], a[208:211], v[16:19]
    ds_read_b64_tr_b16 v[136:137], v208 offset:8192
    ds_read_b64_tr_b16 v[138:139], v208 offset:8704
    v_mfma_f32_16x16x32_bf16 v[20:23], v[148:151], a[212:215], v[20:23]
    buffer_load_dwordx4 v205, s[12:15], s57 offen offset:1024 lds
    v_mfma_f32_16x16x32_bf16 v[24:27], v[148:151], a[216:219], v[24:27]
    ds_read_b64_tr_b16 v[140:141], v209 offset:8192
    ds_read_b64_tr_b16 v[142:143], v209 offset:8704
    v_mfma_f32_16x16x32_bf16 v[28:31], v[148:151], a[220:223], v[28:31]
    v_mfma_f32_16x16x32_bf16 v[32:35], v[152:155], a[208:211], v[32:35]
    v_mfma_f32_16x16x32_bf16 v[36:39], v[152:155], a[212:215], v[36:39]
    buffer_load_dwordx4 v204, s[12:15], s58 offen offset:2048 lds
    v_mfma_f32_16x16x32_bf16 v[40:43], v[152:155], a[216:219], v[40:43]
    v_mfma_f32_16x16x32_bf16 v[44:47], v[152:155], a[220:223], v[44:47]
    v_mfma_f32_16x16x32_bf16 v[48:51], v[156:159], a[208:211], v[48:51]
    v_mfma_f32_16x16x32_bf16 v[52:55], v[156:159], a[212:215], v[52:55]
    buffer_load_dwordx4 v205, s[12:15], s59 offen offset:3072 lds
    v_mfma_f32_16x16x32_bf16 v[56:59], v[156:159], a[216:219], v[56:59]
    v_add_u32 v204, 0x40000, v204
    v_add_u32 v205, 0x40000, v205
    v_mfma_f32_16x16x32_bf16 v[60:63], v[156:159], a[220:223], v[60:63]
    s_waitcnt lgkmcnt(0)
    s_barrier
    v_mfma_f32_16x16x32_bf16 v[64:67], v[128:131], a[0:3], 0
    s_add_u32 m0, s60, 8192
    s_waitcnt vmcnt(8)
    v_mfma_f32_16x16x32_bf16 v[68:71], v[128:131], a[4:7], 0
    buffer_load_dwordx4 v204, s[12:15], s56 offen offset:0 lds
    v_mfma_f32_16x16x32_bf16 v[72:75], v[128:131], a[8:11], 0
    ds_read_b64_tr_b16 v[144:145], v206 offset:12288
    ds_read_b64_tr_b16 v[146:147], v206 offset:12800
    v_mfma_f32_16x16x32_bf16 v[76:79], v[128:131], a[12:15], 0
    ds_read_b64_tr_b16 v[148:149], v207 offset:12288
    ds_read_b64_tr_b16 v[150:151], v207 offset:12800
    v_mfma_f32_16x16x32_bf16 v[80:83], v[132:135], a[0:3], 0
    ds_read_b64_tr_b16 v[152:153], v208 offset:12288
    ds_read_b64_tr_b16 v[154:155], v208 offset:12800
    v_mfma_f32_16x16x32_bf16 v[84:87], v[132:135], a[4:7], 0
    buffer_load_dwordx4 v205, s[12:15], s57 offen offset:1024 lds
    v_mfma_f32_16x16x32_bf16 v[88:91], v[132:135], a[8:11], 0
    ds_read_b64_tr_b16 v[156:157], v209 offset:12288
    ds_read_b64_tr_b16 v[158:159], v209 offset:12800
    v_mfma_f32_16x16x32_bf16 v[92:95], v[132:135], a[12:15], 0
    v_mfma_f32_16x16x32_bf16 v[96:99], v[136:139], a[0:3], 0
    v_mfma_f32_16x16x32_bf16 v[100:103], v[136:139], a[4:7], 0
    buffer_load_dwordx4 v204, s[12:15], s58 offen offset:2048 lds
    v_mfma_f32_16x16x32_bf16 v[104:107], v[136:139], a[8:11], 0
    v_mfma_f32_16x16x32_bf16 v[108:111], v[136:139], a[12:15], 0
    v_mfma_f32_16x16x32_bf16 v[112:115], v[140:143], a[0:3], 0
    v_mfma_f32_16x16x32_bf16 v[116:119], v[140:143], a[4:7], 0
    buffer_load_dwordx4 v205, s[12:15], s59 offen offset:3072 lds
    v_mfma_f32_16x16x32_bf16 v[120:123], v[140:143], a[8:11], 0
    v_add_u32 v204, 0x40000, v204
    v_add_u32 v205, 0x40000, v205
    v_mfma_f32_16x16x32_bf16 v[124:127], v[140:143], a[12:15], 0
    s_waitcnt lgkmcnt(0)
    v_mfma_f32_16x16x32_bf16 v[64:67], v[144:147], a[16:19], v[64:67]
    s_add_u32 m0, s60, 12288
    s_waitcnt vmcnt(8)
    v_mfma_f32_16x16x32_bf16 v[68:71], v[144:147], a[20:23], v[68:71]
    buffer_load_dwordx4 v204, s[12:15], s56 offen offset:0 lds
    v_mfma_f32_16x16x32_bf16 v[72:75], v[144:147], a[24:27], v[72:75]
    ds_read_b64_tr_b16 v[128:129], v206 offset:0
    ds_read_b64_tr_b16 v[130:131], v206 offset:512
    v_mfma_f32_16x16x32_bf16 v[76:79], v[144:147], a[28:31], v[76:79]
    ds_read_b64_tr_b16 v[132:133], v207 offset:0
    ds_read_b64_tr_b16 v[134:135], v207 offset:512
    v_mfma_f32_16x16x32_bf16 v[80:83], v[148:151], a[16:19], v[80:83]
    ds_read_b64_tr_b16 v[136:137], v208 offset:0
    ds_read_b64_tr_b16 v[138:139], v208 offset:512
    v_mfma_f32_16x16x32_bf16 v[84:87], v[148:151], a[20:23], v[84:87]
    buffer_load_dwordx4 v205, s[12:15], s57 offen offset:1024 lds
    v_mfma_f32_16x16x32_bf16 v[88:91], v[148:151], a[24:27], v[88:91]
    ds_read_b64_tr_b16 v[140:141], v209 offset:0
    ds_read_b64_tr_b16 v[142:143], v209 offset:512
    v_mfma_f32_16x16x32_bf16 v[92:95], v[148:151], a[28:31], v[92:95]
    v_pk_mul_f32 v[0:1], v[0:1], v[244:245] op_sel_hi:[1,0]
    v_pk_mul_f32 v[2:3], v[2:3], v[244:245] op_sel_hi:[1,0]
    v_mfma_f32_16x16x32_bf16 v[96:99], v[152:155], a[16:19], v[96:99]
    v_cvt_pk_bf16_f32 v176, v0, v1
    v_cvt_pk_bf16_f32 v177, v2, v3
    v_mfma_f32_16x16x32_bf16 v[100:103], v[152:155], a[20:23], v[100:103]
    buffer_load_dwordx4 v204, s[12:15], s58 offen offset:2048 lds
    v_mfma_f32_16x16x32_bf16 v[104:107], v[152:155], a[24:27], v[104:107]
    ds_write_b64 v212, v[176:177] offset:0
    v_pk_mul_f32 v[16:17], v[16:17], v[244:245] op_sel_hi:[1,0]
    v_mfma_f32_16x16x32_bf16 v[108:111], v[152:155], a[28:31], v[108:111]
    v_pk_mul_f32 v[18:19], v[18:19], v[244:245] op_sel_hi:[1,0]
    v_mfma_f32_16x16x32_bf16 v[112:115], v[156:159], a[16:19], v[112:115]
    v_mfma_f32_16x16x32_bf16 v[116:119], v[156:159], a[20:23], v[116:119]
    buffer_load_dwordx4 v205, s[12:15], s59 offen offset:3072 lds
    v_mfma_f32_16x16x32_bf16 v[120:123], v[156:159], a[24:27], v[120:123]
    v_add_u32 v204, 0x40000, v204
    v_add_u32 v205, 0x40000, v205
    v_mfma_f32_16x16x32_bf16 v[124:127], v[156:159], a[28:31], v[124:127]
    s_waitcnt lgkmcnt(1)
    v_mfma_f32_16x16x32_bf16 v[64:67], v[128:131], a[32:35], v[64:67]
    s_add_u32 m0, s60, 0
    s_waitcnt vmcnt(8)
    v_mfma_f32_16x16x32_bf16 v[68:71], v[128:131], a[36:39], v[68:71]
    buffer_load_dwordx4 v204, s[12:15], s56 offen offset:0 lds
    v_mfma_f32_16x16x32_bf16 v[72:75], v[128:131], a[40:43], v[72:75]
    ds_read_b64_tr_b16 v[144:145], v206 offset:4096
    ds_read_b64_tr_b16 v[146:147], v206 offset:4608
    v_mfma_f32_16x16x32_bf16 v[76:79], v[128:131], a[44:47], v[76:79]
    ds_read_b64_tr_b16 v[148:149], v207 offset:4096
    ds_read_b64_tr_b16 v[150:151], v207 offset:4608
    v_mfma_f32_16x16x32_bf16 v[80:83], v[132:135], a[32:35], v[80:83]
    ds_read_b64_tr_b16 v[152:153], v208 offset:4096
    ds_read_b64_tr_b16 v[154:155], v208 offset:4608
    v_mfma_f32_16x16x32_bf16 v[84:87], v[132:135], a[36:39], v[84:87]
    buffer_load_dwordx4 v205, s[12:15], s57 offen offset:1024 lds
    v_mfma_f32_16x16x32_bf16 v[88:91], v[132:135], a[40:43], v[88:91]
    ds_read_b64_tr_b16 v[156:157], v209 offset:4096
    ds_read_b64_tr_b16 v[158:159], v209 offset:4608
    v_mfma_f32_16x16x32_bf16 v[92:95], v[132:135], a[44:47], v[92:95]
    v_cvt_pk_bf16_f32 v178, v16, v17
    v_cvt_pk_bf16_f32 v179, v18, v19
    v_mfma_f32_16x16x32_bf16 v[96:99], v[136:139], a[32:35], v[96:99]
    ds_write_b64 v212, v[178:179] offset:512
    v_pk_mul_f32 v[32:33], v[32:33], v[244:245] op_sel_hi:[1,0]
    v_mfma_f32_16x16x32_bf16 v[100:103], v[136:139], a[36:39], v[100:103]
    buffer_load_dwordx4 v204, s[12:15], s58 offen offset:2048 lds
    v_mfma_f32_16x16x32_bf16 v[104:107], v[136:139], a[40:43], v[104:107]
    v_pk_mul_f32 v[34:35], v[34:35], v[244:245] op_sel_hi:[1,0]
    v_cvt_pk_bf16_f32 v180, v32, v33
    v_mfma_f32_16x16x32_bf16 v[108:111], v[136:139], a[44:47], v[108:111]
    v_cvt_pk_bf16_f32 v181, v34, v35
    v_mfma_f32_16x16x32_bf16 v[112:115], v[140:143], a[32:35], v[112:115]
    v_mfma_f32_16x16x32_bf16 v[116:119], v[140:143], a[36:39], v[116:119]
    buffer_load_dwordx4 v205, s[12:15], s59 offen offset:3072 lds
    v_mfma_f32_16x16x32_bf16 v[120:123], v[140:143], a[40:43], v[120:123]
    v_add_u32 v204, 0x40000, v204
    v_add_u32 v205, 0x40000, v205
    v_mfma_f32_16x16x32_bf16 v[124:127], v[140:143], a[44:47], v[124:127]
    s_waitcnt lgkmcnt(1)
    v_mfma_f32_16x16x32_bf16 v[64:67], v[144:147], a[48:51], v[64:67]
    s_add_u32 m0, s60, 4096
    s_waitcnt vmcnt(8)
    v_mfma_f32_16x16x32_bf16 v[68:71], v[144:147], a[52:55], v[68:71]
    buffer_load_dwordx4 v204, s[12:15], s56 offen offset:0 lds
    v_mfma_f32_16x16x32_bf16 v[72:75], v[144:147], a[56:59], v[72:75]
    ds_read_b64_tr_b16 v[128:129], v206 offset:8192
    ds_read_b64_tr_b16 v[130:131], v206 offset:8704
    v_mfma_f32_16x16x32_bf16 v[76:79], v[144:147], a[60:63], v[76:79]
    ds_read_b64_tr_b16 v[132:133], v207 offset:8192
    ds_read_b64_tr_b16 v[134:135], v207 offset:8704
    v_mfma_f32_16x16x32_bf16 v[80:83], v[148:151], a[48:51], v[80:83]
    ds_read_b64_tr_b16 v[136:137], v208 offset:8192
    ds_read_b64_tr_b16 v[138:139], v208 offset:8704
    v_mfma_f32_16x16x32_bf16 v[84:87], v[148:151], a[52:55], v[84:87]
    buffer_load_dwordx4 v205, s[12:15], s57 offen offset:1024 lds
    v_mfma_f32_16x16x32_bf16 v[88:91], v[148:151], a[56:59], v[88:91]
    ds_read_b64_tr_b16 v[140:141], v209 offset:8192
    ds_read_b64_tr_b16 v[142:143], v209 offset:8704
    v_mfma_f32_16x16x32_bf16 v[92:95], v[148:151], a[60:63], v[92:95]
    ds_write_b64 v212, v[180:181] offset:1024
    v_pk_mul_f32 v[48:49], v[48:49], v[244:245] op_sel_hi:[1,0]
    v_mfma_f32_16x16x32_bf16 v[96:99], v[152:155], a[48:51], v[96:99]
    v_pk_mul_f32 v[50:51], v[50:51], v[244:245] op_sel_hi:[1,0]
    v_cvt_pk_bf16_f32 v182, v48, v49
    v_mfma_f32_16x16x32_bf16 v[100:103], v[152:155], a[52:55], v[100:103]
    buffer_load_dwordx4 v204, s[12:15], s58 offen offset:2048 lds
    v_mfma_f32_16x16x32_bf16 v[104:107], v[152:155], a[56:59], v[104:107]
    v_cvt_pk_bf16_f32 v183, v50, v51
    ds_write_b64 v212, v[182:183] offset:1536
    v_mfma_f32_16x16x32_bf16 v[108:111], v[152:155], a[60:63], v[108:111]
    v_pk_mul_f32 v[4:5], v[4:5], v[244:245] op_sel_hi:[1,0]
    v_mfma_f32_16x16x32_bf16 v[112:115], v[156:159], a[48:51], v[112:115]
    v_mfma_f32_16x16x32_bf16 v[116:119], v[156:159], a[52:55], v[116:119]
    buffer_load_dwordx4 v205, s[12:15], s59 offen offset:3072 lds
    v_mfma_f32_16x16x32_bf16 v[120:123], v[156:159], a[56:59], v[120:123]
    v_add_u32 v204, 0x40000, v204
    v_add_u32 v205, 0x40000, v205
    v_mfma_f32_16x16x32_bf16 v[124:127], v[156:159], a[60:63], v[124:127]
    s_waitcnt lgkmcnt(2)
    v_mfma_f32_16x16x32_bf16 v[64:67], v[128:131], a[64:67], v[64:67]
    s_add_u32 m0, s60, 8192
    s_waitcnt vmcnt(8)
    v_mfma_f32_16x16x32_bf16 v[68:71], v[128:131], a[68:71], v[68:71]
    buffer_load_dwordx4 v204, s[12:15], s56 offen offset:0 lds
    v_mfma_f32_16x16x32_bf16 v[72:75], v[128:131], a[72:75], v[72:75]
    ds_read_b64_tr_b16 v[144:145], v206 offset:12288
    ds_read_b64_tr_b16 v[146:147], v206 offset:12800
    v_mfma_f32_16x16x32_bf16 v[76:79], v[128:131], a[76:79], v[76:79]
    ds_read_b64_tr_b16 v[148:149], v207 offset:12288
    ds_read_b64_tr_b16 v[150:151], v207 offset:12800
    v_mfma_f32_16x16x32_bf16 v[80:83], v[132:135], a[64:67], v[80:83]
    ds_read_b64_tr_b16 v[152:153], v208 offset:12288
    ds_read_b64_tr_b16 v[154:155], v208 offset:12800
    v_mfma_f32_16x16x32_bf16 v[84:87], v[132:135], a[68:71], v[84:87]
    buffer_load_dwordx4 v205, s[12:15], s57 offen offset:1024 lds
    v_mfma_f32_16x16x32_bf16 v[88:91], v[132:135], a[72:75], v[88:91]
    ds_read_b64_tr_b16 v[156:157], v209 offset:12288
    ds_read_b64_tr_b16 v[158:159], v209 offset:12800
    v_mfma_f32_16x16x32_bf16 v[92:95], v[132:135], a[76:79], v[92:95]
    v_pk_mul_f32 v[6:7], v[6:7], v[244:245] op_sel_hi:[1,0]
    v_cvt_pk_bf16_f32 v176, v4, v5
    v_mfma_f32_16x16x32_bf16 v[96:99], v[136:139], a[64:67], v[96:99]
    v_cvt_pk_bf16_f32 v177, v6, v7
    ds_write_b64 v212, v[176:177] offset:2048
    v_mfma_f32_16x16x32_bf16 v[100:103], v[136:139], a[68:71], v[100:103]
    buffer_load_dwordx4 v204, s[12:15], s58 offen offset:2048 lds
    v_mfma_f32_16x16x32_bf16 v[104:107], v[136:139], a[72:75], v[104:107]
    v_pk_mul_f32 v[20:21], v[20:21], v[244:245] op_sel_hi:[1,0]
    v_pk_mul_f32 v[22:23], v[22:23], v[244:245] op_sel_hi:[1,0]
    v_mfma_f32_16x16x32_bf16 v[108:111], v[136:139], a[76:79], v[108:111]
    v_cvt_pk_bf16_f32 v178, v20, v21
    v_mfma_f32_16x16x32_bf16 v[112:115], v[140:143], a[64:67], v[112:115]
    v_mfma_f32_16x16x32_bf16 v[116:119], v[140:143], a[68:71], v[116:119]
    buffer_load_dwordx4 v205, s[12:15], s59 offen offset:3072 lds
    v_mfma_f32_16x16x32_bf16 v[120:123], v[140:143], a[72:75], v[120:123]
    v_add_u32 v204, 0x40000, v204
    v_add_u32 v205, 0x40000, v205
    v_mfma_f32_16x16x32_bf16 v[124:127], v[140:143], a[76:79], v[124:127]
    s_waitcnt lgkmcnt(1)
    v_mfma_f32_16x16x32_bf16 v[64:67], v[144:147], a[80:83], v[64:67]
    s_add_u32 m0, s60, 12288
    s_waitcnt vmcnt(8)
    v_mfma_f32_16x16x32_bf16 v[68:71], v[144:147], a[84:87], v[68:71]
    buffer_load_dwordx4 v204, s[12:15], s56 offen offset:0 lds
    v_mfma_f32_16x16x32_bf16 v[72:75], v[144:147], a[88:91], v[72:75]
    ds_read_b64_tr_b16 v[128:129], v206 offset:0
    ds_read_b64_tr_b16 v[130:131], v206 offset:512
    v_mfma_f32_16x16x32_bf16 v[76:79], v[144:147], a[92:95], v[76:79]
    ds_read_b64_tr_b16 v[132:133], v207 offset:0
    ds_read_b64_tr_b16 v[134:135], v207 offset:512
    v_mfma_f32_16x16x32_bf16 v[80:83], v[148:151], a[80:83], v[80:83]
    ds_read_b64_tr_b16 v[136:137], v208 offset:0
    ds_read_b64_tr_b16 v[138:139], v208 offset:512
    v_mfma_f32_16x16x32_bf16 v[84:87], v[148:151], a[84:87], v[84:87]
    buffer_load_dwordx4 v205, s[12:15], s57 offen offset:1024 lds
    v_mfma_f32_16x16x32_bf16 v[88:91], v[148:151], a[88:91], v[88:91]
    ds_read_b64_tr_b16 v[140:141], v209 offset:0
    ds_read_b64_tr_b16 v[142:143], v209 offset:512
    v_mfma_f32_16x16x32_bf16 v[92:95], v[148:151], a[92:95], v[92:95]
    v_cvt_pk_bf16_f32 v179, v22, v23
    ds_write_b64 v212, v[178:179] offset:2560
    v_mfma_f32_16x16x32_bf16 v[96:99], v[152:155], a[80:83], v[96:99]
    v_pk_mul_f32 v[36:37], v[36:37], v[244:245] op_sel_hi:[1,0]
    v_pk_mul_f32 v[38:39], v[38:39], v[244:245] op_sel_hi:[1,0]
    v_mfma_f32_16x16x32_bf16 v[100:103], v[152:155], a[84:87], v[100:103]
    buffer_load_dwordx4 v204, s[12:15], s58 offen offset:2048 lds
    v_mfma_f32_16x16x32_bf16 v[104:107], v[152:155], a[88:91], v[104:107]
    v_cvt_pk_bf16_f32 v180, v36, v37
    v_cvt_pk_bf16_f32 v181, v38, v39
    v_mfma_f32_16x16x32_bf16 v[108:111], v[152:155], a[92:95], v[108:111]
    ds_write_b64 v212, v[180:181] offset:3072
    v_mfma_f32_16x16x32_bf16 v[112:115], v[156:159], a[80:83], v[112:115]
    v_mfma_f32_16x16x32_bf16 v[116:119], v[156:159], a[84:87], v[116:119]
    buffer_load_dwordx4 v205, s[12:15], s59 offen offset:3072 lds
    v_mfma_f32_16x16x32_bf16 v[120:123], v[156:159], a[88:91], v[120:123]
    v_add_u32 v204, 0x40000, v204
    v_add_u32 v205, 0x40000, v205
    v_mfma_f32_16x16x32_bf16 v[124:127], v[156:159], a[92:95], v[124:127]
    s_waitcnt lgkmcnt(2)
    v_mfma_f32_16x16x32_bf16 v[64:67], v[128:131], a[96:99], v[64:67]
    s_add_u32 m0, s60, 0
    s_waitcnt vmcnt(8)
    v_mfma_f32_16x16x32_bf16 v[68:71], v[128:131], a[100:103], v[68:71]
    buffer_load_dwordx4 v204, s[12:15], s56 offen offset:0 lds
    v_mfma_f32_16x16x32_bf16 v[72:75], v[128:131], a[104:107], v[72:75]
    ds_read_b64_tr_b16 v[144:145], v206 offset:4096
    ds_read_b64_tr_b16 v[146:147], v206 offset:4608
    v_mfma_f32_16x16x32_bf16 v[76:79], v[128:131], a[108:111], v[76:79]
    ds_read_b64_tr_b16 v[148:149], v207 offset:4096
    ds_read_b64_tr_b16 v[150:151], v207 offset:4608
    v_mfma_f32_16x16x32_bf16 v[80:83], v[132:135], a[96:99], v[80:83]
    ds_read_b64_tr_b16 v[152:153], v208 offset:4096
    ds_read_b64_tr_b16 v[154:155], v208 offset:4608
    v_mfma_f32_16x16x32_bf16 v[84:87], v[132:135], a[100:103], v[84:87]
    buffer_load_dwordx4 v205, s[12:15], s57 offen offset:1024 lds
    v_mfma_f32_16x16x32_bf16 v[88:91], v[132:135], a[104:107], v[88:91]
    ds_read_b64_tr_b16 v[156:157], v209 offset:4096
    ds_read_b64_tr_b16 v[158:159], v209 offset:4608
    v_mfma_f32_16x16x32_bf16 v[92:95], v[132:135], a[108:111], v[92:95]
    v_pk_mul_f32 v[52:53], v[52:53], v[244:245] op_sel_hi:[1,0]
    v_pk_mul_f32 v[54:55], v[54:55], v[244:245] op_sel_hi:[1,0]
    v_mfma_f32_16x16x32_bf16 v[96:99], v[136:139], a[96:99], v[96:99]
    v_cvt_pk_bf16_f32 v182, v52, v53
    v_cvt_pk_bf16_f32 v183, v54, v55
    v_mfma_f32_16x16x32_bf16 v[100:103], v[136:139], a[100:103], v[100:103]
    buffer_load_dwordx4 v204, s[12:15], s58 offen offset:2048 lds
    v_mfma_f32_16x16x32_bf16 v[104:107], v[136:139], a[104:107], v[104:107]
    ds_write_b64 v212, v[182:183] offset:3584
    v_pk_mul_f32 v[8:9], v[8:9], v[244:245] op_sel_hi:[1,0]
    v_mfma_f32_16x16x32_bf16 v[108:111], v[136:139], a[108:111], v[108:111]
    v_pk_mul_f32 v[10:11], v[10:11], v[244:245] op_sel_hi:[1,0]
    v_mfma_f32_16x16x32_bf16 v[112:115], v[140:143], a[96:99], v[112:115]
    v_mfma_f32_16x16x32_bf16 v[116:119], v[140:143], a[100:103], v[116:119]
    buffer_load_dwordx4 v205, s[12:15], s59 offen offset:3072 lds
    v_mfma_f32_16x16x32_bf16 v[120:123], v[140:143], a[104:107], v[120:123]
    v_add_u32 v204, 0x40000, v204
    v_add_u32 v205, 0x40000, v205
    v_mfma_f32_16x16x32_bf16 v[124:127], v[140:143], a[108:111], v[124:127]
    s_waitcnt lgkmcnt(1)
    v_mfma_f32_16x16x32_bf16 v[64:67], v[144:147], a[112:115], v[64:67]
    s_add_u32 m0, s60, 4096
    s_waitcnt vmcnt(8)
    v_mfma_f32_16x16x32_bf16 v[68:71], v[144:147], a[116:119], v[68:71]
    buffer_load_dwordx4 v204, s[12:15], s56 offen offset:0 lds
    v_mfma_f32_16x16x32_bf16 v[72:75], v[144:147], a[120:123], v[72:75]
    ds_read_b64_tr_b16 v[128:129], v206 offset:8192
    ds_read_b64_tr_b16 v[130:131], v206 offset:8704
    v_mfma_f32_16x16x32_bf16 v[76:79], v[144:147], a[124:127], v[76:79]
    ds_read_b64_tr_b16 v[132:133], v207 offset:8192
    ds_read_b64_tr_b16 v[134:135], v207 offset:8704
    v_mfma_f32_16x16x32_bf16 v[80:83], v[148:151], a[112:115], v[80:83]
    ds_read_b64_tr_b16 v[136:137], v208 offset:8192
    ds_read_b64_tr_b16 v[138:139], v208 offset:8704
    v_mfma_f32_16x16x32_bf16 v[84:87], v[148:151], a[116:119], v[84:87]
    buffer_load_dwordx4 v205, s[12:15], s57 offen offset:1024 lds
    v_mfma_f32_16x16x32_bf16 v[88:91], v[148:151], a[120:123], v[88:91]
    ds_read_b64_tr_b16 v[140:141], v209 offset:8192
    ds_read_b64_tr_b16 v[142:143], v209 offset:8704
    v_mfma_f32_16x16x32_bf16 v[92:95], v[148:151], a[124:127], v[92:95]
    v_cvt_pk_bf16_f32 v176, v8, v9
    v_cvt_pk_bf16_f32 v177, v10, v11
    v_mfma_f32_16x16x32_bf16 v[96:99], v[152:155], a[112:115], v[96:99]
    ds_write_b64 v212, v[176:177] offset:4096
    v_pk_mul_f32 v[24:25], v[24:25], v[244:245] op_sel_hi:[1,0]
    v_mfma_f32_16x16x32_bf16 v[100:103], v[152:155], a[116:119], v[100:103]
    buffer_load_dwordx4 v204, s[12:15], s58 offen offset:2048 lds
    v_mfma_f32_16x16x32_bf16 v[104:107], v[152:155], a[120:123], v[104:107]
    v_pk_mul_f32 v[26:27], v[26:27], v[244:245] op_sel_hi:[1,0]
    v_cvt_pk_bf16_f32 v178, v24, v25
    v_mfma_f32_16x16x32_bf16 v[108:111], v[152:155], a[124:127], v[108:111]
    v_cvt_pk_bf16_f32 v179, v26, v27
    v_mfma_f32_16x16x32_bf16 v[112:115], v[156:159], a[112:115], v[112:115]
    v_mfma_f32_16x16x32_bf16 v[116:119], v[156:159], a[116:119], v[116:119]
    buffer_load_dwordx4 v205, s[12:15], s59 offen offset:3072 lds
    v_mfma_f32_16x16x32_bf16 v[120:123], v[156:159], a[120:123], v[120:123]
    v_add_u32 v204, 0x40000, v204
    v_add_u32 v205, 0x40000, v205
    v_mfma_f32_16x16x32_bf16 v[124:127], v[156:159], a[124:127], v[124:127]
    s_waitcnt lgkmcnt(1)
    v_mfma_f32_16x16x32_bf16 v[64:67], v[128:131], a[128:131], v[64:67]
    s_add_u32 m0, s60, 8192
    s_waitcnt vmcnt(8)
    v_mfma_f32_16x16x32_bf16 v[68:71], v[128:131], a[132:135], v[68:71]
    buffer_load_dwordx4 v204, s[12:15], s56 offen offset:0 lds
    v_mfma_f32_16x16x32_bf16 v[72:75], v[128:131], a[136:139], v[72:75]
    ds_read_b64_tr_b16 v[144:145], v206 offset:12288
    ds_read_b64_tr_b16 v[146:147], v206 offset:12800
    v_mfma_f32_16x16x32_bf16 v[76:79], v[128:131], a[140:143], v[76:79]
    ds_read_b64_tr_b16 v[148:149], v207 offset:12288
    ds_read_b64_tr_b16 v[150:151], v207 offset:12800
    v_mfma_f32_16x16x32_bf16 v[80:83], v[132:135], a[128:131], v[80:83]
    ds_read_b64_tr_b16 v[152:153], v208 offset:12288
    ds_read_b64_tr_b16 v[154:155], v208 offset:12800
    v_mfma_f32_16x16x32_bf16 v[84:87], v[132:135], a[132:135], v[84:87]
    buffer_load_dwordx4 v205, s[12:15], s57 offen offset:1024 lds
    v_mfma_f32_16x16x32_bf16 v[88:91], v[132:135], a[136:139], v[88:91]
    ds_read_b64_tr_b16 v[156:157], v209 offset:12288
    ds_read_b64_tr_b16 v[158:159], v209 offset:12800
    v_mfma_f32_16x16x32_bf16 v[92:95], v[132:135], a[140:143], v[92:95]
    ds_write_b64 v212, v[178:179] offset:4608
    v_pk_mul_f32 v[40:41], v[40:41], v[244:245] op_sel_hi:[1,0]
    v_mfma_f32_16x16x32_bf16 v[96:99], v[136:139], a[128:131], v[96:99]
    v_pk_mul_f32 v[42:43], v[42:43], v[244:245] op_sel_hi:[1,0]
    v_cvt_pk_bf16_f32 v180, v40, v41
    v_mfma_f32_16x16x32_bf16 v[100:103], v[136:139], a[132:135], v[100:103]
    buffer_load_dwordx4 v204, s[12:15], s58 offen offset:2048 lds
    v_mfma_f32_16x16x32_bf16 v[104:107], v[136:139], a[136:139], v[104:107]
    v_cvt_pk_bf16_f32 v181, v42, v43
    ds_write_b64 v212, v[180:181] offset:5120
    v_mfma_f32_16x16x32_bf16 v[108:111], v[136:139], a[140:143], v[108:111]
    v_pk_mul_f32 v[56:57], v[56:57], v[244:245] op_sel_hi:[1,0]
    v_mfma_f32_16x16x32_bf16 v[112:115], v[140:143], a[128:131], v[112:115]
    v_mfma_f32_16x16x32_bf16 v[116:119], v[140:143], a[132:135], v[116:119]
    buffer_load_dwordx4 v205, s[12:15], s59 offen offset:3072 lds
    v_mfma_f32_16x16x32_bf16 v[120:123], v[140:143], a[136:139], v[120:123]
    v_add_u32 v204, 0x40000, v204
    v_add_u32 v205, 0x40000, v205
    v_mfma_f32_16x16x32_bf16 v[124:127], v[140:143], a[140:143], v[124:127]
    s_waitcnt lgkmcnt(2)
    v_mfma_f32_16x16x32_bf16 v[64:67], v[144:147], a[144:147], v[64:67]
    s_add_u32 m0, s60, 12288
    s_waitcnt vmcnt(8)
    v_mfma_f32_16x16x32_bf16 v[68:71], v[144:147], a[148:151], v[68:71]
    buffer_load_dwordx4 v204, s[12:15], s56 offen offset:0 lds
    v_mfma_f32_16x16x32_bf16 v[72:75], v[144:147], a[152:155], v[72:75]
    ds_read_b64_tr_b16 v[128:129], v206 offset:0
    ds_read_b64_tr_b16 v[130:131], v206 offset:512
    v_mfma_f32_16x16x32_bf16 v[76:79], v[144:147], a[156:159], v[76:79]
    ds_read_b64_tr_b16 v[132:133], v207 offset:0
    ds_read_b64_tr_b16 v[134:135], v207 offset:512
    v_mfma_f32_16x16x32_bf16 v[80:83], v[148:151], a[144:147], v[80:83]
    ds_read_b64_tr_b16 v[136:137], v208 offset:0
    ds_read_b64_tr_b16 v[138:139], v208 offset:512
    v_mfma_f32_16x16x32_bf16 v[84:87], v[148:151], a[148:151], v[84:87]
    buffer_load_dwordx4 v205, s[12:15], s57 offen offset:1024 lds
    v_mfma_f32_16x16x32_bf16 v[88:91], v[148:151], a[152:155], v[88:91]
    ds_read_b64_tr_b16 v[140:141], v209 offset:0
    ds_read_b64_tr_b16 v[142:143], v209 offset:512
    v_mfma_f32_16x16x32_bf16 v[92:95], v[148:151], a[156:159], v[92:95]
    v_pk_mul_f32 v[58:59], v[58:59], v[244:245] op_sel_hi:[1,0]
    v_cvt_pk_bf16_f32 v182, v56, v57
    v_mfma_f32_16x16x32_bf16 v[96:99], v[152:155], a[144:147], v[96:99]
    v_cvt_pk_bf16_f32 v183, v58, v59
    ds_write_b64 v212, v[182:183] offset:5632
    v_mfma_f32_16x16x32_bf16 v[100:103], v[152:155], a[148:151], v[100:103]
    buffer_load_dwordx4 v204, s[12:15], s58 offen offset:2048 lds
    v_mfma_f32_16x16x32_bf16 v[104:107], v[152:155], a[152:155], v[104:107]
    v_pk_mul_f32 v[12:13], v[12:13], v[244:245] op_sel_hi:[1,0]
    v_pk_mul_f32 v[14:15], v[14:15], v[244:245] op_sel_hi:[1,0]
    v_mfma_f32_16x16x32_bf16 v[108:111], v[152:155], a[156:159], v[108:111]
    v_cvt_pk_bf16_f32 v176, v12, v13
    v_mfma_f32_16x16x32_bf16 v[112:115], v[156:159], a[144:147], v[112:115]
    v_mfma_f32_16x16x32_bf16 v[116:119], v[156:159], a[148:151], v[116:119]
    buffer_load_dwordx4 v205, s[12:15], s59 offen offset:3072 lds
    v_mfma_f32_16x16x32_bf16 v[120:123], v[156:159], a[152:155], v[120:123]
    v_add_u32 v204, 0xffcc0080, v204
    v_add_u32 v205, 0xffcc0080, v205
    v_mfma_f32_16x16x32_bf16 v[124:127], v[156:159], a[156:159], v[124:127]
    s_waitcnt lgkmcnt(1)
    v_mfma_f32_16x16x32_bf16 v[64:67], v[128:131], a[160:163], v[64:67]
    s_add_u32 m0, s52, 32768
    s_waitcnt vmcnt(8)
    v_mfma_f32_16x16x32_bf16 v[68:71], v[128:131], a[164:167], v[68:71]
    buffer_load_dwordx4 v222, s[4:7], s44 offen offset:0 lds
    v_mfma_f32_16x16x32_bf16 v[72:75], v[128:131], a[168:171], v[72:75]
    ds_read_b64_tr_b16 v[144:145], v206 offset:4096
    ds_read_b64_tr_b16 v[146:147], v206 offset:4608
    v_mfma_f32_16x16x32_bf16 v[76:79], v[128:131], a[172:175], v[76:79]
    ds_read_b64_tr_b16 v[148:149], v207 offset:4096
    ds_read_b64_tr_b16 v[150:151], v207 offset:4608
    v_mfma_f32_16x16x32_bf16 v[80:83], v[132:135], a[160:163], v[80:83]
    ds_read_b64_tr_b16 v[152:153], v208 offset:4096
    ds_read_b64_tr_b16 v[154:155], v208 offset:4608
    v_mfma_f32_16x16x32_bf16 v[84:87], v[132:135], a[164:167], v[84:87]
    buffer_load_dwordx4 v222, s[4:7], s45 offen offset:1024 lds
    v_mfma_f32_16x16x32_bf16 v[88:91], v[132:135], a[168:171], v[88:91]
    ds_read_b64_tr_b16 v[156:157], v209 offset:4096
    ds_read_b64_tr_b16 v[158:159], v209 offset:4608
    v_mfma_f32_16x16x32_bf16 v[92:95], v[132:135], a[172:175], v[92:95]
    v_cvt_pk_bf16_f32 v177, v14, v15
    ds_write_b64 v212, v[176:177] offset:6144
    v_mfma_f32_16x16x32_bf16 v[96:99], v[136:139], a[160:163], v[96:99]
    v_pk_mul_f32 v[28:29], v[28:29], v[244:245] op_sel_hi:[1,0]
    v_pk_mul_f32 v[30:31], v[30:31], v[244:245] op_sel_hi:[1,0]
    v_mfma_f32_16x16x32_bf16 v[100:103], v[136:139], a[164:167], v[100:103]
    buffer_load_dwordx4 v222, s[4:7], s46 offen offset:2048 lds
    v_mfma_f32_16x16x32_bf16 v[104:107], v[136:139], a[168:171], v[104:107]
    v_cvt_pk_bf16_f32 v178, v28, v29
    v_cvt_pk_bf16_f32 v179, v30, v31
    v_mfma_f32_16x16x32_bf16 v[108:111], v[136:139], a[172:175], v[108:111]
    ds_write_b64 v212, v[178:179] offset:6656
    v_mfma_f32_16x16x32_bf16 v[112:115], v[140:143], a[160:163], v[112:115]
    v_mfma_f32_16x16x32_bf16 v[116:119], v[140:143], a[164:167], v[116:119]
    buffer_load_dwordx4 v222, s[4:7], s47 offen offset:3072 lds
    v_mfma_f32_16x16x32_bf16 v[120:123], v[140:143], a[168:171], v[120:123]
    v_mfma_f32_16x16x32_bf16 v[124:127], v[140:143], a[172:175], v[124:127]
    s_waitcnt lgkmcnt(2)
    v_mfma_f32_16x16x32_bf16 v[64:67], v[144:147], a[176:179], v[64:67]
    s_add_u32 m0, s52, 49152
    s_waitcnt vmcnt(8)
    v_mfma_f32_16x16x32_bf16 v[68:71], v[144:147], a[180:183], v[68:71]
    buffer_load_dwordx4 v222, s[4:7], s48 offen offset:0 lds
    v_mfma_f32_16x16x32_bf16 v[72:75], v[144:147], a[184:187], v[72:75]
    ds_read_b64_tr_b16 v[128:129], v206 offset:8192
    ds_read_b64_tr_b16 v[130:131], v206 offset:8704
    v_mfma_f32_16x16x32_bf16 v[76:79], v[144:147], a[188:191], v[76:79]
    ds_read_b64_tr_b16 v[132:133], v207 offset:8192
    ds_read_b64_tr_b16 v[134:135], v207 offset:8704
    v_mfma_f32_16x16x32_bf16 v[80:83], v[148:151], a[176:179], v[80:83]
    ds_read_b64_tr_b16 v[136:137], v208 offset:8192
    ds_read_b64_tr_b16 v[138:139], v208 offset:8704
    v_mfma_f32_16x16x32_bf16 v[84:87], v[148:151], a[180:183], v[84:87]
    buffer_load_dwordx4 v222, s[4:7], s49 offen offset:1024 lds
    v_mfma_f32_16x16x32_bf16 v[88:91], v[148:151], a[184:187], v[88:91]
    ds_read_b64_tr_b16 v[140:141], v209 offset:8192
    ds_read_b64_tr_b16 v[142:143], v209 offset:8704
    v_mfma_f32_16x16x32_bf16 v[92:95], v[148:151], a[188:191], v[92:95]
    v_pk_mul_f32 v[44:45], v[44:45], v[244:245] op_sel_hi:[1,0]
    v_pk_mul_f32 v[46:47], v[46:47], v[244:245] op_sel_hi:[1,0]
    v_mfma_f32_16x16x32_bf16 v[96:99], v[152:155], a[176:179], v[96:99]
    v_cvt_pk_bf16_f32 v180, v44, v45
    v_cvt_pk_bf16_f32 v181, v46, v47
    v_mfma_f32_16x16x32_bf16 v[100:103], v[152:155], a[180:183], v[100:103]
    buffer_load_dwordx4 v222, s[4:7], s50 offen offset:2048 lds
    v_mfma_f32_16x16x32_bf16 v[104:107], v[152:155], a[184:187], v[104:107]
    ds_write_b64 v212, v[180:181] offset:7168
    v_pk_mul_f32 v[60:61], v[60:61], v[244:245] op_sel_hi:[1,0]
    v_mfma_f32_16x16x32_bf16 v[108:111], v[152:155], a[188:191], v[108:111]
    v_pk_mul_f32 v[62:63], v[62:63], v[244:245] op_sel_hi:[1,0]
    v_mfma_f32_16x16x32_bf16 v[112:115], v[156:159], a[176:179], v[112:115]
    v_mfma_f32_16x16x32_bf16 v[116:119], v[156:159], a[180:183], v[116:119]
    buffer_load_dwordx4 v222, s[4:7], s51 offen offset:3072 lds
    v_mfma_f32_16x16x32_bf16 v[120:123], v[156:159], a[184:187], v[120:123]
    v_add_u32 v222, 0x8000, v222
    v_mfma_f32_16x16x32_bf16 v[124:127], v[156:159], a[188:191], v[124:127]
    s_waitcnt lgkmcnt(1)
    v_mfma_f32_16x16x32_bf16 v[64:67], v[128:131], a[192:195], v[64:67]
    s_waitcnt vmcnt(8)
    ds_read_b64_tr_b16 v[144:145], v206 offset:12288
    v_mfma_f32_16x16x32_bf16 v[68:71], v[128:131], a[196:199], v[68:71]
    buffer_load_dword v255, v215, s[8:11], 0 offen
    v_mfma_f32_16x16x32_bf16 v[72:75], v[128:131], a[200:203], v[72:75]
    ds_read_b64_tr_b16 v[146:147], v206 offset:12800
    ds_read_b64_tr_b16 v[148:149], v207 offset:12288
    v_mfma_f32_16x16x32_bf16 v[76:79], v[128:131], a[204:207], v[76:79]
    ds_read_b64_tr_b16 v[150:151], v207 offset:12800
    ds_read_b64_tr_b16 v[152:153], v208 offset:12288
    v_mfma_f32_16x16x32_bf16 v[80:83], v[132:135], a[192:195], v[80:83]
    ds_read_b64_tr_b16 v[154:155], v208 offset:12800
    ds_read_b64_tr_b16 v[156:157], v209 offset:12288
    v_mfma_f32_16x16x32_bf16 v[84:87], v[132:135], a[196:199], v[84:87]
    ds_read_b64_tr_b16 v[158:159], v209 offset:12800
    v_cvt_pk_bf16_f32 v182, v60, v61
    v_mfma_f32_16x16x32_bf16 v[88:91], v[132:135], a[200:203], v[88:91]
    v_cvt_pk_bf16_f32 v183, v62, v63
    ds_write_b64 v212, v[182:183] offset:7680
    v_mfma_f32_16x16x32_bf16 v[92:95], v[132:135], a[204:207], v[92:95]
    v_mfma_f32_16x16x32_bf16 v[96:99], v[136:139], a[192:195], v[96:99]
    v_mfma_f32_16x16x32_bf16 v[100:103], v[136:139], a[196:199], v[100:103]
    buffer_load_dword v255, v215, s[4:7], s96 offen
    v_mfma_f32_16x16x32_bf16 v[104:107], v[136:139], a[200:203], v[104:107]
    v_mfma_f32_16x16x32_bf16 v[108:111], v[136:139], a[204:207], v[108:111]
    v_mfma_f32_16x16x32_bf16 v[112:115], v[140:143], a[192:195], v[112:115]
    v_mfma_f32_16x16x32_bf16 v[116:119], v[140:143], a[196:199], v[116:119]
    v_mfma_f32_16x16x32_bf16 v[120:123], v[140:143], a[200:203], v[120:123]
    v_mfma_f32_16x16x32_bf16 v[124:127], v[140:143], a[204:207], v[124:127]
    s_waitcnt lgkmcnt(1)
    v_mfma_f32_16x16x32_bf16 v[64:67], v[144:147], a[208:211], v[64:67]
    v_mfma_f32_16x16x32_bf16 v[68:71], v[144:147], a[212:215], v[68:71]
    v_mfma_f32_16x16x32_bf16 v[72:75], v[144:147], a[216:219], v[72:75]
    v_mfma_f32_16x16x32_bf16 v[76:79], v[144:147], a[220:223], v[76:79]
    v_mfma_f32_16x16x32_bf16 v[80:83], v[148:151], a[208:211], v[80:83]
    v_mfma_f32_16x16x32_bf16 v[84:87], v[148:151], a[212:215], v[84:87]
    v_mfma_f32_16x16x32_bf16 v[88:91], v[148:151], a[216:219], v[88:91]
    v_mfma_f32_16x16x32_bf16 v[92:95], v[148:151], a[220:223], v[92:95]
    v_mfma_f32_16x16x32_bf16 v[96:99], v[152:155], a[208:211], v[96:99]
    v_mfma_f32_16x16x32_bf16 v[100:103], v[152:155], a[212:215], v[100:103]
    v_mfma_f32_16x16x32_bf16 v[104:107], v[152:155], a[216:219], v[104:107]
    v_mfma_f32_16x16x32_bf16 v[108:111], v[152:155], a[220:223], v[108:111]
    v_mfma_f32_16x16x32_bf16 v[112:115], v[156:159], a[208:211], v[112:115]
    v_mfma_f32_16x16x32_bf16 v[116:119], v[156:159], a[212:215], v[116:119]
    v_mfma_f32_16x16x32_bf16 v[120:123], v[156:159], a[216:219], v[120:123]
    v_mfma_f32_16x16x32_bf16 v[124:127], v[156:159], a[220:223], v[124:127]
    s_nop 7
    v_pk_mul_f32 v[64:65], v[64:65], v[244:245] op_sel_hi:[1,0]
    v_pk_mul_f32 v[66:67], v[66:67], v[244:245] op_sel_hi:[1,0]
    v_cvt_pk_bf16_f32 v176, v64, v65
    v_cvt_pk_bf16_f32 v177, v66, v67
    ds_write_b64 v213, v[176:177] offset:0
    v_pk_mul_f32 v[80:81], v[80:81], v[244:245] op_sel_hi:[1,0]
    v_pk_mul_f32 v[82:83], v[82:83], v[244:245] op_sel_hi:[1,0]
    v_cvt_pk_bf16_f32 v178, v80, v81
    v_cvt_pk_bf16_f32 v179, v82, v83
    ds_write_b64 v213, v[178:179] offset:512
    v_pk_mul_f32 v[96:97], v[96:97], v[244:245] op_sel_hi:[1,0]
    v_pk_mul_f32 v[98:99], v[98:99], v[244:245] op_sel_hi:[1,0]
    v_cvt_pk_bf16_f32 v180, v96, v97
    v_cvt_pk_bf16_f32 v181, v98, v99
    ds_write_b64 v213, v[180:181] offset:1024
    v_pk_mul_f32 v[112:113], v[112:113], v[244:245] op_sel_hi:[1,0]
    v_pk_mul_f32 v[114:115], v[114:115], v[244:245] op_sel_hi:[1,0]
    v_cvt_pk_bf16_f32 v182, v112, v113
    v_cvt_pk_bf16_f32 v183, v114, v115
    ds_write_b64 v213, v[182:183] offset:1536
    v_pk_mul_f32 v[68:69], v[68:69], v[244:245] op_sel_hi:[1,0]
    v_pk_mul_f32 v[70:71], v[70:71], v[244:245] op_sel_hi:[1,0]
    v_cvt_pk_bf16_f32 v176, v68, v69
    v_cvt_pk_bf16_f32 v177, v70, v71
    ds_write_b64 v213, v[176:177] offset:2048
    v_pk_mul_f32 v[84:85], v[84:85], v[244:245] op_sel_hi:[1,0]
    v_pk_mul_f32 v[86:87], v[86:87], v[244:245] op_sel_hi:[1,0]
    v_cvt_pk_bf16_f32 v178, v84, v85
    v_cvt_pk_bf16_f32 v179, v86, v87
    ds_write_b64 v213, v[178:179] offset:2560
    v_pk_mul_f32 v[100:101], v[100:101], v[244:245] op_sel_hi:[1,0]
    v_pk_mul_f32 v[102:103], v[102:103], v[244:245] op_sel_hi:[1,0]
    v_cvt_pk_bf16_f32 v180, v100, v101
    v_cvt_pk_bf16_f32 v181, v102, v103
    ds_write_b64 v213, v[180:181] offset:3072
    v_pk_mul_f32 v[116:117], v[116:117], v[244:245] op_sel_hi:[1,0]
    v_pk_mul_f32 v[118:119], v[118:119], v[244:245] op_sel_hi:[1,0]
    v_cvt_pk_bf16_f32 v182, v116, v117
    v_cvt_pk_bf16_f32 v183, v118, v119
    ds_write_b64 v213, v[182:183] offset:3584
    v_pk_mul_f32 v[72:73], v[72:73], v[244:245] op_sel_hi:[1,0]
    v_pk_mul_f32 v[74:75], v[74:75], v[244:245] op_sel_hi:[1,0]
    v_cvt_pk_bf16_f32 v176, v72, v73
    v_cvt_pk_bf16_f32 v177, v74, v75
    ds_write_b64 v213, v[176:177] offset:4096
    v_pk_mul_f32 v[88:89], v[88:89], v[244:245] op_sel_hi:[1,0]
    v_pk_mul_f32 v[90:91], v[90:91], v[244:245] op_sel_hi:[1,0]
    v_cvt_pk_bf16_f32 v178, v88, v89
    v_cvt_pk_bf16_f32 v179, v90, v91
    ds_write_b64 v213, v[178:179] offset:4608
    v_pk_mul_f32 v[104:105], v[104:105], v[244:245] op_sel_hi:[1,0]
    v_pk_mul_f32 v[106:107], v[106:107], v[244:245] op_sel_hi:[1,0]
    v_cvt_pk_bf16_f32 v180, v104, v105
    v_cvt_pk_bf16_f32 v181, v106, v107
    ds_write_b64 v213, v[180:181] offset:5120
    v_pk_mul_f32 v[120:121], v[120:121], v[244:245] op_sel_hi:[1,0]
    v_pk_mul_f32 v[122:123], v[122:123], v[244:245] op_sel_hi:[1,0]
    v_cvt_pk_bf16_f32 v182, v120, v121
    v_cvt_pk_bf16_f32 v183, v122, v123
    ds_write_b64 v213, v[182:183] offset:5632
    v_pk_mul_f32 v[76:77], v[76:77], v[244:245] op_sel_hi:[1,0]
    v_pk_mul_f32 v[78:79], v[78:79], v[244:245] op_sel_hi:[1,0]
    v_cvt_pk_bf16_f32 v176, v76, v77
    v_cvt_pk_bf16_f32 v177, v78, v79
    ds_write_b64 v213, v[176:177] offset:6144
    v_pk_mul_f32 v[92:93], v[92:93], v[244:245] op_sel_hi:[1,0]
    v_pk_mul_f32 v[94:95], v[94:95], v[244:245] op_sel_hi:[1,0]
    v_cvt_pk_bf16_f32 v178, v92, v93
    v_cvt_pk_bf16_f32 v179, v94, v95
    ds_write_b64 v213, v[178:179] offset:6656
    v_pk_mul_f32 v[108:109], v[108:109], v[244:245] op_sel_hi:[1,0]
    v_pk_mul_f32 v[110:111], v[110:111], v[244:245] op_sel_hi:[1,0]
    v_cvt_pk_bf16_f32 v180, v108, v109
    v_cvt_pk_bf16_f32 v181, v110, v111
    ds_write_b64 v213, v[180:181] offset:7168
    v_pk_mul_f32 v[124:125], v[124:125], v[244:245] op_sel_hi:[1,0]
    v_pk_mul_f32 v[126:127], v[126:127], v[244:245] op_sel_hi:[1,0]
    v_cvt_pk_bf16_f32 v182, v124, v125
    v_cvt_pk_bf16_f32 v183, v126, v127
    ds_write_b64 v213, v[182:183] offset:7680
    s_waitcnt lgkmcnt(0)
    s_barrier
    ds_read_b128 v[0:3], v240 offset:0
    ds_read_b128 v[32:35], v240 offset:2048
    ds_read_b128 v[64:67], v240 offset:4096
    ds_read_b128 v[96:99], v240 offset:6144
    ds_read_b128 v[192:195], v216 offset:0
    ds_read_b128 v[4:7], v240 offset:1024
    ds_read_b128 v[36:39], v240 offset:3072
    ds_read_b128 v[68:71], v240 offset:5120
    ds_read_b128 v[100:103], v240 offset:7168
    ds_read_b128 v[196:199], v217 offset:0
    s_waitcnt lgkmcnt(5)
    v_mfma_f32_16x16x32_bf16 v[128:131], v[192:195], v[0:3], 0
    ds_read_b128 v[8:11], v241 offset:0
    ds_read_b128 v[40:43], v241 offset:2048
    v_mfma_f32_16x16x32_bf16 v[132:135], v[192:195], v[32:35], 0
    ds_read_b128 v[72:75], v241 offset:4096
    v_mfma_f32_16x16x32_bf16 v[136:139], v[192:195], v[64:67], 0
    ds_read_b128 v[104:107], v241 offset:6144
    v_mfma_f32_16x16x32_bf16 v[140:143], v[192:195], v[96:99], 0
    ds_read_b128 v[200:203], v216 offset:4096
    s_waitcnt lgkmcnt(5)
    v_mfma_f32_16x16x32_bf16 v[128:131], v[196:199], v[4:7], v[128:131]
    ds_read_b128 v[12:15], v241 offset:1024
    ds_read_b128 v[44:47], v241 offset:3072
    v_mfma_f32_16x16x32_bf16 v[132:135], v[196:199], v[36:39], v[132:135]
    ds_read_b128 v[76:79], v241 offset:5120
    v_mfma_f32_16x16x32_bf16 v[136:139], v[196:199], v[68:71], v[136:139]
    ds_read_b128 v[108:111], v241 offset:7168
    v_mfma_f32_16x16x32_bf16 v[140:143], v[196:199], v[100:103], v[140:143]
    ds_read_b128 v[204:207], v217 offset:4096
    s_waitcnt lgkmcnt(5)
    v_mfma_f32_16x16x32_bf16 v[128:131], v[200:203], v[8:11], v[128:131]
    ds_read_b128 v[16:19], v242 offset:0
    ds_read_b128 v[48:51], v242 offset:2048
    v_mfma_f32_16x16x32_bf16 v[132:135], v[200:203], v[40:43], v[132:135]
    ds_read_b128 v[80:83], v242 offset:4096
    v_mfma_f32_16x16x32_bf16 v[136:139], v[200:203], v[72:75], v[136:139]
    ds_read_b128 v[112:115], v242 offset:6144
    v_mfma_f32_16x16x32_bf16 v[140:143], v[200:203], v[104:107], v[140:143]
    ds_read_b128 v[192:195], v216 offset:8192
    s_waitcnt lgkmcnt(5)
    v_mfma_f32_16x16x32_bf16 v[128:131], v[204:207], v[12:15], v[128:131]
    ds_read_b128 v[20:23], v242 offset:1024
    ds_read_b128 v[52:55], v242 offset:3072
    v_mfma_f32_16x16x32_bf16 v[132:135], v[204:207], v[44:47], v[132:135]
    ds_read_b128 v[84:87], v242 offset:5120
    v_mfma_f32_16x16x32_bf16 v[136:139], v[204:207], v[76:79], v[136:139]
    ds_read_b128 v[116:119], v242 offset:7168
    v_mfma_f32_16x16x32_bf16 v[140:143], v[204:207], v[108:111], v[140:143]
    ds_read_b128 v[196:199], v217 offset:8192
    s_waitcnt lgkmcnt(5)
    v_mfma_f32_16x16x32_bf16 v[128:131], v[192:195], v[16:19], v[128:131]
    ds_read_b128 v[24:27], v243 offset:0
    ds_read_b128 v[56:59], v243 offset:2048
    v_mfma_f32_16x16x32_bf16 v[132:135], v[192:195], v[48:51], v[132:135]
    ds_read_b128 v[88:91], v243 offset:4096
    v_mfma_f32_16x16x32_bf16 v[136:139], v[192:195], v[80:83], v[136:139]
    ds_read_b128 v[120:123], v243 offset:6144
    v_mfma_f32_16x16x32_bf16 v[140:143], v[192:195], v[112:115], v[140:143]
    ds_read_b128 v[200:203], v216 offset:12288
    s_waitcnt lgkmcnt(5)
    v_mfma_f32_16x16x32_bf16 v[128:131], v[196:199], v[20:23], v[128:131]
    ds_read_b128 v[28:31], v243 offset:1024
    ds_read_b128 v[60:63], v243 offset:3072
    v_mfma_f32_16x16x32_bf16 v[132:135], v[196:199], v[52:55], v[132:135]
    ds_read_b128 v[92:95], v243 offset:5120
    v_mfma_f32_16x16x32_bf16 v[136:139], v[196:199], v[84:87], v[136:139]
    ds_read_b128 v[124:127], v243 offset:7168
    v_mfma_f32_16x16x32_bf16 v[140:143], v[196:199], v[116:119], v[140:143]
    ds_read_b128 v[204:207], v217 offset:12288
    s_waitcnt lgkmcnt(5)
    v_mfma_f32_16x16x32_bf16 v[128:131], v[200:203], v[24:27], v[128:131]
    ds_read_b128 v[192:195], v216 offset:2048
    ds_read_b128 v[196:199], v217 offset:2048
    v_mfma_f32_16x16x32_bf16 v[132:135], v[200:203], v[56:59], v[132:135]
    v_mfma_f32_16x16x32_bf16 v[136:139], v[200:203], v[88:91], v[136:139]
    v_mfma_f32_16x16x32_bf16 v[140:143], v[200:203], v[120:123], v[140:143]
    s_waitcnt lgkmcnt(2)
    v_mfma_f32_16x16x32_bf16 v[128:131], v[204:207], v[28:31], v[128:131]
    ds_read_b128 v[200:203], v216 offset:6144
    v_mfma_f32_16x16x32_bf16 v[132:135], v[204:207], v[60:63], v[132:135]
    v_mfma_f32_16x16x32_bf16 v[136:139], v[204:207], v[92:95], v[136:139]
    v_mfma_f32_16x16x32_bf16 v[140:143], v[204:207], v[124:127], v[140:143]
    s_waitcnt lgkmcnt(2)
    s_barrier
    v_mfma_f32_16x16x32_bf16 v[144:147], v[192:195], v[0:3], 0
    ds_read_b128 v[204:207], v217 offset:6144
    v_mfma_f32_16x16x32_bf16 v[148:151], v[192:195], v[32:35], 0
    s_add_u32 m0, s52, 65536
    v_mfma_f32_16x16x32_bf16 v[152:155], v[192:195], v[64:67], 0
    buffer_load_dwordx4 v223, s[8:11], s44 offen offset:0 lds
    v_mfma_f32_16x16x32_bf16 v[156:159], v[192:195], v[96:99], 0
    s_waitcnt lgkmcnt(2)
    v_mfma_f32_16x16x32_bf16 v[144:147], v[196:199], v[4:7], v[144:147]
    ds_read_b128 v[192:195], v216 offset:10240
    v_mfma_f32_16x16x32_bf16 v[148:151], v[196:199], v[36:39], v[148:151]
    v_mfma_f32_16x16x32_bf16 v[152:155], v[196:199], v[68:71], v[152:155]
    buffer_load_dwordx4 v223, s[8:11], s45 offen offset:1024 lds
    v_mfma_f32_16x16x32_bf16 v[156:159], v[196:199], v[100:103], v[156:159]
    s_waitcnt lgkmcnt(2)
    v_mfma_f32_16x16x32_bf16 v[144:147], v[200:203], v[8:11], v[144:147]
    ds_read_b128 v[196:199], v217 offset:10240
    v_mfma_f32_16x16x32_bf16 v[148:151], v[200:203], v[40:43], v[148:151]
    v_mfma_f32_16x16x32_bf16 v[152:155], v[200:203], v[72:75], v[152:155]
    buffer_load_dwordx4 v223, s[8:11], s46 offen offset:2048 lds
    v_mfma_f32_16x16x32_bf16 v[156:159], v[200:203], v[104:107], v[156:159]
    s_waitcnt lgkmcnt(2)
    v_mfma_f32_16x16x32_bf16 v[144:147], v[204:207], v[12:15], v[144:147]
    ds_read_b128 v[200:203], v216 offset:14336
    v_mfma_f32_16x16x32_bf16 v[148:151], v[204:207], v[44:47], v[148:151]
    v_mfma_f32_16x16x32_bf16 v[152:155], v[204:207], v[76:79], v[152:155]
    buffer_load_dwordx4 v223, s[8:11], s47 offen offset:3072 lds
    v_mfma_f32_16x16x32_bf16 v[156:159], v[204:207], v[108:111], v[156:159]
    s_waitcnt lgkmcnt(2)
    v_mfma_f32_16x16x32_bf16 v[144:147], v[192:195], v[16:19], v[144:147]
    ds_read_b128 v[204:207], v217 offset:14336
    v_mfma_f32_16x16x32_bf16 v[148:151], v[192:195], v[48:51], v[148:151]
    s_add_u32 m0, s52, 81920
    v_mfma_f32_16x16x32_bf16 v[152:155], v[192:195], v[80:83], v[152:155]
    buffer_load_dwordx4 v223, s[8:11], s48 offen offset:0 lds
    v_mfma_f32_16x16x32_bf16 v[156:159], v[192:195], v[112:115], v[156:159]
    s_waitcnt lgkmcnt(2)
    v_mfma_f32_16x16x32_bf16 v[144:147], v[196:199], v[20:23], v[144:147]
    v_mfma_f32_16x16x32_bf16 v[148:151], v[196:199], v[52:55], v[148:151]
    v_mfma_f32_16x16x32_bf16 v[152:155], v[196:199], v[84:87], v[152:155]
    buffer_load_dwordx4 v223, s[8:11], s49 offen offset:1024 lds
    v_mfma_f32_16x16x32_bf16 v[156:159], v[196:199], v[116:119], v[156:159]
    s_waitcnt lgkmcnt(1)
    v_mfma_f32_16x16x32_bf16 v[144:147], v[200:203], v[24:27], v[144:147]
    v_mfma_f32_16x16x32_bf16 v[148:151], v[200:203], v[56:59], v[148:151]
    v_mfma_f32_16x16x32_bf16 v[152:155], v[200:203], v[88:91], v[152:155]
    buffer_load_dwordx4 v223, s[8:11], s50 offen offset:2048 lds
    v_mfma_f32_16x16x32_bf16 v[156:159], v[200:203], v[120:123], v[156:159]
    s_waitcnt lgkmcnt(0)
    v_mfma_f32_16x16x32_bf16 v[144:147], v[204:207], v[28:31], v[144:147]
    v_mfma_f32_16x16x32_bf16 v[148:151], v[204:207], v[60:63], v[148:151]
    v_mfma_f32_16x16x32_bf16 v[152:155], v[204:207], v[92:95], v[152:155]
    buffer_load_dwordx4 v223, s[8:11], s51 offen offset:3072 lds
    v_mfma_f32_16x16x32_bf16 v[156:159], v[204:207], v[124:127], v[156:159]
    v_add_u32 v223, 0x8000, v223
    s_lshl_b32 s62, s40, 10
    s_add_u32 s62, s62, 98304
    v_add_u32 v248, s62, v211
    v_xor_b32 v249, 2048, v248
    s_nop 3
    v_max3_f32 v208, v128, v129, v130
    v_max3_f32 v208, v208, v131, v144
    v_max3_f32 v208, v208, v145, v146
    v_max_f32 v208, v208, v147
    v_max3_f32 v209, v132, v133, v134
    v_max3_f32 v209, v209, v135, v148
    v_max3_f32 v209, v209, v149, v150
    v_max_f32 v209, v209, v151
    v_max3_f32 v210, v136, v137, v138
    v_max3_f32 v210, v210, v139, v152
    v_max3_f32 v210, v210, v153, v154
    v_max_f32 v210, v210, v155
    v_max3_f32 v211, v140, v141, v142
    v_max3_f32 v211, v211, v143, v156
    v_max3_f32 v211, v211, v157, v158
    v_max_f32 v211, v211, v159
    v_mov_b32 v212, v208
    v_mov_b32 v213, v209
    v_mov_b32 v214, v210
    v_mov_b32 v215, v211
    s_nop 1
    v_permlane32_swap_b32 v208, v212
    v_permlane32_swap_b32 v209, v213
    v_permlane32_swap_b32 v210, v214
    v_permlane32_swap_b32 v211, v215
    s_nop 1
    v_max_f32 v208, v208, v212
    v_max_f32 v209, v209, v213
    v_max_f32 v210, v210, v214
    v_max_f32 v211, v211, v215
    v_mov_b32 v212, v208
    v_mov_b32 v213, v209
    v_mov_b32 v214, v210
    v_mov_b32 v215, v211
    s_nop 1
    v_permlane16_swap_b32 v208, v212
    v_permlane16_swap_b32 v209, v213
    v_permlane16_swap_b32 v210, v214
    v_permlane16_swap_b32 v211, v215
    s_nop 1
    v_max_f32 v208, v208, v212
    v_max_f32 v209, v209, v213
    v_max_f32 v210, v210, v214
    v_max_f32 v211, v211, v215
    ds_write_b128 v248, v[208:211]
    s_waitcnt lgkmcnt(0)
    s_waitcnt vmcnt(10)
    s_barrier
    ds_read_b128 v[212:215], v249
    ds_read_b128 v[192:195], v216 offset:32768
    ds_read_b128 v[196:199], v217 offset:32768
    ds_read_b128 v[200:203], v216 offset:36864
    ds_read_b128 v[204:207], v217 offset:36864
    s_add_u32 m0, s52, 0
    s_nop 0
    buffer_load_dwordx4 v222, s[4:7], s44 offen offset:0 lds
    buffer_load_dwordx4 v222, s[4:7], s45 offen offset:1024 lds
    s_waitcnt lgkmcnt(4)
    v_max_f32 v208, v208, v212
    v_max_f32 v209, v209, v213
    v_max_f32 v210, v210, v214
    v_max_f32 v211, v211, v215
    v_add_f32 v208, 0x42c80000, v208
    v_add_f32 v209, 0x42c80000, v209
    buffer_load_dwordx4 v222, s[4:7], s46 offen offset:2048 lds
    v_add_f32 v210, 0x42c80000, v210
    v_add_f32 v211, 0x42c80000, v211
    v_sub_f32 v224, 0, v208
    v_sub_f32 v225, 0, v208
    v_sub_f32 v226, 0, v208
    v_sub_f32 v227, 0, v208
    v_sub_f32 v228, 0, v209
    v_sub_f32 v229, 0, v209
    v_sub_f32 v230, 0, v209
    v_sub_f32 v231, 0, v209
    v_sub_f32 v232, 0, v210
    v_sub_f32 v233, 0, v210
    v_sub_f32 v234, 0, v210
    v_sub_f32 v235, 0, v210
    buffer_load_dwordx4 v222, s[4:7], s47 offen offset:3072 lds
    v_sub_f32 v236, 0, v211
    v_sub_f32 v237, 0, v211
    v_sub_f32 v238, 0, v211
    v_sub_f32 v239, 0, v211
    v_sub_f32 v248, v128, v208
    v_sub_f32 v249, v129, v208
    v_sub_f32 v250, v130, v208
    v_sub_f32 v251, v131, v208
    v_exp_f32 v248, v248
    v_exp_f32 v249, v249
    v_exp_f32 v250, v250
    v_exp_f32 v251, v251
    s_nop 0
    v_cvt_pk_bf16_f32 v160, v248, v249
    v_cvt_pk_bf16_f32 v161, v250, v251
    s_add_u32 m0, s52, 16384
    s_nop 0
    buffer_load_dwordx4 v222, s[4:7], s48 offen offset:0 lds
    v_add_f32 v244, v248, v249
    v_add_f32 v244, v244, v250
    v_add_f32 v244, v244, v251
    v_sub_f32 v248, v144, v208
    v_sub_f32 v249, v145, v208
    v_sub_f32 v250, v146, v208
    v_sub_f32 v251, v147, v208
    v_exp_f32 v248, v248
    v_exp_f32 v249, v249
    v_exp_f32 v250, v250
    v_exp_f32 v251, v251
    s_nop 0
    v_cvt_pk_bf16_f32 v162, v248, v249
    v_cvt_pk_bf16_f32 v163, v250, v251
    v_add_f32 v244, v244, v248
    buffer_load_dwordx4 v222, s[4:7], s49 offen offset:1024 lds
    v_add_f32 v244, v244, v249
    v_add_f32 v244, v244, v250
    v_add_f32 v244, v244, v251
    v_sub_f32 v248, v132, v209
    v_sub_f32 v249, v133, v209
    v_sub_f32 v250, v134, v209
    v_sub_f32 v251, v135, v209
    v_exp_f32 v248, v248
    v_exp_f32 v249, v249
    v_exp_f32 v250, v250
    v_exp_f32 v251, v251
    s_nop 0
    v_cvt_pk_bf16_f32 v164, v248, v249
    v_cvt_pk_bf16_f32 v165, v250, v251
    v_add_f32 v245, v248, v249
    buffer_load_dwordx4 v222, s[4:7], s50 offen offset:2048 lds
    v_add_f32 v245, v245, v250
    v_add_f32 v245, v245, v251
    v_sub_f32 v248, v148, v209
    v_sub_f32 v249, v149, v209
    v_sub_f32 v250, v150, v209
    v_sub_f32 v251, v151, v209
    v_exp_f32 v248, v248
    v_exp_f32 v249, v249
    v_exp_f32 v250, v250
    v_exp_f32 v251, v251
    s_nop 0
    v_cvt_pk_bf16_f32 v166, v248, v249
    v_cvt_pk_bf16_f32 v167, v250, v251
    v_add_f32 v245, v245, v248
    v_add_f32 v245, v245, v249
    buffer_load_dwordx4 v222, s[4:7], s51 offen offset:3072 lds
    v_add_u32 v222, 0x8000, v222
    v_add_f32 v245, v245, v250
    v_add_f32 v245, v245, v251
    v_sub_f32 v248, v136, v210
    v_sub_f32 v249, v137, v210
    v_sub_f32 v250, v138, v210
    v_sub_f32 v251, v139, v210
    v_exp_f32 v248, v248
    v_exp_f32 v249, v249
    v_exp_f32 v250, v250
    v_exp_f32 v251, v251
    s_nop 0
    v_cvt_pk_bf16_f32 v168, v248, v249
    v_cvt_pk_bf16_f32 v169, v250, v251
    v_add_f32 v246, v248, v249
    v_add_f32 v246, v246, v250
    v_add_f32 v246, v246, v251
    v_sub_f32 v248, v152, v210
    v_sub_f32 v249, v153, v210
    v_sub_f32 v250, v154, v210
    v_sub_f32 v251, v155, v210
    v_exp_f32 v248, v248
    v_exp_f32 v249, v249
    v_exp_f32 v250, v250
    v_exp_f32 v251, v251
    s_nop 0
    v_cvt_pk_bf16_f32 v170, v248, v249
    v_cvt_pk_bf16_f32 v171, v250, v251
    v_add_f32 v246, v246, v248
    v_add_f32 v246, v246, v249
    v_add_f32 v246, v246, v250
    v_add_f32 v246, v246, v251
    v_sub_f32 v248, v140, v211
    v_sub_f32 v249, v141, v211
    v_sub_f32 v250, v142, v211
    v_sub_f32 v251, v143, v211
    v_exp_f32 v248, v248
    v_exp_f32 v249, v249
    v_exp_f32 v250, v250
    v_exp_f32 v251, v251
    s_nop 0
    v_cvt_pk_bf16_f32 v172, v248, v249
    v_cvt_pk_bf16_f32 v173, v250, v251
    v_add_f32 v247, v248, v249
    v_add_f32 v247, v247, v250
    v_add_f32 v247, v247, v251
    v_sub_f32 v248, v156, v211
    v_sub_f32 v249, v157, v211
    v_sub_f32 v250, v158, v211
    v_sub_f32 v251, v159, v211
    v_exp_f32 v248, v248
    v_exp_f32 v249, v249
    v_exp_f32 v250, v250
    v_exp_f32 v251, v251
    s_nop 0
    v_cvt_pk_bf16_f32 v174, v248, v249
    v_cvt_pk_bf16_f32 v175, v250, v251
    v_add_f32 v247, v247, v248
    v_add_f32 v247, v247, v249
    v_add_f32 v247, v247, v250
    v_add_f32 v247, v247, v251
    v_mov_b32 v240, v244
    v_mov_b32 v241, v245
    v_mov_b32 v242, v246
    v_mov_b32 v243, v247
    s_waitcnt vmcnt(8)
    s_barrier
    s_waitcnt lgkmcnt(2)
    v_mfma_f32_16x16x32_bf16 v[128:131], v[192:195], v[0:3], v[224:227]
    s_add_u32 m0, s52, 98304
    v_mfma_f32_16x16x32_bf16 v[132:135], v[192:195], v[32:35], v[228:231]
    buffer_load_dwordx4 v223, s[8:11], s44 offen offset:0 lds
    v_mfma_f32_16x16x32_bf16 v[136:139], v[192:195], v[64:67], v[232:235]
    v_mfma_f32_16x16x32_bf16 v[140:143], v[192:195], v[96:99], v[236:239]
    ds_read_b128 v[192:195], v216 offset:40960
    v_mfma_f32_16x16x32_bf16 v[128:131], v[196:199], v[4:7], v[128:131]
    v_mfma_f32_16x16x32_bf16 v[132:135], v[196:199], v[36:39], v[132:135]
    buffer_load_dwordx4 v223, s[8:11], s45 offen offset:1024 lds
    v_mfma_f32_16x16x32_bf16 v[136:139], v[196:199], v[68:71], v[136:139]
    v_mfma_f32_16x16x32_bf16 v[140:143], v[196:199], v[100:103], v[140:143]
    ds_read_b128 v[196:199], v217 offset:40960
    s_waitcnt lgkmcnt(2)
    v_mfma_f32_16x16x32_bf16 v[128:131], v[200:203], v[8:11], v[128:131]
    v_mfma_f32_16x16x32_bf16 v[132:135], v[200:203], v[40:43], v[132:135]
    buffer_load_dwordx4 v223, s[8:11], s46 offen offset:2048 lds
    v_mfma_f32_16x16x32_bf16 v[136:139], v[200:203], v[72:75], v[136:139]
    v_mfma_f32_16x16x32_bf16 v[140:143], v[200:203], v[104:107], v[140:143]
    ds_read_b128 v[200:203], v216 offset:45056
    v_mfma_f32_16x16x32_bf16 v[128:131], v[204:207], v[12:15], v[128:131]
    v_mfma_f32_16x16x32_bf16 v[132:135], v[204:207], v[44:47], v[132:135]
    buffer_load_dwordx4 v223, s[8:11], s47 offen offset:3072 lds
    v_mfma_f32_16x16x32_bf16 v[136:139], v[204:207], v[76:79], v[136:139]
    v_mfma_f32_16x16x32_bf16 v[140:143], v[204:207], v[108:111], v[140:143]
    ds_read_b128 v[204:207], v217 offset:45056
    s_waitcnt lgkmcnt(2)
    v_mfma_f32_16x16x32_bf16 v[128:131], v[192:195], v[16:19], v[128:131]
    s_add_u32 m0, s52, 114688
    v_mfma_f32_16x16x32_bf16 v[132:135], v[192:195], v[48:51], v[132:135]
    buffer_load_dwordx4 v223, s[8:11], s48 offen offset:0 lds
    v_mfma_f32_16x16x32_bf16 v[136:139], v[192:195], v[80:83], v[136:139]
    v_mfma_f32_16x16x32_bf16 v[140:143], v[192:195], v[112:115], v[140:143]
    ds_read_b128 v[192:195], v216 offset:34816
    v_mfma_f32_16x16x32_bf16 v[128:131], v[196:199], v[20:23], v[128:131]
    v_mfma_f32_16x16x32_bf16 v[132:135], v[196:199], v[52:55], v[132:135]
    buffer_load_dwordx4 v223, s[8:11], s49 offen offset:1024 lds
    v_mfma_f32_16x16x32_bf16 v[136:139], v[196:199], v[84:87], v[136:139]
    v_mfma_f32_16x16x32_bf16 v[140:143], v[196:199], v[116:119], v[140:143]
    ds_read_b128 v[196:199], v217 offset:34816
    s_waitcnt lgkmcnt(2)
    v_mfma_f32_16x16x32_bf16 v[128:131], v[200:203], v[24:27], v[128:131]
    v_mfma_f32_16x16x32_bf16 v[132:135], v[200:203], v[56:59], v[132:135]
    buffer_load_dwordx4 v223, s[8:11], s50 offen offset:2048 lds
    v_mfma_f32_16x16x32_bf16 v[136:139], v[200:203], v[88:91], v[136:139]
    v_mfma_f32_16x16x32_bf16 v[140:143], v[200:203], v[120:123], v[140:143]
    ds_read_b128 v[200:203], v216 offset:38912
    v_mfma_f32_16x16x32_bf16 v[128:131], v[204:207], v[28:31], v[128:131]
    v_mfma_f32_16x16x32_bf16 v[132:135], v[204:207], v[60:63], v[132:135]
    buffer_load_dwordx4 v223, s[8:11], s51 offen offset:3072 lds
    v_mfma_f32_16x16x32_bf16 v[136:139], v[204:207], v[92:95], v[136:139]
    v_mfma_f32_16x16x32_bf16 v[140:143], v[204:207], v[124:127], v[140:143]
    ds_read_b128 v[204:207], v217 offset:38912
    s_waitcnt lgkmcnt(2)
    v_mfma_f32_16x16x32_bf16 v[144:147], v[192:195], v[0:3], v[224:227]
    v_add_u32 v223, 0x8000, v223
    v_mfma_f32_16x16x32_bf16 v[148:151], v[192:195], v[32:35], v[228:231]
    v_mfma_f32_16x16x32_bf16 v[152:155], v[192:195], v[64:67], v[232:235]
    v_exp_f32 v248, v128
    v_mfma_f32_16x16x32_bf16 v[156:159], v[192:195], v[96:99], v[236:239]
    ds_read_b128 v[192:195], v216 offset:43008
    v_mfma_f32_16x16x32_bf16 v[144:147], v[196:199], v[4:7], v[144:147]
    v_exp_f32 v249, v129
    v_mfma_f32_16x16x32_bf16 v[148:151], v[196:199], v[36:39], v[148:151]
    v_cvt_pk_bf16_f32 v176, v248, v249
    v_add_f32 v244, v248, v249
    v_mfma_f32_16x16x32_bf16 v[152:155], v[196:199], v[68:71], v[152:155]
    v_exp_f32 v250, v130
    v_mfma_f32_16x16x32_bf16 v[156:159], v[196:199], v[100:103], v[156:159]
    ds_read_b128 v[196:199], v217 offset:43008
    s_waitcnt lgkmcnt(2)
    v_mfma_f32_16x16x32_bf16 v[144:147], v[200:203], v[8:11], v[144:147]
    v_exp_f32 v251, v131
    v_mfma_f32_16x16x32_bf16 v[148:151], v[200:203], v[40:43], v[148:151]
    v_cvt_pk_bf16_f32 v177, v250, v251
    v_add_f32 v244, v244, v250
    v_mfma_f32_16x16x32_bf16 v[152:155], v[200:203], v[72:75], v[152:155]
    v_add_f32 v244, v244, v251
    v_mfma_f32_16x16x32_bf16 v[156:159], v[200:203], v[104:107], v[156:159]
    ds_read_b128 v[200:203], v216 offset:47104
    v_mfma_f32_16x16x32_bf16 v[144:147], v[204:207], v[12:15], v[144:147]
    v_exp_f32 v208, v132
    v_mfma_f32_16x16x32_bf16 v[148:151], v[204:207], v[44:47], v[148:151]
    v_exp_f32 v209, v133
    v_mfma_f32_16x16x32_bf16 v[152:155], v[204:207], v[76:79], v[152:155]
    v_cvt_pk_bf16_f32 v180, v208, v209
    v_add_f32 v245, v208, v209
    v_mfma_f32_16x16x32_bf16 v[156:159], v[204:207], v[108:111], v[156:159]
    ds_read_b128 v[204:207], v217 offset:47104
    s_waitcnt lgkmcnt(2)
    v_mfma_f32_16x16x32_bf16 v[144:147], v[192:195], v[16:19], v[144:147]
    v_exp_f32 v210, v134
    v_mfma_f32_16x16x32_bf16 v[148:151], v[192:195], v[48:51], v[148:151]
    v_exp_f32 v211, v135
    v_mfma_f32_16x16x32_bf16 v[152:155], v[192:195], v[80:83], v[152:155]
    v_cvt_pk_bf16_f32 v181, v210, v211
    v_add_f32 v245, v245, v210
    v_mfma_f32_16x16x32_bf16 v[156:159], v[192:195], v[112:115], v[156:159]
    ds_read_b64_tr_b16 v[192:193], v218 offset:0
    ds_read_b64_tr_b16 v[194:195], v218 offset:2048
    v_mfma_f32_16x16x32_bf16 v[144:147], v[196:199], v[20:23], v[144:147]
    v_add_f32 v245, v245, v211
    v_mfma_f32_16x16x32_bf16 v[148:151], v[196:199], v[52:55], v[148:151]
    v_exp_f32 v212, v136
    v_mfma_f32_16x16x32_bf16 v[152:155], v[196:199], v[84:87], v[152:155]
    s_waitcnt lgkmcnt(2)
    v_mfma_f32_16x16x32_bf16 v[156:159], v[196:199], v[116:119], v[156:159]
    ds_read_b64_tr_b16 v[196:197], v219 offset:0
    ds_read_b64_tr_b16 v[198:199], v219 offset:2048
    v_mfma_f32_16x16x32_bf16 v[144:147], v[200:203], v[24:27], v[144:147]
    v_exp_f32 v213, v137
    v_mfma_f32_16x16x32_bf16 v[148:151], v[200:203], v[56:59], v[148:151]
    v_cvt_pk_bf16_f32 v184, v212, v213
    v_add_f32 v246, v212, v213
    v_mfma_f32_16x16x32_bf16 v[152:155], v[200:203], v[88:91], v[152:155]
    v_exp_f32 v214, v138
    v_mfma_f32_16x16x32_bf16 v[156:159], v[200:203], v[120:123], v[156:159]
    ds_read_b64_tr_b16 v[200:201], v220 offset:0
    ds_read_b64_tr_b16 v[202:203], v220 offset:2048
    v_mfma_f32_16x16x32_bf16 v[144:147], v[204:207], v[28:31], v[144:147]
    v_exp_f32 v215, v139
    v_mfma_f32_16x16x32_bf16 v[148:151], v[204:207], v[60:63], v[148:151]
    v_cvt_pk_bf16_f32 v185, v214, v215
    v_add_f32 v246, v246, v214
    v_mfma_f32_16x16x32_bf16 v[152:155], v[204:207], v[92:95], v[152:155]
    v_add_f32 v246, v246, v215
    v_mfma_f32_16x16x32_bf16 v[156:159], v[204:207], v[124:127], v[156:159]
    ds_read_b64_tr_b16 v[204:205], v221 offset:0
    ds_read_b64_tr_b16 v[206:207], v221 offset:2048
    s_waitcnt vmcnt(8)
    s_barrier
    s_waitcnt lgkmcnt(4)
    v_mfma_f32_16x16x32_bf16 a[0:3], v[192:195], v[160:163], 0
    s_add_u32 m0, s52, 32768
    v_mfma_f32_16x16x32_bf16 a[4:7], v[192:195], v[164:167], 0
    buffer_load_dwordx4 v222, s[4:7], s44 offen offset:0 lds
    v_mfma_f32_16x16x32_bf16 a[8:11], v[192:195], v[168:171], 0
    v_exp_f32 v248, v140
    v_mfma_f32_16x16x32_bf16 a[12:15], v[192:195], v[172:175], 0
    ds_read_b64_tr_b16 v[192:193], v218 offset:4096
    ds_read_b64_tr_b16 v[194:195], v218 offset:6144
    v_mfma_f32_16x16x32_bf16 a[16:19], v[196:199], v[160:163], 0
    v_exp_f32 v249, v141
    v_mfma_f32_16x16x32_bf16 a[20:23], v[196:199], v[164:167], 0
    buffer_load_dwordx4 v222, s[4:7], s45 offen offset:1024 lds
    v_mfma_f32_16x16x32_bf16 a[24:27], v[196:199], v[168:171], 0
    v_cvt_pk_bf16_f32 v188, v248, v249
    s_waitcnt lgkmcnt(2)
    v_mfma_f32_16x16x32_bf16 a[28:31], v[196:199], v[172:175], 0
    ds_read_b64_tr_b16 v[196:197], v219 offset:4096
    ds_read_b64_tr_b16 v[198:199], v219 offset:6144
    v_mfma_f32_16x16x32_bf16 a[32:35], v[200:203], v[160:163], 0
    v_add_f32 v247, v248, v249
    v_mfma_f32_16x16x32_bf16 a[36:39], v[200:203], v[164:167], 0
    buffer_load_dwordx4 v222, s[4:7], s46 offen offset:2048 lds
    v_mfma_f32_16x16x32_bf16 a[40:43], v[200:203], v[168:171], 0
    v_exp_f32 v250, v142
    v_mfma_f32_16x16x32_bf16 a[44:47], v[200:203], v[172:175], 0
    ds_read_b64_tr_b16 v[200:201], v220 offset:4096
    ds_read_b64_tr_b16 v[202:203], v220 offset:6144
    v_add_f32 v247, v247, v250
    v_mfma_f32_16x16x32_bf16 a[48:51], v[204:207], v[160:163], 0
    v_exp_f32 v251, v143
    v_mfma_f32_16x16x32_bf16 a[52:55], v[204:207], v[164:167], 0
    buffer_load_dwordx4 v222, s[4:7], s47 offen offset:3072 lds
    v_mfma_f32_16x16x32_bf16 a[56:59], v[204:207], v[168:171], 0
    v_cvt_pk_bf16_f32 v189, v250, v251
    s_waitcnt lgkmcnt(2)
    v_mfma_f32_16x16x32_bf16 a[60:63], v[204:207], v[172:175], 0
    ds_read_b64_tr_b16 v[204:205], v221 offset:4096
    ds_read_b64_tr_b16 v[206:207], v221 offset:6144
    v_mfma_f32_16x16x32_bf16 a[64:67], v[192:195], v[160:163], 0
    s_add_u32 m0, s52, 49152
    v_add_f32 v247, v247, v251
    v_mfma_f32_16x16x32_bf16 a[68:71], v[192:195], v[164:167], 0
    buffer_load_dwordx4 v222, s[4:7], s48 offen offset:0 lds
    v_mfma_f32_16x16x32_bf16 a[72:75], v[192:195], v[168:171], 0
    v_exp_f32 v208, v144
    v_mfma_f32_16x16x32_bf16 a[76:79], v[192:195], v[172:175], 0
    ds_read_b64_tr_b16 v[192:193], v218 offset:8192
    ds_read_b64_tr_b16 v[194:195], v218 offset:10240
    v_mfma_f32_16x16x32_bf16 a[80:83], v[196:199], v[160:163], 0
    v_exp_f32 v209, v145
    v_mfma_f32_16x16x32_bf16 a[84:87], v[196:199], v[164:167], 0
    buffer_load_dwordx4 v222, s[4:7], s49 offen offset:1024 lds
    v_mfma_f32_16x16x32_bf16 a[88:91], v[196:199], v[168:171], 0
    v_cvt_pk_bf16_f32 v178, v208, v209
    s_waitcnt lgkmcnt(2)
    v_mfma_f32_16x16x32_bf16 a[92:95], v[196:199], v[172:175], 0
    ds_read_b64_tr_b16 v[196:197], v219 offset:8192
    ds_read_b64_tr_b16 v[198:199], v219 offset:10240
    v_mfma_f32_16x16x32_bf16 a[96:99], v[200:203], v[160:163], 0
    v_add_f32 v244, v244, v208
    v_add_f32 v244, v244, v209
    v_mfma_f32_16x16x32_bf16 a[100:103], v[200:203], v[164:167], 0
    buffer_load_dwordx4 v222, s[4:7], s50 offen offset:2048 lds
    v_mfma_f32_16x16x32_bf16 a[104:107], v[200:203], v[168:171], 0
    v_exp_f32 v210, v146
    v_mfma_f32_16x16x32_bf16 a[108:111], v[200:203], v[172:175], 0
    ds_read_b64_tr_b16 v[200:201], v220 offset:8192
    ds_read_b64_tr_b16 v[202:203], v220 offset:10240
    v_mfma_f32_16x16x32_bf16 a[112:115], v[204:207], v[160:163], 0
    v_exp_f32 v211, v147
    v_mfma_f32_16x16x32_bf16 a[116:119], v[204:207], v[164:167], 0
    buffer_load_dwordx4 v222, s[4:7], s51 offen offset:3072 lds
    v_mfma_f32_16x16x32_bf16 a[120:123], v[204:207], v[168:171], 0
    v_cvt_pk_bf16_f32 v179, v210, v211
    s_waitcnt lgkmcnt(2)
    v_mfma_f32_16x16x32_bf16 a[124:127], v[204:207], v[172:175], 0
    ds_read_b64_tr_b16 v[204:205], v221 offset:8192
    ds_read_b64_tr_b16 v[206:207], v221 offset:10240
    v_mfma_f32_16x16x32_bf16 a[128:131], v[192:195], v[160:163], 0
    v_add_u32 v222, 0x8000, v222
    v_add_f32 v244, v244, v210
    v_mfma_f32_16x16x32_bf16 a[132:135], v[192:195], v[164:167], 0
    v_add_f32 v244, v244, v211
    v_mfma_f32_16x16x32_bf16 a[136:139], v[192:195], v[168:171], 0
    v_exp_f32 v212, v148
    v_mfma_f32_16x16x32_bf16 a[140:143], v[192:195], v[172:175], 0
    ds_read_b64_tr_b16 v[192:193], v218 offset:12288
    ds_read_b64_tr_b16 v[194:195], v218 offset:14336
    v_add_f32 v245, v245, v212
    v_mfma_f32_16x16x32_bf16 a[144:147], v[196:199], v[160:163], 0
    v_exp_f32 v213, v149
    v_mfma_f32_16x16x32_bf16 a[148:151], v[196:199], v[164:167], 0
    v_cvt_pk_bf16_f32 v182, v212, v213
    v_add_f32 v245, v245, v213
    v_mfma_f32_16x16x32_bf16 a[152:155], v[196:199], v[168:171], 0
    s_waitcnt lgkmcnt(2)
    v_mfma_f32_16x16x32_bf16 a[156:159], v[196:199], v[172:175], 0
    ds_read_b64_tr_b16 v[196:197], v219 offset:12288
    ds_read_b64_tr_b16 v[198:199], v219 offset:14336
    v_mfma_f32_16x16x32_bf16 a[160:163], v[200:203], v[160:163], 0
    v_exp_f32 v214, v150
    v_mfma_f32_16x16x32_bf16 a[164:167], v[200:203], v[164:167], 0
    v_exp_f32 v215, v151
    v_add_f32 v245, v245, v214
    v_mfma_f32_16x16x32_bf16 a[168:171], v[200:203], v[168:171], 0
    v_cvt_pk_bf16_f32 v183, v214, v215
    v_add_f32 v245, v245, v215
    v_mfma_f32_16x16x32_bf16 a[172:175], v[200:203], v[172:175], 0
    ds_read_b64_tr_b16 v[200:201], v220 offset:12288
    ds_read_b64_tr_b16 v[202:203], v220 offset:14336
    v_mfma_f32_16x16x32_bf16 a[176:179], v[204:207], v[160:163], 0
    v_exp_f32 v248, v152
    v_mfma_f32_16x16x32_bf16 a[180:183], v[204:207], v[164:167], 0
    v_exp_f32 v249, v153
    v_mfma_f32_16x16x32_bf16 a[184:187], v[204:207], v[168:171], 0
    v_cvt_pk_bf16_f32 v186, v248, v249
    s_waitcnt lgkmcnt(2)
    v_mfma_f32_16x16x32_bf16 a[188:191], v[204:207], v[172:175], 0
    ds_read_b64_tr_b16 v[204:205], v221 offset:12288
    ds_read_b64_tr_b16 v[206:207], v221 offset:14336
    v_mfma_f32_16x16x32_bf16 a[192:195], v[192:195], v[160:163], 0
    v_add_f32 v246, v246, v248
    v_add_f32 v246, v246, v249
    v_mfma_f32_16x16x32_bf16 a[196:199], v[192:195], v[164:167], 0
    v_exp_f32 v250, v154
    v_mfma_f32_16x16x32_bf16 a[200:203], v[192:195], v[168:171], 0
    v_exp_f32 v251, v155
    v_mfma_f32_16x16x32_bf16 a[204:207], v[192:195], v[172:175], 0
    ds_read_b128 v[192:195], v216 offset:0
    v_cvt_pk_bf16_f32 v187, v250, v251
    v_mfma_f32_16x16x32_bf16 a[208:211], v[196:199], v[160:163], 0
    v_add_f32 v246, v246, v250
    v_add_f32 v246, v246, v251
    v_mfma_f32_16x16x32_bf16 a[212:215], v[196:199], v[164:167], 0
    v_exp_f32 v208, v156
    v_mfma_f32_16x16x32_bf16 a[216:219], v[196:199], v[168:171], 0
    v_exp_f32 v209, v157
    v_mfma_f32_16x16x32_bf16 a[220:223], v[196:199], v[172:175], 0
    ds_read_b128 v[196:199], v217 offset:0
    s_waitcnt lgkmcnt(2)
    v_mfma_f32_16x16x32_bf16 a[224:227], v[200:203], v[160:163], 0
    v_cvt_pk_bf16_f32 v190, v208, v209
    v_add_f32 v247, v247, v208
    v_mfma_f32_16x16x32_bf16 a[228:231], v[200:203], v[164:167], 0
    v_add_f32 v247, v247, v209
    v_max3_f32 v252, v244, v245, v246
    v_mfma_f32_16x16x32_bf16 a[232:235], v[200:203], v[168:171], 0
    v_exp_f32 v210, v158
    v_mfma_f32_16x16x32_bf16 a[236:239], v[200:203], v[172:175], 0
    ds_read_b128 v[200:203], v216 offset:4096
    v_add_f32 v247, v247, v210
    v_mfma_f32_16x16x32_bf16 a[240:243], v[204:207], v[160:163], 0
    v_exp_f32 v211, v159
    v_mfma_f32_16x16x32_bf16 a[244:247], v[204:207], v[164:167], 0
    v_cvt_pk_bf16_f32 v191, v210, v211
    v_add_f32 v247, v247, v211
    v_mfma_f32_16x16x32_bf16 a[248:251], v[204:207], v[168:171], 0
    v_max_f32 v252, v252, v247
    v_cmp_nge_f32 vcc, s53, v252
    v_mfma_f32_16x16x32_bf16 a[252:255], v[204:207], v[172:175], 0
    ds_read_b128 v[204:207], v217 offset:4096
    s_cbranch_vccnz L_stub0
L_back0:
    s_mov_b32 s43, 14
    s_mov_b32 s96, 262144
    s_mov_b32 s97, 196608
.p2align 6
L_k2_loop:
    s_waitcnt vmcnt(8)
    s_barrier
    s_waitcnt lgkmcnt(2)
    v_mfma_f32_16x16x32_bf16 v[128:131], v[192:195], v[0:3], v[224:227]
    v_mfma_f32_16x16x32_bf16 v[132:135], v[192:195], v[32:35], v[228:231]
    buffer_load_dword v255, v254, s[8:11], s97 offen
    v_mfma_f32_16x16x32_bf16 v[136:139], v[192:195], v[64:67], v[232:235]
    v_add_f32 v240, v240, v244
    v_mfma_f32_16x16x32_bf16 v[140:143], v[192:195], v[96:99], v[236:239]
    ds_read_b128 v[192:195], v216 offset:8192
    v_mfma_f32_16x16x32_bf16 v[128:131], v[196:199], v[4:7], v[128:131]
    s_add_u32 s97, s97, 65536
    s_add_u32 m0, s52, 65536
    v_mfma_f32_16x16x32_bf16 v[132:135], v[196:199], v[36:39], v[132:135]
    buffer_load_dwordx4 v223, s[8:11], s44 offen offset:0 lds
    v_mfma_f32_16x16x32_bf16 v[136:139], v[196:199], v[68:71], v[136:139]
    v_add_f32 v241, v241, v245
    v_mfma_f32_16x16x32_bf16 v[140:143], v[196:199], v[100:103], v[140:143]
    ds_read_b128 v[196:199], v217 offset:8192
    s_waitcnt lgkmcnt(2)
    v_mfma_f32_16x16x32_bf16 v[128:131], v[200:203], v[8:11], v[128:131]
    v_mfma_f32_16x16x32_bf16 v[132:135], v[200:203], v[40:43], v[132:135]
    buffer_load_dwordx4 v223, s[8:11], s45 offen offset:1024 lds
    v_mfma_f32_16x16x32_bf16 v[136:139], v[200:203], v[72:75], v[136:139]
    v_add_f32 v242, v242, v246
    v_mfma_f32_16x16x32_bf16 v[140:143], v[200:203], v[104:107], v[140:143]
    ds_read_b128 v[200:203], v216 offset:12288
    v_mfma_f32_16x16x32_bf16 v[128:131], v[204:207], v[12:15], v[128:131]
    v_mfma_f32_16x16x32_bf16 v[132:135], v[204:207], v[44:47], v[132:135]
    buffer_load_dwordx4 v223, s[8:11], s46 offen offset:2048 lds
    v_mfma_f32_16x16x32_bf16 v[136:139], v[204:207], v[76:79], v[136:139]
    v_add_f32 v243, v243, v247
    v_mfma_f32_16x16x32_bf16 v[140:143], v[204:207], v[108:111], v[140:143]
    ds_read_b128 v[204:207], v217 offset:12288
    s_waitcnt lgkmcnt(2)
    v_mfma_f32_16x16x32_bf16 v[128:131], v[192:195], v[16:19], v[128:131]
    v_mfma_f32_16x16x32_bf16 v[132:135], v[192:195], v[48:51], v[132:135]
    buffer_load_dwordx4 v223, s[8:11], s47 offen offset:3072 lds
    v_mfma_f32_16x16x32_bf16 v[136:139], v[192:195], v[80:83], v[136:139]
    v_mfma_f32_16x16x32_bf16 v[140:143], v[192:195], v[112:115], v[140:143]
    ds_read_b128 v[192:195], v216 offset:2048
    v_mfma_f32_16x16x32_bf16 v[128:131], v[196:199], v[20:23], v[128:131]
    s_add_u32 m0, s52, 81920
    v_mfma_f32_16x16x32_bf16 v[132:135], v[196:199], v[52:55], v[132:135]
    buffer_load_dwordx4 v223, s[8:11], s48 offen offset:0 lds
    v_mfma_f32_16x16x32_bf16 v[136:139], v[196:199], v[84:87], v[136:139]
    v_mfma_f32_16x16x32_bf16 v[140:143], v[196:199], v[116:119], v[140:143]
    ds_read_b128 v[196:199], v217 offset:2048
    s_waitcnt lgkmcnt(2)
    v_mfma_f32_16x16x32_bf16 v[128:131], v[200:203], v[24:27], v[128:131]
    v_mfma_f32_16x16x32_bf16 v[132:135], v[200:203], v[56:59], v[132:135]
    buffer_load_dwordx4 v223, s[8:11], s49 offen offset:1024 lds
    v_mfma_f32_16x16x32_bf16 v[136:139], v[200:203], v[88:91], v[136:139]
    v_mfma_f32_16x16x32_bf16 v[140:143], v[200:203], v[120:123], v[140:143]
    ds_read_b128 v[200:203], v216 offset:6144
    v_mfma_f32_16x16x32_bf16 v[128:131], v[204:207], v[28:31], v[128:131]
    v_mfma_f32_16x16x32_bf16 v[132:135], v[204:207], v[60:63], v[132:135]
    buffer_load_dwordx4 v223, s[8:11], s50 offen offset:2048 lds
    v_mfma_f32_16x16x32_bf16 v[136:139], v[204:207], v[92:95], v[136:139]
    v_mfma_f32_16x16x32_bf16 v[140:143], v[204:207], v[124:127], v[140:143]
    ds_read_b128 v[204:207], v217 offset:6144
    s_waitcnt lgkmcnt(2)
    v_mfma_f32_16x16x32_bf16 v[144:147], v[192:195], v[0:3], v[224:227]
    v_mfma_f32_16x16x32_bf16 v[148:151], v[192:195], v[32:35], v[228:231]
    buffer_load_dwordx4 v223, s[8:11], s51 offen offset:3072 lds
    v_mfma_f32_16x16x32_bf16 v[152:155], v[192:195], v[64:67], v[232:235]
    v_exp_f32 v248, v128
    v_mfma_f32_16x16x32_bf16 v[156:159], v[192:195], v[96:99], v[236:239]
    ds_read_b128 v[192:195], v216 offset:10240
    v_mfma_f32_16x16x32_bf16 v[144:147], v[196:199], v[4:7], v[144:147]
    v_add_u32 v223, 0x8000, v223
    v_mfma_f32_16x16x32_bf16 v[148:151], v[196:199], v[36:39], v[148:151]
    v_exp_f32 v249, v129
    v_mfma_f32_16x16x32_bf16 v[152:155], v[196:199], v[68:71], v[152:155]
    v_cvt_pk_bf16_f32 v160, v248, v249
    v_add_f32 v244, v248, v249
    v_mfma_f32_16x16x32_bf16 v[156:159], v[196:199], v[100:103], v[156:159]
    ds_read_b128 v[196:199], v217 offset:10240
    s_waitcnt lgkmcnt(2)
    v_mfma_f32_16x16x32_bf16 v[144:147], v[200:203], v[8:11], v[144:147]
    v_exp_f32 v250, v130
    v_mfma_f32_16x16x32_bf16 v[148:151], v[200:203], v[40:43], v[148:151]
    v_exp_f32 v251, v131
    v_mfma_f32_16x16x32_bf16 v[152:155], v[200:203], v[72:75], v[152:155]
    v_cvt_pk_bf16_f32 v161, v250, v251
    v_add_f32 v244, v244, v250
    v_mfma_f32_16x16x32_bf16 v[156:159], v[200:203], v[104:107], v[156:159]
    ds_read_b128 v[200:203], v216 offset:14336
    v_add_f32 v244, v244, v251
    v_mfma_f32_16x16x32_bf16 v[144:147], v[204:207], v[12:15], v[144:147]
    v_exp_f32 v208, v132
    v_mfma_f32_16x16x32_bf16 v[148:151], v[204:207], v[44:47], v[148:151]
    v_exp_f32 v209, v133
    v_mfma_f32_16x16x32_bf16 v[152:155], v[204:207], v[76:79], v[152:155]
    v_cvt_pk_bf16_f32 v164, v208, v209
    v_add_f32 v245, v208, v209
    v_mfma_f32_16x16x32_bf16 v[156:159], v[204:207], v[108:111], v[156:159]
    ds_read_b128 v[204:207], v217 offset:14336
    s_waitcnt lgkmcnt(2)
    v_mfma_f32_16x16x32_bf16 v[144:147], v[192:195], v[16:19], v[144:147]
    v_exp_f32 v210, v134
    v_mfma_f32_16x16x32_bf16 v[148:151], v[192:195], v[48:51], v[148:151]
    v_exp_f32 v211, v135
    v_mfma_f32_16x16x32_bf16 v[152:155], v[192:195], v[80:83], v[152:155]
    v_cvt_pk_bf16_f32 v165, v210, v211
    v_add_f32 v245, v245, v210
    v_mfma_f32_16x16x32_bf16 v[156:159], v[192:195], v[112:115], v[156:159]
    ds_read_b64_tr_b16 v[192:193], v218 offset:32768
    ds_read_b64_tr_b16 v[194:195], v218 offset:34816
    v_mfma_f32_16x16x32_bf16 v[144:147], v[196:199], v[20:23], v[144:147]
    v_add_f32 v245, v245, v211
    v_mfma_f32_16x16x32_bf16 v[148:151], v[196:199], v[52:55], v[148:151]
    v_exp_f32 v212, v136
    v_mfma_f32_16x16x32_bf16 v[152:155], v[196:199], v[84:87], v[152:155]
    s_waitcnt lgkmcnt(2)
    v_mfma_f32_16x16x32_bf16 v[156:159], v[196:199], v[116:119], v[156:159]
    ds_read_b64_tr_b16 v[196:197], v219 offset:32768
    ds_read_b64_tr_b16 v[198:199], v219 offset:34816
    v_mfma_f32_16x16x32_bf16 v[144:147], v[200:203], v[24:27], v[144:147]
    v_exp_f32 v213, v137
    v_mfma_f32_16x16x32_bf16 v[148:151], v[200:203], v[56:59], v[148:151]
    v_cvt_pk_bf16_f32 v168, v212, v213
    v_add_f32 v246, v212, v213
    v_mfma_f32_16x16x32_bf16 v[152:155], v[200:203], v[88:91], v[152:155]
    v_exp_f32 v214, v138
    v_mfma_f32_16x16x32_bf16 v[156:159], v[200:203], v[120:123], v[156:159]
    ds_read_b64_tr_b16 v[200:201], v220 offset:32768
    ds_read_b64_tr_b16 v[202:203], v220 offset:34816
    v_mfma_f32_16x16x32_bf16 v[144:147], v[204:207], v[28:31], v[144:147]
    v_exp_f32 v215, v139
    v_mfma_f32_16x16x32_bf16 v[148:151], v[204:207], v[60:63], v[148:151]
    v_cvt_pk_bf16_f32 v169, v214, v215
    v_add_f32 v246, v246, v214
    v_mfma_f32_16x16x32_bf16 v[152:155], v[204:207], v[92:95], v[152:155]
    v_add_f32 v246, v246, v215
    v_mfma_f32_16x16x32_bf16 v[156:159], v[204:207], v[124:127], v[156:159]
    ds_read_b64_tr_b16 v[204:205], v221 offset:32768
    ds_read_b64_tr_b16 v[206:207], v221 offset:34816
    s_waitcnt vmcnt(9)
    s_barrier
    s_waitcnt lgkmcnt(4)
    v_mfma_f32_16x16x32_bf16 a[0:3], v[192:195], v[176:179], a[0:3]
    s_add_u32 m0, s52, 0
    v_mfma_f32_16x16x32_bf16 a[4:7], v[192:195], v[180:183], a[4:7]
    buffer_load_dwordx4 v222, s[4:7], s44 offen offset:0 lds
    v_mfma_f32_16x16x32_bf16 a[8:11], v[192:195], v[184:187], a[8:11]
    v_exp_f32 v248, v140
    v_mfma_f32_16x16x32_bf16 a[12:15], v[192:195], v[188:191], a[12:15]
    ds_read_b64_tr_b16 v[192:193], v218 offset:36864
    ds_read_b64_tr_b16 v[194:195], v218 offset:38912
    v_mfma_f32_16x16x32_bf16 a[16:19], v[196:199], v[176:179], a[16:19]
    v_exp_f32 v249, v141
    v_mfma_f32_16x16x32_bf16 a[20:23], v[196:199], v[180:183], a[20:23]
    buffer_load_dwordx4 v222, s[4:7], s45 offen offset:1024 lds
    v_mfma_f32_16x16x32_bf16 a[24:27], v[196:199], v[184:187], a[24:27]
    v_cvt_pk_bf16_f32 v172, v248, v249
    s_waitcnt lgkmcnt(2)
    v_mfma_f32_16x16x32_bf16 a[28:31], v[196:199], v[188:191], a[28:31]
    ds_read_b64_tr_b16 v[196:197], v219 offset:36864
    ds_read_b64_tr_b16 v[198:199], v219 offset:38912
    v_mfma_f32_16x16x32_bf16 a[32:35], v[200:203], v[176:179], a[32:35]
    v_add_f32 v247, v248, v249
    v_mfma_f32_16x16x32_bf16 a[36:39], v[200:203], v[180:183], a[36:39]
    buffer_load_dwordx4 v222, s[4:7], s46 offen offset:2048 lds
    v_mfma_f32_16x16x32_bf16 a[40:43], v[200:203], v[184:187], a[40:43]
    v_exp_f32 v250, v142
    v_mfma_f32_16x16x32_bf16 a[44:47], v[200:203], v[188:191], a[44:47]
    ds_read_b64_tr_b16 v[200:201], v220 offset:36864
    ds_read_b64_tr_b16 v[202:203], v220 offset:38912
    v_add_f32 v247, v247, v250
    v_mfma_f32_16x16x32_bf16 a[48:51], v[204:207], v[176:179], a[48:51]
    v_exp_f32 v251, v143
    v_mfma_f32_16x16x32_bf16 a[52:55], v[204:207], v[180:183], a[52:55]
    buffer_load_dwordx4 v222, s[4:7], s47 offen offset:3072 lds
    v_mfma_f32_16x16x32_bf16 a[56:59], v[204:207], v[184:187], a[56:59]
    v_cvt_pk_bf16_f32 v173, v250, v251
    s_waitcnt lgkmcnt(2)
    v_mfma_f32_16x16x32_bf16 a[60:63], v[204:207], v[188:191], a[60:63]
    ds_read_b64_tr_b16 v[204:205], v221 offset:36864
    ds_read_b64_tr_b16 v[206:207], v221 offset:38912
    v_mfma_f32_16x16x32_bf16 a[64:67], v[192:195], v[176:179], a[64:67]
    s_add_u32 m0, s52, 16384
    v_add_f32 v247, v247, v251
    v_mfma_f32_16x16x32_bf16 a[68:71], v[192:195], v[180:183], a[68:71]
    buffer_load_dwordx4 v222, s[4:7], s48 offen offset:0 lds
    v_mfma_f32_16x16x32_bf16 a[72:75], v[192:195], v[184:187], a[72:75]
    v_exp_f32 v208, v144
    v_mfma_f32_16x16x32_bf16 a[76:79], v[192:195], v[188:191], a[76:79]
    ds_read_b64_tr_b16 v[192:193], v218 offset:40960
    ds_read_b64_tr_b16 v[194:195], v218 offset:43008
    v_mfma_f32_16x16x32_bf16 a[80:83], v[196:199], v[176:179], a[80:83]
    v_exp_f32 v209, v145
    v_mfma_f32_16x16x32_bf16 a[84:87], v[196:199], v[180:183], a[84:87]
    buffer_load_dwordx4 v222, s[4:7], s49 offen offset:1024 lds
    v_mfma_f32_16x16x32_bf16 a[88:91], v[196:199], v[184:187], a[88:91]
    v_cvt_pk_bf16_f32 v162, v208, v209
    s_waitcnt lgkmcnt(2)
    v_mfma_f32_16x16x32_bf16 a[92:95], v[196:199], v[188:191], a[92:95]
    ds_read_b64_tr_b16 v[196:197], v219 offset:40960
    ds_read_b64_tr_b16 v[198:199], v219 offset:43008
    v_mfma_f32_16x16x32_bf16 a[96:99], v[200:203], v[176:179], a[96:99]
    v_add_f32 v244, v244, v208
    v_add_f32 v244, v244, v209
    v_mfma_f32_16x16x32_bf16 a[100:103], v[200:203], v[180:183], a[100:103]
    buffer_load_dwordx4 v222, s[4:7], s50 offen offset:2048 lds
    v_mfma_f32_16x16x32_bf16 a[104:107], v[200:203], v[184:187], a[104:107]
    v_exp_f32 v210, v146
    v_mfma_f32_16x16x32_bf16 a[108:111], v[200:203], v[188:191], a[108:111]
    ds_read_b64_tr_b16 v[200:201], v220 offset:40960
    ds_read_b64_tr_b16 v[202:203], v220 offset:43008
    v_mfma_f32_16x16x32_bf16 a[112:115], v[204:207], v[176:179], a[112:115]
    v_exp_f32 v211, v147
    v_mfma_f32_16x16x32_bf16 a[116:119], v[204:207], v[180:183], a[116:119]
    buffer_load_dwordx4 v222, s[4:7], s51 offen offset:3072 lds
    v_mfma_f32_16x16x32_bf16 a[120:123], v[204:207], v[184:187], a[120:123]
    v_cvt_pk_bf16_f32 v163, v210, v211
    s_waitcnt lgkmcnt(2)
    v_mfma_f32_16x16x32_bf16 a[124:127], v[204:207], v[188:191], a[124:127]
    ds_read_b64_tr_b16 v[204:205], v221 offset:40960
    ds_read_b64_tr_b16 v[206:207], v221 offset:43008
    v_mfma_f32_16x16x32_bf16 a[128:131], v[192:195], v[176:179], a[128:131]
    v_add_u32 v222, 0x8000, v222
    v_add_f32 v244, v244, v210
    v_mfma_f32_16x16x32_bf16 a[132:135], v[192:195], v[180:183], a[132:135]
    v_add_f32 v244, v244, v211
    v_mfma_f32_16x16x32_bf16 a[136:139], v[192:195], v[184:187], a[136:139]
    v_exp_f32 v212, v148
    v_mfma_f32_16x16x32_bf16 a[140:143], v[192:195], v[188:191], a[140:143]
    ds_read_b64_tr_b16 v[192:193], v218 offset:45056
    ds_read_b64_tr_b16 v[194:195], v218 offset:47104
    v_add_f32 v245, v245, v212
    v_mfma_f32_16x16x32_bf16 a[144:147], v[196:199], v[176:179], a[144:147]
    v_exp_f32 v213, v149
    v_mfma_f32_16x16x32_bf16 a[148:151], v[196:199], v[180:183], a[148:151]
    v_cvt_pk_bf16_f32 v166, v212, v213
    v_add_f32 v245, v245, v213
    v_mfma_f32_16x16x32_bf16 a[152:155], v[196:199], v[184:187], a[152:155]
    s_waitcnt lgkmcnt(2)
    v_mfma_f32_16x16x32_bf16 a[156:159], v[196:199], v[188:191], a[156:159]
    ds_read_b64_tr_b16 v[196:197], v219 offset:45056
    ds_read_b64_tr_b16 v[198:199], v219 offset:47104
    v_mfma_f32_16x16x32_bf16 a[160:163], v[200:203], v[176:179], a[160:163]
    v_exp_f32 v214, v150
    v_mfma_f32_16x16x32_bf16 a[164:167], v[200:203], v[180:183], a[164:167]
    v_exp_f32 v215, v151
    v_add_f32 v245, v245, v214
    v_mfma_f32_16x16x32_bf16 a[168:171], v[200:203], v[184:187], a[168:171]
    v_cvt_pk_bf16_f32 v167, v214, v215
    v_add_f32 v245, v245, v215
    v_mfma_f32_16x16x32_bf16 a[172:175], v[200:203], v[188:191], a[172:175]
    ds_read_b64_tr_b16 v[200:201], v220 offset:45056
    ds_read_b64_tr_b16 v[202:203], v220 offset:47104
    v_mfma_f32_16x16x32_bf16 a[176:179], v[204:207], v[176:179], a[176:179]
    v_exp_f32 v248, v152
    v_mfma_f32_16x16x32_bf16 a[180:183], v[204:207], v[180:183], a[180:183]
    v_exp_f32 v249, v153
    v_mfma_f32_16x16x32_bf16 a[184:187], v[204:207], v[184:187], a[184:187]
    v_cvt_pk_bf16_f32 v170, v248, v249
    s_waitcnt lgkmcnt(2)
    v_mfma_f32_16x16x32_bf16 a[188:191], v[204:207], v[188:191], a[188:191]
    ds_read_b64_tr_b16 v[204:205], v221 offset:45056
    ds_read_b64_tr_b16 v[206:207], v221 offset:47104
    v_mfma_f32_16x16x32_bf16 a[192:195], v[192:195], v[176:179], a[192:195]
    v_add_f32 v246, v246, v248
    v_add_f32 v246, v246, v249
    v_mfma_f32_16x16x32_bf16 a[196:199], v[192:195], v[180:183], a[196:199]
    v_exp_f32 v250, v154
    v_mfma_f32_16x16x32_bf16 a[200:203], v[192:195], v[184:187], a[200:203]
    v_exp_f32 v251, v155
    v_mfma_f32_16x16x32_bf16 a[204:207], v[192:195], v[188:191], a[204:207]
    ds_read_b128 v[192:195], v216 offset:32768
    v_cvt_pk_bf16_f32 v171, v250, v251
    v_mfma_f32_16x16x32_bf16 a[208:211], v[196:199], v[176:179], a[208:211]
    v_add_f32 v246, v246, v250
    v_add_f32 v246, v246, v251
    v_mfma_f32_16x16x32_bf16 a[212:215], v[196:199], v[180:183], a[212:215]
    v_exp_f32 v208, v156
    v_mfma_f32_16x16x32_bf16 a[216:219], v[196:199], v[184:187], a[216:219]
    v_exp_f32 v209, v157
    v_mfma_f32_16x16x32_bf16 a[220:223], v[196:199], v[188:191], a[220:223]
    ds_read_b128 v[196:199], v217 offset:32768
    s_waitcnt lgkmcnt(2)
    v_mfma_f32_16x16x32_bf16 a[224:227], v[200:203], v[176:179], a[224:227]
    v_cvt_pk_bf16_f32 v174, v208, v209
    v_add_f32 v247, v247, v208
    v_mfma_f32_16x16x32_bf16 a[228:231], v[200:203], v[180:183], a[228:231]
    v_add_f32 v247, v247, v209
    v_max3_f32 v252, v244, v245, v246
    v_mfma_f32_16x16x32_bf16 a[232:235], v[200:203], v[184:187], a[232:235]
    v_exp_f32 v210, v158
    v_mfma_f32_16x16x32_bf16 a[236:239], v[200:203], v[188:191], a[236:239]
    ds_read_b128 v[200:203], v216 offset:36864
    v_add_f32 v247, v247, v210
    v_mfma_f32_16x16x32_bf16 a[240:243], v[204:207], v[176:179], a[240:243]
    v_exp_f32 v211, v159
    v_mfma_f32_16x16x32_bf16 a[244:247], v[204:207], v[180:183], a[244:247]
    v_cvt_pk_bf16_f32 v175, v210, v211
    v_add_f32 v247, v247, v211
    v_mfma_f32_16x16x32_bf16 a[248:251], v[204:207], v[184:187], a[248:251]
    v_max_f32 v252, v252, v247
    v_cmp_nge_f32 vcc, s53, v252
    v_mfma_f32_16x16x32_bf16 a[252:255], v[204:207], v[188:191], a[252:255]
    ds_read_b128 v[204:207], v217 offset:36864
    s_cbranch_vccnz L_stub1
L_back1:
    s_waitcnt vmcnt(8)
    s_barrier
    s_waitcnt lgkmcnt(2)
    v_mfma_f32_16x16x32_bf16 v[128:131], v[192:195], v[0:3], v[224:227]
    v_mfma_f32_16x16x32_bf16 v[132:135], v[192:195], v[32:35], v[228:231]
    buffer_load_dword v255, v254, s[4:7], s96 offen
    v_mfma_f32_16x16x32_bf16 v[136:139], v[192:195], v[64:67], v[232:235]
    v_add_f32 v240, v240, v244
    v_mfma_f32_16x16x32_bf16 v[140:143], v[192:195], v[96:99], v[236:239]
    ds_read_b128 v[192:195], v216 offset:40960
    v_mfma_f32_16x16x32_bf16 v[128:131], v[196:199], v[4:7], v[128:131]
    s_add_u32 s96, s96, 65536
    s_add_u32 m0, s52, 98304
    v_mfma_f32_16x16x32_bf16 v[132:135], v[196:199], v[36:39], v[132:135]
    buffer_load_dwordx4 v223, s[8:11], s44 offen offset:0 lds
    v_mfma_f32_16x16x32_bf16 v[136:139], v[196:199], v[68:71], v[136:139]
    v_add_f32 v241, v241, v245
    v_mfma_f32_16x16x32_bf16 v[140:143], v[196:199], v[100:103], v[140:143]
    ds_read_b128 v[196:199], v217 offset:40960
    s_waitcnt lgkmcnt(2)
    v_mfma_f32_16x16x32_bf16 v[128:131], v[200:203], v[8:11], v[128:131]
    v_mfma_f32_16x16x32_bf16 v[132:135], v[200:203], v[40:43], v[132:135]
    buffer_load_dwordx4 v223, s[8:11], s45 offen offset:1024 lds
    v_mfma_f32_16x16x32_bf16 v[136:139], v[200:203], v[72:75], v[136:139]
    v_add_f32 v242, v242, v246
    v_mfma_f32_16x16x32_bf16 v[140:143], v[200:203], v[104:107], v[140:143]
    ds_read_b128 v[200:203], v216 offset:45056
    v_mfma_f32_16x16x32_bf16 v[128:131], v[204:207], v[12:15], v[128:131]
    v_mfma_f32_16x16x32_bf16 v[132:135], v[204:207], v[44:47], v[132:135]
    buffer_load_dwordx4 v223, s[8:11], s46 offen offset:2048 lds
    v_mfma_f32_16x16x32_bf16 v[136:139], v[204:207], v[76:79], v[136:139]
    v_add_f32 v243, v243, v247
    v_mfma_f32_16x16x32_bf16 v[140:143], v[204:207], v[108:111], v[140:143]
    ds_read_b128 v[204:207], v217 offset:45056
    s_waitcnt lgkmcnt(2)
    v_mfma_f32_16x16x32_bf16 v[128:131], v[192:195], v[16:19], v[128:131]
    v_mfma_f32_16x16x32_bf16 v[132:135], v[192:195], v[48:51], v[132:135]
    buffer_load_dwordx4 v223, s[8:11], s47 offen offset:3072 lds
    v_mfma_f32_16x16x32_bf16 v[136:139], v[192:195], v[80:83], v[136:139]
    v_mfma_f32_16x16x32_bf16 v[140:143], v[192:195], v[112:115], v[140:143]
    ds_read_b128 v[192:195], v216 offset:34816
    v_mfma_f32_16x16x32_bf16 v[128:131], v[196:199], v[20:23], v[128:131]
    s_add_u32 m0, s52, 114688
    v_mfma_f32_16x16x32_bf16 v[132:135], v[196:199], v[52:55], v[132:135]
    buffer_load_dwordx4 v223, s[8:11], s48 offen offset:0 lds
    v_mfma_f32_16x16x32_bf16 v[136:139], v[196:199], v[84:87], v[136:139]
    v_mfma_f32_16x16x32_bf16 v[140:143], v[196:199], v[116:119], v[140:143]
    ds_read_b128 v[196:199], v217 offset:34816
    s_waitcnt lgkmcnt(2)
    v_mfma_f32_16x16x32_bf16 v[128:131], v[200:203], v[24:27], v[128:131]
    v_mfma_f32_16x16x32_bf16 v[132:135], v[200:203], v[56:59], v[132:135]
    buffer_load_dwordx4 v223, s[8:11], s49 offen offset:1024 lds
    v_mfma_f32_16x16x32_bf16 v[136:139], v[200:203], v[88:91], v[136:139]
    v_mfma_f32_16x16x32_bf16 v[140:143], v[200:203], v[120:123], v[140:143]
    ds_read_b128 v[200:203], v216 offset:38912
    v_mfma_f32_16x16x32_bf16 v[128:131], v[204:207], v[28:31], v[128:131]
    v_mfma_f32_16x16x32_bf16 v[132:135], v[204:207], v[60:63], v[132:135]
    buffer_load_dwordx4 v223, s[8:11], s50 offen offset:2048 lds
    v_mfma_f32_16x16x32_bf16 v[136:139], v[204:207], v[92:95], v[136:139]
    v_mfma_f32_16x16x32_bf16 v[140:143], v[204:207], v[124:127], v[140:143]
    ds_read_b128 v[204:207], v217 offset:38912
    s_waitcnt lgkmcnt(2)
    v_mfma_f32_16x16x32_bf16 v[144:147], v[192:195], v[0:3], v[224:227]
    v_mfma_f32_16x16x32_bf16 v[148:151], v[192:195], v[32:35], v[228:231]
    buffer_load_dwordx4 v223, s[8:11], s51 offen offset:3072 lds
    v_mfma_f32_16x16x32_bf16 v[152:155], v[192:195], v[64:67], v[232:235]
    v_exp_f32 v248, v128
    v_mfma_f32_16x16x32_bf16 v[156:159], v[192:195], v[96:99], v[236:239]
    ds_read_b128 v[192:195], v216 offset:43008
    v_mfma_f32_16x16x32_bf16 v[144:147], v[196:199], v[4:7], v[144:147]
    v_add_u32 v223, 0x8000, v223
    v_mfma_f32_16x16x32_bf16 v[148:151], v[196:199], v[36:39], v[148:151]
    v_exp_f32 v249, v129
    v_mfma_f32_16x16x32_bf16 v[152:155], v[196:199], v[68:71], v[152:155]
    v_cvt_pk_bf16_f32 v176, v248, v249
    v_add_f32 v244, v248, v249
    v_mfma_f32_16x16x32_bf16 v[156:159], v[196:199], v[100:103], v[156:159]
    ds_read_b128 v[196:199], v217 offset:43008
    s_waitcnt lgkmcnt(2)
    v_mfma_f32_16x16x32_bf16 v[144:147], v[200:203], v[8:11], v[144:147]
    v_exp_f32 v250, v130
    v_mfma_f32_16x16x32_bf16 v[148:151], v[200:203], v[40:43], v[148:151]
    v_exp_f32 v251, v131
    v_mfma_f32_16x16x32_bf16 v[152:155], v[200:203], v[72:75], v[152:155]
    v_cvt_pk_bf16_f32 v177, v250, v251
    v_add_f32 v244, v244, v250
    v_mfma_f32_16x16x32_bf16 v[156:159], v[200:203], v[104:107], v[156:159]
    ds_read_b128 v[200:203], v216 offset:47104
    v_add_f32 v244, v244, v251
    v_mfma_f32_16x16x32_bf16 v[144:147], v[204:207], v[12:15], v[144:147]
    v_exp_f32 v208, v132
    v_mfma_f32_16x16x32_bf16 v[148:151], v[204:207], v[44:47], v[148:151]
    v_exp_f32 v209, v133
    v_mfma_f32_16x16x32_bf16 v[152:155], v[204:207], v[76:79], v[152:155]
    v_cvt_pk_bf16_f32 v180, v208, v209
    v_add_f32 v245, v208, v209
    v_mfma_f32_16x16x32_bf16 v[156:159], v[204:207], v[108:111], v[156:159]
    ds_read_b128 v[204:207], v217 offset:47104
    s_waitcnt lgkmcnt(2)
    v_mfma_f32_16x16x32_bf16 v[144:147], v[192:195], v[16:19], v[144:147]
    v_exp_f32 v210, v134
    v_mfma_f32_16x16x32_bf16 v[148:151], v[192:195], v[48:51], v[148:151]
    v_exp_f32 v211, v135
    v_mfma_f32_16x16x32_bf16 v[152:155], v[192:195], v[80:83], v[152:155]
    v_cvt_pk_bf16_f32 v181, v210, v211
    v_add_f32 v245, v245, v210
    v_mfma_f32_16x16x32_bf16 v[156:159], v[192:195], v[112:115], v[156:159]
    ds_read_b64_tr_b16 v[192:193], v218 offset:0
    ds_read_b64_tr_b16 v[194:195], v218 offset:2048
    v_mfma_f32_16x16x32_bf16 v[144:147], v[196:199], v[20:23], v[144:147]
    v_add_f32 v245, v245, v211
    v_mfma_f32_16x16x32_bf16 v[148:151], v[196:199], v[52:55], v[148:151]
    v_exp_f32 v212, v136
    v_mfma_f32_16x16x32_bf16 v[152:155], v[196:199], v[84:87], v[152:155]
    s_waitcnt lgkmcnt(2)
    v_mfma_f32_16x16x32_bf16 v[156:159], v[196:199], v[116:119], v[156:159]
    ds_read_b64_tr_b16 v[196:197], v219 offset:0
    ds_read_b64_tr_b16 v[198:199], v219 offset:2048
    v_mfma_f32_16x16x32_bf16 v[144:147], v[200:203], v[24:27], v[144:147]
    v_exp_f32 v213, v137
    v_mfma_f32_16x16x32_bf16 v[148:151], v[200:203], v[56:59], v[148:151]
    v_cvt_pk_bf16_f32 v184, v212, v213
    v_add_f32 v246, v212, v213
    v_mfma_f32_16x16x32_bf16 v[152:155], v[200:203], v[88:91], v[152:155]
    v_exp_f32 v214, v138
    v_mfma_f32_16x16x32_bf16 v[156:159], v[200:203], v[120:123], v[156:159]
    ds_read_b64_tr_b16 v[200:201], v220 offset:0
    ds_read_b64_tr_b16 v[202:203], v220 offset:2048
    v_mfma_f32_16x16x32_bf16 v[144:147], v[204:207], v[28:31], v[144:147]
    v_exp_f32 v215, v139
    v_mfma_f32_16x16x32_bf16 v[148:151], v[204:207], v[60:63], v[148:151]
    v_cvt_pk_bf16_f32 v185, v214, v215
    v_add_f32 v246, v246, v214
    v_mfma_f32_16x16x32_bf16 v[152:155], v[204:207], v[92:95], v[152:155]
    v_add_f32 v246, v246, v215
    v_mfma_f32_16x16x32_bf16 v[156:159], v[204:207], v[124:127], v[156:159]
    ds_read_b64_tr_b16 v[204:205], v221 offset:0
    ds_read_b64_tr_b16 v[206:207], v221 offset:2048
    s_waitcnt vmcnt(9)
    s_barrier
    s_waitcnt lgkmcnt(4)
    v_mfma_f32_16x16x32_bf16 a[0:3], v[192:195], v[160:163], a[0:3]
    s_add_u32 m0, s52, 32768
    v_mfma_f32_16x16x32_bf16 a[4:7], v[192:195], v[164:167], a[4:7]
    buffer_load_dwordx4 v222, s[4:7], s44 offen offset:0 lds
    v_mfma_f32_16x16x32_bf16 a[8:11], v[192:195], v[168:171], a[8:11]
    v_exp_f32 v248, v140
    v_mfma_f32_16x16x32_bf16 a[12:15], v[192:195], v[172:175], a[12:15]
    ds_read_b64_tr_b16 v[192:193], v218 offset:4096
    ds_read_b64_tr_b16 v[194:195], v218 offset:6144
    v_mfma_f32_16x16x32_bf16 a[16:19], v[196:199], v[160:163], a[16:19]
    v_exp_f32 v249, v141
    v_mfma_f32_16x16x32_bf16 a[20:23], v[196:199], v[164:167], a[20:23]
    buffer_load_dwordx4 v222, s[4:7], s45 offen offset:1024 lds
    v_mfma_f32_16x16x32_bf16 a[24:27], v[196:199], v[168:171], a[24:27]
    v_cvt_pk_bf16_f32 v188, v248, v249
    s_waitcnt lgkmcnt(2)
    v_mfma_f32_16x16x32_bf16 a[28:31], v[196:199], v[172:175], a[28:31]
    ds_read_b64_tr_b16 v[196:197], v219 offset:4096
    ds_read_b64_tr_b16 v[198:199], v219 offset:6144
    v_mfma_f32_16x16x32_bf16 a[32:35], v[200:203], v[160:163], a[32:35]
    v_add_f32 v247, v248, v249
    v_mfma_f32_16x16x32_bf16 a[36:39], v[200:203], v[164:167], a[36:39]
    buffer_load_dwordx4 v222, s[4:7], s46 offen offset:2048 lds
    v_mfma_f32_16x16x32_bf16 a[40:43], v[200:203], v[168:171], a[40:43]
    v_exp_f32 v250, v142
    v_mfma_f32_16x16x32_bf16 a[44:47], v[200:203], v[172:175], a[44:47]
    ds_read_b64_tr_b16 v[200:201], v220 offset:4096
    ds_read_b64_tr_b16 v[202:203], v220 offset:6144
    v_add_f32 v247, v247, v250
    v_mfma_f32_16x16x32_bf16 a[48:51], v[204:207], v[160:163], a[48:51]
    v_exp_f32 v251, v143
    v_mfma_f32_16x16x32_bf16 a[52:55], v[204:207], v[164:167], a[52:55]
    buffer_load_dwordx4 v222, s[4:7], s47 offen offset:3072 lds
    v_mfma_f32_16x16x32_bf16 a[56:59], v[204:207], v[168:171], a[56:59]
    v_cvt_pk_bf16_f32 v189, v250, v251
    s_waitcnt lgkmcnt(2)
    v_mfma_f32_16x16x32_bf16 a[60:63], v[204:207], v[172:175], a[60:63]
    ds_read_b64_tr_b16 v[204:205], v221 offset:4096
    ds_read_b64_tr_b16 v[206:207], v221 offset:6144
    v_mfma_f32_16x16x32_bf16 a[64:67], v[192:195], v[160:163], a[64:67]
    s_add_u32 m0, s52, 49152
    v_add_f32 v247, v247, v251
    v_mfma_f32_16x16x32_bf16 a[68:71], v[192:195], v[164:167], a[68:71]
    buffer_load_dwordx4 v222, s[4:7], s48 offen offset:0 lds
    v_mfma_f32_16x16x32_bf16 a[72:75], v[192:195], v[168:171], a[72:75]
    v_exp_f32 v208, v144
    v_mfma_f32_16x16x32_bf16 a[76:79], v[192:195], v[172:175], a[76:79]
    ds_read_b64_tr_b16 v[192:193], v218 offset:8192
    ds_read_b64_tr_b16 v[194:195], v218 offset:10240
    v_mfma_f32_16x16x32_bf16 a[80:83], v[196:199], v[160:163], a[80:83]
    v_exp_f32 v209, v145
    v_mfma_f32_16x16x32_bf16 a[84:87], v[196:199], v[164:167], a[84:87]
    buffer_load_dwordx4 v222, s[4:7], s49 offen offset:1024 lds
    v_mfma_f32_16x16x32_bf16 a[88:91], v[196:199], v[168:171], a[88:91]
    v_cvt_pk_bf16_f32 v178, v208, v209
    s_waitcnt lgkmcnt(2)
    v_mfma_f32_16x16x32_bf16 a[92:95], v[196:199], v[172:175], a[92:95]
    ds_read_b64_tr_b16 v[196:197], v219 offset:8192
    ds_read_b64_tr_b16 v[198:199], v219 offset:10240
    v_mfma_f32_16x16x32_bf16 a[96:99], v[200:203], v[160:163], a[96:99]
    v_add_f32 v244, v244, v208
    v_add_f32 v244, v244, v209
    v_mfma_f32_16x16x32_bf16 a[100:103], v[200:203], v[164:167], a[100:103]
    buffer_load_dwordx4 v222, s[4:7], s50 offen offset:2048 lds
    v_mfma_f32_16x16x32_bf16 a[104:107], v[200:203], v[168:171], a[104:107]
    v_exp_f32 v210, v146
    v_mfma_f32_16x16x32_bf16 a[108:111], v[200:203], v[172:175], a[108:111]
    ds_read_b64_tr_b16 v[200:201], v220 offset:8192
    ds_read_b64_tr_b16 v[202:203], v220 offset:10240
    v_mfma_f32_16x16x32_bf16 a[112:115], v[204:207], v[160:163], a[112:115]
    v_exp_f32 v211, v147
    v_mfma_f32_16x16x32_bf16 a[116:119], v[204:207], v[164:167], a[116:119]
    buffer_load_dwordx4 v222, s[4:7], s51 offen offset:3072 lds
    v_mfma_f32_16x16x32_bf16 a[120:123], v[204:207], v[168:171], a[120:123]
    v_cvt_pk_bf16_f32 v179, v210, v211
    s_waitcnt lgkmcnt(2)
    v_mfma_f32_16x16x32_bf16 a[124:127], v[204:207], v[172:175], a[124:127]
    ds_read_b64_tr_b16 v[204:205], v221 offset:8192
    ds_read_b64_tr_b16 v[206:207], v221 offset:10240
    v_mfma_f32_16x16x32_bf16 a[128:131], v[192:195], v[160:163], a[128:131]
    v_add_u32 v222, 0x8000, v222
    v_add_f32 v244, v244, v210
    v_mfma_f32_16x16x32_bf16 a[132:135], v[192:195], v[164:167], a[132:135]
    v_add_f32 v244, v244, v211
    v_mfma_f32_16x16x32_bf16 a[136:139], v[192:195], v[168:171], a[136:139]
    v_exp_f32 v212, v148
    v_mfma_f32_16x16x32_bf16 a[140:143], v[192:195], v[172:175], a[140:143]
    ds_read_b64_tr_b16 v[192:193], v218 offset:12288
    ds_read_b64_tr_b16 v[194:195], v218 offset:14336
    v_add_f32 v245, v245, v212
    v_mfma_f32_16x16x32_bf16 a[144:147], v[196:199], v[160:163], a[144:147]
    v_exp_f32 v213, v149
    v_mfma_f32_16x16x32_bf16 a[148:151], v[196:199], v[164:167], a[148:151]
    v_cvt_pk_bf16_f32 v182, v212, v213
    v_add_f32 v245, v245, v213
    v_mfma_f32_16x16x32_bf16 a[152:155], v[196:199], v[168:171], a[152:155]
    s_waitcnt lgkmcnt(2)
    v_mfma_f32_16x16x32_bf16 a[156:159], v[196:199], v[172:175], a[156:159]
    ds_read_b64_tr_b16 v[196:197], v219 offset:12288
    ds_read_b64_tr_b16 v[198:199], v219 offset:14336
    v_mfma_f32_16x16x32_bf16 a[160:163], v[200:203], v[160:163], a[160:163]
    v_exp_f32 v214, v150
    v_mfma_f32_16x16x32_bf16 a[164:167], v[200:203], v[164:167], a[164:167]
    v_exp_f32 v215, v151
    v_add_f32 v245, v245, v214
    v_mfma_f32_16x16x32_bf16 a[168:171], v[200:203], v[168:171], a[168:171]
    v_cvt_pk_bf16_f32 v183, v214, v215
    v_add_f32 v245, v245, v215
    v_mfma_f32_16x16x32_bf16 a[172:175], v[200:203], v[172:175], a[172:175]
    ds_read_b64_tr_b16 v[200:201], v220 offset:12288
    ds_read_b64_tr_b16 v[202:203], v220 offset:14336
    v_mfma_f32_16x16x32_bf16 a[176:179], v[204:207], v[160:163], a[176:179]
    v_exp_f32 v248, v152
    v_mfma_f32_16x16x32_bf16 a[180:183], v[204:207], v[164:167], a[180:183]
    v_exp_f32 v249, v153
    v_mfma_f32_16x16x32_bf16 a[184:187], v[204:207], v[168:171], a[184:187]
    v_cvt_pk_bf16_f32 v186, v248, v249
    s_waitcnt lgkmcnt(2)
    v_mfma_f32_16x16x32_bf16 a[188:191], v[204:207], v[172:175], a[188:191]
    ds_read_b64_tr_b16 v[204:205], v221 offset:12288
    ds_read_b64_tr_b16 v[206:207], v221 offset:14336
    v_mfma_f32_16x16x32_bf16 a[192:195], v[192:195], v[160:163], a[192:195]
    v_add_f32 v246, v246, v248
    v_add_f32 v246, v246, v249
    v_mfma_f32_16x16x32_bf16 a[196:199], v[192:195], v[164:167], a[196:199]
    v_exp_f32 v250, v154
    v_mfma_f32_16x16x32_bf16 a[200:203], v[192:195], v[168:171], a[200:203]
    v_exp_f32 v251, v155
    v_mfma_f32_16x16x32_bf16 a[204:207], v[192:195], v[172:175], a[204:207]
    ds_read_b128 v[192:195], v216 offset:0
    v_cvt_pk_bf16_f32 v187, v250, v251
    v_mfma_f32_16x16x32_bf16 a[208:211], v[196:199], v[160:163], a[208:211]
    v_add_f32 v246, v246, v250
    v_add_f32 v246, v246, v251
    v_mfma_f32_16x16x32_bf16 a[212:215], v[196:199], v[164:167], a[212:215]
    v_exp_f32 v208, v156
    v_mfma_f32_16x16x32_bf16 a[216:219], v[196:199], v[168:171], a[216:219]
    v_exp_f32 v209, v157
    v_mfma_f32_16x16x32_bf16 a[220:223], v[196:199], v[172:175], a[220:223]
    ds_read_b128 v[196:199], v217 offset:0
    s_waitcnt lgkmcnt(2)
    v_mfma_f32_16x16x32_bf16 a[224:227], v[200:203], v[160:163], a[224:227]
    v_cvt_pk_bf16_f32 v190, v208, v209
    v_add_f32 v247, v247, v208
    v_mfma_f32_16x16x32_bf16 a[228:231], v[200:203], v[164:167], a[228:231]
    v_add_f32 v247, v247, v209
    v_max3_f32 v252, v244, v245, v246
    v_mfma_f32_16x16x32_bf16 a[232:235], v[200:203], v[168:171], a[232:235]
    v_exp_f32 v210, v158
    v_mfma_f32_16x16x32_bf16 a[236:239], v[200:203], v[172:175], a[236:239]
    ds_read_b128 v[200:203], v216 offset:4096
    v_add_f32 v247, v247, v210
    v_mfma_f32_16x16x32_bf16 a[240:243], v[204:207], v[160:163], a[240:243]
    v_exp_f32 v211, v159
    v_mfma_f32_16x16x32_bf16 a[244:247], v[204:207], v[164:167], a[244:247]
    v_cvt_pk_bf16_f32 v191, v210, v211
    v_add_f32 v247, v247, v211
    v_mfma_f32_16x16x32_bf16 a[248:251], v[204:207], v[168:171], a[248:251]
    v_max_f32 v252, v252, v247
    v_cmp_nge_f32 vcc, s53, v252
    v_mfma_f32_16x16x32_bf16 a[252:255], v[204:207], v[172:175], a[252:255]
    ds_read_b128 v[204:207], v217 offset:4096
    s_cbranch_vccnz L_stub2
L_back2:
L_k2_bottom:
    s_cmp_eq_u32 s43, s75
    s_cbranch_scc1 L_side_issue
    s_cmp_eq_u32 s43, s100
    s_cbranch_scc1 L_side_finish
    s_cmp_eq_u32 s43, s54
    s_cbranch_scc1 L_side_publish
L_side_back:
    s_sub_u32 s43, s43, 1
    s_cmp_lg_u32 s43, 0
    s_cbranch_scc1 L_k2_loop
    v_mbcnt_lo_u32_b32 v212, -1, 0
    v_mbcnt_hi_u32_b32 v212, -1, v212
    v_lshrrev_b32 v213, 3, v212
    v_and_b32 v214, 0x70, v222
    v_mul_u32_u24 v213, 896, v213
    s_mul_i32 s74, s40, 28672
    v_add3_u32 v253, v213, v214, s74
    s_lshl_b32 s61, s40, 13
    v_lshlrev_b32 v254, 4, v212
    s_mov_b32 s56, 0
    s_mov_b32 s57, 6144
    s_mov_b32 s58, 12288
    s_mov_b32 s59, 18432
    v_mov_b32 v255, 0
    buffer_load_dword v255, v255, s[20:23], 0 offen offset:128 sc1
    s_waitcnt vmcnt(9)
    s_barrier
    s_waitcnt lgkmcnt(2)
    v_mfma_f32_16x16x32_bf16 v[128:131], v[192:195], v[0:3], v[224:227]
    s_add_u32 m0, s52, 65536
    v_mfma_f32_16x16x32_bf16 v[132:135], v[192:195], v[32:35], v[228:231]
    buffer_load_dwordx4 v223, s[8:11], s44 offen offset:0 lds
    v_mfma_f32_16x16x32_bf16 v[136:139], v[192:195], v[64:67], v[232:235]
    v_add_f32 v240, v240, v244
    v_mfma_f32_16x16x32_bf16 v[140:143], v[192:195], v[96:99], v[236:239]
    ds_read_b128 v[192:195], v216 offset:8192
    v_mfma_f32_16x16x32_bf16 v[128:131], v[196:199], v[4:7], v[128:131]
    v_mfma_f32_16x16x32_bf16 v[132:135], v[196:199], v[36:39], v[132:135]
    buffer_load_dwordx4 v223, s[8:11], s45 offen offset:1024 lds
    v_mfma_f32_16x16x32_bf16 v[136:139], v[196:199], v[68:71], v[136:139]
    v_add_f32 v241, v241, v245
    v_mfma_f32_16x16x32_bf16 v[140:143], v[196:199], v[100:103], v[140:143]
    ds_read_b128 v[196:199], v217 offset:8192
    s_waitcnt lgkmcnt(2)
    v_mfma_f32_16x16x32_bf16 v[128:131], v[200:203], v[8:11], v[128:131]
    v_mfma_f32_16x16x32_bf16 v[132:135], v[200:203], v[40:43], v[132:135]
    buffer_load_dwordx4 v223, s[8:11], s46 offen offset:2048 lds
    v_mfma_f32_16x16x32_bf16 v[136:139], v[200:203], v[72:75], v[136:139]
    v_add_f32 v242, v242, v246
    v_mfma_f32_16x16x32_bf16 v[140:143], v[200:203], v[104:107], v[140:143]
    ds_read_b128 v[200:203], v216 offset:12288
    v_mfma_f32_16x16x32_bf16 v[128:131], v[204:207], v[12:15], v[128:131]
    v_mfma_f32_16x16x32_bf16 v[132:135], v[204:207], v[44:47], v[132:135]
    buffer_load_dwordx4 v223, s[8:11], s47 offen offset:3072 lds
    v_mfma_f32_16x16x32_bf16 v[136:139], v[204:207], v[76:79], v[136:139]
    v_add_f32 v243, v243, v247
    v_mfma_f32_16x16x32_bf16 v[140:143], v[204:207], v[108:111], v[140:143]
    ds_read_b128 v[204:207], v217 offset:12288
    s_waitcnt lgkmcnt(2)
    v_mfma_f32_16x16x32_bf16 v[128:131], v[192:195], v[16:19], v[128:131]
    s_add_u32 m0, s52, 81920
    v_mfma_f32_16x16x32_bf16 v[132:135], v[192:195], v[48:51], v[132:135]
    buffer_load_dwordx4 v223, s[8:11], s48 offen offset:0 lds
    v_mfma_f32_16x16x32_bf16 v[136:139], v[192:195], v[80:83], v[136:139]
    v_mfma_f32_16x16x32_bf16 v[140:143], v[192:195], v[112:115], v[140:143]
    ds_read_b128 v[192:195], v216 offset:2048
    v_mfma_f32_16x16x32_bf16 v[128:131], v[196:199], v[20:23], v[128:131]
    v_mfma_f32_16x16x32_bf16 v[132:135], v[196:199], v[52:55], v[132:135]
    buffer_load_dwordx4 v223, s[8:11], s49 offen offset:1024 lds
    v_mfma_f32_16x16x32_bf16 v[136:139], v[196:199], v[84:87], v[136:139]
    v_mfma_f32_16x16x32_bf16 v[140:143], v[196:199], v[116:119], v[140:143]
    ds_read_b128 v[196:199], v217 offset:2048
    s_waitcnt lgkmcnt(2)
    v_mfma_f32_16x16x32_bf16 v[128:131], v[200:203], v[24:27], v[128:131]
    v_mfma_f32_16x16x32_bf16 v[132:135], v[200:203], v[56:59], v[132:135]
    buffer_load_dwordx4 v223, s[8:11], s50 offen offset:2048 lds
    v_mfma_f32_16x16x32_bf16 v[136:139], v[200:203], v[88:91], v[136:139]
    v_mfma_f32_16x16x32_bf16 v[140:143], v[200:203], v[120:123], v[140:143]
    ds_read_b128 v[200:203], v216 offset:6144
    v_mfma_f32_16x16x32_bf16 v[128:131], v[204:207], v[28:31], v[128:131]
    v_mfma_f32_16x16x32_bf16 v[132:135], v[204:207], v[60:63], v[132:135]
    buffer_load_dwordx4 v223, s[8:11], s51 offen offset:3072 lds
    v_mfma_f32_16x16x32_bf16 v[136:139], v[204:207], v[92:95], v[136:139]
    v_mfma_f32_16x16x32_bf16 v[140:143], v[204:207], v[124:127], v[140:143]
    ds_read_b128 v[204:207], v217 offset:6144
    s_waitcnt lgkmcnt(2)
    v_mfma_f32_16x16x32_bf16 v[144:147], v[192:195], v[0:3], v[224:227]
    v_add_u32 v223, 0x8000, v223
    v_mfma_f32_16x16x32_bf16 v[148:151], v[192:195], v[32:35], v[228:231]
    v_mfma_f32_16x16x32_bf16 v[152:155], v[192:195], v[64:67], v[232:235]
    v_exp_f32 v248, v128
    v_mfma_f32_16x16x32_bf16 v[156:159], v[192:195], v[96:99], v[236:239]
    ds_read_b128 v[192:195], v216 offset:10240
    v_mfma_f32_16x16x32_bf16 v[144:147], v[196:199], v[4:7], v[144:147]
    v_exp_f32 v249, v129
    v_mfma_f32_16x16x32_bf16 v[148:151], v[196:199], v[36:39], v[148:151]
    v_cvt_pk_bf16_f32 v160, v248, v249
    v_add_f32 v244, v248, v249
    v_mfma_f32_16x16x32_bf16 v[152:155], v[196:199], v[68:71], v[152:155]
    v_exp_f32 v250, v130
    v_mfma_f32_16x16x32_bf16 v[156:159], v[196:199], v[100:103], v[156:159]
    ds_read_b128 v[196:199], v217 offset:10240
    s_waitcnt lgkmcnt(2)
    v_mfma_f32_16x16x32_bf16 v[144:147], v[200:203], v[8:11], v[144:147]
    v_exp_f32 v251, v131
    v_mfma_f32_16x16x32_bf16 v[148:151], v[200:203], v[40:43], v[148:151]
    v_cvt_pk_bf16_f32 v161, v250, v251
    v_add_f32 v244, v244, v250
    v_mfma_f32_16x16x32_bf16 v[152:155], v[200:203], v[72:75], v[152:155]
    v_add_f32 v244, v244, v251
    v_mfma_f32_16x16x32_bf16 v[156:159], v[200:203], v[104:107], v[156:159]
    ds_read_b128 v[200:203], v216 offset:14336
    v_mfma_f32_16x16x32_bf16 v[144:147], v[204:207], v[12:15], v[144:147]
    v_exp_f32 v208, v132
    v_mfma_f32_16x16x32_bf16 v[148:151], v[204:207], v[44:47], v[148:151]
    v_exp_f32 v209, v133
    v_mfma_f32_16x16x32_bf16 v[152:155], v[204:207], v[76:79], v[152:155]
    v_cvt_pk_bf16_f32 v164, v208, v209
    v_add_f32 v245, v208, v209
    v_mfma_f32_16x16x32_bf16 v[156:159], v[204:207], v[108:111], v[156:159]
    ds_read_b128 v[204:207], v217 offset:14336
    s_waitcnt lgkmcnt(2)
    v_mfma_f32_16x16x32_bf16 v[144:147], v[192:195], v[16:19], v[144:147]
    v_exp_f32 v210, v134
    v_mfma_f32_16x16x32_bf16 v[148:151], v[192:195], v[48:51], v[148:151]
    v_exp_f32 v211, v135
    v_mfma_f32_16x16x32_bf16 v[152:155], v[192:195], v[80:83], v[152:155]
    v_cvt_pk_bf16_f32 v165, v210, v211
    v_add_f32 v245, v245, v210
    v_mfma_f32_16x16x32_bf16 v[156:159], v[192:195], v[112:115], v[156:159]
    ds_read_b64_tr_b16 v[192:193], v218 offset:32768
    ds_read_b64_tr_b16 v[194:195], v218 offset:34816
    v_mfma_f32_16x16x32_bf16 v[144:147], v[196:199], v[20:23], v[144:147]
    v_add_f32 v245, v245, v211
    v_mfma_f32_16x16x32_bf16 v[148:151], v[196:199], v[52:55], v[148:151]
    v_exp_f32 v212, v136
    v_mfma_f32_16x16x32_bf16 v[152:155], v[196:199], v[84:87], v[152:155]
    s_waitcnt lgkmcnt(2)
    v_mfma_f32_16x16x32_bf16 v[156:159], v[196:199], v[116:119], v[156:159]
    ds_read_b64_tr_b16 v[196:197], v219 offset:32768
    ds_read_b64_tr_b16 v[198:199], v219 offset:34816
    v_mfma_f32_16x16x32_bf16 v[144:147], v[200:203], v[24:27], v[144:147]
    v_exp_f32 v213, v137
    v_mfma_f32_16x16x32_bf16 v[148:151], v[200:203], v[56:59], v[148:151]
    v_cvt_pk_bf16_f32 v168, v212, v213
    v_add_f32 v246, v212, v213
    v_mfma_f32_16x16x32_bf16 v[152:155], v[200:203], v[88:91], v[152:155]
    v_exp_f32 v214, v138
    v_mfma_f32_16x16x32_bf16 v[156:159], v[200:203], v[120:123], v[156:159]
    ds_read_b64_tr_b16 v[200:201], v220 offset:32768
    ds_read_b64_tr_b16 v[202:203], v220 offset:34816
    v_mfma_f32_16x16x32_bf16 v[144:147], v[204:207], v[28:31], v[144:147]
    v_exp_f32 v215, v139
    v_mfma_f32_16x16x32_bf16 v[148:151], v[204:207], v[60:63], v[148:151]
    v_cvt_pk_bf16_f32 v169, v214, v215
    v_add_f32 v246, v246, v214
    v_mfma_f32_16x16x32_bf16 v[152:155], v[204:207], v[92:95], v[152:155]
    v_add_f32 v246, v246, v215
    v_mfma_f32_16x16x32_bf16 v[156:159], v[204:207], v[124:127], v[156:159]
    ds_read_b64_tr_b16 v[204:205], v221 offset:32768
    ds_read_b64_tr_b16 v[206:207], v221 offset:34816
    s_waitcnt vmcnt(8)
    s_barrier
    s_waitcnt lgkmcnt(4)
    v_mfma_f32_16x16x32_bf16 a[0:3], v[192:195], v[176:179], a[0:3]
    v_exp_f32 v248, v140
    v_mfma_f32_16x16x32_bf16 a[4:7], v[192:195], v[180:183], a[4:7]
    v_exp_f32 v249, v141
    v_mfma_f32_16x16x32_bf16 a[8:11], v[192:195], v[184:187], a[8:11]
    v_cvt_pk_bf16_f32 v172, v248, v249
    v_add_f32 v247, v248, v249
    v_mfma_f32_16x16x32_bf16 a[12:15], v[192:195], v[188:191], a[12:15]
    ds_read_b64_tr_b16 v[192:193], v218 offset:36864
    ds_read_b64_tr_b16 v[194:195], v218 offset:38912
    v_mfma_f32_16x16x32_bf16 a[16:19], v[196:199], v[176:179], a[16:19]
    v_exp_f32 v250, v142
    v_mfma_f32_16x16x32_bf16 a[20:23], v[196:199], v[180:183], a[20:23]
    v_exp_f32 v251, v143
    v_mfma_f32_16x16x32_bf16 a[24:27], v[196:199], v[184:187], a[24:27]
    v_cvt_pk_bf16_f32 v173, v250, v251
    s_waitcnt lgkmcnt(2)
    v_mfma_f32_16x16x32_bf16 a[28:31], v[196:199], v[188:191], a[28:31]
    ds_read_b64_tr_b16 v[196:197], v219 offset:36864
    ds_read_b64_tr_b16 v[198:199], v219 offset:38912
    v_mfma_f32_16x16x32_bf16 a[32:35], v[200:203], v[176:179], a[32:35]
    v_add_f32 v247, v247, v250
    v_add_f32 v247, v247, v251
    v_mfma_f32_16x16x32_bf16 a[36:39], v[200:203], v[180:183], a[36:39]
    v_exp_f32 v208, v144
    v_mfma_f32_16x16x32_bf16 a[40:43], v[200:203], v[184:187], a[40:43]
    v_exp_f32 v209, v145
    v_mfma_f32_16x16x32_bf16 a[44:47], v[200:203], v[188:191], a[44:47]
    ds_read_b64_tr_b16 v[200:201], v220 offset:36864
    ds_read_b64_tr_b16 v[202:203], v220 offset:38912
    v_mfma_f32_16x16x32_bf16 a[48:51], v[204:207], v[176:179], a[48:51]
    v_cvt_pk_bf16_f32 v162, v208, v209
    v_add_f32 v244, v244, v208
    v_mfma_f32_16x16x32_bf16 a[52:55], v[204:207], v[180:183], a[52:55]
    v_add_f32 v244, v244, v209
    v_mfma_f32_16x16x32_bf16 a[56:59], v[204:207], v[184:187], a[56:59]
    s_waitcnt lgkmcnt(2)
    v_mfma_f32_16x16x32_bf16 a[60:63], v[204:207], v[188:191], a[60:63]
    ds_read_b64_tr_b16 v[204:205], v221 offset:36864
    ds_read_b64_tr_b16 v[206:207], v221 offset:38912
    v_mfma_f32_16x16x32_bf16 a[64:67], v[192:195], v[176:179], a[64:67]
    v_exp_f32 v210, v146
    v_mfma_f32_16x16x32_bf16 a[68:71], v[192:195], v[180:183], a[68:71]
    v_exp_f32 v211, v147
    v_mfma_f32_16x16x32_bf16 a[72:75], v[192:195], v[184:187], a[72:75]
    v_cvt_pk_bf16_f32 v163, v210, v211
    v_add_f32 v244, v244, v210
    v_mfma_f32_16x16x32_bf16 a[76:79], v[192:195], v[188:191], a[76:79]
    ds_read_b64_tr_b16 v[192:193], v218 offset:40960
    ds_read_b64_tr_b16 v[194:195], v218 offset:43008
    v_mfma_f32_16x16x32_bf16 a[80:83], v[196:199], v[176:179], a[80:83]
    v_add_f32 v244, v244, v211
    v_mfma_f32_16x16x32_bf16 a[84:87], v[196:199], v[180:183], a[84:87]
    v_exp_f32 v212, v148
    v_mfma_f32_16x16x32_bf16 a[88:91], v[196:199], v[184:187], a[88:91]
    v_add_f32 v245, v245, v212
    s_waitcnt lgkmcnt(2)
    v_mfma_f32_16x16x32_bf16 a[92:95], v[196:199], v[188:191], a[92:95]
    ds_read_b64_tr_b16 v[196:197], v219 offset:40960
    ds_read_b64_tr_b16 v[198:199], v219 offset:43008
    v_mfma_f32_16x16x32_bf16 a[96:99], v[200:203], v[176:179], a[96:99]
    v_exp_f32 v213, v149
    v_mfma_f32_16x16x32_bf16 a[100:103], v[200:203], v[180:183], a[100:103]
    v_cvt_pk_bf16_f32 v166, v212, v213
    v_add_f32 v245, v245, v213
    v_mfma_f32_16x16x32_bf16 a[104:107], v[200:203], v[184:187], a[104:107]
    v_exp_f32 v214, v150
    v_mfma_f32_16x16x32_bf16 a[108:111], v[200:203], v[188:191], a[108:111]
    ds_read_b64_tr_b16 v[200:201], v220 offset:40960
    ds_read_b64_tr_b16 v[202:203], v220 offset:43008
    v_mfma_f32_16x16x32_bf16 a[112:115], v[204:207], v[176:179], a[112:115]
    v_exp_f32 v215, v151
    v_mfma_f32_16x16x32_bf16 a[116:119], v[204:207], v[180:183], a[116:119]
    v_cvt_pk_bf16_f32 v167, v214, v215
    v_add_f32 v245, v245, v214
    v_mfma_f32_16x16x32_bf16 a[120:123], v[204:207], v[184:187], a[120:123]
    v_add_f32 v245, v245, v215
    s_waitcnt lgkmcnt(2)
    v_mfma_f32_16x16x32_bf16 a[124:127], v[204:207], v[188:191], a[124:127]
    ds_read_b64_tr_b16 v[204:205], v221 offset:40960
    ds_read_b64_tr_b16 v[206:207], v221 offset:43008
    v_mfma_f32_16x16x32_bf16 a[128:131], v[192:195], v[176:179], a[128:131]
    v_exp_f32 v248, v152
    v_mfma_f32_16x16x32_bf16 a[132:135], v[192:195], v[180:183], a[132:135]
    v_exp_f32 v249, v153
    v_mfma_f32_16x16x32_bf16 a[136:139], v[192:195], v[184:187], a[136:139]
    v_cvt_pk_bf16_f32 v170, v248, v249
    v_add_f32 v246, v246, v248
    v_mfma_f32_16x16x32_bf16 a[140:143], v[192:195], v[188:191], a[140:143]
    ds_read_b64_tr_b16 v[192:193], v218 offset:45056
    ds_read_b64_tr_b16 v[194:195], v218 offset:47104
    v_mfma_f32_16x16x32_bf16 a[144:147], v[196:199], v[176:179], a[144:147]
    v_add_f32 v246, v246, v249
    v_mfma_f32_16x16x32_bf16 a[148:151], v[196:199], v[180:183], a[148:151]
    v_exp_f32 v250, v154
    v_mfma_f32_16x16x32_bf16 a[152:155], v[196:199], v[184:187], a[152:155]
    v_add_f32 v246, v246, v250
    s_waitcnt lgkmcnt(2)
    v_mfma_f32_16x16x32_bf16 a[156:159], v[196:199], v[188:191], a[156:159]
    ds_read_b64_tr_b16 v[196:197], v219 offset:45056
    ds_read_b64_tr_b16 v[198:199], v219 offset:47104
    v_mfma_f32_16x16x32_bf16 a[160:163], v[200:203], v[176:179], a[160:163]
    v_exp_f32 v251, v155
    v_mfma_f32_16x16x32_bf16 a[164:167], v[200:203], v[180:183], a[164:167]
    v_cvt_pk_bf16_f32 v171, v250, v251
    v_add_f32 v246, v246, v251
    v_mfma_f32_16x16x32_bf16 a[168:171], v[200:203], v[184:187], a[168:171]
    v_exp_f32 v208, v156
    v_mfma_f32_16x16x32_bf16 a[172:175], v[200:203], v[188:191], a[172:175]
    ds_read_b64_tr_b16 v[200:201], v220 offset:45056
    ds_read_b64_tr_b16 v[202:203], v220 offset:47104
    v_mfma_f32_16x16x32_bf16 a[176:179], v[204:207], v[176:179], a[176:179]
    v_exp_f32 v209, v157
    v_mfma_f32_16x16x32_bf16 a[180:183], v[204:207], v[180:183], a[180:183]
    v_cvt_pk_bf16_f32 v174, v208, v209
    v_add_f32 v247, v247, v208
    v_mfma_f32_16x16x32_bf16 a[184:187], v[204:207], v[184:187], a[184:187]
    v_add_f32 v247, v247, v209
    s_waitcnt lgkmcnt(2)
    v_mfma_f32_16x16x32_bf16 a[188:191], v[204:207], v[188:191], a[188:191]
    ds_read_b64_tr_b16 v[204:205], v221 offset:45056
    ds_read_b64_tr_b16 v[206:207], v221 offset:47104
    v_mfma_f32_16x16x32_bf16 a[192:195], v[192:195], v[176:179], a[192:195]
    v_exp_f32 v210, v158
    v_mfma_f32_16x16x32_bf16 a[196:199], v[192:195], v[180:183], a[196:199]
    v_exp_f32 v211, v159
    v_mfma_f32_16x16x32_bf16 a[200:203], v[192:195], v[184:187], a[200:203]
    v_cvt_pk_bf16_f32 v175, v210, v211
    v_add_f32 v247, v247, v210
    v_mfma_f32_16x16x32_bf16 a[204:207], v[192:195], v[188:191], a[204:207]
    ds_read_b128 v[192:195], v216 offset:32768
    v_add_f32 v247, v247, v211
    v_mfma_f32_16x16x32_bf16 a[208:211], v[196:199], v[176:179], a[208:211]
    v_max3_f32 v252, v244, v245, v246
    v_max_f32 v252, v252, v247
    v_mfma_f32_16x16x32_bf16 a[212:215], v[196:199], v[180:183], a[212:215]
    v_cmp_nge_f32 vcc, s53, v252
    v_mfma_f32_16x16x32_bf16 a[216:219], v[196:199], v[184:187], a[216:219]
    v_mfma_f32_16x16x32_bf16 a[220:223], v[196:199], v[188:191], a[220:223]
    ds_read_b128 v[196:199], v217 offset:32768
    s_waitcnt lgkmcnt(2)
    v_mfma_f32_16x16x32_bf16 a[224:227], v[200:203], v[176:179], a[224:227]
    v_mfma_f32_16x16x32_bf16 a[228:231], v[200:203], v[180:183], a[228:231]
    v_mfma_f32_16x16x32_bf16 a[232:235], v[200:203], v[184:187], a[232:235]
    v_mfma_f32_16x16x32_bf16 a[236:239], v[200:203], v[188:191], a[236:239]
    ds_read_b128 v[200:203], v216 offset:36864
    v_mfma_f32_16x16x32_bf16 a[240:243], v[204:207], v[176:179], a[240:243]
    v_mfma_f32_16x16x32_bf16 a[244:247], v[204:207], v[180:183], a[244:247]
    v_mfma_f32_16x16x32_bf16 a[248:251], v[204:207], v[184:187], a[248:251]
    v_mfma_f32_16x16x32_bf16 a[252:255], v[204:207], v[188:191], a[252:255]
    ds_read_b128 v[204:207], v217 offset:36864
    s_cbranch_vccnz L_stub5
L_back5:
    v_readfirstlane_b32 s54, v255
    s_mov_b32 s63, 0
    v_mov_b32 v208, 0
L_cnt:
    s_cmp_ge_u32 s54, 256
    s_cbranch_scc1 L_cnt_ok
    buffer_load_dword v255, v208, s[20:23], 0 offen offset:128 sc1
    s_waitcnt vmcnt(0)
    v_readfirstlane_b32 s54, v255
    s_add_u32 s63, s63, 1
    s_cmp_lt_u32 s63, 0x100000
    s_cbranch_scc1 L_cnt
L_cnt_ok:
    v_lshrrev_b32 v208, 4, v254
    v_min_u32 v208, 27, v208
    v_lshlrev_b32 v208, 7, v208
    s_lshl_b32 s62, s41, 2
    s_add_u32 s62, s62, s40
    s_mul_i32 s62, s62, 3584
    buffer_load_dword v253, v208, s[16:19], s62 offen
    s_add_u32 s12, s86, 36765696
    s_addc_u32 s13, s87, 0
    s_mov_b32 s14, 802816
    s_mov_b32 s15, 0x20000
    buffer_load_dword v253, v208, s[12:15], s62 offen
    s_waitcnt vmcnt(2)
    s_barrier
    s_waitcnt lgkmcnt(2)
    v_mfma_f32_16x16x32_bf16 v[128:131], v[192:195], v[0:3], v[224:227]
    s_add_u32 m0, s52, 98304
    v_mfma_f32_16x16x32_bf16 v[132:135], v[192:195], v[32:35], v[228:231]
    buffer_load_dwordx4 v223, s[8:11], s44 offen offset:0 lds
    v_mfma_f32_16x16x32_bf16 v[136:139], v[192:195], v[64:67], v[232:235]
    v_add_f32 v240, v240, v244
    v_mfma_f32_16x16x32_bf16 v[140:143], v[192:195], v[96:99], v[236:239]
    ds_read_b128 v[192:195], v216 offset:40960
    v_mfma_f32_16x16x32_bf16 v[128:131], v[196:199], v[4:7], v[128:131]
    v_mfma_f32_16x16x32_bf16 v[132:135], v[196:199], v[36:39], v[132:135]
    buffer_load_dwordx4 v223, s[8:11], s45 offen offset:1024 lds
    v_mfma_f32_16x16x32_bf16 v[136:139], v[196:199], v[68:71], v[136:139]
    v_add_f32 v241, v241, v245
    v_mfma_f32_16x16x32_bf16 v[140:143], v[196:199], v[100:103], v[140:143]
    ds_read_b128 v[196:199], v217 offset:40960
    s_waitcnt lgkmcnt(2)
    v_mfma_f32_16x16x32_bf16 v[128:131], v[200:203], v[8:11], v[128:131]
    v_mfma_f32_16x16x32_bf16 v[132:135], v[200:203], v[40:43], v[132:135]
    buffer_load_dwordx4 v223, s[8:11], s46 offen offset:2048 lds
    v_mfma_f32_16x16x32_bf16 v[136:139], v[200:203], v[72:75], v[136:139]
    v_add_f32 v242, v242, v246
    v_mfma_f32_16x16x32_bf16 v[140:143], v[200:203], v[104:107], v[140:143]
    ds_read_b128 v[200:203], v216 offset:45056
    v_mfma_f32_16x16x32_bf16 v[128:131], v[204:207], v[12:15], v[128:131]
    v_mfma_f32_16x16x32_bf16 v[132:135], v[204:207], v[44:47], v[132:135]
    buffer_load_dwordx4 v223, s[8:11], s47 offen offset:3072 lds
    v_mfma_f32_16x16x32_bf16 v[136:139], v[204:207], v[76:79], v[136:139]
    v_add_f32 v243, v243, v247
    v_mfma_f32_16x16x32_bf16 v[140:143], v[204:207], v[108:111], v[140:143]
    ds_read_b128 v[204:207], v217 offset:45056
    s_waitcnt lgkmcnt(2)
    v_mfma_f32_16x16x32_bf16 v[128:131], v[192:195], v[16:19], v[128:131]
    s_add_u32 m0, s52, 114688
    v_mfma_f32_16x16x32_bf16 v[132:135], v[192:195], v[48:51], v[132:135]
    buffer_load_dwordx4 v223, s[8:11], s48 offen offset:0 lds
    v_mfma_f32_16x16x32_bf16 v[136:139], v[192:195], v[80:83], v[136:139]
    v_mfma_f32_16x16x32_bf16 v[140:143], v[192:195], v[112:115], v[140:143]
    ds_read_b128 v[192:195], v216 offset:34816
    v_mfma_f32_16x16x32_bf16 v[128:131], v[196:199], v[20:23], v[128:131]
    v_mfma_f32_16x16x32_bf16 v[132:135], v[196:199], v[52:55], v[132:135]
    buffer_load_dwordx4 v223, s[8:11], s49 offen offset:1024 lds
    v_mfma_f32_16x16x32_bf16 v[136:139], v[196:199], v[84:87], v[136:139]
    v_mfma_f32_16x16x32_bf16 v[140:143], v[196:199], v[116:119], v[140:143]
    ds_read_b128 v[196:199], v217 offset:34816
    s_waitcnt lgkmcnt(2)
    v_mfma_f32_16x16x32_bf16 v[128:131], v[200:203], v[24:27], v[128:131]
    v_mfma_f32_16x16x32_bf16 v[132:135], v[200:203], v[56:59], v[132:135]
    buffer_load_dwordx4 v223, s[8:11], s50 offen offset:2048 lds
    v_mfma_f32_16x16x32_bf16 v[136:139], v[200:203], v[88:91], v[136:139]
    v_mfma_f32_16x16x32_bf16 v[140:143], v[200:203], v[120:123], v[140:143]
    ds_read_b128 v[200:203], v216 offset:38912
    v_mfma_f32_16x16x32_bf16 v[128:131], v[204:207], v[28:31], v[128:131]
    v_mfma_f32_16x16x32_bf16 v[132:135], v[204:207], v[60:63], v[132:135]
    buffer_load_dwordx4 v223, s[8:11], s51 offen offset:3072 lds
    v_mfma_f32_16x16x32_bf16 v[136:139], v[204:207], v[92:95], v[136:139]
    v_mfma_f32_16x16x32_bf16 v[140:143], v[204:207], v[124:127], v[140:143]
    ds_read_b128 v[204:207], v217 offset:38912
    s_waitcnt lgkmcnt(2)
    v_mfma_f32_16x16x32_bf16 v[144:147], v[192:195], v[0:3], v[224:227]
    v_add_u32 v223, 0x8000, v223
    v_mfma_f32_16x16x32_bf16 v[148:151], v[192:195], v[32:35], v[228:231]
    v_mfma_f32_16x16x32_bf16 v[152:155], v[192:195], v[64:67], v[232:235]
    v_exp_f32 v248, v128
    v_mfma_f32_16x16x32_bf16 v[156:159], v[192:195], v[96:99], v[236:239]
    ds_read_b128 v[192:195], v216 offset:43008
    v_mfma_f32_16x16x32_bf16 v[144:147], v[196:199], v[4:7], v[144:147]
    v_exp_f32 v249, v129
    v_mfma_f32_16x16x32_bf16 v[148:151], v[196:199], v[36:39], v[148:151]
    v_cvt_pk_bf16_f32 v176, v248, v249
    v_add_f32 v244, v248, v249
    v_mfma_f32_16x16x32_bf16 v[152:155], v[196:199], v[68:71], v[152:155]
    v_exp_f32 v250, v130
    v_mfma_f32_16x16x32_bf16 v[156:159], v[196:199], v[100:103], v[156:159]
    ds_read_b128 v[196:199], v217 offset:43008
    s_waitcnt lgkmcnt(2)
    v_mfma_f32_16x16x32_bf16 v[144:147], v[200:203], v[8:11], v[144:147]
    v_exp_f32 v251, v131
    v_mfma_f32_16x16x32_bf16 v[148:151], v[200:203], v[40:43], v[148:151]
    v_cvt_pk_bf16_f32 v177, v250, v251
    v_add_f32 v244, v244, v250
    v_mfma_f32_16x16x32_bf16 v[152:155], v[200:203], v[72:75], v[152:155]
    v_add_f32 v244, v244, v251
    v_mfma_f32_16x16x32_bf16 v[156:159], v[200:203], v[104:107], v[156:159]
    ds_read_b128 v[200:203], v216 offset:47104
    v_mfma_f32_16x16x32_bf16 v[144:147], v[204:207], v[12:15], v[144:147]
    v_exp_f32 v208, v132
    v_mfma_f32_16x16x32_bf16 v[148:151], v[204:207], v[44:47], v[148:151]
    v_exp_f32 v209, v133
    v_mfma_f32_16x16x32_bf16 v[152:155], v[204:207], v[76:79], v[152:155]
    v_cvt_pk_bf16_f32 v180, v208, v209
    v_add_f32 v245, v208, v209
    v_mfma_f32_16x16x32_bf16 v[156:159], v[204:207], v[108:111], v[156:159]
    ds_read_b128 v[204:207], v217 offset:47104
    s_waitcnt lgkmcnt(2)
    v_mfma_f32_16x16x32_bf16 v[144:147], v[192:195], v[16:19], v[144:147]
    v_exp_f32 v210, v134
    v_mfma_f32_16x16x32_bf16 v[148:151], v[192:195], v[48:51], v[148:151]
    v_exp_f32 v211, v135
    v_mfma_f32_16x16x32_bf16 v[152:155], v[192:195], v[80:83], v[152:155]
    v_cvt_pk_bf16_f32 v181, v210, v211
    v_add_f32 v245, v245, v210
    v_mfma_f32_16x16x32_bf16 v[156:159], v[192:195], v[112:115], v[156:159]
    ds_read_b64_tr_b16 v[192:193], v218 offset:0
    ds_read_b64_tr_b16 v[194:195], v218 offset:2048
    v_mfma_f32_16x16x32_bf16 v[144:147], v[196:199], v[20:23], v[144:147]
    v_add_f32 v245, v245, v211
    v_mfma_f32_16x16x32_bf16 v[148:151], v[196:199], v[52:55], v[148:151]
    v_exp_f32 v212, v136
    v_mfma_f32_16x16x32_bf16 v[152:155], v[196:199], v[84:87], v[152:155]
    s_waitcnt lgkmcnt(2)
    v_mfma_f32_16x16x32_bf16 v[156:159], v[196:199], v[116:119], v[156:159]
    ds_read_b64_tr_b16 v[196:197], v219 offset:0
    ds_read_b64_tr_b16 v[198:199], v219 offset:2048
    v_mfma_f32_16x16x32_bf16 v[144:147], v[200:203], v[24:27], v[144:147]
    v_exp_f32 v213, v137
    v_mfma_f32_16x16x32_bf16 v[148:151], v[200:203], v[56:59], v[148:151]
    v_cvt_pk_bf16_f32 v184, v212, v213
    v_add_f32 v246, v212, v213
    v_mfma_f32_16x16x32_bf16 v[152:155], v[200:203], v[88:91], v[152:155]
    v_exp_f32 v214, v138
    v_mfma_f32_16x16x32_bf16 v[156:159], v[200:203], v[120:123], v[156:159]
    ds_read_b64_tr_b16 v[200:201], v220 offset:0
    ds_read_b64_tr_b16 v[202:203], v220 offset:2048
    v_mfma_f32_16x16x32_bf16 v[144:147], v[204:207], v[28:31], v[144:147]
    v_exp_f32 v215, v139
    v_mfma_f32_16x16x32_bf16 v[148:151], v[204:207], v[60:63], v[148:151]
    v_cvt_pk_bf16_f32 v185, v214, v215
    v_add_f32 v246, v246, v214
    v_mfma_f32_16x16x32_bf16 v[152:155], v[204:207], v[92:95], v[152:155]
    v_add_f32 v246, v246, v215
    v_mfma_f32_16x16x32_bf16 v[156:159], v[204:207], v[124:127], v[156:159]
    ds_read_b64_tr_b16 v[204:205], v221 offset:0
    ds_read_b64_tr_b16 v[206:207], v221 offset:2048
    s_barrier
    s_waitcnt lgkmcnt(4)
    v_mfma_f32_16x16x32_bf16 a[0:3], v[192:195], v[160:163], a[0:3]
    v_exp_f32 v248, v140
    v_mfma_f32_16x16x32_bf16 a[4:7], v[192:195], v[164:167], a[4:7]
    v_exp_f32 v249, v141
    v_mfma_f32_16x16x32_bf16 a[8:11], v[192:195], v[168:171], a[8:11]
    v_cvt_pk_bf16_f32 v188, v248, v249
    v_add_f32 v247, v248, v249
    v_mfma_f32_16x16x32_bf16 a[12:15], v[192:195], v[172:175], a[12:15]
    ds_read_b64_tr_b16 v[192:193], v218 offset:4096
    ds_read_b64_tr_b16 v[194:195], v218 offset:6144
    v_mfma_f32_16x16x32_bf16 a[16:19], v[196:199], v[160:163], a[16:19]
    v_exp_f32 v250, v142
    v_mfma_f32_16x16x32_bf16 a[20:23], v[196:199], v[164:167], a[20:23]
    v_exp_f32 v251, v143
    v_mfma_f32_16x16x32_bf16 a[24:27], v[196:199], v[168:171], a[24:27]
    v_cvt_pk_bf16_f32 v189, v250, v251
    s_waitcnt lgkmcnt(2)
    v_mfma_f32_16x16x32_bf16 a[28:31], v[196:199], v[172:175], a[28:31]
    ds_read_b64_tr_b16 v[196:197], v219 offset:4096
    ds_read_b64_tr_b16 v[198:199], v219 offset:6144
    v_mfma_f32_16x16x32_bf16 a[32:35], v[200:203], v[160:163], a[32:35]
    v_add_f32 v247, v247, v250
    v_add_f32 v247, v247, v251
    v_mfma_f32_16x16x32_bf16 a[36:39], v[200:203], v[164:167], a[36:39]
    v_exp_f32 v208, v144
    v_mfma_f32_16x16x32_bf16 a[40:43], v[200:203], v[168:171], a[40:43]
    v_exp_f32 v209, v145
    v_mfma_f32_16x16x32_bf16 a[44:47], v[200:203], v[172:175], a[44:47]
    ds_read_b64_tr_b16 v[200:201], v220 offset:4096
    ds_read_b64_tr_b16 v[202:203], v220 offset:6144
    v_mfma_f32_16x16x32_bf16 a[48:51], v[204:207], v[160:163], a[48:51]
    v_cvt_pk_bf16_f32 v178, v208, v209
    v_add_f32 v244, v244, v208
    v_mfma_f32_16x16x32_bf16 a[52:55], v[204:207], v[164:167], a[52:55]
    v_add_f32 v244, v244, v209
    v_mfma_f32_16x16x32_bf16 a[56:59], v[204:207], v[168:171], a[56:59]
    s_waitcnt lgkmcnt(2)
    v_mfma_f32_16x16x32_bf16 a[60:63], v[204:207], v[172:175], a[60:63]
    ds_read_b64_tr_b16 v[204:205], v221 offset:4096
    ds_read_b64_tr_b16 v[206:207], v221 offset:6144
    v_mfma_f32_16x16x32_bf16 a[64:67], v[192:195], v[160:163], a[64:67]
    v_exp_f32 v210, v146
    v_mfma_f32_16x16x32_bf16 a[68:71], v[192:195], v[164:167], a[68:71]
    v_exp_f32 v211, v147
    v_mfma_f32_16x16x32_bf16 a[72:75], v[192:195], v[168:171], a[72:75]
    v_cvt_pk_bf16_f32 v179, v210, v211
    v_add_f32 v244, v244, v210
    v_mfma_f32_16x16x32_bf16 a[76:79], v[192:195], v[172:175], a[76:79]
    ds_read_b64_tr_b16 v[192:193], v218 offset:8192
    ds_read_b64_tr_b16 v[194:195], v218 offset:10240
    v_mfma_f32_16x16x32_bf16 a[80:83], v[196:199], v[160:163], a[80:83]
    v_add_f32 v244, v244, v211
    v_mfma_f32_16x16x32_bf16 a[84:87], v[196:199], v[164:167], a[84:87]
    v_exp_f32 v212, v148
    v_mfma_f32_16x16x32_bf16 a[88:91], v[196:199], v[168:171], a[88:91]
    v_add_f32 v245, v245, v212
    s_waitcnt lgkmcnt(2)
    v_mfma_f32_16x16x32_bf16 a[92:95], v[196:199], v[172:175], a[92:95]
    ds_read_b64_tr_b16 v[196:197], v219 offset:8192
    ds_read_b64_tr_b16 v[198:199], v219 offset:10240
    v_mfma_f32_16x16x32_bf16 a[96:99], v[200:203], v[160:163], a[96:99]
    v_exp_f32 v213, v149
    v_mfma_f32_16x16x32_bf16 a[100:103], v[200:203], v[164:167], a[100:103]
    v_cvt_pk_bf16_f32 v182, v212, v213
    v_add_f32 v245, v245, v213
    v_mfma_f32_16x16x32_bf16 a[104:107], v[200:203], v[168:171], a[104:107]
    v_exp_f32 v214, v150
    v_mfma_f32_16x16x32_bf16 a[108:111], v[200:203], v[172:175], a[108:111]
    ds_read_b64_tr_b16 v[200:201], v220 offset:8192
    ds_read_b64_tr_b16 v[202:203], v220 offset:10240
    v_mfma_f32_16x16x32_bf16 a[112:115], v[204:207], v[160:163], a[112:115]
    v_exp_f32 v215, v151
    v_mfma_f32_16x16x32_bf16 a[116:119], v[204:207], v[164:167], a[116:119]
    v_cvt_pk_bf16_f32 v183, v214, v215
    v_add_f32 v245, v245, v214
    v_mfma_f32_16x16x32_bf16 a[120:123], v[204:207], v[168:171], a[120:123]
    v_add_f32 v245, v245, v215
    s_waitcnt lgkmcnt(2)
    v_mfma_f32_16x16x32_bf16 a[124:127], v[204:207], v[172:175], a[124:127]
    ds_read_b64_tr_b16 v[204:205], v221 offset:8192
    ds_read_b64_tr_b16 v[206:207], v221 offset:10240
    v_mfma_f32_16x16x32_bf16 a[128:131], v[192:195], v[160:163], a[128:131]
    v_exp_f32 v248, v152
    v_mfma_f32_16x16x32_bf16 a[132:135], v[192:195], v[164:167], a[132:135]
    v_exp_f32 v249, v153
    v_mfma_f32_16x16x32_bf16 a[136:139], v[192:195], v[168:171], a[136:139]
    v_cvt_pk_bf16_f32 v186, v248, v249
    v_add_f32 v246, v246, v248
    v_mfma_f32_16x16x32_bf16 a[140:143], v[192:195], v[172:175], a[140:143]
    ds_read_b64_tr_b16 v[192:193], v218 offset:12288
    ds_read_b64_tr_b16 v[194:195], v218 offset:14336
    v_mfma_f32_16x16x32_bf16 a[144:147], v[196:199], v[160:163], a[144:147]
    v_add_f32 v246, v246, v249
    v_mfma_f32_16x16x32_bf16 a[148:151], v[196:199], v[164:167], a[148:151]
    v_exp_f32 v250, v154
    v_mfma_f32_16x16x32_bf16 a[152:155], v[196:199], v[168:171], a[152:155]
    v_add_f32 v246, v246, v250
    s_waitcnt lgkmcnt(2)
    v_mfma_f32_16x16x32_bf16 a[156:159], v[196:199], v[172:175], a[156:159]
    ds_read_b64_tr_b16 v[196:197], v219 offset:12288
    ds_read_b64_tr_b16 v[198:199], v219 offset:14336
    v_mfma_f32_16x16x32_bf16 a[160:163], v[200:203], v[160:163], a[160:163]
    v_exp_f32 v251, v155
    v_mfma_f32_16x16x32_bf16 a[164:167], v[200:203], v[164:167], a[164:167]
    v_cvt_pk_bf16_f32 v187, v250, v251
    v_add_f32 v246, v246, v251
    v_mfma_f32_16x16x32_bf16 a[168:171], v[200:203], v[168:171], a[168:171]
    v_exp_f32 v208, v156
    v_mfma_f32_16x16x32_bf16 a[172:175], v[200:203], v[172:175], a[172:175]
    ds_read_b64_tr_b16 v[200:201], v220 offset:12288
    ds_read_b64_tr_b16 v[202:203], v220 offset:14336
    v_mfma_f32_16x16x32_bf16 a[176:179], v[204:207], v[160:163], a[176:179]
    v_exp_f32 v209, v157
    v_mfma_f32_16x16x32_bf16 a[180:183], v[204:207], v[164:167], a[180:183]
    v_cvt_pk_bf16_f32 v190, v208, v209
    v_add_f32 v247, v247, v208
    v_mfma_f32_16x16x32_bf16 a[184:187], v[204:207], v[168:171], a[184:187]
    v_add_f32 v247, v247, v209
    s_waitcnt lgkmcnt(2)
    v_mfma_f32_16x16x32_bf16 a[188:191], v[204:207], v[172:175], a[188:191]
    ds_read_b64_tr_b16 v[204:205], v221 offset:12288
    ds_read_b64_tr_b16 v[206:207], v221 offset:14336
    v_mfma_f32_16x16x32_bf16 a[192:195], v[192:195], v[160:163], a[192:195]
    v_exp_f32 v210, v158
    v_mfma_f32_16x16x32_bf16 a[196:199], v[192:195], v[164:167], a[196:199]
    v_exp_f32 v211, v159
    v_mfma_f32_16x16x32_bf16 a[200:203], v[192:195], v[168:171], a[200:203]
    v_cvt_pk_bf16_f32 v191, v210, v211
    v_add_f32 v247, v247, v210
    v_mfma_f32_16x16x32_bf16 a[204:207], v[192:195], v[172:175], a[204:207]
    v_add_f32 v247, v247, v211
    v_max3_f32 v252, v244, v245, v246
    v_mfma_f32_16x16x32_bf16 a[208:211], v[196:199], v[160:163], a[208:211]
    v_max_f32 v252, v252, v247
    v_cmp_nge_f32 vcc, s53, v252
    v_mfma_f32_16x16x32_bf16 a[212:215], v[196:199], v[164:167], a[212:215]
    v_mfma_f32_16x16x32_bf16 a[216:219], v[196:199], v[168:171], a[216:219]
    v_mfma_f32_16x16x32_bf16 a[220:223], v[196:199], v[172:175], a[220:223]
    s_waitcnt lgkmcnt(0)
    v_mfma_f32_16x16x32_bf16 a[224:227], v[200:203], v[160:163], a[224:227]
    v_mfma_f32_16x16x32_bf16 a[228:231], v[200:203], v[164:167], a[228:231]
    v_mfma_f32_16x16x32_bf16 a[232:235], v[200:203], v[168:171], a[232:235]
    v_mfma_f32_16x16x32_bf16 a[236:239], v[200:203], v[172:175], a[236:239]
    v_mfma_f32_16x16x32_bf16 a[240:243], v[204:207], v[160:163], a[240:243]
    v_mfma_f32_16x16x32_bf16 a[244:247], v[204:207], v[164:167], a[244:247]
    v_mfma_f32_16x16x32_bf16 a[248:251], v[204:207], v[168:171], a[248:251]
    v_mfma_f32_16x16x32_bf16 a[252:255], v[204:207], v[172:175], a[252:255]
    s_cbranch_vccnz L_stub6
L_back6:
    s_setreg_imm32_b32 hwreg(HW_REG_MODE, 4, 2), 3
    s_waitcnt vmcnt(0)
    s_barrier
    ds_read_b64_tr_b16 v[0:1], v218 offset:40960
    ds_read_b64_tr_b16 v[2:3], v218 offset:43008
    ds_read_b64_tr_b16 v[4:5], v219 offset:40960
    ds_read_b64_tr_b16 v[6:7], v219 offset:43008
    ds_read_b64_tr_b16 v[8:9], v220 offset:40960
    ds_read_b64_tr_b16 v[10:11], v220 offset:43008
    s_waitcnt lgkmcnt(4)
    v_mfma_f32_16x16x32_bf16 a[128:131], v[0:3], v[176:179], a[128:131]
    ds_read_b64_tr_b16 v[12:13], v221 offset:40960
    ds_read_b64_tr_b16 v[14:15], v221 offset:43008
    v_mfma_f32_16x16x32_bf16 a[132:135], v[0:3], v[180:183], a[132:135]
    ds_read_b64_tr_b16 v[16:17], v218 offset:45056
    ds_read_b64_tr_b16 v[18:19], v218 offset:47104
    v_mfma_f32_16x16x32_bf16 a[136:139], v[0:3], v[184:187], a[136:139]
    ds_read_b64_tr_b16 v[20:21], v219 offset:45056
    ds_read_b64_tr_b16 v[22:23], v219 offset:47104
    v_mfma_f32_16x16x32_bf16 a[140:143], v[0:3], v[188:191], a[140:143]
    ds_read_b64_tr_b16 v[24:25], v220 offset:45056
    ds_read_b64_tr_b16 v[26:27], v220 offset:47104
    s_waitcnt lgkmcnt(10)
    v_mfma_f32_16x16x32_bf16 a[144:147], v[4:7], v[176:179], a[144:147]
    ds_read_b64_tr_b16 v[28:29], v221 offset:45056
    ds_read_b64_tr_b16 v[30:31], v221 offset:47104
    v_mfma_f32_16x16x32_bf16 a[148:151], v[4:7], v[180:183], a[148:151]
    ds_read_b64_tr_b16 v[32:33], v218 offset:32768
    ds_read_b64_tr_b16 v[34:35], v218 offset:34816
    v_mfma_f32_16x16x32_bf16 a[152:155], v[4:7], v[184:187], a[152:155]
    ds_read_b64_tr_b16 v[36:37], v219 offset:32768
    ds_read_b64_tr_b16 v[38:39], v219 offset:34816
    v_mfma_f32_16x16x32_bf16 a[156:159], v[4:7], v[188:191], a[156:159]
    ds_read_b64_tr_b16 v[40:41], v220 offset:32768
    ds_read_b64_tr_b16 v[42:43], v220 offset:34816
    s_waitcnt lgkmcnt(15)
    v_mfma_f32_16x16x32_bf16 a[160:163], v[8:11], v[176:179], a[160:163]
    ds_read_b64_tr_b16 v[44:45], v221 offset:32768
    ds_read_b64_tr_b16 v[46:47], v221 offset:34816
    v_mfma_f32_16x16x32_bf16 a[164:167], v[8:11], v[180:183], a[164:167]
    ds_read_b64_tr_b16 v[48:49], v218 offset:36864
    ds_read_b64_tr_b16 v[50:51], v218 offset:38912
    v_mfma_f32_16x16x32_bf16 a[168:171], v[8:11], v[184:187], a[168:171]
    ds_read_b64_tr_b16 v[52:53], v219 offset:36864
    ds_read_b64_tr_b16 v[54:55], v219 offset:38912
    v_mfma_f32_16x16x32_bf16 a[172:175], v[8:11], v[188:191], a[172:175]
    ds_read_b64_tr_b16 v[56:57], v220 offset:36864
    ds_read_b64_tr_b16 v[58:59], v220 offset:38912
    s_waitcnt lgkmcnt(15)
    v_mfma_f32_16x16x32_bf16 a[176:179], v[12:15], v[176:179], a[176:179]
    ds_read_b64_tr_b16 v[60:61], v221 offset:36864
    ds_read_b64_tr_b16 v[62:63], v221 offset:38912
    v_mfma_f32_16x16x32_bf16 a[180:183], v[12:15], v[180:183], a[180:183]
    s_add_u32 s62, s61, 32768
    v_add_u32 v208, s62, v254
    v_mfma_f32_16x16x32_bf16 a[184:187], v[12:15], v[184:187], a[184:187]
    v_add_u32 v209, 0x10000, v208
    v_xor_b32 v210, 0x4000, v208
    v_mfma_f32_16x16x32_bf16 a[188:191], v[12:15], v[188:191], a[188:191]
    v_xor_b32 v211, 0x4000, v209
    v_lshrrev_b32 v217, 1, v254
    v_mfma_f32_16x16x32_bf16 a[192:195], v[16:19], v[176:179], a[192:195]
    v_sub_u32 v216, v211, v217
    v_sub_u32 v217, v209, v217
    v_mfma_f32_16x16x32_bf16 a[196:199], v[16:19], v[180:183], a[196:199]
    v_add_f32 v240, v240, v244
    v_add_f32 v241, v241, v245
    v_mfma_f32_16x16x32_bf16 a[200:203], v[16:19], v[184:187], a[200:203]
    v_add_f32 v242, v242, v246
    v_add_f32 v243, v243, v247
    v_mfma_f32_16x16x32_bf16 a[204:207], v[16:19], v[188:191], a[204:207]
    ds_write_b128 v208, a[128:131] offset:0
    v_mfma_f32_16x16x32_bf16 a[208:211], v[20:23], v[176:179], a[208:211]
    v_mov_b32 v212, v240
    v_mov_b32 v213, v241
    v_mfma_f32_16x16x32_bf16 a[212:215], v[20:23], v[180:183], a[212:215]
    v_mov_b32 v214, v242
    v_mov_b32 v215, v243
    v_mfma_f32_16x16x32_bf16 a[216:219], v[20:23], v[184:187], a[216:219]
    ds_write_b128 v208, a[132:135] offset:1024
    v_mfma_f32_16x16x32_bf16 a[220:223], v[20:23], v[188:191], a[220:223]
    v_mfma_f32_16x16x32_bf16 a[224:227], v[24:27], v[176:179], a[224:227]
    v_permlane32_swap_b32 v240, v212
    v_permlane32_swap_b32 v241, v213
    v_mfma_f32_16x16x32_bf16 a[228:231], v[24:27], v[180:183], a[228:231]
    ds_write_b128 v208, a[136:139] offset:2048
    v_mfma_f32_16x16x32_bf16 a[232:235], v[24:27], v[184:187], a[232:235]
    v_permlane32_swap_b32 v242, v214
    v_permlane32_swap_b32 v243, v215
    v_mfma_f32_16x16x32_bf16 a[236:239], v[24:27], v[188:191], a[236:239]
    s_waitcnt lgkmcnt(15)
    v_mfma_f32_16x16x32_bf16 a[240:243], v[28:31], v[176:179], a[240:243]
    ds_write_b128 v208, a[140:143] offset:3072
    v_mfma_f32_16x16x32_bf16 a[244:247], v[28:31], v[180:183], a[244:247]
    v_add_f32 v240, v240, v212
    v_add_f32 v241, v241, v213
    v_mfma_f32_16x16x32_bf16 a[248:251], v[28:31], v[184:187], a[248:251]
    v_add_f32 v242, v242, v214
    v_add_f32 v243, v243, v215
    v_mfma_f32_16x16x32_bf16 a[252:255], v[28:31], v[188:191], a[252:255]
    ds_write_b128 v208, a[144:147] offset:4096
    v_mfma_f32_16x16x32_bf16 a[0:3], v[32:35], v[176:179], a[0:3]
    v_mov_b32 v212, v240
    v_mov_b32 v213, v241
    v_mfma_f32_16x16x32_bf16 a[4:7], v[32:35], v[180:183], a[4:7]
    v_mov_b32 v214, v242
    v_mov_b32 v215, v243
    v_mfma_f32_16x16x32_bf16 a[8:11], v[32:35], v[184:187], a[8:11]
    ds_write_b128 v208, a[148:151] offset:5120
    v_mfma_f32_16x16x32_bf16 a[12:15], v[32:35], v[188:191], a[12:15]
    v_mfma_f32_16x16x32_bf16 a[16:19], v[36:39], v[176:179], a[16:19]
    v_permlane16_swap_b32 v240, v212
    v_permlane16_swap_b32 v241, v213
    v_mfma_f32_16x16x32_bf16 a[20:23], v[36:39], v[180:183], a[20:23]
    ds_write_b128 v208, a[152:155] offset:6144
    v_mfma_f32_16x16x32_bf16 a[24:27], v[36:39], v[184:187], a[24:27]
    v_permlane16_swap_b32 v242, v214
    v_permlane16_swap_b32 v243, v215
    v_mfma_f32_16x16x32_bf16 a[28:31], v[36:39], v[188:191], a[28:31]
    s_waitcnt lgkmcnt(15)
    v_mfma_f32_16x16x32_bf16 a[32:35], v[40:43], v[176:179], a[32:35]
    ds_write_b128 v208, a[156:159] offset:7168
    v_mfma_f32_16x16x32_bf16 a[36:39], v[40:43], v[180:183], a[36:39]
    v_add_f32 v240, v240, v212
    v_add_f32 v241, v241, v213
    v_mfma_f32_16x16x32_bf16 a[40:43], v[40:43], v[184:187], a[40:43]
    v_add_f32 v242, v242, v214
    v_add_f32 v243, v243, v215
    v_mfma_f32_16x16x32_bf16 a[44:47], v[40:43], v[188:191], a[44:47]
    ds_write_b128 v208, a[160:163] offset:32768
    v_mfma_f32_16x16x32_bf16 a[48:51], v[44:47], v[176:179], a[48:51]
    v_mov_b32 v192, v224
    v_mov_b32 v193, v240
    v_mfma_f32_16x16x32_bf16 a[52:55], v[44:47], v[180:183], a[52:55]
    ds_write_b64 v216, v[192:193] offset:32768
    v_mov_b32 v194, v228
    v_mfma_f32_16x16x32_bf16 a[56:59], v[44:47], v[184:187], a[56:59]
    ds_write_b128 v208, a[164:167] offset:33792
    v_mfma_f32_16x16x32_bf16 a[60:63], v[44:47], v[188:191], a[60:63]
    v_mov_b32 v195, v241
    ds_write_b64 v216, v[194:195] offset:33280
    s_waitcnt lgkmcnt(15)
    v_mfma_f32_16x16x32_bf16 a[64:67], v[48:51], v[176:179], a[64:67]
    v_mov_b32 v196, v232
    v_mov_b32 v197, v242
    v_mfma_f32_16x16x32_bf16 a[68:71], v[48:51], v[180:183], a[68:71]
    ds_write_b128 v208, a[168:171] offset:34816
    v_mfma_f32_16x16x32_bf16 a[72:75], v[48:51], v[184:187], a[72:75]
    ds_write_b64 v216, v[196:197] offset:33792
    v_mov_b32 v198, v236
    v_mfma_f32_16x16x32_bf16 a[76:79], v[48:51], v[188:191], a[76:79]
    v_mov_b32 v199, v243
    ds_write_b64 v216, v[198:199] offset:34304
    v_mfma_f32_16x16x32_bf16 a[80:83], v[52:55], v[176:179], a[80:83]
    ds_write_b128 v208, a[172:175] offset:35840
    v_mfma_f32_16x16x32_bf16 a[84:87], v[52:55], v[180:183], a[84:87]
    v_accvgpr_read_b32 v64, a0
    v_accvgpr_read_b32 v65, a1
    v_mfma_f32_16x16x32_bf16 a[88:91], v[52:55], v[184:187], a[88:91]
    v_accvgpr_read_b32 v66, a2
    v_accvgpr_read_b32 v67, a3
    v_mfma_f32_16x16x32_bf16 a[92:95], v[52:55], v[188:191], a[92:95]
    ds_write_b128 v208, a[176:179] offset:36864
    s_waitcnt lgkmcnt(15)
    v_mfma_f32_16x16x32_bf16 a[96:99], v[56:59], v[176:179], a[96:99]
    v_accvgpr_read_b32 v68, a4
    v_accvgpr_read_b32 v69, a5
    v_mfma_f32_16x16x32_bf16 a[100:103], v[56:59], v[180:183], a[100:103]
    v_accvgpr_read_b32 v70, a6
    v_accvgpr_read_b32 v71, a7
    v_mfma_f32_16x16x32_bf16 a[104:107], v[56:59], v[184:187], a[104:107]
    ds_write_b128 v208, a[180:183] offset:37888
    v_mfma_f32_16x16x32_bf16 a[108:111], v[56:59], v[188:191], a[108:111]
    v_accvgpr_read_b32 v72, a8
    v_accvgpr_read_b32 v73, a9
    v_mfma_f32_16x16x32_bf16 a[112:115], v[60:63], v[176:179], a[112:115]
    v_accvgpr_read_b32 v74, a10
    v_accvgpr_read_b32 v75, a11
    v_mfma_f32_16x16x32_bf16 a[116:119], v[60:63], v[180:183], a[116:119]
    ds_write_b128 v208, a[184:187] offset:38912
    v_mfma_f32_16x16x32_bf16 a[120:123], v[60:63], v[184:187], a[120:123]
    v_accvgpr_read_b32 v76, a12
    v_accvgpr_read_b32 v77, a13
    v_mfma_f32_16x16x32_bf16 a[124:127], v[60:63], v[188:191], a[124:127]
    v_accvgpr_read_b32 v78, a14
    v_accvgpr_read_b32 v79, a15
    s_waitcnt lgkmcnt(0)
    s_barrier
    ds_read_b64 v[192:193], v217 offset:32768
    ds_read_b64 v[194:195], v217 offset:33280
    ds_read_b64 v[196:197], v217 offset:33792
    ds_read_b64 v[198:199], v217 offset:34304
    s_add_u32 s12, s86, 36765696
    s_addc_u32 s13, s87, 0
    s_mov_b32 s14, 802816
    s_mov_b32 s15, 0x20000
    ds_write_b128 v208, a[188:191] offset:39936
    v_accvgpr_read_b32 v80, a16
    v_accvgpr_read_b32 v81, a17
    v_accvgpr_read_b32 v82, a18
    v_accvgpr_read_b32 v83, a19
    v_accvgpr_read_b32 v84, a20
    v_accvgpr_read_b32 v85, a21
    ds_write_b128 v209, a[224:227] offset:0
    v_accvgpr_read_b32 v86, a22
    v_accvgpr_read_b32 v87, a23
    v_accvgpr_read_b32 v88, a24
    v_accvgpr_read_b32 v89, a25
    v_accvgpr_read_b32 v90, a26
    v_accvgpr_read_b32 v91, a27
    ds_write_b128 v209, a[228:231] offset:1024
    v_accvgpr_read_b32 v92, a28
    v_accvgpr_read_b32 v93, a29
    v_accvgpr_read_b32 v94, a30
    v_accvgpr_read_b32 v95, a31
    v_accvgpr_read_b32 v96, a32
    v_accvgpr_read_b32 v97, a33
    ds_write_b128 v209, a[232:235] offset:2048
    v_accvgpr_read_b32 v98, a34
    v_accvgpr_read_b32 v99, a35
    v_accvgpr_read_b32 v100, a36
    v_accvgpr_read_b32 v101, a37
    v_accvgpr_read_b32 v102, a38
    v_accvgpr_read_b32 v103, a39
    ds_write_b128 v209, a[236:239] offset:3072
    v_accvgpr_read_b32 v104, a40
    v_accvgpr_read_b32 v105, a41
    v_accvgpr_read_b32 v106, a42
    v_accvgpr_read_b32 v107, a43
    v_accvgpr_read_b32 v108, a44
    v_accvgpr_read_b32 v109, a45
    s_waitcnt lgkmcnt(5)
    ds_write_b128 v209, a[240:243] offset:4096
    v_log_f32 v248, v193
    v_log_f32 v249, v240
    v_sub_f32 v250, v224, v192
    v_add_f32 v248, v248, v250
    v_sub_f32 v249, v249, v250
    v_exp_f32 v248, v248
    v_exp_f32 v249, v249
    v_accvgpr_read_b32 v110, a46
    v_add_f32 v248, v248, v240
    v_add_f32 v249, v249, v193
    v_rcp_f32 v200, v248
    ds_write_b128 v209, a[244:247] offset:5120
    v_rcp_f32 v192, v249
    v_log_f32 v248, v195
    v_log_f32 v249, v241
    v_sub_f32 v250, v228, v194
    v_add_f32 v248, v248, v250
    v_sub_f32 v249, v249, v250
    v_exp_f32 v248, v248
    v_exp_f32 v249, v249
    v_accvgpr_read_b32 v111, a47
    v_add_f32 v248, v248, v241
    v_add_f32 v249, v249, v195
    ds_write_b128 v209, a[248:251] offset:6144
    v_rcp_f32 v202, v248
    v_rcp_f32 v194, v249
    v_log_f32 v248, v197
    v_log_f32 v249, v242
    v_sub_f32 v250, v232, v196
    v_add_f32 v248, v248, v250
    v_sub_f32 v249, v249, v250
    v_exp_f32 v248, v248
    v_exp_f32 v249, v249
    v_accvgpr_read_b32 v112, a48
    v_add_f32 v248, v248, v242
    ds_write_b128 v209, a[252:255] offset:7168
    v_add_f32 v249, v249, v197
    v_rcp_f32 v204, v248
    v_rcp_f32 v196, v249
    v_log_f32 v248, v199
    v_log_f32 v249, v243
    v_sub_f32 v250, v236, v198
    v_add_f32 v248, v248, v250
    v_sub_f32 v249, v249, v250
    v_exp_f32 v248, v248
    v_exp_f32 v249, v249
    v_accvgpr_read_b32 v113, a49
    ds_write_b128 v209, a[192:195] offset:32768
    v_add_f32 v248, v248, v243
    v_add_f32 v249, v249, v199
    v_rcp_f32 v206, v248
    v_rcp_f32 v198, v249
    v_accvgpr_read_b32 v114, a50
    v_accvgpr_read_b32 v115, a51
    v_accvgpr_read_b32 v116, a52
    v_accvgpr_read_b32 v117, a53
    v_accvgpr_read_b32 v118, a54
    v_accvgpr_read_b32 v119, a55
    v_accvgpr_read_b32 v120, a56
    ds_write_b128 v209, a[196:199] offset:33792
    v_accvgpr_read_b32 v121, a57
    v_accvgpr_read_b32 v122, a58
    v_accvgpr_read_b32 v123, a59
    v_accvgpr_read_b32 v124, a60
    v_accvgpr_read_b32 v125, a61
    v_accvgpr_read_b32 v126, a62
    v_accvgpr_read_b32 v127, a63
    v_accvgpr_read_b32 v128, a64
    v_accvgpr_read_b32 v129, a65
    v_accvgpr_read_b32 v130, a66
    v_accvgpr_read_b32 v131, a67
    ds_write_b128 v209, a[200:203] offset:34816
    v_accvgpr_read_b32 v132, a68
    v_accvgpr_read_b32 v133, a69
    v_accvgpr_read_b32 v134, a70
    v_accvgpr_read_b32 v135, a71
    v_accvgpr_read_b32 v136, a72
    v_accvgpr_read_b32 v137, a73
    v_accvgpr_read_b32 v138, a74
    v_accvgpr_read_b32 v139, a75
    v_accvgpr_read_b32 v140, a76
    v_accvgpr_read_b32 v141, a77
    v_accvgpr_read_b32 v142, a78
    ds_write_b128 v209, a[204:207] offset:35840
    v_accvgpr_read_b32 v143, a79
    v_accvgpr_read_b32 v144, a80
    v_accvgpr_read_b32 v145, a81
    v_accvgpr_read_b32 v146, a82
    v_accvgpr_read_b32 v147, a83
    v_accvgpr_read_b32 v148, a84
    v_accvgpr_read_b32 v149, a85
    v_accvgpr_read_b32 v150, a86
    v_accvgpr_read_b32 v151, a87
    v_accvgpr_read_b32 v152, a88
    v_accvgpr_read_b32 v153, a89
    ds_write_b128 v209, a[208:211] offset:36864
    v_accvgpr_read_b32 v154, a90
    v_accvgpr_read_b32 v155, a91
    v_accvgpr_read_b32 v156, a92
    v_accvgpr_read_b32 v157, a93
    v_accvgpr_read_b32 v158, a94
    v_accvgpr_read_b32 v159, a95
    v_accvgpr_read_b32 v160, a96
    v_accvgpr_read_b32 v161, a97
    v_accvgpr_read_b32 v162, a98
    v_accvgpr_read_b32 v163, a99
    v_accvgpr_read_b32 v164, a100
    ds_write_b128 v209, a[212:215] offset:37888
    v_accvgpr_read_b32 v165, a101
    v_accvgpr_read_b32 v166, a102
    v_accvgpr_read_b32 v167, a103
    v_accvgpr_read_b32 v168, a104
    v_accvgpr_read_b32 v169, a105
    v_accvgpr_read_b32 v170, a106
    v_accvgpr_read_b32 v171, a107
    v_accvgpr_read_b32 v172, a108
    v_accvgpr_read_b32 v173, a109
    v_accvgpr_read_b32 v174, a110
    v_accvgpr_read_b32 v175, a111
    ds_write_b128 v209, a[216:219] offset:38912
    v_accvgpr_read_b32 v176, a112
    v_accvgpr_read_b32 v177, a113
    v_accvgpr_read_b32 v178, a114
    v_accvgpr_read_b32 v179, a115
    v_accvgpr_read_b32 v180, a116
    v_accvgpr_read_b32 v181, a117
    v_accvgpr_read_b32 v182, a118
    v_accvgpr_read_b32 v183, a119
    v_accvgpr_read_b32 v184, a120
    v_accvgpr_read_b32 v185, a121
    v_accvgpr_read_b32 v186, a122
    ds_write_b128 v209, a[220:223] offset:39936
    v_accvgpr_read_b32 v187, a123
    v_accvgpr_read_b32 v188, a124
    v_accvgpr_read_b32 v189, a125
    v_accvgpr_read_b32 v190, a126
    v_accvgpr_read_b32 v191, a127
    v_pk_mul_f32 v[64:65], v[64:65], v[200:201] op_sel_hi:[1,0]
    v_pk_mul_f32 v[66:67], v[66:67], v[200:201] op_sel_hi:[1,0]
    v_pk_mul_f32 v[68:69], v[68:69], v[202:203] op_sel_hi:[1,0]
    v_pk_mul_f32 v[70:71], v[70:71], v[202:203] op_sel_hi:[1,0]
    v_pk_mul_f32 v[72:73], v[72:73], v[204:205] op_sel_hi:[1,0]
    v_pk_mul_f32 v[74:75], v[74:75], v[204:205] op_sel_hi:[1,0]
    v_pk_mul_f32 v[76:77], v[76:77], v[206:207] op_sel_hi:[1,0]
    v_pk_mul_f32 v[78:79], v[78:79], v[206:207] op_sel_hi:[1,0]
    v_pk_mul_f32 v[80:81], v[80:81], v[200:201] op_sel_hi:[1,0]
    v_pk_mul_f32 v[82:83], v[82:83], v[200:201] op_sel_hi:[1,0]
    v_pk_mul_f32 v[84:85], v[84:85], v[202:203] op_sel_hi:[1,0]
    v_pk_mul_f32 v[86:87], v[86:87], v[202:203] op_sel_hi:[1,0]
    v_pk_mul_f32 v[88:89], v[88:89], v[204:205] op_sel_hi:[1,0]
    v_pk_mul_f32 v[90:91], v[90:91], v[204:205] op_sel_hi:[1,0]
    v_pk_mul_f32 v[92:93], v[92:93], v[206:207] op_sel_hi:[1,0]
    v_pk_mul_f32 v[94:95], v[94:95], v[206:207] op_sel_hi:[1,0]
    v_pk_mul_f32 v[96:97], v[96:97], v[200:201] op_sel_hi:[1,0]
    v_pk_mul_f32 v[98:99], v[98:99], v[200:201] op_sel_hi:[1,0]
    v_pk_mul_f32 v[100:101], v[100:101], v[202:203] op_sel_hi:[1,0]
    v_pk_mul_f32 v[102:103], v[102:103], v[202:203] op_sel_hi:[1,0]
    v_pk_mul_f32 v[104:105], v[104:105], v[204:205] op_sel_hi:[1,0]
    v_pk_mul_f32 v[106:107], v[106:107], v[204:205] op_sel_hi:[1,0]
    v_pk_mul_f32 v[108:109], v[108:109], v[206:207] op_sel_hi:[1,0]
    v_pk_mul_f32 v[110:111], v[110:111], v[206:207] op_sel_hi:[1,0]
    v_pk_mul_f32 v[112:113], v[112:113], v[200:201] op_sel_hi:[1,0]
    v_pk_mul_f32 v[114:115], v[114:115], v[200:201] op_sel_hi:[1,0]
    v_pk_mul_f32 v[116:117], v[116:117], v[202:203] op_sel_hi:[1,0]
    v_pk_mul_f32 v[118:119], v[118:119], v[202:203] op_sel_hi:[1,0]
    v_pk_mul_f32 v[120:121], v[120:121], v[204:205] op_sel_hi:[1,0]
    v_pk_mul_f32 v[122:123], v[122:123], v[204:205] op_sel_hi:[1,0]
    v_pk_mul_f32 v[124:125], v[124:125], v[206:207] op_sel_hi:[1,0]
    v_pk_mul_f32 v[126:127], v[126:127], v[206:207] op_sel_hi:[1,0]
    v_pk_mul_f32 v[128:129], v[128:129], v[200:201] op_sel_hi:[1,0]
    v_pk_mul_f32 v[130:131], v[130:131], v[200:201] op_sel_hi:[1,0]
    v_pk_mul_f32 v[132:133], v[132:133], v[202:203] op_sel_hi:[1,0]
    v_pk_mul_f32 v[134:135], v[134:135], v[202:203] op_sel_hi:[1,0]
    v_pk_mul_f32 v[136:137], v[136:137], v[204:205] op_sel_hi:[1,0]
    v_pk_mul_f32 v[138:139], v[138:139], v[204:205] op_sel_hi:[1,0]
    v_pk_mul_f32 v[140:141], v[140:141], v[206:207] op_sel_hi:[1,0]
    v_pk_mul_f32 v[142:143], v[142:143], v[206:207] op_sel_hi:[1,0]
    v_pk_mul_f32 v[144:145], v[144:145], v[200:201] op_sel_hi:[1,0]
    v_pk_mul_f32 v[146:147], v[146:147], v[200:201] op_sel_hi:[1,0]
    v_pk_mul_f32 v[148:149], v[148:149], v[202:203] op_sel_hi:[1,0]
    v_pk_mul_f32 v[150:151], v[150:151], v[202:203] op_sel_hi:[1,0]
    v_pk_mul_f32 v[152:153], v[152:153], v[204:205] op_sel_hi:[1,0]
    v_pk_mul_f32 v[154:155], v[154:155], v[204:205] op_sel_hi:[1,0]
    v_pk_mul_f32 v[156:157], v[156:157], v[206:207] op_sel_hi:[1,0]
    v_pk_mul_f32 v[158:159], v[158:159], v[206:207] op_sel_hi:[1,0]
    v_pk_mul_f32 v[160:161], v[160:161], v[200:201] op_sel_hi:[1,0]
    v_pk_mul_f32 v[162:163], v[162:163], v[200:201] op_sel_hi:[1,0]
    v_pk_mul_f32 v[164:165], v[164:165], v[202:203] op_sel_hi:[1,0]
    v_pk_mul_f32 v[166:167], v[166:167], v[202:203] op_sel_hi:[1,0]
    v_pk_mul_f32 v[168:169], v[168:169], v[204:205] op_sel_hi:[1,0]
    v_pk_mul_f32 v[170:171], v[170:171], v[204:205] op_sel_hi:[1,0]
    v_pk_mul_f32 v[172:173], v[172:173], v[206:207] op_sel_hi:[1,0]
    v_pk_mul_f32 v[174:175], v[174:175], v[206:207] op_sel_hi:[1,0]
    v_pk_mul_f32 v[176:177], v[176:177], v[200:201] op_sel_hi:[1,0]
    v_pk_mul_f32 v[178:179], v[178:179], v[200:201] op_sel_hi:[1,0]
    v_pk_mul_f32 v[180:181], v[180:181], v[202:203] op_sel_hi:[1,0]
    v_pk_mul_f32 v[182:183], v[182:183], v[202:203] op_sel_hi:[1,0]
    v_pk_mul_f32 v[184:185], v[184:185], v[204:205] op_sel_hi:[1,0]
    v_pk_mul_f32 v[186:187], v[186:187], v[204:205] op_sel_hi:[1,0]
    v_pk_mul_f32 v[188:189], v[188:189], v[206:207] op_sel_hi:[1,0]
    v_pk_mul_f32 v[190:191], v[190:191], v[206:207] op_sel_hi:[1,0]
    s_waitcnt lgkmcnt(0)
    s_barrier
    ds_read_b128 v[0:3], v210 offset:0
    ds_read_b128 v[4:7], v210 offset:1024
    ds_read_b128 v[8:11], v210 offset:2048
    ds_read_b128 v[12:15], v210 offset:3072
    ds_read_b128 v[16:19], v210 offset:4096
    ds_read_b128 v[20:23], v210 offset:5120
    ds_read_b128 v[24:27], v210 offset:6144
    ds_read_b128 v[28:31], v210 offset:7168
    ds_read_b128 v[32:35], v210 offset:32768
    ds_read_b128 v[36:39], v210 offset:33792
    ds_read_b128 v[40:43], v210 offset:34816
    ds_read_b128 v[44:47], v210 offset:35840
    ds_read_b128 v[48:51], v210 offset:36864
    ds_read_b128 v[52:55], v210 offset:37888
    s_lshl_b32 s56, s40, 15
    s_add_u32 s57, s56, 16384
    s_and_b32 s62, s40, 1
    s_lshl_b32 s62, s62, 15
    s_add_u32 s58, s62, 393216
    s_add_u32 s59, s58, 16384
    v_add_u32 v240, 0, v254
    v_add_u32 v241, 4096, v254
    v_add_u32 v242, 8192, v254
    v_add_u32 v243, 12288, v254
    v_add_u32 v216, s61, v254
    s_waitcnt lgkmcnt(12)
    v_pk_fma_f32 v[64:65], v[0:1], v[192:193], v[64:65] op_sel_hi:[1,0,1]
    v_pk_fma_f32 v[66:67], v[2:3], v[192:193], v[66:67] op_sel_hi:[1,0,1]
    ds_read_b128 v[0:3], v210 offset:38912
    v_cvt_pk_bf16_f32 v64, v64, v65
    v_cvt_pk_bf16_f32 v65, v66, v67
    buffer_load_dwordx4 a[160:163], v240, s[16:19], s56 offen offset:0
    v_pk_fma_f32 v[68:69], v[4:5], v[194:195], v[68:69] op_sel_hi:[1,0,1]
    v_pk_fma_f32 v[70:71], v[6:7], v[194:195], v[70:71] op_sel_hi:[1,0,1]
    ds_read_b128 v[4:7], v210 offset:39936
    v_cvt_pk_bf16_f32 v68, v68, v69
    v_cvt_pk_bf16_f32 v69, v70, v71
    s_waitcnt lgkmcnt(12)
    v_pk_fma_f32 v[72:73], v[8:9], v[196:197], v[72:73] op_sel_hi:[1,0,1]
    v_pk_fma_f32 v[74:75], v[10:11], v[196:197], v[74:75] op_sel_hi:[1,0,1]
    ds_read_b128 v[8:11], v211 offset:32768
    v_cvt_pk_bf16_f32 v72, v72, v73
    v_cvt_pk_bf16_f32 v73, v74, v75
    buffer_load_dwordx4 a[164:167], v240, s[16:19], s57 offen offset:0
    v_pk_fma_f32 v[76:77], v[12:13], v[198:199], v[76:77] op_sel_hi:[1,0,1]
    v_pk_fma_f32 v[78:79], v[14:15], v[198:199], v[78:79] op_sel_hi:[1,0,1]
    ds_read_b128 v[12:15], v211 offset:33792
    v_cvt_pk_bf16_f32 v76, v76, v77
    v_cvt_pk_bf16_f32 v77, v78, v79
    s_waitcnt lgkmcnt(12)
    v_pk_fma_f32 v[80:81], v[16:17], v[192:193], v[80:81] op_sel_hi:[1,0,1]
    v_pk_fma_f32 v[82:83], v[18:19], v[192:193], v[82:83] op_sel_hi:[1,0,1]
    ds_read_b128 v[16:19], v211 offset:34816
    v_cvt_pk_bf16_f32 v66, v80, v81
    v_cvt_pk_bf16_f32 v67, v82, v83
    buffer_load_dwordx4 a[168:171], v240, s[16:19], s56 offen offset:1024
    v_pk_fma_f32 v[84:85], v[20:21], v[194:195], v[84:85] op_sel_hi:[1,0,1]
    v_pk_fma_f32 v[86:87], v[22:23], v[194:195], v[86:87] op_sel_hi:[1,0,1]
    ds_read_b128 v[20:23], v211 offset:35840
    v_cvt_pk_bf16_f32 v70, v84, v85
    v_cvt_pk_bf16_f32 v71, v86, v87
    s_waitcnt lgkmcnt(12)
    v_pk_fma_f32 v[88:89], v[24:25], v[196:197], v[88:89] op_sel_hi:[1,0,1]
    v_pk_fma_f32 v[90:91], v[26:27], v[196:197], v[90:91] op_sel_hi:[1,0,1]
    ds_read_b128 v[24:27], v211 offset:36864
    v_cvt_pk_bf16_f32 v74, v88, v89
    v_cvt_pk_bf16_f32 v75, v90, v91
    buffer_load_dwordx4 a[172:175], v240, s[16:19], s57 offen offset:1024
    v_pk_fma_f32 v[92:93], v[28:29], v[198:199], v[92:93] op_sel_hi:[1,0,1]
    v_pk_fma_f32 v[94:95], v[30:31], v[198:199], v[94:95] op_sel_hi:[1,0,1]
    ds_read_b128 v[28:31], v211 offset:37888
    v_cvt_pk_bf16_f32 v78, v92, v93
    v_cvt_pk_bf16_f32 v79, v94, v95
    s_waitcnt lgkmcnt(12)
    v_pk_fma_f32 v[96:97], v[32:33], v[192:193], v[96:97] op_sel_hi:[1,0,1]
    v_pk_fma_f32 v[98:99], v[34:35], v[192:193], v[98:99] op_sel_hi:[1,0,1]
    ds_read_b128 v[32:35], v211 offset:38912
    v_cvt_pk_bf16_f32 v96, v96, v97
    v_cvt_pk_bf16_f32 v97, v98, v99
    buffer_load_dwordx4 a[176:179], v241, s[16:19], s56 offen offset:0
    v_pk_fma_f32 v[100:101], v[36:37], v[194:195], v[100:101] op_sel_hi:[1,0,1]
    v_pk_fma_f32 v[102:103], v[38:39], v[194:195], v[102:103] op_sel_hi:[1,0,1]
    ds_read_b128 v[36:39], v211 offset:39936
    v_cvt_pk_bf16_f32 v100, v100, v101
    v_cvt_pk_bf16_f32 v101, v102, v103
    s_waitcnt lgkmcnt(12)
    v_pk_fma_f32 v[104:105], v[40:41], v[196:197], v[104:105] op_sel_hi:[1,0,1]
    v_pk_fma_f32 v[106:107], v[42:43], v[196:197], v[106:107] op_sel_hi:[1,0,1]
    ds_read_b128 v[40:43], v211 offset:0
    v_cvt_pk_bf16_f32 v104, v104, v105
    v_cvt_pk_bf16_f32 v105, v106, v107
    buffer_load_dwordx4 a[180:183], v241, s[16:19], s57 offen offset:0
    v_pk_fma_f32 v[108:109], v[44:45], v[198:199], v[108:109] op_sel_hi:[1,0,1]
    v_pk_fma_f32 v[110:111], v[46:47], v[198:199], v[110:111] op_sel_hi:[1,0,1]
    ds_read_b128 v[44:47], v211 offset:1024
    v_cvt_pk_bf16_f32 v108, v108, v109
    v_cvt_pk_bf16_f32 v109, v110, v111
    s_waitcnt lgkmcnt(12)
    v_pk_fma_f32 v[112:113], v[48:49], v[192:193], v[112:113] op_sel_hi:[1,0,1]
    v_pk_fma_f32 v[114:115], v[50:51], v[192:193], v[114:115] op_sel_hi:[1,0,1]
    ds_read_b128 v[48:51], v211 offset:2048
    v_cvt_pk_bf16_f32 v98, v112, v113
    v_cvt_pk_bf16_f32 v99, v114, v115
    buffer_load_dwordx4 a[184:187], v241, s[16:19], s56 offen offset:1024
    v_pk_fma_f32 v[116:117], v[52:53], v[194:195], v[116:117] op_sel_hi:[1,0,1]
    v_pk_fma_f32 v[118:119], v[54:55], v[194:195], v[118:119] op_sel_hi:[1,0,1]
    ds_read_b128 v[52:55], v211 offset:3072
    v_cvt_pk_bf16_f32 v102, v116, v117
    v_cvt_pk_bf16_f32 v103, v118, v119
    s_waitcnt lgkmcnt(12)
    v_pk_fma_f32 v[120:121], v[0:1], v[196:197], v[120:121] op_sel_hi:[1,0,1]
    v_pk_fma_f32 v[122:123], v[2:3], v[196:197], v[122:123] op_sel_hi:[1,0,1]
    ds_read_b128 v[0:3], v211 offset:4096
    v_cvt_pk_bf16_f32 v106, v120, v121
    v_cvt_pk_bf16_f32 v107, v122, v123
    buffer_load_dwordx4 a[188:191], v241, s[16:19], s57 offen offset:1024
    v_pk_fma_f32 v[124:125], v[4:5], v[198:199], v[124:125] op_sel_hi:[1,0,1]
    v_pk_fma_f32 v[126:127], v[6:7], v[198:199], v[126:127] op_sel_hi:[1,0,1]
    ds_read_b128 v[4:7], v211 offset:5120
    v_cvt_pk_bf16_f32 v110, v124, v125
    v_cvt_pk_bf16_f32 v111, v126, v127
    s_waitcnt lgkmcnt(12)
    v_pk_fma_f32 v[128:129], v[8:9], v[192:193], v[128:129] op_sel_hi:[1,0,1]
    v_pk_fma_f32 v[130:131], v[10:11], v[192:193], v[130:131] op_sel_hi:[1,0,1]
    ds_read_b128 v[8:11], v211 offset:6144
    v_cvt_pk_bf16_f32 v128, v128, v129
    v_cvt_pk_bf16_f32 v129, v130, v131
    buffer_load_dwordx4 a[224:227], v242, s[16:19], s56 offen offset:0
    v_pk_fma_f32 v[132:133], v[12:13], v[194:195], v[132:133] op_sel_hi:[1,0,1]
    v_pk_fma_f32 v[134:135], v[14:15], v[194:195], v[134:135] op_sel_hi:[1,0,1]
    ds_read_b128 v[12:15], v211 offset:7168
    v_cvt_pk_bf16_f32 v132, v132, v133
    v_cvt_pk_bf16_f32 v133, v134, v135
    s_waitcnt lgkmcnt(12)
    v_pk_fma_f32 v[136:137], v[16:17], v[196:197], v[136:137] op_sel_hi:[1,0,1]
    v_pk_fma_f32 v[138:139], v[18:19], v[196:197], v[138:139] op_sel_hi:[1,0,1]
    v_cvt_pk_bf16_f32 v136, v136, v137
    v_cvt_pk_bf16_f32 v137, v138, v139
    buffer_load_dwordx4 a[228:231], v242, s[16:19], s57 offen offset:0
    ds_write_b128 v216, v[64:67] offset:0
    v_pk_fma_f32 v[140:141], v[20:21], v[198:199], v[140:141] op_sel_hi:[1,0,1]
    v_pk_fma_f32 v[142:143], v[22:23], v[198:199], v[142:143] op_sel_hi:[1,0,1]
    v_cvt_pk_bf16_f32 v140, v140, v141
    v_cvt_pk_bf16_f32 v141, v142, v143
    ds_write_b128 v216, v[68:71] offset:1024
    s_waitcnt lgkmcnt(12)
    v_pk_fma_f32 v[144:145], v[24:25], v[192:193], v[144:145] op_sel_hi:[1,0,1]
    v_pk_fma_f32 v[146:147], v[26:27], v[192:193], v[146:147] op_sel_hi:[1,0,1]
    v_cvt_pk_bf16_f32 v130, v144, v145
    v_cvt_pk_bf16_f32 v131, v146, v147
    buffer_load_dwordx4 a[232:235], v242, s[16:19], s56 offen offset:1024
    ds_write_b128 v216, v[72:75] offset:2048
    v_pk_fma_f32 v[148:149], v[28:29], v[194:195], v[148:149] op_sel_hi:[1,0,1]
    v_pk_fma_f32 v[150:151], v[30:31], v[194:195], v[150:151] op_sel_hi:[1,0,1]
    v_cvt_pk_bf16_f32 v134, v148, v149
    v_cvt_pk_bf16_f32 v135, v150, v151
    ds_write_b128 v216, v[76:79] offset:3072
    s_waitcnt lgkmcnt(12)
    v_pk_fma_f32 v[152:153], v[32:33], v[196:197], v[152:153] op_sel_hi:[1,0,1]
    v_pk_fma_f32 v[154:155], v[34:35], v[196:197], v[154:155] op_sel_hi:[1,0,1]
    v_cvt_pk_bf16_f32 v138, v152, v153
    v_cvt_pk_bf16_f32 v139, v154, v155
    buffer_load_dwordx4 a[236:239], v242, s[16:19], s57 offen offset:1024
    ds_write_b128 v216, v[96:99] offset:4096
    v_pk_fma_f32 v[156:157], v[36:37], v[198:199], v[156:157] op_sel_hi:[1,0,1]
    v_pk_fma_f32 v[158:159], v[38:39], v[198:199], v[158:159] op_sel_hi:[1,0,1]
    v_cvt_pk_bf16_f32 v142, v156, v157
    v_cvt_pk_bf16_f32 v143, v158, v159
    ds_write_b128 v216, v[100:103] offset:5120
    s_waitcnt lgkmcnt(12)
    v_pk_fma_f32 v[160:161], v[40:41], v[192:193], v[160:161] op_sel_hi:[1,0,1]
    v_pk_fma_f32 v[162:163], v[42:43], v[192:193], v[162:163] op_sel_hi:[1,0,1]
    v_cvt_pk_bf16_f32 v160, v160, v161
    v_cvt_pk_bf16_f32 v161, v162, v163
    buffer_load_dwordx4 a[240:243], v243, s[16:19], s56 offen offset:0
    ds_write_b128 v216, v[104:107] offset:6144
    v_pk_fma_f32 v[164:165], v[44:45], v[194:195], v[164:165] op_sel_hi:[1,0,1]
    v_pk_fma_f32 v[166:167], v[46:47], v[194:195], v[166:167] op_sel_hi:[1,0,1]
    v_cvt_pk_bf16_f32 v164, v164, v165
    v_cvt_pk_bf16_f32 v165, v166, v167
    ds_write_b128 v216, v[108:111] offset:7168
    s_waitcnt lgkmcnt(12)
    v_pk_fma_f32 v[168:169], v[48:49], v[196:197], v[168:169] op_sel_hi:[1,0,1]
    v_pk_fma_f32 v[170:171], v[50:51], v[196:197], v[170:171] op_sel_hi:[1,0,1]
    v_cvt_pk_bf16_f32 v168, v168, v169
    v_cvt_pk_bf16_f32 v169, v170, v171
    buffer_load_dwordx4 a[244:247], v243, s[16:19], s57 offen offset:0
    v_pk_fma_f32 v[172:173], v[52:53], v[198:199], v[172:173] op_sel_hi:[1,0,1]
    v_pk_fma_f32 v[174:175], v[54:55], v[198:199], v[174:175] op_sel_hi:[1,0,1]
    v_cvt_pk_bf16_f32 v172, v172, v173
    v_cvt_pk_bf16_f32 v173, v174, v175
    s_waitcnt lgkmcnt(10)
    v_pk_fma_f32 v[176:177], v[0:1], v[192:193], v[176:177] op_sel_hi:[1,0,1]
    v_pk_fma_f32 v[178:179], v[2:3], v[192:193], v[178:179] op_sel_hi:[1,0,1]
    v_cvt_pk_bf16_f32 v162, v176, v177
    v_cvt_pk_bf16_f32 v163, v178, v179
    buffer_load_dwordx4 a[248:251], v243, s[16:19], s56 offen offset:1024
    v_pk_fma_f32 v[180:181], v[4:5], v[194:195], v[180:181] op_sel_hi:[1,0,1]
    v_pk_fma_f32 v[182:183], v[6:7], v[194:195], v[182:183] op_sel_hi:[1,0,1]
    v_cvt_pk_bf16_f32 v166, v180, v181
    v_cvt_pk_bf16_f32 v167, v182, v183
    s_waitcnt lgkmcnt(8)
    v_pk_fma_f32 v[184:185], v[8:9], v[196:197], v[184:185] op_sel_hi:[1,0,1]
    v_pk_fma_f32 v[186:187], v[10:11], v[196:197], v[186:187] op_sel_hi:[1,0,1]
    v_cvt_pk_bf16_f32 v170, v184, v185
    v_cvt_pk_bf16_f32 v171, v186, v187
    buffer_load_dwordx4 a[252:255], v243, s[16:19], s57 offen offset:1024
    v_pk_fma_f32 v[188:189], v[12:13], v[198:199], v[188:189] op_sel_hi:[1,0,1]
    v_pk_fma_f32 v[190:191], v[14:15], v[198:199], v[190:191] op_sel_hi:[1,0,1]
    v_cvt_pk_bf16_f32 v174, v188, v189
    v_cvt_pk_bf16_f32 v175, v190, v191
    s_waitcnt lgkmcnt(0)
    s_barrier
    s_lshr_b32 s55, s40, 1
    s_lshl_b32 s55, s55, 11
    v_add_u32 v211, s55, v254
    s_xor_b32 s55, s55, 2048
    v_add_u32 v210, s55, v254
    ds_read_b128 a[0:3], v211 offset:0
    ds_read_b128 a[4:7], v211 offset:1024
    ds_read_b128 a[8:11], v210 offset:0
    ds_read_b128 a[12:15], v210 offset:1024
    ds_read_b128 a[16:19], v211 offset:4096
    ds_read_b128 a[20:23], v211 offset:5120
    ds_read_b128 a[24:27], v210 offset:4096
    ds_read_b128 a[28:31], v210 offset:5120
    s_mul_i32 s62, s41, 57344
    s_lshl_b32 s63, s40, 10
    s_add_u32 s64, s62, s63
    s_add_u32 s65, s64, 4096
    s_add_u32 s66, s64, 8192
    s_and_b32 s63, s63, 1024
    s_add_u32 s67, s62, s63
    s_add_u32 s67, s67, 12288
    s_lshr_b32 s55, s40, 1
    s_mul_i32 s62, s55, 28672
    s_sub_u32 s63, 28672, s62
    v_add_u32 v234, s62, v254
    v_add_u32 v235, 14336, v234
    v_add_u32 v236, s63, v254
    v_add_u32 v237, 14336, v236
    s_waitcnt lgkmcnt(4)
    s_waitcnt vmcnt(15)
    v_mfma_f32_16x16x32_bf16 v[0:3], a[160:163], a[0:3], 0
    ds_read_b128 a[64:67], v211 offset:16384
    v_mfma_f32_16x16x32_bf16 v[4:7], a[160:163], a[4:7], 0
    buffer_load_dwordx4 v[64:67], v240, s[16:19], s56 offen offset:2048
    v_mfma_f32_16x16x32_bf16 v[8:11], a[160:163], a[8:11], 0
    ds_read_b128 a[68:71], v211 offset:17408
    v_mfma_f32_16x16x32_bf16 v[12:15], a[160:163], a[12:15], 0
    ds_write_b128 v216, v[128:131] offset:32768
    s_waitcnt vmcnt(15)
    v_mfma_f32_16x16x32_bf16 v[16:19], a[164:167], a[0:3], 0
    ds_read_b128 a[72:75], v210 offset:16384
    v_mfma_f32_16x16x32_bf16 v[20:23], a[164:167], a[4:7], 0
    buffer_load_dwordx4 v[68:71], v240, s[16:19], s57 offen offset:2048
    v_mfma_f32_16x16x32_bf16 v[24:27], a[164:167], a[8:11], 0
    ds_read_b128 a[76:79], v210 offset:17408
    v_mfma_f32_16x16x32_bf16 v[28:31], a[164:167], a[12:15], 0
    ds_write_b128 v216, v[132:135] offset:33792
    s_waitcnt lgkmcnt(6)
    s_waitcnt vmcnt(15)
    v_mfma_f32_16x16x32_bf16 v[0:3], a[168:171], a[16:19], v[0:3]
    ds_read_b128 a[80:83], v211 offset:20480
    v_mfma_f32_16x16x32_bf16 v[4:7], a[168:171], a[20:23], v[4:7]
    buffer_load_dwordx4 v[72:75], v240, s[16:19], s56 offen offset:3072
    v_mfma_f32_16x16x32_bf16 v[8:11], a[168:171], a[24:27], v[8:11]
    ds_read_b128 a[84:87], v211 offset:21504
    v_mfma_f32_16x16x32_bf16 v[12:15], a[168:171], a[28:31], v[12:15]
    ds_write_b128 v216, v[136:139] offset:34816
    s_waitcnt vmcnt(15)
    v_mfma_f32_16x16x32_bf16 v[16:19], a[172:175], a[16:19], v[16:19]
    ds_read_b128 a[88:91], v210 offset:20480
    v_mfma_f32_16x16x32_bf16 v[20:23], a[172:175], a[20:23], v[20:23]
    buffer_load_dwordx4 v[76:79], v240, s[16:19], s57 offen offset:3072
    v_mfma_f32_16x16x32_bf16 v[24:27], a[172:175], a[24:27], v[24:27]
    ds_read_b128 a[92:95], v210 offset:21504
    v_mfma_f32_16x16x32_bf16 v[28:31], a[172:175], a[28:31], v[28:31]
    ds_write_b128 v216, v[140:143] offset:35840
    s_waitcnt lgkmcnt(7)
    s_waitcnt vmcnt(15)
    v_mfma_f32_16x16x32_bf16 v[0:3], a[176:179], a[64:67], v[0:3]
    ds_read_b128 a[128:131], v211 offset:8192
    v_mfma_f32_16x16x32_bf16 v[4:7], a[176:179], a[68:71], v[4:7]
    buffer_load_dwordx4 v[80:83], v241, s[16:19], s56 offen offset:2048
    v_mfma_f32_16x16x32_bf16 v[8:11], a[176:179], a[72:75], v[8:11]
    ds_read_b128 a[132:135], v211 offset:9216
    v_mfma_f32_16x16x32_bf16 v[12:15], a[176:179], a[76:79], v[12:15]
    s_waitcnt vmcnt(15)
    v_mfma_f32_16x16x32_bf16 v[16:19], a[180:183], a[64:67], v[16:19]
    ds_read_b128 a[136:139], v210 offset:8192
    v_mfma_f32_16x16x32_bf16 v[20:23], a[180:183], a[68:71], v[20:23]
    buffer_load_dwordx4 v[84:87], v241, s[16:19], s57 offen offset:2048
    v_mfma_f32_16x16x32_bf16 v[24:27], a[180:183], a[72:75], v[24:27]
    ds_read_b128 a[140:143], v210 offset:9216
    v_mfma_f32_16x16x32_bf16 v[28:31], a[180:183], a[76:79], v[28:31]
    ds_write_b128 v216, v[160:163] offset:36864
    s_waitcnt lgkmcnt(6)
    s_waitcnt vmcnt(15)
    v_mfma_f32_16x16x32_bf16 v[0:3], a[184:187], a[80:83], v[0:3]
    ds_read_b128 a[144:147], v211 offset:12288
    v_mfma_f32_16x16x32_bf16 v[4:7], a[184:187], a[84:87], v[4:7]
    buffer_load_dwordx4 v[88:91], v241, s[16:19], s56 offen offset:3072
    v_mfma_f32_16x16x32_bf16 v[8:11], a[184:187], a[88:91], v[8:11]
    ds_read_b128 a[148:151], v211 offset:13312
    v_mfma_f32_16x16x32_bf16 v[12:15], a[184:187], a[92:95], v[12:15]
    s_waitcnt vmcnt(15)
    v_mfma_f32_16x16x32_bf16 v[16:19], a[188:191], a[80:83], v[16:19]
    ds_read_b128 a[152:155], v210 offset:12288
    v_mfma_f32_16x16x32_bf16 v[20:23], a[188:191], a[84:87], v[20:23]
    buffer_load_dwordx4 v[92:95], v241, s[16:19], s57 offen offset:3072
    v_mfma_f32_16x16x32_bf16 v[24:27], a[188:191], a[88:91], v[24:27]
    ds_read_b128 a[156:159], v210 offset:13312
    v_mfma_f32_16x16x32_bf16 v[28:31], a[188:191], a[92:95], v[28:31]
    ds_write_b128 v216, v[164:167] offset:37888
    s_waitcnt lgkmcnt(6)
    s_waitcnt vmcnt(15)
    v_mfma_f32_16x16x32_bf16 v[0:3], a[224:227], a[128:131], v[0:3]
    ds_read_b128 a[192:195], v211 offset:24576
    v_mfma_f32_16x16x32_bf16 v[4:7], a[224:227], a[132:135], v[4:7]
    buffer_load_dwordx4 v[96:99], v242, s[16:19], s56 offen offset:2048
    v_mfma_f32_16x16x32_bf16 v[8:11], a[224:227], a[136:139], v[8:11]
    ds_read_b128 a[196:199], v211 offset:25600
    v_mfma_f32_16x16x32_bf16 v[12:15], a[224:227], a[140:143], v[12:15]
    s_waitcnt vmcnt(15)
    v_mfma_f32_16x16x32_bf16 v[16:19], a[228:231], a[128:131], v[16:19]
    ds_read_b128 a[200:203], v210 offset:24576
    v_mfma_f32_16x16x32_bf16 v[20:23], a[228:231], a[132:135], v[20:23]
    buffer_load_dwordx4 v[100:103], v242, s[16:19], s57 offen offset:2048
    v_mfma_f32_16x16x32_bf16 v[24:27], a[228:231], a[136:139], v[24:27]
    ds_read_b128 a[204:207], v210 offset:25600
    v_mfma_f32_16x16x32_bf16 v[28:31], a[228:231], a[140:143], v[28:31]
    ds_write_b128 v216, v[168:171] offset:38912
    s_waitcnt lgkmcnt(6)
    s_waitcnt vmcnt(15)
    v_mfma_f32_16x16x32_bf16 v[0:3], a[232:235], a[144:147], v[0:3]
    ds_read_b128 a[208:211], v211 offset:28672
    v_mfma_f32_16x16x32_bf16 v[4:7], a[232:235], a[148:151], v[4:7]
    buffer_load_dwordx4 v[104:107], v242, s[16:19], s56 offen offset:3072
    v_mfma_f32_16x16x32_bf16 v[8:11], a[232:235], a[152:155], v[8:11]
    ds_read_b128 a[212:215], v211 offset:29696
    v_mfma_f32_16x16x32_bf16 v[12:15], a[232:235], a[156:159], v[12:15]
    s_waitcnt vmcnt(15)
    v_mfma_f32_16x16x32_bf16 v[16:19], a[236:239], a[144:147], v[16:19]
    ds_read_b128 a[216:219], v210 offset:28672
    v_mfma_f32_16x16x32_bf16 v[20:23], a[236:239], a[148:151], v[20:23]
    buffer_load_dwordx4 v[108:111], v242, s[16:19], s57 offen offset:3072
    v_mfma_f32_16x16x32_bf16 v[24:27], a[236:239], a[152:155], v[24:27]
    ds_read_b128 a[220:223], v210 offset:29696
    v_mfma_f32_16x16x32_bf16 v[28:31], a[236:239], a[156:159], v[28:31]
    ds_write_b128 v216, v[172:175] offset:39936
    s_waitcnt lgkmcnt(0)
    s_barrier
    s_waitcnt vmcnt(15)
    v_mfma_f32_16x16x32_bf16 v[0:3], a[240:243], a[192:195], v[0:3]
    ds_read_b128 a[32:35], v211 offset:32768
    v_mfma_f32_16x16x32_bf16 v[4:7], a[240:243], a[196:199], v[4:7]
    buffer_load_dwordx4 v[112:115], v243, s[16:19], s56 offen offset:2048
    v_mfma_f32_16x16x32_bf16 v[8:11], a[240:243], a[200:203], v[8:11]
    ds_read_b128 a[36:39], v211 offset:33792
    v_mfma_f32_16x16x32_bf16 v[12:15], a[240:243], a[204:207], v[12:15]
    buffer_load_dwordx4 v[116:119], v243, s[16:19], s57 offen offset:2048
    s_waitcnt vmcnt(16)
    v_mfma_f32_16x16x32_bf16 v[16:19], a[244:247], a[192:195], v[16:19]
    ds_read_b128 a[40:43], v210 offset:32768
    v_mfma_f32_16x16x32_bf16 v[20:23], a[244:247], a[196:199], v[20:23]
    buffer_load_dwordx4 v[120:123], v243, s[16:19], s56 offen offset:3072
    v_mfma_f32_16x16x32_bf16 v[24:27], a[244:247], a[200:203], v[24:27]
    ds_read_b128 a[44:47], v210 offset:33792
    v_mfma_f32_16x16x32_bf16 v[28:31], a[244:247], a[204:207], v[28:31]
    buffer_load_dwordx4 v[124:127], v243, s[16:19], s57 offen offset:3072
    s_waitcnt vmcnt(17)
    v_mfma_f32_16x16x32_bf16 v[0:3], a[248:251], a[208:211], v[0:3]
    ds_read_b128 a[48:51], v211 offset:36864
    v_mfma_f32_16x16x32_bf16 v[4:7], a[248:251], a[212:215], v[4:7]
    s_add_u32 s56, s56, 131072
    s_add_u32 s57, s57, 131072
    buffer_load_dwordx4 v[128:131], v240, s[16:19], s56 offen offset:0
    v_mfma_f32_16x16x32_bf16 v[8:11], a[248:251], a[216:219], v[8:11]
    ds_read_b128 a[52:55], v211 offset:37888
    v_mfma_f32_16x16x32_bf16 v[12:15], a[248:251], a[220:223], v[12:15]
    buffer_load_dwordx4 v[132:135], v240, s[16:19], s57 offen offset:0
    s_waitcnt vmcnt(18)
    v_mfma_f32_16x16x32_bf16 v[16:19], a[252:255], a[208:211], v[16:19]
    ds_read_b128 a[56:59], v210 offset:36864
    v_mfma_f32_16x16x32_bf16 v[20:23], a[252:255], a[212:215], v[20:23]
    buffer_load_dwordx4 v[136:139], v240, s[16:19], s56 offen offset:1024
    v_mfma_f32_16x16x32_bf16 v[24:27], a[252:255], a[216:219], v[24:27]
    ds_read_b128 a[60:63], v210 offset:37888
    v_mfma_f32_16x16x32_bf16 v[28:31], a[252:255], a[220:223], v[28:31]
    buffer_load_dwordx4 v[140:143], v240, s[16:19], s57 offen offset:1024
    s_waitcnt lgkmcnt(4)
    s_waitcnt vmcnt(19)
    v_mfma_f32_16x16x32_bf16 v[0:3], v[64:67], a[32:35], v[0:3]
    ds_read_b128 a[96:99], v211 offset:49152
    v_mfma_f32_16x16x32_bf16 v[4:7], v[64:67], a[36:39], v[4:7]
    buffer_load_dwordx4 v[144:147], v241, s[16:19], s56 offen offset:0
    v_mfma_f32_16x16x32_bf16 v[8:11], v[64:67], a[40:43], v[8:11]
    ds_read_b128 a[100:103], v211 offset:50176
    v_mfma_f32_16x16x32_bf16 v[12:15], v[64:67], a[44:47], v[12:15]
    buffer_load_dwordx4 v[148:151], v241, s[16:19], s57 offen offset:0
    s_waitcnt vmcnt(20)
    v_mfma_f32_16x16x32_bf16 v[16:19], v[68:71], a[32:35], v[16:19]
    ds_read_b128 a[104:107], v210 offset:49152
    v_mfma_f32_16x16x32_bf16 v[20:23], v[68:71], a[36:39], v[20:23]
    buffer_load_dwordx4 v[152:155], v241, s[16:19], s56 offen offset:1024
    v_mfma_f32_16x16x32_bf16 v[24:27], v[68:71], a[40:43], v[24:27]
    ds_read_b128 a[108:111], v210 offset:50176
    v_mfma_f32_16x16x32_bf16 v[28:31], v[68:71], a[44:47], v[28:31]
    buffer_load_dwordx4 v[156:159], v241, s[16:19], s57 offen offset:1024
    s_waitcnt lgkmcnt(4)
    s_waitcnt vmcnt(21)
    v_mfma_f32_16x16x32_bf16 v[0:3], v[72:75], a[48:51], v[0:3]
    ds_read_b128 a[112:115], v211 offset:53248
    v_mfma_f32_16x16x32_bf16 v[4:7], v[72:75], a[52:55], v[4:7]
    buffer_load_dwordx4 v[160:163], v242, s[16:19], s56 offen offset:0
    v_mfma_f32_16x16x32_bf16 v[8:11], v[72:75], a[56:59], v[8:11]
    ds_read_b128 a[116:119], v211 offset:54272
    v_mfma_f32_16x16x32_bf16 v[12:15], v[72:75], a[60:63], v[12:15]
    buffer_load_dwordx4 v[164:167], v242, s[16:19], s57 offen offset:0
    s_waitcnt vmcnt(22)
    v_mfma_f32_16x16x32_bf16 v[16:19], v[76:79], a[48:51], v[16:19]
    ds_read_b128 a[120:123], v210 offset:53248
    v_mfma_f32_16x16x32_bf16 v[20:23], v[76:79], a[52:55], v[20:23]
    buffer_load_dwordx4 v[168:171], v242, s[16:19], s56 offen offset:1024
    v_mfma_f32_16x16x32_bf16 v[24:27], v[76:79], a[56:59], v[24:27]
    ds_read_b128 a[124:127], v210 offset:54272
    v_mfma_f32_16x16x32_bf16 v[28:31], v[76:79], a[60:63], v[28:31]
    buffer_load_dwordx4 v[172:175], v242, s[16:19], s57 offen offset:1024
    s_waitcnt lgkmcnt(4)
    s_waitcnt vmcnt(23)
    v_mfma_f32_16x16x32_bf16 v[0:3], v[80:83], a[96:99], v[0:3]
    ds_read_b128 a[160:163], v211 offset:40960
    v_mfma_f32_16x16x32_bf16 v[4:7], v[80:83], a[100:103], v[4:7]
    buffer_load_dwordx4 v[176:179], v243, s[16:19], s56 offen offset:0
    v_mfma_f32_16x16x32_bf16 v[8:11], v[80:83], a[104:107], v[8:11]
    ds_read_b128 a[164:167], v211 offset:41984
    v_mfma_f32_16x16x32_bf16 v[12:15], v[80:83], a[108:111], v[12:15]
    buffer_load_dwordx4 v[180:183], v243, s[16:19], s57 offen offset:0
    s_waitcnt vmcnt(24)
    v_mfma_f32_16x16x32_bf16 v[16:19], v[84:87], a[96:99], v[16:19]
    ds_read_b128 a[168:171], v210 offset:40960
    v_mfma_f32_16x16x32_bf16 v[20:23], v[84:87], a[100:103], v[20:23]
    buffer_load_dwordx4 v[184:187], v243, s[16:19], s56 offen offset:1024
    v_mfma_f32_16x16x32_bf16 v[24:27], v[84:87], a[104:107], v[24:27]
    ds_read_b128 a[172:175], v210 offset:41984
    v_mfma_f32_16x16x32_bf16 v[28:31], v[84:87], a[108:111], v[28:31]
    buffer_load_dwordx4 v[188:191], v243, s[16:19], s57 offen offset:1024
    s_waitcnt lgkmcnt(4)
    s_waitcnt vmcnt(25)
    v_mfma_f32_16x16x32_bf16 v[0:3], v[88:91], a[112:115], v[0:3]
    ds_read_b128 a[176:179], v211 offset:45056
    v_mfma_f32_16x16x32_bf16 v[4:7], v[88:91], a[116:119], v[4:7]
    buffer_load_dwordx4 v[64:67], v240, s[16:19], s56 offen offset:2048
    v_mfma_f32_16x16x32_bf16 v[8:11], v[88:91], a[120:123], v[8:11]
    ds_read_b128 a[180:183], v211 offset:46080
    v_mfma_f32_16x16x32_bf16 v[12:15], v[88:91], a[124:127], v[12:15]
    buffer_load_dwordx4 v[68:71], v240, s[16:19], s57 offen offset:2048
    s_waitcnt vmcnt(26)
    v_mfma_f32_16x16x32_bf16 v[16:19], v[92:95], a[112:115], v[16:19]
    ds_read_b128 a[184:187], v210 offset:45056
    v_mfma_f32_16x16x32_bf16 v[20:23], v[92:95], a[116:119], v[20:23]
    buffer_load_dwordx4 v[72:75], v240, s[16:19], s56 offen offset:3072
    v_mfma_f32_16x16x32_bf16 v[24:27], v[92:95], a[120:123], v[24:27]
    ds_read_b128 a[188:191], v210 offset:46080
    v_mfma_f32_16x16x32_bf16 v[28:31], v[92:95], a[124:127], v[28:31]
    buffer_load_dwordx4 v[76:79], v240, s[16:19], s57 offen offset:3072
    s_waitcnt lgkmcnt(4)
    s_waitcnt vmcnt(27)
    v_mfma_f32_16x16x32_bf16 v[0:3], v[96:99], a[160:163], v[0:3]
    ds_read_b128 a[224:227], v211 offset:57344
    v_mfma_f32_16x16x32_bf16 v[4:7], v[96:99], a[164:167], v[4:7]
    buffer_load_dwordx4 v[80:83], v241, s[16:19], s56 offen offset:2048
    v_mfma_f32_16x16x32_bf16 v[8:11], v[96:99], a[168:171], v[8:11]
    ds_read_b128 a[228:231], v211 offset:58368
    v_mfma_f32_16x16x32_bf16 v[12:15], v[96:99], a[172:175], v[12:15]
    buffer_load_dwordx4 v[84:87], v241, s[16:19], s57 offen offset:2048
    s_waitcnt vmcnt(28)
    v_mfma_f32_16x16x32_bf16 v[16:19], v[100:103], a[160:163], v[16:19]
    ds_read_b128 a[232:235], v210 offset:57344
    v_mfma_f32_16x16x32_bf16 v[20:23], v[100:103], a[164:167], v[20:23]
    buffer_load_dwordx4 v[88:91], v241, s[16:19], s56 offen offset:3072
    v_mfma_f32_16x16x32_bf16 v[24:27], v[100:103], a[168:171], v[24:27]
    ds_read_b128 a[236:239], v210 offset:58368
    v_mfma_f32_16x16x32_bf16 v[28:31], v[100:103], a[172:175], v[28:31]
    buffer_load_dwordx4 v[92:95], v241, s[16:19], s57 offen offset:3072
    s_waitcnt lgkmcnt(4)
    s_waitcnt vmcnt(29)
    v_mfma_f32_16x16x32_bf16 v[0:3], v[104:107], a[176:179], v[0:3]
    ds_read_b128 a[240:243], v211 offset:61440
    v_mfma_f32_16x16x32_bf16 v[4:7], v[104:107], a[180:183], v[4:7]
    buffer_load_dwordx4 v[96:99], v242, s[16:19], s56 offen offset:2048
    v_mfma_f32_16x16x32_bf16 v[8:11], v[104:107], a[184:187], v[8:11]
    ds_read_b128 a[244:247], v211 offset:62464
    v_mfma_f32_16x16x32_bf16 v[12:15], v[104:107], a[188:191], v[12:15]
    buffer_load_dwordx4 v[100:103], v242, s[16:19], s57 offen offset:2048
    s_waitcnt vmcnt(30)
    v_mfma_f32_16x16x32_bf16 v[16:19], v[108:111], a[176:179], v[16:19]
    ds_read_b128 a[248:251], v210 offset:61440
    v_mfma_f32_16x16x32_bf16 v[20:23], v[108:111], a[180:183], v[20:23]
    buffer_load_dwordx4 v[104:107], v242, s[16:19], s56 offen offset:3072
    v_mfma_f32_16x16x32_bf16 v[24:27], v[108:111], a[184:187], v[24:27]
    ds_read_b128 a[252:255], v210 offset:62464
    v_mfma_f32_16x16x32_bf16 v[28:31], v[108:111], a[188:191], v[28:31]
    s_waitcnt lgkmcnt(4)
    s_waitcnt vmcnt(30)
    v_mfma_f32_16x16x32_bf16 v[0:3], v[112:115], a[224:227], v[0:3]
    v_mfma_f32_16x16x32_bf16 v[4:7], v[112:115], a[228:231], v[4:7]
    buffer_load_dwordx4 v[108:111], v242, s[16:19], s57 offen offset:3072
    v_mfma_f32_16x16x32_bf16 v[8:11], v[112:115], a[232:235], v[8:11]
    v_mfma_f32_16x16x32_bf16 v[12:15], v[112:115], a[236:239], v[12:15]
    s_waitcnt vmcnt(30)
    v_mfma_f32_16x16x32_bf16 v[16:19], v[116:119], a[224:227], v[16:19]
    v_mfma_f32_16x16x32_bf16 v[20:23], v[116:119], a[228:231], v[20:23]
    buffer_load_dwordx4 v[112:115], v243, s[16:19], s56 offen offset:2048
    v_mfma_f32_16x16x32_bf16 v[24:27], v[116:119], a[232:235], v[24:27]
    v_mfma_f32_16x16x32_bf16 v[28:31], v[116:119], a[236:239], v[28:31]
    s_waitcnt lgkmcnt(0)
    s_waitcnt vmcnt(30)
    v_mfma_f32_16x16x32_bf16 v[0:3], v[120:123], a[240:243], v[0:3]
    v_mfma_f32_16x16x32_bf16 v[4:7], v[120:123], a[244:247], v[4:7]
    buffer_load_dwordx4 v[116:119], v243, s[16:19], s57 offen offset:2048
    v_mfma_f32_16x16x32_bf16 v[8:11], v[120:123], a[248:251], v[8:11]
    v_mfma_f32_16x16x32_bf16 v[12:15], v[120:123], a[252:255], v[12:15]
    s_waitcnt vmcnt(30)
    v_mfma_f32_16x16x32_bf16 v[16:19], v[124:127], a[240:243], v[16:19]
    v_mfma_f32_16x16x32_bf16 v[20:23], v[124:127], a[244:247], v[20:23]
    buffer_load_dwordx4 v[120:123], v243, s[16:19], s56 offen offset:3072
    v_mfma_f32_16x16x32_bf16 v[24:27], v[124:127], a[248:251], v[24:27]
    v_mfma_f32_16x16x32_bf16 v[28:31], v[124:127], a[252:255], v[28:31]
    s_waitcnt vmcnt(30)
    v_mfma_f32_16x16x32_bf16 v[32:35], v[128:131], a[0:3], 0
    v_mfma_f32_16x16x32_bf16 v[36:39], v[128:131], a[4:7], 0
    buffer_load_dwordx4 v[124:127], v243, s[16:19], s57 offen offset:3072
    v_mfma_f32_16x16x32_bf16 v[40:43], v[128:131], a[8:11], 0
    v_mfma_f32_16x16x32_bf16 v[44:47], v[128:131], a[12:15], 0
    s_waitcnt vmcnt(30)
    v_mfma_f32_16x16x32_bf16 v[48:51], v[132:135], a[0:3], 0
    v_mfma_f32_16x16x32_bf16 v[52:55], v[132:135], a[4:7], 0
    s_add_u32 s56, s56, 131072
    s_add_u32 s57, s57, 131072
    buffer_load_dwordx4 v[128:131], v240, s[16:19], s56 offen offset:0
    v_mfma_f32_16x16x32_bf16 v[56:59], v[132:135], a[8:11], 0
    v_mfma_f32_16x16x32_bf16 v[60:63], v[132:135], a[12:15], 0
    s_waitcnt vmcnt(30)
    v_mfma_f32_16x16x32_bf16 v[32:35], v[136:139], a[16:19], v[32:35]
    v_cvt_pk_bf16_f32 v192, v0, v1
    v_mfma_f32_16x16x32_bf16 v[36:39], v[136:139], a[20:23], v[36:39]
    buffer_load_dwordx4 v[132:135], v240, s[16:19], s57 offen offset:0
    v_mfma_f32_16x16x32_bf16 v[40:43], v[136:139], a[24:27], v[40:43]
    v_cvt_pk_bf16_f32 v193, v2, v3
    v_mfma_f32_16x16x32_bf16 v[44:47], v[136:139], a[28:31], v[44:47]
    v_cvt_pk_bf16_f32 v194, v16, v17
    s_waitcnt vmcnt(30)
    v_mfma_f32_16x16x32_bf16 v[48:51], v[140:143], a[16:19], v[48:51]
    v_cvt_pk_bf16_f32 v195, v18, v19
    v_mfma_f32_16x16x32_bf16 v[52:55], v[140:143], a[20:23], v[52:55]
    buffer_load_dwordx4 v[136:139], v240, s[16:19], s56 offen offset:1024
    v_mfma_f32_16x16x32_bf16 v[56:59], v[140:143], a[24:27], v[56:59]
    buffer_store_dwordx4 v[192:195], v234, s[28:31], s64 offen sc1
    v_mfma_f32_16x16x32_bf16 v[60:63], v[140:143], a[28:31], v[60:63]
    s_waitcnt vmcnt(31)
    v_mfma_f32_16x16x32_bf16 v[32:35], v[144:147], a[64:67], v[32:35]
    v_mfma_f32_16x16x32_bf16 v[36:39], v[144:147], a[68:71], v[36:39]
    buffer_load_dwordx4 v[140:143], v240, s[16:19], s57 offen offset:1024
    v_mfma_f32_16x16x32_bf16 v[40:43], v[144:147], a[72:75], v[40:43]
    v_mfma_f32_16x16x32_bf16 v[44:47], v[144:147], a[76:79], v[44:47]
    s_waitcnt vmcnt(31)
    v_mfma_f32_16x16x32_bf16 v[48:51], v[148:151], a[64:67], v[48:51]
    v_mfma_f32_16x16x32_bf16 v[52:55], v[148:151], a[68:71], v[52:55]
    buffer_load_dwordx4 v[144:147], v241, s[16:19], s56 offen offset:0
    v_mfma_f32_16x16x32_bf16 v[56:59], v[148:151], a[72:75], v[56:59]
    v_mfma_f32_16x16x32_bf16 v[60:63], v[148:151], a[76:79], v[60:63]
    s_waitcnt vmcnt(31)
    v_mfma_f32_16x16x32_bf16 v[32:35], v[152:155], a[80:83], v[32:35]
    v_mfma_f32_16x16x32_bf16 v[36:39], v[152:155], a[84:87], v[36:39]
    buffer_load_dwordx4 v[148:151], v241, s[16:19], s57 offen offset:0
    v_mfma_f32_16x16x32_bf16 v[40:43], v[152:155], a[88:91], v[40:43]
    v_mfma_f32_16x16x32_bf16 v[44:47], v[152:155], a[92:95], v[44:47]
    s_waitcnt vmcnt(31)
    v_mfma_f32_16x16x32_bf16 v[48:51], v[156:159], a[80:83], v[48:51]
    v_mfma_f32_16x16x32_bf16 v[52:55], v[156:159], a[84:87], v[52:55]
    buffer_load_dwordx4 v[152:155], v241, s[16:19], s56 offen offset:1024
    v_mfma_f32_16x16x32_bf16 v[56:59], v[156:159], a[88:91], v[56:59]
    v_mfma_f32_16x16x32_bf16 v[60:63], v[156:159], a[92:95], v[60:63]
    s_waitcnt vmcnt(31)
    v_mfma_f32_16x16x32_bf16 v[32:35], v[160:163], a[128:131], v[32:35]
    v_mfma_f32_16x16x32_bf16 v[36:39], v[160:163], a[132:135], v[36:39]
    buffer_load_dwordx4 v[156:159], v241, s[16:19], s57 offen offset:1024
    v_mfma_f32_16x16x32_bf16 v[40:43], v[160:163], a[136:139], v[40:43]
    v_mfma_f32_16x16x32_bf16 v[44:47], v[160:163], a[140:143], v[44:47]
    s_waitcnt vmcnt(31)
    v_mfma_f32_16x16x32_bf16 v[48:51], v[164:167], a[128:131], v[48:51]
    v_mfma_f32_16x16x32_bf16 v[52:55], v[164:167], a[132:135], v[52:55]
    buffer_load_dwordx4 v[160:163], v242, s[16:19], s56 offen offset:0
    v_mfma_f32_16x16x32_bf16 v[56:59], v[164:167], a[136:139], v[56:59]
    v_mfma_f32_16x16x32_bf16 v[60:63], v[164:167], a[140:143], v[60:63]
    s_waitcnt vmcnt(31)
    v_mfma_f32_16x16x32_bf16 v[32:35], v[168:171], a[144:147], v[32:35]
    v_cvt_pk_bf16_f32 v196, v4, v5
    v_mfma_f32_16x16x32_bf16 v[36:39], v[168:171], a[148:151], v[36:39]
    buffer_load_dwordx4 v[164:167], v242, s[16:19], s57 offen offset:0
    v_mfma_f32_16x16x32_bf16 v[40:43], v[168:171], a[152:155], v[40:43]
    v_cvt_pk_bf16_f32 v197, v6, v7
    v_mfma_f32_16x16x32_bf16 v[44:47], v[168:171], a[156:159], v[44:47]
    v_cvt_pk_bf16_f32 v198, v20, v21
    s_waitcnt vmcnt(31)
    v_mfma_f32_16x16x32_bf16 v[48:51], v[172:175], a[144:147], v[48:51]
    v_cvt_pk_bf16_f32 v199, v22, v23
    v_mfma_f32_16x16x32_bf16 v[52:55], v[172:175], a[148:151], v[52:55]
    buffer_load_dwordx4 v[168:171], v242, s[16:19], s56 offen offset:1024
    v_mfma_f32_16x16x32_bf16 v[56:59], v[172:175], a[152:155], v[56:59]
    buffer_store_dwordx4 v[196:199], v235, s[28:31], s64 offen sc1
    v_mfma_f32_16x16x32_bf16 v[60:63], v[172:175], a[156:159], v[60:63]
    s_waitcnt vmcnt(32)
    v_mfma_f32_16x16x32_bf16 v[32:35], v[176:179], a[192:195], v[32:35]
    v_mfma_f32_16x16x32_bf16 v[36:39], v[176:179], a[196:199], v[36:39]
    buffer_load_dwordx4 v[172:175], v242, s[16:19], s57 offen offset:1024
    v_mfma_f32_16x16x32_bf16 v[40:43], v[176:179], a[200:203], v[40:43]
    v_mfma_f32_16x16x32_bf16 v[44:47], v[176:179], a[204:207], v[44:47]
    s_waitcnt vmcnt(32)
    v_mfma_f32_16x16x32_bf16 v[48:51], v[180:183], a[192:195], v[48:51]
    v_mfma_f32_16x16x32_bf16 v[52:55], v[180:183], a[196:199], v[52:55]
    buffer_load_dwordx4 v[176:179], v243, s[16:19], s56 offen offset:0
    v_mfma_f32_16x16x32_bf16 v[56:59], v[180:183], a[200:203], v[56:59]
    v_mfma_f32_16x16x32_bf16 v[60:63], v[180:183], a[204:207], v[60:63]
    s_waitcnt vmcnt(32)
    v_mfma_f32_16x16x32_bf16 v[32:35], v[184:187], a[208:211], v[32:35]
    v_mfma_f32_16x16x32_bf16 v[36:39], v[184:187], a[212:215], v[36:39]
    buffer_load_dwordx4 v[180:183], v243, s[16:19], s57 offen offset:0
    v_mfma_f32_16x16x32_bf16 v[40:43], v[184:187], a[216:219], v[40:43]
    v_mfma_f32_16x16x32_bf16 v[44:47], v[184:187], a[220:223], v[44:47]
    s_waitcnt vmcnt(32)
    v_mfma_f32_16x16x32_bf16 v[48:51], v[188:191], a[208:211], v[48:51]
    v_mfma_f32_16x16x32_bf16 v[52:55], v[188:191], a[212:215], v[52:55]
    buffer_load_dwordx4 v[184:187], v243, s[16:19], s56 offen offset:1024
    v_mfma_f32_16x16x32_bf16 v[56:59], v[188:191], a[216:219], v[56:59]
    v_mfma_f32_16x16x32_bf16 v[60:63], v[188:191], a[220:223], v[60:63]
    s_waitcnt vmcnt(32)
    v_mfma_f32_16x16x32_bf16 v[32:35], v[64:67], a[32:35], v[32:35]
    v_mfma_f32_16x16x32_bf16 v[36:39], v[64:67], a[36:39], v[36:39]
    buffer_load_dwordx4 v[188:191], v243, s[16:19], s57 offen offset:1024
    v_mfma_f32_16x16x32_bf16 v[40:43], v[64:67], a[40:43], v[40:43]
    v_mfma_f32_16x16x32_bf16 v[44:47], v[64:67], a[44:47], v[44:47]
    s_waitcnt vmcnt(32)
    v_mfma_f32_16x16x32_bf16 v[48:51], v[68:71], a[32:35], v[48:51]
    v_mfma_f32_16x16x32_bf16 v[52:55], v[68:71], a[36:39], v[52:55]
    buffer_load_dwordx4 v[64:67], v240, s[16:19], s56 offen offset:2048
    v_mfma_f32_16x16x32_bf16 v[56:59], v[68:71], a[40:43], v[56:59]
    v_mfma_f32_16x16x32_bf16 v[60:63], v[68:71], a[44:47], v[60:63]
    s_waitcnt vmcnt(32)
    v_mfma_f32_16x16x32_bf16 v[32:35], v[72:75], a[48:51], v[32:35]
    v_cvt_pk_bf16_f32 v200, v8, v9
    v_mfma_f32_16x16x32_bf16 v[36:39], v[72:75], a[52:55], v[36:39]
    buffer_load_dwordx4 v[68:71], v240, s[16:19], s57 offen offset:2048
    v_mfma_f32_16x16x32_bf16 v[40:43], v[72:75], a[56:59], v[40:43]
    v_cvt_pk_bf16_f32 v201, v10, v11
    v_mfma_f32_16x16x32_bf16 v[44:47], v[72:75], a[60:63], v[44:47]
    v_cvt_pk_bf16_f32 v202, v24, v25
    s_waitcnt vmcnt(32)
    v_mfma_f32_16x16x32_bf16 v[48:51], v[76:79], a[48:51], v[48:51]
    v_cvt_pk_bf16_f32 v203, v26, v27
    v_mfma_f32_16x16x32_bf16 v[52:55], v[76:79], a[52:55], v[52:55]
    buffer_load_dwordx4 v[72:75], v240, s[16:19], s56 offen offset:3072
    v_mfma_f32_16x16x32_bf16 v[56:59], v[76:79], a[56:59], v[56:59]
    buffer_store_dwordx4 v[200:203], v236, s[28:31], s64 offen sc1
    v_mfma_f32_16x16x32_bf16 v[60:63], v[76:79], a[60:63], v[60:63]
    s_waitcnt vmcnt(33)
    v_mfma_f32_16x16x32_bf16 v[32:35], v[80:83], a[96:99], v[32:35]
    v_mfma_f32_16x16x32_bf16 v[36:39], v[80:83], a[100:103], v[36:39]
    buffer_load_dwordx4 v[76:79], v240, s[16:19], s57 offen offset:3072
    v_mfma_f32_16x16x32_bf16 v[40:43], v[80:83], a[104:107], v[40:43]
    v_mfma_f32_16x16x32_bf16 v[44:47], v[80:83], a[108:111], v[44:47]
    s_waitcnt vmcnt(33)
    v_mfma_f32_16x16x32_bf16 v[48:51], v[84:87], a[96:99], v[48:51]
    v_mfma_f32_16x16x32_bf16 v[52:55], v[84:87], a[100:103], v[52:55]
    buffer_load_dwordx4 v[80:83], v241, s[16:19], s56 offen offset:2048
    v_mfma_f32_16x16x32_bf16 v[56:59], v[84:87], a[104:107], v[56:59]
    v_mfma_f32_16x16x32_bf16 v[60:63], v[84:87], a[108:111], v[60:63]
    s_waitcnt vmcnt(33)
    v_mfma_f32_16x16x32_bf16 v[32:35], v[88:91], a[112:115], v[32:35]
    v_mfma_f32_16x16x32_bf16 v[36:39], v[88:91], a[116:119], v[36:39]
    buffer_load_dwordx4 v[84:87], v241, s[16:19], s57 offen offset:2048
    v_mfma_f32_16x16x32_bf16 v[40:43], v[88:91], a[120:123], v[40:43]
    v_mfma_f32_16x16x32_bf16 v[44:47], v[88:91], a[124:127], v[44:47]
    s_waitcnt vmcnt(33)
    v_mfma_f32_16x16x32_bf16 v[48:51], v[92:95], a[112:115], v[48:51]
    v_mfma_f32_16x16x32_bf16 v[52:55], v[92:95], a[116:119], v[52:55]
    buffer_load_dwordx4 v[88:91], v241, s[16:19], s56 offen offset:3072
    v_mfma_f32_16x16x32_bf16 v[56:59], v[92:95], a[120:123], v[56:59]
    v_mfma_f32_16x16x32_bf16 v[60:63], v[92:95], a[124:127], v[60:63]
    s_waitcnt vmcnt(33)
    v_mfma_f32_16x16x32_bf16 v[32:35], v[96:99], a[160:163], v[32:35]
    v_mfma_f32_16x16x32_bf16 v[36:39], v[96:99], a[164:167], v[36:39]
    buffer_load_dwordx4 v[92:95], v241, s[16:19], s57 offen offset:3072
    v_mfma_f32_16x16x32_bf16 v[40:43], v[96:99], a[168:171], v[40:43]
    v_mfma_f32_16x16x32_bf16 v[44:47], v[96:99], a[172:175], v[44:47]
    s_waitcnt vmcnt(33)
    v_mfma_f32_16x16x32_bf16 v[48:51], v[100:103], a[160:163], v[48:51]
    v_mfma_f32_16x16x32_bf16 v[52:55], v[100:103], a[164:167], v[52:55]
    buffer_load_dwordx4 v[96:99], v242, s[16:19], s56 offen offset:2048
    v_mfma_f32_16x16x32_bf16 v[56:59], v[100:103], a[168:171], v[56:59]
    v_mfma_f32_16x16x32_bf16 v[60:63], v[100:103], a[172:175], v[60:63]
    s_waitcnt vmcnt(33)
    v_mfma_f32_16x16x32_bf16 v[32:35], v[104:107], a[176:179], v[32:35]
    v_cvt_pk_bf16_f32 v204, v12, v13
    v_mfma_f32_16x16x32_bf16 v[36:39], v[104:107], a[180:183], v[36:39]
    buffer_load_dwordx4 v[100:103], v242, s[16:19], s57 offen offset:2048
    v_mfma_f32_16x16x32_bf16 v[40:43], v[104:107], a[184:187], v[40:43]
    v_cvt_pk_bf16_f32 v205, v14, v15
    v_mfma_f32_16x16x32_bf16 v[44:47], v[104:107], a[188:191], v[44:47]
    v_cvt_pk_bf16_f32 v206, v28, v29
    s_waitcnt vmcnt(33)
    v_mfma_f32_16x16x32_bf16 v[48:51], v[108:111], a[176:179], v[48:51]
    v_cvt_pk_bf16_f32 v207, v30, v31
    v_mfma_f32_16x16x32_bf16 v[52:55], v[108:111], a[180:183], v[52:55]
    buffer_load_dwordx4 v[104:107], v242, s[16:19], s56 offen offset:3072
    v_mfma_f32_16x16x32_bf16 v[56:59], v[108:111], a[184:187], v[56:59]
    buffer_store_dwordx4 v[204:207], v237, s[28:31], s64 offen sc1
    v_mfma_f32_16x16x32_bf16 v[60:63], v[108:111], a[188:191], v[60:63]
    s_waitcnt vmcnt(34)
    v_mfma_f32_16x16x32_bf16 v[32:35], v[112:115], a[224:227], v[32:35]
    v_mfma_f32_16x16x32_bf16 v[36:39], v[112:115], a[228:231], v[36:39]
    buffer_load_dwordx4 v[108:111], v242, s[16:19], s57 offen offset:3072
    v_mfma_f32_16x16x32_bf16 v[40:43], v[112:115], a[232:235], v[40:43]
    v_mfma_f32_16x16x32_bf16 v[44:47], v[112:115], a[236:239], v[44:47]
    s_waitcnt vmcnt(34)
    v_mfma_f32_16x16x32_bf16 v[48:51], v[116:119], a[224:227], v[48:51]
    v_mfma_f32_16x16x32_bf16 v[52:55], v[116:119], a[228:231], v[52:55]
    buffer_load_dwordx4 v[112:115], v243, s[16:19], s56 offen offset:2048
    v_mfma_f32_16x16x32_bf16 v[56:59], v[116:119], a[232:235], v[56:59]
    v_mfma_f32_16x16x32_bf16 v[60:63], v[116:119], a[236:239], v[60:63]
    s_waitcnt vmcnt(34)
    v_mfma_f32_16x16x32_bf16 v[32:35], v[120:123], a[240:243], v[32:35]
    v_mfma_f32_16x16x32_bf16 v[36:39], v[120:123], a[244:247], v[36:39]
    buffer_load_dwordx4 v[116:119], v243, s[16:19], s57 offen offset:2048
    v_mfma_f32_16x16x32_bf16 v[40:43], v[120:123], a[248:251], v[40:43]
    v_mfma_f32_16x16x32_bf16 v[44:47], v[120:123], a[252:255], v[44:47]
    s_waitcnt vmcnt(34)
    v_mfma_f32_16x16x32_bf16 v[48:51], v[124:127], a[240:243], v[48:51]
    v_mfma_f32_16x16x32_bf16 v[52:55], v[124:127], a[244:247], v[52:55]
    buffer_load_dwordx4 v[120:123], v243, s[16:19], s56 offen offset:3072
    v_mfma_f32_16x16x32_bf16 v[56:59], v[124:127], a[248:251], v[56:59]
    v_mfma_f32_16x16x32_bf16 v[60:63], v[124:127], a[252:255], v[60:63]
    s_waitcnt vmcnt(34)
    v_mfma_f32_16x16x32_bf16 v[0:3], v[128:131], a[0:3], 0
    s_load_dwordx2 s[72:73], s[0:1], 0
    s_bfe_u32 s45, s2, 0x10003
    v_mfma_f32_16x16x32_bf16 v[4:7], v[128:131], a[4:7], 0
    buffer_load_dwordx4 v[124:127], v243, s[16:19], s57 offen offset:3072
    v_mfma_f32_16x16x32_bf16 v[8:11], v[128:131], a[8:11], 0
    s_lshr_b32 s44, s2, 4
    s_lshl_b32 s62, s42, 4
    v_mfma_f32_16x16x32_bf16 v[12:15], v[128:131], a[12:15], 0
    s_or_b32 s44, s44, s62
    s_add_u32 s32, s86, 32768
    s_addc_u32 s33, s87, 0
    s_waitcnt vmcnt(34)
    v_mfma_f32_16x16x32_bf16 v[16:19], v[132:135], a[0:3], 0
    s_mov_b32 s34, 32768
    s_mov_b32 s35, 0x20000
    v_mfma_f32_16x16x32_bf16 v[20:23], v[132:135], a[4:7], 0
    buffer_load_dwordx4 v[128:131], v240, s[16:19], s58 offen offset:0
    v_mfma_f32_16x16x32_bf16 v[24:27], v[132:135], a[8:11], 0
    v_lshrrev_b32 v244, 4, v254
    s_lshr_b32 s62, s44, 2
    v_mfma_f32_16x16x32_bf16 v[28:31], v[132:135], a[12:15], 0
    s_lshl_b32 s62, s62, 3
    v_and_b32 v246, 7, v244
    s_waitcnt vmcnt(34)
    v_mfma_f32_16x16x32_bf16 v[0:3], v[136:139], a[16:19], v[0:3]
    v_cvt_pk_bf16_f32 v208, v32, v33
    v_mfma_f32_16x16x32_bf16 v[4:7], v[136:139], a[20:23], v[4:7]
    buffer_load_dwordx4 v[132:135], v240, s[16:19], s59 offen offset:0
    v_mfma_f32_16x16x32_bf16 v[8:11], v[136:139], a[24:27], v[8:11]
    v_cvt_pk_bf16_f32 v209, v34, v35
    v_mfma_f32_16x16x32_bf16 v[12:15], v[136:139], a[28:31], v[12:15]
    v_cvt_pk_bf16_f32 v210, v48, v49
    s_waitcnt vmcnt(33)
    v_mfma_f32_16x16x32_bf16 v[16:19], v[140:143], a[16:19], v[16:19]
    v_cvt_pk_bf16_f32 v211, v50, v51
    v_mfma_f32_16x16x32_bf16 v[20:23], v[140:143], a[20:23], v[20:23]
    buffer_load_dwordx4 v[136:139], v240, s[16:19], s58 offen offset:1024
    v_mfma_f32_16x16x32_bf16 v[24:27], v[140:143], a[24:27], v[24:27]
    buffer_store_dwordx4 v[208:211], v234, s[28:31], s65 offen sc1
    v_mfma_f32_16x16x32_bf16 v[28:31], v[140:143], a[28:31], v[28:31]
    v_add_lshl_u32 v228, v246, s62, 7
    s_mul_i32 s62, s40, 3
    s_waitcnt vmcnt(34)
    v_mfma_f32_16x16x32_bf16 v[0:3], v[144:147], a[64:67], v[0:3]
    s_add_u32 s62, s62, 2
    s_lshl_b32 s46, s40, 2
    v_mfma_f32_16x16x32_bf16 v[4:7], v[144:147], a[68:71], v[4:7]
    buffer_load_dwordx4 v[140:143], v240, s[16:19], s59 offen offset:1024
    v_mfma_f32_16x16x32_bf16 v[8:11], v[144:147], a[72:75], v[8:11]
    s_cmp_ge_u32 s40, 2
    s_cselect_b32 s46, s62, s46
    s_cselect_b64 s[98:99], -1, 0
    s_mul_i32 s47, s44, 14
    v_mfma_f32_16x16x32_bf16 v[12:15], v[144:147], a[76:79], v[12:15]
    s_add_u32 s47, s47, s46
    s_lshl_b32 s47, s47, 10
    s_waitcnt vmcnt(34)
    v_mfma_f32_16x16x32_bf16 v[16:19], v[148:151], a[64:67], v[16:19]
    s_mul_i32 s51, s40, 5120
    s_add_u32 s51, s51, 65536
    v_mfma_f32_16x16x32_bf16 v[20:23], v[148:151], a[68:71], v[20:23]
    buffer_load_dwordx4 v[144:147], v241, s[16:19], s58 offen offset:0
    v_mfma_f32_16x16x32_bf16 v[24:27], v[148:151], a[72:75], v[24:27]
    v_mov_b32 v245, 1879048192
    v_lshrrev_b32 v246, 2, v244
    v_mfma_f32_16x16x32_bf16 v[28:31], v[148:151], a[76:79], v[28:31]
    v_and_b32 v247, 3, v244
    s_lshl_b32 s62, s44, 4
    s_waitcnt vmcnt(34)
    v_mfma_f32_16x16x32_bf16 v[0:3], v[152:155], a[80:83], v[0:3]
    v_add_u32 v246, s62, v246
    v_mul_u32_u24 v246, 896, v246
    v_mfma_f32_16x16x32_bf16 v[4:7], v[152:155], a[84:87], v[4:7]
    buffer_load_dwordx4 v[148:151], v241, s[16:19], s59 offen offset:0
    v_mfma_f32_16x16x32_bf16 v[8:11], v[152:155], a[88:91], v[8:11]
    s_lshl_b32 s62, s46, 6
    v_lshl_add_u32 v246, v247, 4, v246
    v_mfma_f32_16x16x32_bf16 v[12:15], v[152:155], a[92:95], v[12:15]
    v_add_u32 v225, s62, v246
    v_cndmask_b32 v226, v225, v245, s[98:99]
    s_waitcnt vmcnt(34)
    v_mfma_f32_16x16x32_bf16 v[16:19], v[156:159], a[80:83], v[16:19]
    v_lshrrev_b32 v246, 4, v244
    v_and_b32 v247, 15, v244
    v_mfma_f32_16x16x32_bf16 v[20:23], v[156:159], a[84:87], v[20:23]
    buffer_load_dwordx4 v[152:155], v241, s[16:19], s58 offen offset:1024
    v_mfma_f32_16x16x32_bf16 v[24:27], v[156:159], a[88:91], v[24:27]
    v_mul_u32_u24 v248, 896, v246
    v_lshl_add_u32 v248, v247, 4, v248
    v_mfma_f32_16x16x32_bf16 v[28:31], v[156:159], a[92:95], v[28:31]
    v_add_u32 v248, s62, v248
    v_cmp_lt_u32 vcc, 11, v247
    s_waitcnt vmcnt(34)
    v_mfma_f32_16x16x32_bf16 v[0:3], v[160:163], a[128:131], v[0:3]
    v_add_u32 v224, 3072, v254
    s_and_b64 vcc, vcc, s[98:99]
    v_mfma_f32_16x16x32_bf16 v[4:7], v[160:163], a[132:135], v[4:7]
    buffer_load_dwordx4 v[156:159], v241, s[16:19], s59 offen offset:1024
    v_mfma_f32_16x16x32_bf16 v[8:11], v[160:163], a[136:139], v[8:11]
    v_cndmask_b32 v224, v224, v245, s[98:99]
    v_cndmask_b32 v227, v248, v245, vcc
    v_mfma_f32_16x16x32_bf16 v[12:15], v[160:163], a[140:143], v[12:15]
    s_add_u32 s4, s86, 65536
    s_addc_u32 s5, s87, 0
    s_mov_b32 s6, 14680064
    s_waitcnt vmcnt(34)
    v_mfma_f32_16x16x32_bf16 v[16:19], v[164:167], a[128:131], v[16:19]
    s_mov_b32 s7, 0x20000
    s_add_u32 s24, s86, 12288
    s_addc_u32 s25, s87, 0
    v_mfma_f32_16x16x32_bf16 v[20:23], v[164:167], a[132:135], v[20:23]
    buffer_load_dwordx4 v[160:163], v242, s[16:19], s58 offen offset:0
    v_mfma_f32_16x16x32_bf16 v[24:27], v[164:167], a[136:139], v[24:27]
    s_mov_b32 s26, 4480
    s_mov_b32 s27, 0x20000
    v_mfma_f32_16x16x32_bf16 v[28:31], v[164:167], a[140:143], v[28:31]
    s_bfe_u32 s63, s2, 0x10003
    s_mul_i32 s63, s63, 14
    s_lshl_b32 s55, s40, 2
    s_add_u32 s63, s63, s55
    s_mul_i32 s96, s63, 14336
    s_add_u32 s97, s96, 14336
    s_add_u32 s52, s97, 14336
    s_add_u32 s53, s52, 14336
    s_cmp_eq_u32 s40, 3
    s_cselect_b32 s52, 1879048192, s52
    s_cselect_b32 s53, 1879048192, s53
    s_waitcnt vmcnt(34)
    v_mfma_f32_16x16x32_bf16 v[0:3], v[168:171], a[144:147], v[0:3]
    v_cvt_pk_bf16_f32 v212, v36, v37
    v_mfma_f32_16x16x32_bf16 v[4:7], v[168:171], a[148:151], v[4:7]
    buffer_load_dwordx4 v[164:167], v242, s[16:19], s59 offen offset:0
    v_mfma_f32_16x16x32_bf16 v[8:11], v[168:171], a[152:155], v[8:11]
    v_cvt_pk_bf16_f32 v213, v38, v39
    v_mfma_f32_16x16x32_bf16 v[12:15], v[168:171], a[156:159], v[12:15]
    v_cvt_pk_bf16_f32 v214, v52, v53
    s_waitcnt vmcnt(33)
    v_mfma_f32_16x16x32_bf16 v[16:19], v[172:175], a[144:147], v[16:19]
    v_cvt_pk_bf16_f32 v215, v54, v55
    v_mfma_f32_16x16x32_bf16 v[20:23], v[172:175], a[148:151], v[20:23]
    buffer_load_dwordx4 v[168:171], v242, s[16:19], s58 offen offset:1024
    v_mfma_f32_16x16x32_bf16 v[24:27], v[172:175], a[152:155], v[24:27]
    buffer_store_dwordx4 v[212:215], v235, s[28:31], s65 offen sc1
    v_mfma_f32_16x16x32_bf16 v[28:31], v[172:175], a[156:159], v[28:31]
    s_waitcnt vmcnt(34)
    v_mfma_f32_16x16x32_bf16 v[0:3], v[176:179], a[192:195], v[0:3]
    v_mfma_f32_16x16x32_bf16 v[4:7], v[176:179], a[196:199], v[4:7]
    buffer_load_dwordx4 v[172:175], v242, s[16:19], s59 offen offset:1024
    v_mfma_f32_16x16x32_bf16 v[8:11], v[176:179], a[200:203], v[8:11]
    v_mfma_f32_16x16x32_bf16 v[12:15], v[176:179], a[204:207], v[12:15]
    s_waitcnt vmcnt(34)
    v_mfma_f32_16x16x32_bf16 v[16:19], v[180:183], a[192:195], v[16:19]
    v_mfma_f32_16x16x32_bf16 v[20:23], v[180:183], a[196:199], v[20:23]
    buffer_load_dwordx4 v[176:179], v243, s[16:19], s58 offen offset:0
    v_mfma_f32_16x16x32_bf16 v[24:27], v[180:183], a[200:203], v[24:27]
    v_mfma_f32_16x16x32_bf16 v[28:31], v[180:183], a[204:207], v[28:31]
    s_waitcnt vmcnt(34)
    v_mfma_f32_16x16x32_bf16 v[0:3], v[184:187], a[208:211], v[0:3]
    v_mfma_f32_16x16x32_bf16 v[4:7], v[184:187], a[212:215], v[4:7]
    buffer_load_dwordx4 v[180:183], v243, s[16:19], s59 offen offset:0
    v_mfma_f32_16x16x32_bf16 v[8:11], v[184:187], a[216:219], v[8:11]
    v_mfma_f32_16x16x32_bf16 v[12:15], v[184:187], a[220:223], v[12:15]
    s_waitcnt vmcnt(34)
    v_mfma_f32_16x16x32_bf16 v[16:19], v[188:191], a[208:211], v[16:19]
    v_mfma_f32_16x16x32_bf16 v[20:23], v[188:191], a[212:215], v[20:23]
    buffer_load_dwordx4 v[184:187], v243, s[16:19], s58 offen offset:1024
    v_mfma_f32_16x16x32_bf16 v[24:27], v[188:191], a[216:219], v[24:27]
    v_mfma_f32_16x16x32_bf16 v[28:31], v[188:191], a[220:223], v[28:31]
    s_waitcnt vmcnt(34)
    v_mfma_f32_16x16x32_bf16 v[0:3], v[64:67], a[32:35], v[0:3]
    v_mfma_f32_16x16x32_bf16 v[4:7], v[64:67], a[36:39], v[4:7]
    buffer_load_dwordx4 v[188:191], v243, s[16:19], s59 offen offset:1024
    v_mfma_f32_16x16x32_bf16 v[8:11], v[64:67], a[40:43], v[8:11]
    v_mfma_f32_16x16x32_bf16 v[12:15], v[64:67], a[44:47], v[12:15]
    s_waitcnt vmcnt(34)
    v_mfma_f32_16x16x32_bf16 v[16:19], v[68:71], a[32:35], v[16:19]
    v_mfma_f32_16x16x32_bf16 v[20:23], v[68:71], a[36:39], v[20:23]
    buffer_load_dwordx4 v[64:67], v240, s[16:19], s58 offen offset:2048
    v_mfma_f32_16x16x32_bf16 v[24:27], v[68:71], a[40:43], v[24:27]
    v_mfma_f32_16x16x32_bf16 v[28:31], v[68:71], a[44:47], v[28:31]
    s_waitcnt vmcnt(34)
    v_mfma_f32_16x16x32_bf16 v[0:3], v[72:75], a[48:51], v[0:3]
    v_cvt_pk_bf16_f32 v216, v40, v41
    v_mfma_f32_16x16x32_bf16 v[4:7], v[72:75], a[52:55], v[4:7]
    buffer_load_dwordx4 v[68:71], v240, s[16:19], s59 offen offset:2048
    v_mfma_f32_16x16x32_bf16 v[8:11], v[72:75], a[56:59], v[8:11]
    v_cvt_pk_bf16_f32 v217, v42, v43
    v_mfma_f32_16x16x32_bf16 v[12:15], v[72:75], a[60:63], v[12:15]
    v_cvt_pk_bf16_f32 v218, v56, v57
    s_waitcnt vmcnt(33)
    v_mfma_f32_16x16x32_bf16 v[16:19], v[76:79], a[48:51], v[16:19]
    v_cvt_pk_bf16_f32 v219, v58, v59
    v_mfma_f32_16x16x32_bf16 v[20:23], v[76:79], a[52:55], v[20:23]
    buffer_load_dwordx4 v[72:75], v240, s[16:19], s58 offen offset:3072
    v_mfma_f32_16x16x32_bf16 v[24:27], v[76:79], a[56:59], v[24:27]
    buffer_store_dwordx4 v[216:219], v236, s[28:31], s65 offen sc1
    v_mfma_f32_16x16x32_bf16 v[28:31], v[76:79], a[60:63], v[28:31]
    s_waitcnt vmcnt(34)
    v_mfma_f32_16x16x32_bf16 v[0:3], v[80:83], a[96:99], v[0:3]
    v_mfma_f32_16x16x32_bf16 v[4:7], v[80:83], a[100:103], v[4:7]
    buffer_load_dwordx4 v[76:79], v240, s[16:19], s59 offen offset:3072
    v_mfma_f32_16x16x32_bf16 v[8:11], v[80:83], a[104:107], v[8:11]
    v_mfma_f32_16x16x32_bf16 v[12:15], v[80:83], a[108:111], v[12:15]
    s_waitcnt vmcnt(34)
    v_mfma_f32_16x16x32_bf16 v[16:19], v[84:87], a[96:99], v[16:19]
    v_mfma_f32_16x16x32_bf16 v[20:23], v[84:87], a[100:103], v[20:23]
    buffer_load_dwordx4 v[80:83], v241, s[16:19], s58 offen offset:2048
    v_mfma_f32_16x16x32_bf16 v[24:27], v[84:87], a[104:107], v[24:27]
    v_mfma_f32_16x16x32_bf16 v[28:31], v[84:87], a[108:111], v[28:31]
    s_waitcnt vmcnt(34)
    v_mfma_f32_16x16x32_bf16 v[0:3], v[88:91], a[112:115], v[0:3]
    v_mfma_f32_16x16x32_bf16 v[4:7], v[88:91], a[116:119], v[4:7]
    buffer_load_dwordx4 v[84:87], v241, s[16:19], s59 offen offset:2048
    v_mfma_f32_16x16x32_bf16 v[8:11], v[88:91], a[120:123], v[8:11]
    v_mfma_f32_16x16x32_bf16 v[12:15], v[88:91], a[124:127], v[12:15]
    s_waitcnt vmcnt(34)
    v_mfma_f32_16x16x32_bf16 v[16:19], v[92:95], a[112:115], v[16:19]
    v_mfma_f32_16x16x32_bf16 v[20:23], v[92:95], a[116:119], v[20:23]
    buffer_load_dwordx4 v[88:91], v241, s[16:19], s58 offen offset:3072
    v_mfma_f32_16x16x32_bf16 v[24:27], v[92:95], a[120:123], v[24:27]
    v_mfma_f32_16x16x32_bf16 v[28:31], v[92:95], a[124:127], v[28:31]
    s_waitcnt vmcnt(34)
    v_mfma_f32_16x16x32_bf16 v[0:3], v[96:99], a[160:163], v[0:3]
    v_mfma_f32_16x16x32_bf16 v[4:7], v[96:99], a[164:167], v[4:7]
    buffer_load_dwordx4 v[92:95], v241, s[16:19], s59 offen offset:3072
    v_mfma_f32_16x16x32_bf16 v[8:11], v[96:99], a[168:171], v[8:11]
    v_mfma_f32_16x16x32_bf16 v[12:15], v[96:99], a[172:175], v[12:15]
    s_waitcnt vmcnt(34)
    v_mfma_f32_16x16x32_bf16 v[16:19], v[100:103], a[160:163], v[16:19]
    v_mfma_f32_16x16x32_bf16 v[20:23], v[100:103], a[164:167], v[20:23]
    buffer_load_dwordx4 v[96:99], v242, s[16:19], s58 offen offset:2048
    v_mfma_f32_16x16x32_bf16 v[24:27], v[100:103], a[168:171], v[24:27]
    v_mfma_f32_16x16x32_bf16 v[28:31], v[100:103], a[172:175], v[28:31]
    s_waitcnt vmcnt(34)
    v_mfma_f32_16x16x32_bf16 v[0:3], v[104:107], a[176:179], v[0:3]
    v_cvt_pk_bf16_f32 v220, v44, v45
    v_mfma_f32_16x16x32_bf16 v[4:7], v[104:107], a[180:183], v[4:7]
    buffer_load_dwordx4 v[100:103], v242, s[16:19], s59 offen offset:2048
    v_mfma_f32_16x16x32_bf16 v[8:11], v[104:107], a[184:187], v[8:11]
    v_cvt_pk_bf16_f32 v221, v46, v47
    v_mfma_f32_16x16x32_bf16 v[12:15], v[104:107], a[188:191], v[12:15]
    v_cvt_pk_bf16_f32 v222, v60, v61
    s_waitcnt vmcnt(33)
    v_mfma_f32_16x16x32_bf16 v[16:19], v[108:111], a[176:179], v[16:19]
    v_cvt_pk_bf16_f32 v223, v62, v63
    v_mfma_f32_16x16x32_bf16 v[20:23], v[108:111], a[180:183], v[20:23]
    buffer_load_dwordx4 v[104:107], v242, s[16:19], s58 offen offset:3072
    v_mfma_f32_16x16x32_bf16 v[24:27], v[108:111], a[184:187], v[24:27]
    buffer_store_dwordx4 v[220:223], v237, s[28:31], s65 offen sc1
    v_mfma_f32_16x16x32_bf16 v[28:31], v[108:111], a[188:191], v[28:31]
    s_waitcnt vmcnt(34)
    v_mfma_f32_16x16x32_bf16 v[0:3], v[112:115], a[224:227], v[0:3]
    v_mfma_f32_16x16x32_bf16 v[4:7], v[112:115], a[228:231], v[4:7]
    buffer_load_dwordx4 v[108:111], v242, s[16:19], s59 offen offset:3072
    v_mfma_f32_16x16x32_bf16 v[8:11], v[112:115], a[232:235], v[8:11]
    v_mfma_f32_16x16x32_bf16 v[12:15], v[112:115], a[236:239], v[12:15]
    s_waitcnt vmcnt(34)
    v_mfma_f32_16x16x32_bf16 v[16:19], v[116:119], a[224:227], v[16:19]
    v_mfma_f32_16x16x32_bf16 v[20:23], v[116:119], a[228:231], v[20:23]
    buffer_load_dwordx4 v[112:115], v243, s[16:19], s58 offen offset:2048
    v_mfma_f32_16x16x32_bf16 v[24:27], v[116:119], a[232:235], v[24:27]
    v_mfma_f32_16x16x32_bf16 v[28:31], v[116:119], a[236:239], v[28:31]
    s_waitcnt vmcnt(34)
    v_mfma_f32_16x16x32_bf16 v[0:3], v[120:123], a[240:243], v[0:3]
    v_mfma_f32_16x16x32_bf16 v[4:7], v[120:123], a[244:247], v[4:7]
    buffer_load_dwordx4 v[116:119], v243, s[16:19], s59 offen offset:2048
    v_mfma_f32_16x16x32_bf16 v[8:11], v[120:123], a[248:251], v[8:11]
    v_mfma_f32_16x16x32_bf16 v[12:15], v[120:123], a[252:255], v[12:15]
    s_waitcnt vmcnt(34)
    v_mfma_f32_16x16x32_bf16 v[16:19], v[124:127], a[240:243], v[16:19]
    v_mfma_f32_16x16x32_bf16 v[20:23], v[124:127], a[244:247], v[20:23]
    buffer_load_dwordx4 v[120:123], v243, s[16:19], s58 offen offset:3072
    v_mfma_f32_16x16x32_bf16 v[24:27], v[124:127], a[248:251], v[24:27]
    v_mfma_f32_16x16x32_bf16 v[28:31], v[124:127], a[252:255], v[28:31]
    s_waitcnt vmcnt(33)
    v_mfma_f32_16x16x32_bf16 v[32:35], v[128:131], a[0:3], 0
    buffer_load_dwordx4 v[124:127], v243, s[16:19], s59 offen offset:3072
    v_mfma_f32_16x16x32_bf16 v[36:39], v[128:131], a[4:7], 0
    v_mfma_f32_16x16x32_bf16 v[48:51], v[132:135], a[0:3], 0
    v_mfma_f32_16x16x32_bf16 v[52:55], v[132:135], a[4:7], 0
    s_waitcnt vmcnt(31)
    v_mfma_f32_16x16x32_bf16 v[32:35], v[136:139], a[16:19], v[32:35]
    v_mfma_f32_16x16x32_bf16 v[36:39], v[136:139], a[20:23], v[36:39]
    v_cvt_pk_bf16_f32 v192, v0, v1
    v_mfma_f32_16x16x32_bf16 v[48:51], v[140:143], a[16:19], v[48:51]
    v_mfma_f32_16x16x32_bf16 v[52:55], v[140:143], a[20:23], v[52:55]
    v_cvt_pk_bf16_f32 v193, v2, v3
    s_waitcnt vmcnt(29)
    v_mfma_f32_16x16x32_bf16 v[32:35], v[144:147], a[64:67], v[32:35]
    v_mfma_f32_16x16x32_bf16 v[36:39], v[144:147], a[68:71], v[36:39]
    v_cvt_pk_bf16_f32 v194, v16, v17
    v_mfma_f32_16x16x32_bf16 v[48:51], v[148:151], a[64:67], v[48:51]
    v_mfma_f32_16x16x32_bf16 v[52:55], v[148:151], a[68:71], v[52:55]
    v_cvt_pk_bf16_f32 v195, v18, v19
    s_waitcnt vmcnt(27)
    v_mfma_f32_16x16x32_bf16 v[32:35], v[152:155], a[80:83], v[32:35]
    v_mfma_f32_16x16x32_bf16 v[36:39], v[152:155], a[84:87], v[36:39]
    buffer_store_dwordx4 v[192:195], v234, s[28:31], s66 offen sc1
    v_mfma_f32_16x16x32_bf16 v[48:51], v[156:159], a[80:83], v[48:51]
    v_mfma_f32_16x16x32_bf16 v[52:55], v[156:159], a[84:87], v[52:55]
    s_waitcnt vmcnt(26)
    v_mfma_f32_16x16x32_bf16 v[32:35], v[160:163], a[128:131], v[32:35]
    v_mfma_f32_16x16x32_bf16 v[36:39], v[160:163], a[132:135], v[36:39]
    v_mfma_f32_16x16x32_bf16 v[48:51], v[164:167], a[128:131], v[48:51]
    v_mfma_f32_16x16x32_bf16 v[52:55], v[164:167], a[132:135], v[52:55]
    s_waitcnt vmcnt(23)
    v_mfma_f32_16x16x32_bf16 v[32:35], v[168:171], a[144:147], v[32:35]
    v_mfma_f32_16x16x32_bf16 v[36:39], v[168:171], a[148:151], v[36:39]
    v_cvt_pk_bf16_f32 v196, v4, v5
    v_mfma_f32_16x16x32_bf16 v[48:51], v[172:175], a[144:147], v[48:51]
    v_mfma_f32_16x16x32_bf16 v[52:55], v[172:175], a[148:151], v[52:55]
    v_cvt_pk_bf16_f32 v197, v6, v7
    s_waitcnt vmcnt(21)
    v_mfma_f32_16x16x32_bf16 v[32:35], v[176:179], a[192:195], v[32:35]
    v_mfma_f32_16x16x32_bf16 v[36:39], v[176:179], a[196:199], v[36:39]
    v_cvt_pk_bf16_f32 v198, v20, v21
    v_mfma_f32_16x16x32_bf16 v[48:51], v[180:183], a[192:195], v[48:51]
    v_mfma_f32_16x16x32_bf16 v[52:55], v[180:183], a[196:199], v[52:55]
    v_cvt_pk_bf16_f32 v199, v22, v23
    s_waitcnt vmcnt(19)
    v_mfma_f32_16x16x32_bf16 v[32:35], v[184:187], a[208:211], v[32:35]
    v_mfma_f32_16x16x32_bf16 v[36:39], v[184:187], a[212:215], v[36:39]
    buffer_store_dwordx4 v[196:199], v235, s[28:31], s66 offen sc1
    v_mfma_f32_16x16x32_bf16 v[48:51], v[188:191], a[208:211], v[48:51]
    v_mfma_f32_16x16x32_bf16 v[52:55], v[188:191], a[212:215], v[52:55]
    s_waitcnt vmcnt(18)
    v_mfma_f32_16x16x32_bf16 v[32:35], v[64:67], a[32:35], v[32:35]
    v_mfma_f32_16x16x32_bf16 v[36:39], v[64:67], a[36:39], v[36:39]
    v_mfma_f32_16x16x32_bf16 v[48:51], v[68:71], a[32:35], v[48:51]
    buffer_load_dword v229, v228, s[32:35], 0 offen sc1
    v_mfma_f32_16x16x32_bf16 v[52:55], v[68:71], a[36:39], v[52:55]
    s_waitcnt vmcnt(16)
    v_mfma_f32_16x16x32_bf16 v[32:35], v[72:75], a[48:51], v[32:35]
    v_cvt_pk_bf16_f32 v200, v8, v9
    v_mfma_f32_16x16x32_bf16 v[36:39], v[72:75], a[52:55], v[36:39]
    v_cvt_pk_bf16_f32 v201, v10, v11
    v_mfma_f32_16x16x32_bf16 v[48:51], v[76:79], a[48:51], v[48:51]
    v_cvt_pk_bf16_f32 v202, v24, v25
    v_mfma_f32_16x16x32_bf16 v[52:55], v[76:79], a[52:55], v[52:55]
    v_cvt_pk_bf16_f32 v203, v26, v27
    s_waitcnt vmcnt(14)
    v_mfma_f32_16x16x32_bf16 v[32:35], v[80:83], a[96:99], v[32:35]
    buffer_store_dwordx4 v[200:203], v236, s[28:31], s66 offen sc1
    v_mfma_f32_16x16x32_bf16 v[36:39], v[80:83], a[100:103], v[36:39]
    v_mfma_f32_16x16x32_bf16 v[48:51], v[84:87], a[96:99], v[48:51]
    v_mfma_f32_16x16x32_bf16 v[52:55], v[84:87], a[100:103], v[52:55]
    s_waitcnt vmcnt(13)
    v_mfma_f32_16x16x32_bf16 v[32:35], v[88:91], a[112:115], v[32:35]
    v_mfma_f32_16x16x32_bf16 v[36:39], v[88:91], a[116:119], v[36:39]
    v_mfma_f32_16x16x32_bf16 v[48:51], v[92:95], a[112:115], v[48:51]
    v_mfma_f32_16x16x32_bf16 v[52:55], v[92:95], a[116:119], v[52:55]
    s_waitcnt vmcnt(11)
    v_mfma_f32_16x16x32_bf16 v[32:35], v[96:99], a[160:163], v[32:35]
    v_mfma_f32_16x16x32_bf16 v[36:39], v[96:99], a[164:167], v[36:39]
    v_mfma_f32_16x16x32_bf16 v[48:51], v[100:103], a[160:163], v[48:51]
    v_mfma_f32_16x16x32_bf16 v[52:55], v[100:103], a[164:167], v[52:55]
    s_waitcnt vmcnt(8)
    v_mfma_f32_16x16x32_bf16 v[32:35], v[104:107], a[176:179], v[32:35]
    v_cvt_pk_bf16_f32 v204, v12, v13
    v_mfma_f32_16x16x32_bf16 v[36:39], v[104:107], a[180:183], v[36:39]
    v_cvt_pk_bf16_f32 v205, v14, v15
    v_mfma_f32_16x16x32_bf16 v[48:51], v[108:111], a[176:179], v[48:51]
    v_cvt_pk_bf16_f32 v206, v28, v29
    v_mfma_f32_16x16x32_bf16 v[52:55], v[108:111], a[180:183], v[52:55]
    v_cvt_pk_bf16_f32 v207, v30, v31
    s_waitcnt vmcnt(6)
    v_mfma_f32_16x16x32_bf16 v[32:35], v[112:115], a[224:227], v[32:35]
    buffer_store_dwordx4 v[204:207], v237, s[28:31], s66 offen sc1
    v_mfma_f32_16x16x32_bf16 v[36:39], v[112:115], a[228:231], v[36:39]
    v_mfma_f32_16x16x32_bf16 v[48:51], v[116:119], a[224:227], v[48:51]
    v_mfma_f32_16x16x32_bf16 v[52:55], v[116:119], a[228:231], v[52:55]
    s_waitcnt vmcnt(5)
    v_mfma_f32_16x16x32_bf16 v[32:35], v[120:123], a[240:243], v[32:35]
    v_mfma_f32_16x16x32_bf16 v[36:39], v[120:123], a[244:247], v[36:39]
    v_mfma_f32_16x16x32_bf16 v[48:51], v[124:127], a[240:243], v[48:51]
    v_mfma_f32_16x16x32_bf16 v[52:55], v[124:127], a[244:247], v[52:55]
    s_nop 7
    v_cvt_pk_bf16_f32 v208, v32, v33
    v_cvt_pk_bf16_f32 v209, v34, v35
    v_cvt_pk_bf16_f32 v210, v48, v49
    v_cvt_pk_bf16_f32 v211, v50, v51
    buffer_store_dwordx4 v[208:211], v234, s[28:31], s67 offen sc1
    v_cvt_pk_bf16_f32 v212, v36, v37
    v_cvt_pk_bf16_f32 v213, v38, v39
    v_cvt_pk_bf16_f32 v214, v52, v53
    v_cvt_pk_bf16_f32 v215, v54, v55
    buffer_store_dwordx4 v[212:215], v235, s[28:31], s67 offen sc1
    s_waitcnt lgkmcnt(0)
    s_mov_b32 s8, s72
    s_mov_b32 s9, s73
    s_mov_b32 s10, 1835008
    s_mov_b32 s11, 0x20000
    s_add_u32 s16, s86, 32768
    s_addc_u32 s17, s87, 0
    s_mov_b32 s18, 32768
    s_mov_b32 s19, 0x20000
    s_add_u32 m0, s51, 0
    s_nop 0
    buffer_load_dwordx4 v225, s[8:11], 0 offen offset:0 lds
    s_add_u32 m0, s51, 960
    s_nop 0
    buffer_load_dwordx4 v225, s[8:11], 0 offen offset:64 lds
    s_add_u32 m0, s51, 1920
    s_nop 0
    buffer_load_dwordx4 v225, s[8:11], 0 offen offset:128 lds
    s_add_u32 m0, s51, 2880
    s_nop 0
    buffer_load_dwordx4 v226, s[8:11], 0 offen offset:192 lds
    s_add_u32 m0, s51, 4096
    s_mov_b32 s62, 1792
    buffer_load_dwordx4 v227, s[24:27], s62 offen sc1 lds
    s_waitcnt vmcnt(9)
    v_cmp_ne_u32 vcc, 0, v229
    s_mov_b32 s101, 1879048192
    s_and_b32 s49, vcc_lo, 0xff
    s_mov_b32 s100, 0x08000000
    s_bcnt1_i32_b32 s62, s49
    s_mov_b32 s55, 3
    s_cmp_ge_u32 s62, 6
    s_cbranch_scc1 L_m1_late
    s_mov_b32 s49, 0
    s_mov_b32 s55, 0
    s_waitcnt vmcnt(5)
    s_barrier
    s_cmp_lg_u32 s40, 0
    s_cbranch_scc1 L_m1_noflaga
    v_mov_b32 v165, 0
    v_mov_b32 v166, 1
    s_lshl_b32 s62, s2, 7
    buffer_store_dword v166, v165, s[16:19], s62 offen sc1
L_m1_noflaga:
    s_branch L_m1_both
L_m1_late:
    s_add_u32 s62, s47, 0
    s_bitcmp1_b32 s49, 0
    s_cselect_b32 s62, s62, s100
    buffer_load_dwordx4 a[0:3], v254, s[4:7], s62 offen offset:0 sc1
    buffer_load_dwordx4 a[4:7], v254, s[4:7], s62 offen offset:1024 sc1
    buffer_load_dwordx4 a[16:19], v254, s[4:7], s62 offen offset:2048 sc1
    buffer_load_dwordx4 a[20:23], v224, s[4:7], s62 offen sc1
    s_add_u32 s62, s47, 1835008
    s_bitcmp1_b32 s49, 1
    s_cselect_b32 s62, s62, s100
    buffer_load_dwordx4 a[32:35], v254, s[4:7], s62 offen offset:0 sc1
    buffer_load_dwordx4 a[36:39], v254, s[4:7], s62 offen offset:1024 sc1
    buffer_load_dwordx4 a[48:51], v254, s[4:7], s62 offen offset:2048 sc1
    buffer_load_dwordx4 a[52:55], v224, s[4:7], s62 offen sc1
    s_waitcnt vmcnt(13)
    s_barrier
    s_cmp_lg_u32 s40, 0
    s_cbranch_scc1 L_m1_noflagb
    v_mov_b32 v165, 0
    v_mov_b32 v166, 1
    s_lshl_b32 s62, s2, 7
    buffer_store_dword v166, v165, s[16:19], s62 offen sc1
L_m1_noflagb:
    s_add_u32 s62, s47, 3670016
    s_bitcmp1_b32 s49, 2
    s_cselect_b32 s62, s62, s100
    buffer_load_dwordx4 a[64:67], v254, s[4:7], s62 offen offset:0 sc1
    buffer_load_dwordx4 a[68:71], v254, s[4:7], s62 offen offset:1024 sc1
    buffer_load_dwordx4 a[80:83], v254, s[4:7], s62 offen offset:2048 sc1
    buffer_load_dwordx4 a[84:87], v224, s[4:7], s62 offen sc1
    s_add_u32 s62, s47, 5505024
    s_bitcmp1_b32 s49, 3
    s_cselect_b32 s62, s62, s100
    buffer_load_dwordx4 a[96:99], v254, s[4:7], s62 offen offset:0 sc1
    buffer_load_dwordx4 a[100:103], v254, s[4:7], s62 offen offset:1024 sc1
    buffer_load_dwordx4 a[112:115], v254, s[4:7], s62 offen offset:2048 sc1
    buffer_load_dwordx4 a[116:119], v224, s[4:7], s62 offen sc1
    s_add_u32 s62, s47, 7340032
    s_bitcmp1_b32 s49, 4
    s_cselect_b32 s62, s62, s100
    buffer_load_dwordx4 a[128:131], v254, s[4:7], s62 offen offset:0 sc1
    buffer_load_dwordx4 a[132:135], v254, s[4:7], s62 offen offset:1024 sc1
    buffer_load_dwordx4 a[144:147], v254, s[4:7], s62 offen offset:2048 sc1
    buffer_load_dwordx4 a[148:151], v224, s[4:7], s62 offen sc1
    s_add_u32 s62, s47, 9175040
    s_bitcmp1_b32 s49, 5
    s_cselect_b32 s62, s62, s100
    buffer_load_dwordx4 a[160:163], v254, s[4:7], s62 offen offset:0 sc1
    buffer_load_dwordx4 a[164:167], v254, s[4:7], s62 offen offset:1024 sc1
    buffer_load_dwordx4 a[176:179], v254, s[4:7], s62 offen offset:2048 sc1
    buffer_load_dwordx4 a[180:183], v224, s[4:7], s62 offen sc1
    s_add_u32 s62, s47, 11010048
    s_bitcmp1_b32 s49, 6
    s_cselect_b32 s62, s62, s100
    buffer_load_dwordx4 a[192:195], v254, s[4:7], s62 offen offset:0 sc1
    buffer_load_dwordx4 a[196:199], v254, s[4:7], s62 offen offset:1024 sc1
    buffer_load_dwordx4 a[208:211], v254, s[4:7], s62 offen offset:2048 sc1
    buffer_load_dwordx4 a[212:215], v224, s[4:7], s62 offen sc1
    s_add_u32 s62, s47, 12845056
    s_bitcmp1_b32 s49, 7
    s_cselect_b32 s62, s62, s100
    buffer_load_dwordx4 a[224:227], v254, s[4:7], s62 offen offset:0 sc1
    buffer_load_dwordx4 a[228:231], v254, s[4:7], s62 offen offset:1024 sc1
    buffer_load_dwordx4 a[240:243], v254, s[4:7], s62 offen offset:2048 sc1
    buffer_load_dwordx4 a[244:247], v224, s[4:7], s62 offen sc1
L_m1_both:
    buffer_load_dword v229, v228, s[16:19], 0 offen sc1
    v_mov_b32 v160, v244
    v_mov_b32 v161, v245
    v_mov_b32 v162, v246
    v_mov_b32 v163, v247
    s_mul_i32 s62, s45, 1835008
    s_add_u32 s62, s62, 14745600
    s_add_u32 s32, s86, s62
    s_addc_u32 s33, s87, 0
    s_mov_b32 s34, 1835008
    s_mov_b32 s35, 0x20000
    s_add_u32 s36, s86, 18415616
    s_addc_u32 s37, s87, 0
    s_mov_b32 s38, 1835008
    s_mov_b32 s39, 0x20000
    v_lshrrev_b32 v164, 2, v163
    v_cmp_eq_u32 vcc, v164, v162
    v_and_b32 v164, 1, v160
    v_lshlrev_b32 v164, 4, v164
    v_mov_b32 v165, 0x3f80
    v_lshlrev_b32 v164, v164, v165
    v_cndmask_b32 v164, 0, v164, vcc
    v_and_b32 v165, 2, v160
    v_cmp_eq_u32 vcc, 0, v165
    v_mov_b32 v238, 0
    v_mov_b32 v239, 0
    v_cndmask_b32 v240, 0, v164, vcc
    v_sub_u32 v241, v164, v240
    v_mov_b32 v242, 0
    v_mov_b32 v243, 0
    v_lshlrev_b32 v164, 6, v163
    v_lshl_add_u32 v164, v162, 3, v164
    v_add_u32 v213, s51, v164
    v_lshlrev_b32 v164, 4, v162
    v_add_u32 v214, s51, v164
    v_lshrrev_b32 v216, 1, v254
    v_add_u32 v216, 86016, v216
    s_lshl_b32 s62, s40, 9
    v_add_u32 v215, s62, v216
    s_lshl_b32 s62, s46, 10
    v_add_u32 v217, s62, v254
    v_add_u32 v218, 3072, v217
    v_add_u32 v164, 14336, v254
    v_cndmask_b32 v218, v218, v164, s[98:99]
    v_mov_b32 v0, 0
    v_mov_b32 v1, 0
    v_mov_b32 v2, 0
    v_mov_b32 v3, 0
    v_mov_b32 v4, 0
    v_mov_b32 v5, 0
    v_mov_b32 v6, 0
    v_mov_b32 v7, 0
    v_mov_b32 v8, 0
    v_mov_b32 v9, 0
    v_mov_b32 v10, 0
    v_mov_b32 v11, 0
    v_mov_b32 v12, 0
    v_mov_b32 v13, 0
    v_mov_b32 v14, 0
    v_mov_b32 v15, 0
    v_mov_b32 v16, 0
    v_mov_b32 v17, 0
    v_mov_b32 v18, 0
    v_mov_b32 v19, 0
    v_mov_b32 v20, 0
    v_mov_b32 v21, 0
    v_mov_b32 v22, 0
    v_mov_b32 v23, 0
    v_mov_b32 v24, 0
    v_mov_b32 v25, 0
    v_mov_b32 v26, 0
    v_mov_b32 v27, 0
    v_mov_b32 v28, 0
    v_mov_b32 v29, 0
    v_mov_b32 v30, 0
    v_mov_b32 v31, 0
    s_mov_b32 s48, s49
    s_mov_b32 s50, 0
    s_waitcnt vmcnt(33)
    s_cmp_eq_u32 s55, 3
    s_cbranch_scc1 L_m1_prep
L_m1_poll:
    s_waitcnt vmcnt(0)
L_m1_eval:
    v_cmp_ne_u32 vcc, 0, v229
    s_nop 1
    s_and_b32 s49, vcc_lo, 0xff
    s_andn2_b32 s49, s49, s48
    s_cbranch_scc1 L_m1_take
    buffer_load_dword v229, v228, s[16:19], 0 offen sc1
    s_cmp_eq_u32 s55, 0
    s_cbranch_scc1 L_m1_prep
    s_add_u32 s50, s50, 1
    s_cmp_lt_u32 s50, 0x100000
    s_cbranch_scc1 L_m1_poll
    s_branch L_m1_sum
L_m1_take:
    s_bitcmp1_b32 s49, 0
    s_cbranch_scc0 L_m1_l0
    s_add_u32 s62, s47, 0
    buffer_load_dwordx4 a[0:3], v254, s[4:7], s62 offen offset:0 sc1
    buffer_load_dwordx4 a[4:7], v254, s[4:7], s62 offen offset:1024 sc1
    buffer_load_dwordx4 a[16:19], v254, s[4:7], s62 offen offset:2048 sc1
    buffer_load_dwordx4 a[20:23], v224, s[4:7], s62 offen sc1
L_m1_l0:
    s_bitcmp1_b32 s49, 1
    s_cbranch_scc0 L_m1_l1
    s_add_u32 s62, s47, 1835008
    buffer_load_dwordx4 a[32:35], v254, s[4:7], s62 offen offset:0 sc1
    buffer_load_dwordx4 a[36:39], v254, s[4:7], s62 offen offset:1024 sc1
    buffer_load_dwordx4 a[48:51], v254, s[4:7], s62 offen offset:2048 sc1
    buffer_load_dwordx4 a[52:55], v224, s[4:7], s62 offen sc1
L_m1_l1:
    s_bitcmp1_b32 s49, 2
    s_cbranch_scc0 L_m1_l2
    s_add_u32 s62, s47, 3670016
    buffer_load_dwordx4 a[64:67], v254, s[4:7], s62 offen offset:0 sc1
    buffer_load_dwordx4 a[68:71], v254, s[4:7], s62 offen offset:1024 sc1
    buffer_load_dwordx4 a[80:83], v254, s[4:7], s62 offen offset:2048 sc1
    buffer_load_dwordx4 a[84:87], v224, s[4:7], s62 offen sc1
L_m1_l2:
    s_bitcmp1_b32 s49, 3
    s_cbranch_scc0 L_m1_l3
    s_add_u32 s62, s47, 5505024
    buffer_load_dwordx4 a[96:99], v254, s[4:7], s62 offen offset:0 sc1
    buffer_load_dwordx4 a[100:103], v254, s[4:7], s62 offen offset:1024 sc1
    buffer_load_dwordx4 a[112:115], v254, s[4:7], s62 offen offset:2048 sc1
    buffer_load_dwordx4 a[116:119], v224, s[4:7], s62 offen sc1
L_m1_l3:
    s_bitcmp1_b32 s49, 4
    s_cbranch_scc0 L_m1_l4
    s_add_u32 s62, s47, 7340032
    buffer_load_dwordx4 a[128:131], v254, s[4:7], s62 offen offset:0 sc1
    buffer_load_dwordx4 a[132:135], v254, s[4:7], s62 offen offset:1024 sc1
    buffer_load_dwordx4 a[144:147], v254, s[4:7], s62 offen offset:2048 sc1
    buffer_load_dwordx4 a[148:151], v224, s[4:7], s62 offen sc1
L_m1_l4:
    s_bitcmp1_b32 s49, 5
    s_cbranch_scc0 L_m1_l5
    s_add_u32 s62, s47, 9175040
    buffer_load_dwordx4 a[160:163], v254, s[4:7], s62 offen offset:0 sc1
    buffer_load_dwordx4 a[164:167], v254, s[4:7], s62 offen offset:1024 sc1
    buffer_load_dwordx4 a[176:179], v254, s[4:7], s62 offen offset:2048 sc1
    buffer_load_dwordx4 a[180:183], v224, s[4:7], s62 offen sc1
L_m1_l5:
    s_bitcmp1_b32 s49, 6
    s_cbranch_scc0 L_m1_l6
    s_add_u32 s62, s47, 11010048
    buffer_load_dwordx4 a[192:195], v254, s[4:7], s62 offen offset:0 sc1
    buffer_load_dwordx4 a[196:199], v254, s[4:7], s62 offen offset:1024 sc1
    buffer_load_dwordx4 a[208:211], v254, s[4:7], s62 offen offset:2048 sc1
    buffer_load_dwordx4 a[212:215], v224, s[4:7], s62 offen sc1
L_m1_l6:
    s_bitcmp1_b32 s49, 7
    s_cbranch_scc0 L_m1_l7
    s_add_u32 s62, s47, 12845056
    buffer_load_dwordx4 a[224:227], v254, s[4:7], s62 offen offset:0 sc1
    buffer_load_dwordx4 a[228:231], v254, s[4:7], s62 offen offset:1024 sc1
    buffer_load_dwordx4 a[240:243], v254, s[4:7], s62 offen offset:2048 sc1
    buffer_load_dwordx4 a[244:247], v224, s[4:7], s62 offen sc1
L_m1_l7:
    s_or_b32 s48, s48, s49
    buffer_load_dword v229, v228, s[16:19], 0 offen sc1
    s_cmp_lg_u32 s55, 0
    s_cbranch_scc1 L_m1_acc
L_m1_prep:
    s_max_u32 s55, s55, 1
    ds_read_b64 v[160:161], v213 offset:0
    ds_read_b64 v[162:163], v213 offset:32
    ds_read_b128 v[176:179], v214 offset:4096
    ds_read_b64 v[164:165], v213 offset:1024
    ds_read_b64 v[166:167], v213 offset:1056
    ds_read_b128 v[180:183], v214 offset:4160
    ds_read_b64 v[168:169], v213 offset:2048
    ds_read_b64 v[170:171], v213 offset:2080
    ds_read_b128 v[184:187], v214 offset:4224
    ds_read_b64 v[172:173], v213 offset:3072
    ds_read_b64 v[174:175], v213 offset:3104
    ds_read_b128 v[188:191], v214 offset:4288
    ds_read_b128 v[192:195], v214 offset:4352
    ds_read_b128 v[196:199], v214 offset:4416
    ds_read_b128 v[200:203], v214 offset:4480
    ds_read_b128 v[204:207], v214 offset:4544
    s_waitcnt lgkmcnt(4)
    v_lshlrev_b32 v32, 16, v160
    v_and_b32 v33, 0xffff0000, v160
    v_lshlrev_b32 v34, 16, v161
    v_and_b32 v35, 0xffff0000, v161
    v_lshlrev_b32 v36, 16, v162
    v_and_b32 v37, 0xffff0000, v162
    v_lshlrev_b32 v38, 16, v163
    v_and_b32 v39, 0xffff0000, v163
    v_lshlrev_b32 v40, 16, v164
    v_and_b32 v41, 0xffff0000, v164
    v_lshlrev_b32 v42, 16, v165
    v_and_b32 v43, 0xffff0000, v165
    v_lshlrev_b32 v44, 16, v166
    v_and_b32 v45, 0xffff0000, v166
    v_lshlrev_b32 v46, 16, v167
    v_and_b32 v47, 0xffff0000, v167
    v_lshlrev_b32 v48, 16, v168
    v_and_b32 v49, 0xffff0000, v168
    v_lshlrev_b32 v50, 16, v169
    v_and_b32 v51, 0xffff0000, v169
    v_lshlrev_b32 v52, 16, v170
    v_and_b32 v53, 0xffff0000, v170
    v_lshlrev_b32 v54, 16, v171
    v_and_b32 v55, 0xffff0000, v171
    v_lshlrev_b32 v56, 16, v172
    v_and_b32 v57, 0xffff0000, v172
    v_lshlrev_b32 v58, 16, v173
    v_and_b32 v59, 0xffff0000, v173
    v_lshlrev_b32 v60, 16, v174
    v_and_b32 v61, 0xffff0000, v174
    v_lshlrev_b32 v62, 16, v175
    v_and_b32 v63, 0xffff0000, v175
    v_lshlrev_b32 v64, 16, v176
    v_and_b32 v65, 0xffff0000, v176
    v_lshlrev_b32 v66, 16, v177
    v_and_b32 v67, 0xffff0000, v177
    v_lshlrev_b32 v68, 16, v178
    v_and_b32 v69, 0xffff0000, v178
    v_lshlrev_b32 v70, 16, v179
    v_and_b32 v71, 0xffff0000, v179
    v_lshlrev_b32 v72, 16, v180
    v_and_b32 v73, 0xffff0000, v180
    v_lshlrev_b32 v74, 16, v181
    v_and_b32 v75, 0xffff0000, v181
    v_lshlrev_b32 v76, 16, v182
    v_and_b32 v77, 0xffff0000, v182
    v_lshlrev_b32 v78, 16, v183
    v_and_b32 v79, 0xffff0000, v183
    v_lshlrev_b32 v80, 16, v184
    v_and_b32 v81, 0xffff0000, v184
    v_lshlrev_b32 v82, 16, v185
    v_and_b32 v83, 0xffff0000, v185
    v_lshlrev_b32 v84, 16, v186
    v_and_b32 v85, 0xffff0000, v186
    v_lshlrev_b32 v86, 16, v187
    v_and_b32 v87, 0xffff0000, v187
    v_lshlrev_b32 v88, 16, v188
    v_and_b32 v89, 0xffff0000, v188
    v_lshlrev_b32 v90, 16, v189
    v_and_b32 v91, 0xffff0000, v189
    v_lshlrev_b32 v92, 16, v190
    v_and_b32 v93, 0xffff0000, v190
    v_lshlrev_b32 v94, 16, v191
    v_and_b32 v95, 0xffff0000, v191
    ds_read_b128 v[160:163], v214 offset:4608
    ds_read_b128 v[164:167], v214 offset:4672
    ds_read_b128 v[168:171], v214 offset:4736
    ds_read_b128 v[172:175], v214 offset:4800
    s_waitcnt lgkmcnt(4)
    v_lshlrev_b32 v96, 16, v192
    v_and_b32 v97, 0xffff0000, v192
    v_lshlrev_b32 v98, 16, v193
    v_and_b32 v99, 0xffff0000, v193
    v_lshlrev_b32 v100, 16, v194
    v_and_b32 v101, 0xffff0000, v194
    v_lshlrev_b32 v102, 16, v195
    v_and_b32 v103, 0xffff0000, v195
    v_lshlrev_b32 v104, 16, v196
    v_and_b32 v105, 0xffff0000, v196
    v_lshlrev_b32 v106, 16, v197
    v_and_b32 v107, 0xffff0000, v197
    v_lshlrev_b32 v108, 16, v198
    v_and_b32 v109, 0xffff0000, v198
    v_lshlrev_b32 v110, 16, v199
    v_and_b32 v111, 0xffff0000, v199
    v_lshlrev_b32 v112, 16, v200
    v_and_b32 v113, 0xffff0000, v200
    v_lshlrev_b32 v114, 16, v201
    v_and_b32 v115, 0xffff0000, v201
    v_lshlrev_b32 v116, 16, v202
    v_and_b32 v117, 0xffff0000, v202
    v_lshlrev_b32 v118, 16, v203
    v_and_b32 v119, 0xffff0000, v203
    v_lshlrev_b32 v120, 16, v204
    v_and_b32 v121, 0xffff0000, v204
    v_lshlrev_b32 v122, 16, v205
    v_and_b32 v123, 0xffff0000, v205
    v_lshlrev_b32 v124, 16, v206
    v_and_b32 v125, 0xffff0000, v206
    v_lshlrev_b32 v126, 16, v207
    v_and_b32 v127, 0xffff0000, v207
    s_waitcnt lgkmcnt(0)
    v_lshlrev_b32 v128, 16, v160
    v_and_b32 v129, 0xffff0000, v160
    v_lshlrev_b32 v130, 16, v161
    v_and_b32 v131, 0xffff0000, v161
    v_lshlrev_b32 v132, 16, v162
    v_and_b32 v133, 0xffff0000, v162
    v_lshlrev_b32 v134, 16, v163
    v_and_b32 v135, 0xffff0000, v163
    v_lshlrev_b32 v136, 16, v164
    v_and_b32 v137, 0xffff0000, v164
    v_lshlrev_b32 v138, 16, v165
    v_and_b32 v139, 0xffff0000, v165
    v_lshlrev_b32 v140, 16, v166
    v_and_b32 v141, 0xffff0000, v166
    v_lshlrev_b32 v142, 16, v167
    v_and_b32 v143, 0xffff0000, v167
    v_lshlrev_b32 v144, 16, v168
    v_and_b32 v145, 0xffff0000, v168
    v_lshlrev_b32 v146, 16, v169
    v_and_b32 v147, 0xffff0000, v169
    v_lshlrev_b32 v148, 16, v170
    v_and_b32 v149, 0xffff0000, v170
    v_lshlrev_b32 v150, 16, v171
    v_and_b32 v151, 0xffff0000, v171
    v_lshlrev_b32 v152, 16, v172
    v_and_b32 v153, 0xffff0000, v172
    v_lshlrev_b32 v154, 16, v173
    v_and_b32 v155, 0xffff0000, v173
    v_lshlrev_b32 v156, 16, v174
    v_and_b32 v157, 0xffff0000, v174
    v_lshlrev_b32 v158, 16, v175
    v_and_b32 v159, 0xffff0000, v175
L_m1_acc:
    s_waitcnt vmcnt(1)
    s_bitcmp1_b32 s49, 0
    s_cbranch_scc0 L_m1_a0
    v_mfma_f32_16x16x32_bf16 v[0:3], v[240:243], a[0:3], v[0:3]
    v_mfma_f32_16x16x32_bf16 v[4:7], v[238:241], a[0:3], v[4:7]
    v_mfma_f32_16x16x32_bf16 v[8:11], v[240:243], a[4:7], v[8:11]
    v_mfma_f32_16x16x32_bf16 v[12:15], v[238:241], a[4:7], v[12:15]
    v_mfma_f32_16x16x32_bf16 v[16:19], v[240:243], a[16:19], v[16:19]
    v_mfma_f32_16x16x32_bf16 v[20:23], v[238:241], a[16:19], v[20:23]
    v_mfma_f32_16x16x32_bf16 v[24:27], v[240:243], a[20:23], v[24:27]
    v_mfma_f32_16x16x32_bf16 v[28:31], v[238:241], a[20:23], v[28:31]
L_m1_a0:
    s_bitcmp1_b32 s49, 1
    s_cbranch_scc0 L_m1_a1
    v_mfma_f32_16x16x32_bf16 v[0:3], v[240:243], a[32:35], v[0:3]
    v_mfma_f32_16x16x32_bf16 v[4:7], v[238:241], a[32:35], v[4:7]
    v_mfma_f32_16x16x32_bf16 v[8:11], v[240:243], a[36:39], v[8:11]
    v_mfma_f32_16x16x32_bf16 v[12:15], v[238:241], a[36:39], v[12:15]
    v_mfma_f32_16x16x32_bf16 v[16:19], v[240:243], a[48:51], v[16:19]
    v_mfma_f32_16x16x32_bf16 v[20:23], v[238:241], a[48:51], v[20:23]
    v_mfma_f32_16x16x32_bf16 v[24:27], v[240:243], a[52:55], v[24:27]
    v_mfma_f32_16x16x32_bf16 v[28:31], v[238:241], a[52:55], v[28:31]
L_m1_a1:
    s_bitcmp1_b32 s49, 2
    s_cbranch_scc0 L_m1_a2
    v_mfma_f32_16x16x32_bf16 v[0:3], v[240:243], a[64:67], v[0:3]
    v_mfma_f32_16x16x32_bf16 v[4:7], v[238:241], a[64:67], v[4:7]
    v_mfma_f32_16x16x32_bf16 v[8:11], v[240:243], a[68:71], v[8:11]
    v_mfma_f32_16x16x32_bf16 v[12:15], v[238:241], a[68:71], v[12:15]
    v_mfma_f32_16x16x32_bf16 v[16:19], v[240:243], a[80:83], v[16:19]
    v_mfma_f32_16x16x32_bf16 v[20:23], v[238:241], a[80:83], v[20:23]
    v_mfma_f32_16x16x32_bf16 v[24:27], v[240:243], a[84:87], v[24:27]
    v_mfma_f32_16x16x32_bf16 v[28:31], v[238:241], a[84:87], v[28:31]
L_m1_a2:
    s_bitcmp1_b32 s49, 3
    s_cbranch_scc0 L_m1_a3
    v_mfma_f32_16x16x32_bf16 v[0:3], v[240:243], a[96:99], v[0:3]
    v_mfma_f32_16x16x32_bf16 v[4:7], v[238:241], a[96:99], v[4:7]
    v_mfma_f32_16x16x32_bf16 v[8:11], v[240:243], a[100:103], v[8:11]
    v_mfma_f32_16x16x32_bf16 v[12:15], v[238:241], a[100:103], v[12:15]
    v_mfma_f32_16x16x32_bf16 v[16:19], v[240:243], a[112:115], v[16:19]
    v_mfma_f32_16x16x32_bf16 v[20:23], v[238:241], a[112:115], v[20:23]
    v_mfma_f32_16x16x32_bf16 v[24:27], v[240:243], a[116:119], v[24:27]
    v_mfma_f32_16x16x32_bf16 v[28:31], v[238:241], a[116:119], v[28:31]
L_m1_a3:
    s_bitcmp1_b32 s49, 4
    s_cbranch_scc0 L_m1_a4
    v_mfma_f32_16x16x32_bf16 v[0:3], v[240:243], a[128:131], v[0:3]
    v_mfma_f32_16x16x32_bf16 v[4:7], v[238:241], a[128:131], v[4:7]
    v_mfma_f32_16x16x32_bf16 v[8:11], v[240:243], a[132:135], v[8:11]
    v_mfma_f32_16x16x32_bf16 v[12:15], v[238:241], a[132:135], v[12:15]
    v_mfma_f32_16x16x32_bf16 v[16:19], v[240:243], a[144:147], v[16:19]
    v_mfma_f32_16x16x32_bf16 v[20:23], v[238:241], a[144:147], v[20:23]
    v_mfma_f32_16x16x32_bf16 v[24:27], v[240:243], a[148:151], v[24:27]
    v_mfma_f32_16x16x32_bf16 v[28:31], v[238:241], a[148:151], v[28:31]
L_m1_a4:
    s_bitcmp1_b32 s49, 5
    s_cbranch_scc0 L_m1_a5
    v_mfma_f32_16x16x32_bf16 v[0:3], v[240:243], a[160:163], v[0:3]
    v_mfma_f32_16x16x32_bf16 v[4:7], v[238:241], a[160:163], v[4:7]
    v_mfma_f32_16x16x32_bf16 v[8:11], v[240:243], a[164:167], v[8:11]
    v_mfma_f32_16x16x32_bf16 v[12:15], v[238:241], a[164:167], v[12:15]
    v_mfma_f32_16x16x32_bf16 v[16:19], v[240:243], a[176:179], v[16:19]
    v_mfma_f32_16x16x32_bf16 v[20:23], v[238:241], a[176:179], v[20:23]
    v_mfma_f32_16x16x32_bf16 v[24:27], v[240:243], a[180:183], v[24:27]
    v_mfma_f32_16x16x32_bf16 v[28:31], v[238:241], a[180:183], v[28:31]
L_m1_a5:
    s_bitcmp1_b32 s49, 6
    s_cbranch_scc0 L_m1_a6
    v_mfma_f32_16x16x32_bf16 v[0:3], v[240:243], a[192:195], v[0:3]
    v_mfma_f32_16x16x32_bf16 v[4:7], v[238:241], a[192:195], v[4:7]
    v_mfma_f32_16x16x32_bf16 v[8:11], v[240:243], a[196:199], v[8:11]
    v_mfma_f32_16x16x32_bf16 v[12:15], v[238:241], a[196:199], v[12:15]
    v_mfma_f32_16x16x32_bf16 v[16:19], v[240:243], a[208:211], v[16:19]
    v_mfma_f32_16x16x32_bf16 v[20:23], v[238:241], a[208:211], v[20:23]
    v_mfma_f32_16x16x32_bf16 v[24:27], v[240:243], a[212:215], v[24:27]
    v_mfma_f32_16x16x32_bf16 v[28:31], v[238:241], a[212:215], v[28:31]
L_m1_a6:
    s_bitcmp1_b32 s49, 7
    s_cbranch_scc0 L_m1_a7
    v_mfma_f32_16x16x32_bf16 v[0:3], v[240:243], a[224:227], v[0:3]
    v_mfma_f32_16x16x32_bf16 v[4:7], v[238:241], a[224:227], v[4:7]
    v_mfma_f32_16x16x32_bf16 v[8:11], v[240:243], a[228:231], v[8:11]
    v_mfma_f32_16x16x32_bf16 v[12:15], v[238:241], a[228:231], v[12:15]
    v_mfma_f32_16x16x32_bf16 v[16:19], v[240:243], a[240:243], v[16:19]
    v_mfma_f32_16x16x32_bf16 v[20:23], v[238:241], a[240:243], v[20:23]
    v_mfma_f32_16x16x32_bf16 v[24:27], v[240:243], a[244:247], v[24:27]
    v_mfma_f32_16x16x32_bf16 v[28:31], v[238:241], a[244:247], v[28:31]
L_m1_a7:
    s_cmp_eq_u32 s48, 0xff
    s_cbranch_scc1 L_m1_sum
    s_cmp_ge_u32 s55, 2
    s_cbranch_scc1 L_m1_poll
    s_bcnt1_i32_b32 s62, s48
    s_cmp_gt_u32 s62, 8
    s_cbranch_scc1 L_m1_poll
    s_mov_b32 s55, 2
    buffer_load_dwordx4 a[8:11], v254, s[12:15], s96 offen offset:0 sc1
    buffer_load_dwordx4 a[12:15], v254, s[12:15], s97 offen offset:0 sc1
    buffer_load_dwordx4 a[24:27], v254, s[12:15], s52 offen offset:0 sc1
    buffer_load_dwordx4 a[28:31], v254, s[12:15], s53 offen offset:0 sc1
    buffer_load_dwordx4 a[40:43], v254, s[12:15], s96 offen offset:1024 sc1
    buffer_load_dwordx4 a[44:47], v254, s[12:15], s97 offen offset:1024 sc1
    buffer_load_dwordx4 a[56:59], v254, s[12:15], s52 offen offset:1024 sc1
    buffer_load_dwordx4 a[60:63], v254, s[12:15], s53 offen offset:1024 sc1
    buffer_load_dwordx4 a[72:75], v254, s[12:15], s96 offen offset:2048 sc1
    buffer_load_dwordx4 a[76:79], v254, s[12:15], s97 offen offset:2048 sc1
    buffer_load_dwordx4 a[88:91], v254, s[12:15], s52 offen offset:2048 sc1
    buffer_load_dwordx4 a[92:95], v254, s[12:15], s53 offen offset:2048 sc1
    buffer_load_dwordx4 a[104:107], v254, s[12:15], s96 offen offset:3072 sc1
    buffer_load_dwordx4 a[108:111], v254, s[12:15], s97 offen offset:3072 sc1
    buffer_load_dwordx4 a[120:123], v254, s[12:15], s52 offen offset:3072 sc1
    buffer_load_dwordx4 a[124:127], v254, s[12:15], s53 offen offset:3072 sc1
    s_add_u32 s96, s96, 4096
    s_add_u32 s97, s97, 4096
    s_add_u32 s52, s52, 4096
    s_add_u32 s53, s53, 4096
    buffer_load_dwordx4 a[136:139], v254, s[12:15], s96 offen offset:0 sc1
    buffer_load_dwordx4 a[140:143], v254, s[12:15], s97 offen offset:0 sc1
    buffer_load_dwordx4 a[152:155], v254, s[12:15], s52 offen offset:0 sc1
    buffer_load_dwordx4 a[156:159], v254, s[12:15], s53 offen offset:0 sc1
    buffer_load_dwordx4 a[168:171], v254, s[12:15], s96 offen offset:1024 sc1
    buffer_load_dwordx4 a[172:175], v254, s[12:15], s97 offen offset:1024 sc1
    buffer_load_dwordx4 a[184:187], v254, s[12:15], s52 offen offset:1024 sc1
    buffer_load_dwordx4 a[188:191], v254, s[12:15], s53 offen offset:1024 sc1
    buffer_load_dwordx4 a[200:203], v254, s[12:15], s96 offen offset:2048 sc1
    buffer_load_dwordx4 a[204:207], v254, s[12:15], s97 offen offset:2048 sc1
    buffer_load_dwordx4 a[216:219], v254, s[12:15], s52 offen offset:2048 sc1
    buffer_load_dwordx4 a[220:223], v254, s[12:15], s53 offen offset:2048 sc1
    buffer_load_dwordx4 a[232:235], v254, s[12:15], s96 offen offset:3072 sc1
    buffer_load_dwordx4 a[236:239], v254, s[12:15], s97 offen offset:3072 sc1
    buffer_load_dwordx4 a[248:251], v254, s[12:15], s52 offen offset:3072 sc1
    buffer_load_dwordx4 a[252:255], v254, s[12:15], s53 offen offset:3072 sc1
    s_branch L_m1_poll
L_m1_sum:
    s_cmp_eq_u32 s55, 2
    s_cbranch_scc1 L_m1_chain1
    s_nop 4
    v_pk_fma_f32 v[0:1], v[0:1], v[64:65], v[32:33]
    v_pk_fma_f32 v[2:3], v[2:3], v[66:67], v[34:35]
    v_pk_fma_f32 v[4:5], v[4:5], v[68:69], v[36:37]
    v_pk_fma_f32 v[6:7], v[6:7], v[70:71], v[38:39]
    buffer_load_dwordx4 a[8:11], v254, s[12:15], s96 offen offset:0 sc1
    v_pk_fma_f32 v[8:9], v[8:9], v[72:73], v[40:41]
    v_pk_fma_f32 v[10:11], v[10:11], v[74:75], v[42:43]
    v_pk_fma_f32 v[12:13], v[12:13], v[76:77], v[44:45]
    v_pk_fma_f32 v[14:15], v[14:15], v[78:79], v[46:47]
    buffer_load_dwordx4 a[12:15], v254, s[12:15], s97 offen offset:0 sc1
    v_pk_fma_f32 v[16:17], v[16:17], v[80:81], v[48:49]
    v_pk_fma_f32 v[18:19], v[18:19], v[82:83], v[50:51]
    v_pk_fma_f32 v[20:21], v[20:21], v[84:85], v[52:53]
    v_pk_fma_f32 v[22:23], v[22:23], v[86:87], v[54:55]
    buffer_load_dwordx4 a[24:27], v254, s[12:15], s52 offen offset:0 sc1
    v_pk_fma_f32 v[24:25], v[24:25], v[88:89], v[56:57]
    v_pk_fma_f32 v[26:27], v[26:27], v[90:91], v[58:59]
    v_pk_fma_f32 v[28:29], v[28:29], v[92:93], v[60:61]
    v_pk_fma_f32 v[30:31], v[30:31], v[94:95], v[62:63]
    buffer_load_dwordx4 a[28:31], v254, s[12:15], s53 offen offset:0 sc1
    v_pk_add_f32 v[160:161], v[0:1], v[2:3]
    v_pk_mul_f32 v[162:163], v[0:1], v[0:1]
    v_pk_fma_f32 v[162:163], v[2:3], v[2:3], v[162:163]
    v_pk_add_f32 v[160:161], v[160:161], v[4:5]
    buffer_load_dwordx4 a[40:43], v254, s[12:15], s96 offen offset:1024 sc1
    v_pk_fma_f32 v[162:163], v[4:5], v[4:5], v[162:163]
    v_pk_add_f32 v[160:161], v[160:161], v[6:7]
    v_pk_fma_f32 v[162:163], v[6:7], v[6:7], v[162:163]
    v_pk_add_f32 v[160:161], v[160:161], v[8:9]
    buffer_load_dwordx4 a[44:47], v254, s[12:15], s97 offen offset:1024 sc1
    v_pk_fma_f32 v[162:163], v[8:9], v[8:9], v[162:163]
    v_pk_add_f32 v[160:161], v[160:161], v[10:11]
    v_pk_fma_f32 v[162:163], v[10:11], v[10:11], v[162:163]
    v_pk_add_f32 v[160:161], v[160:161], v[12:13]
    buffer_load_dwordx4 a[56:59], v254, s[12:15], s52 offen offset:1024 sc1
    v_pk_fma_f32 v[162:163], v[12:13], v[12:13], v[162:163]
    v_pk_add_f32 v[160:161], v[160:161], v[14:15]
    v_pk_fma_f32 v[162:163], v[14:15], v[14:15], v[162:163]
    v_pk_add_f32 v[160:161], v[160:161], v[16:17]
    buffer_load_dwordx4 a[60:63], v254, s[12:15], s53 offen offset:1024 sc1
    v_pk_fma_f32 v[162:163], v[16:17], v[16:17], v[162:163]
    v_pk_add_f32 v[160:161], v[160:161], v[18:19]
    v_pk_fma_f32 v[162:163], v[18:19], v[18:19], v[162:163]
    v_pk_add_f32 v[160:161], v[160:161], v[20:21]
    buffer_load_dwordx4 a[72:75], v254, s[12:15], s96 offen offset:2048 sc1
    v_pk_fma_f32 v[162:163], v[20:21], v[20:21], v[162:163]
    v_pk_add_f32 v[160:161], v[160:161], v[22:23]
    v_pk_fma_f32 v[162:163], v[22:23], v[22:23], v[162:163]
    v_pk_add_f32 v[160:161], v[160:161], v[24:25]
    buffer_load_dwordx4 a[76:79], v254, s[12:15], s97 offen offset:2048 sc1
    v_pk_fma_f32 v[162:163], v[24:25], v[24:25], v[162:163]
    v_pk_add_f32 v[160:161], v[160:161], v[26:27]
    v_pk_fma_f32 v[162:163], v[26:27], v[26:27], v[162:163]
    v_pk_add_f32 v[160:161], v[160:161], v[28:29]
    buffer_load_dwordx4 a[88:91], v254, s[12:15], s52 offen offset:2048 sc1
    v_pk_fma_f32 v[162:163], v[28:29], v[28:29], v[162:163]
    v_pk_add_f32 v[160:161], v[160:161], v[30:31]
    v_pk_fma_f32 v[162:163], v[30:31], v[30:31], v[162:163]
    v_add_f32 v160, v160, v161
    buffer_load_dwordx4 a[92:95], v254, s[12:15], s53 offen offset:2048 sc1
    v_add_f32 v161, v162, v163
    v_mov_b32 v162, v160
    v_mov_b32 v163, v161
    s_nop 1
    v_permlane32_swap_b32 v160, v162
    buffer_load_dwordx4 a[104:107], v254, s[12:15], s96 offen offset:3072 sc1
    v_permlane32_swap_b32 v161, v163
    s_nop 1
    v_add_f32 v160, v160, v162
    v_add_f32 v161, v161, v163
    v_mov_b32 v162, v160
    buffer_load_dwordx4 a[108:111], v254, s[12:15], s97 offen offset:3072 sc1
    v_mov_b32 v163, v161
    s_nop 1
    v_permlane16_swap_b32 v160, v162
    v_permlane16_swap_b32 v161, v163
    s_nop 1
    v_add_f32 v160, v160, v162
    buffer_load_dwordx4 a[120:123], v254, s[12:15], s52 offen offset:3072 sc1
    v_add_f32 v161, v161, v163
    ds_write_b64 v215, v[160:161] offset:0
    v_cvt_pk_bf16_f32 v64, v0, v1
    v_cvt_pk_bf16_f32 v65, v2, v3
    v_cvt_pk_bf16_f32 v66, v4, v5
    buffer_load_dwordx4 a[124:127], v254, s[12:15], s53 offen offset:3072 sc1
    v_cvt_pk_bf16_f32 v67, v6, v7
    v_cvt_pk_bf16_f32 v68, v8, v9
    v_cvt_pk_bf16_f32 v69, v10, v11
    v_cvt_pk_bf16_f32 v70, v12, v13
    s_add_u32 s96, s96, 4096
    s_add_u32 s97, s97, 4096
    s_add_u32 s52, s52, 4096
    s_add_u32 s53, s53, 4096
    buffer_load_dwordx4 a[136:139], v254, s[12:15], s96 offen offset:0 sc1
    v_cvt_pk_bf16_f32 v71, v14, v15
    v_cvt_pk_bf16_f32 v72, v16, v17
    v_cvt_pk_bf16_f32 v73, v18, v19
    v_cvt_pk_bf16_f32 v74, v20, v21
    buffer_load_dwordx4 a[140:143], v254, s[12:15], s97 offen offset:0 sc1
    v_cvt_pk_bf16_f32 v75, v22, v23
    v_cvt_pk_bf16_f32 v76, v24, v25
    v_cvt_pk_bf16_f32 v77, v26, v27
    v_cvt_pk_bf16_f32 v78, v28, v29
    buffer_load_dwordx4 a[152:155], v254, s[12:15], s52 offen offset:0 sc1
    v_cvt_pk_bf16_f32 v79, v30, v31
    s_waitcnt lgkmcnt(0)
    s_barrier
    ds_read_b64 v[32:33], v216 offset:0
    ds_read_b64 v[34:35], v216 offset:512
    ds_read_b64 v[36:37], v216 offset:1024
    ds_read_b64 v[38:39], v216 offset:1536
    s_waitcnt lgkmcnt(0)
    v_pk_add_f32 v[160:161], v[32:33], v[34:35]
    v_pk_add_f32 v[160:161], v[160:161], v[36:37]
    v_pk_add_f32 v[160:161], v[160:161], v[38:39]
    buffer_load_dwordx4 a[156:159], v254, s[12:15], s53 offen offset:0 sc1
    v_mul_f32 v168, 0xbb124925, v160
    v_mov_b32 v169, 0x3727c5ac
    v_fmac_f32 v169, 0x3b124925, v161
    v_fma_f32 v169, -v168, v168, v169
    buffer_load_dwordx4 a[168:171], v254, s[12:15], s96 offen offset:1024 sc1
    v_max_f32 v169, 0x3727c5ac, v169
    v_rsq_f32 v170, v169
    s_nop 0
    v_mul_f32 v168, v168, v170
    v_pk_fma_f32 v[0:1], v[0:1], v[170:171], v[168:169] op_sel_hi:[1,0,0]
    buffer_load_dwordx4 a[172:175], v254, s[12:15], s97 offen offset:1024 sc1
    v_pk_fma_f32 v[2:3], v[2:3], v[170:171], v[168:169] op_sel_hi:[1,0,0]
    v_pk_fma_f32 v[4:5], v[4:5], v[170:171], v[168:169] op_sel_hi:[1,0,0]
    v_pk_fma_f32 v[6:7], v[6:7], v[170:171], v[168:169] op_sel_hi:[1,0,0]
    v_pk_fma_f32 v[8:9], v[8:9], v[170:171], v[168:169] op_sel_hi:[1,0,0]
    buffer_load_dwordx4 a[184:187], v254, s[12:15], s52 offen offset:1024 sc1
    v_pk_fma_f32 v[10:11], v[10:11], v[170:171], v[168:169] op_sel_hi:[1,0,0]
    v_pk_fma_f32 v[12:13], v[12:13], v[170:171], v[168:169] op_sel_hi:[1,0,0]
    v_pk_fma_f32 v[14:15], v[14:15], v[170:171], v[168:169] op_sel_hi:[1,0,0]
    v_pk_fma_f32 v[16:17], v[16:17], v[170:171], v[168:169] op_sel_hi:[1,0,0]
    buffer_load_dwordx4 a[188:191], v254, s[12:15], s53 offen offset:1024 sc1
    v_pk_fma_f32 v[18:19], v[18:19], v[170:171], v[168:169] op_sel_hi:[1,0,0]
    v_pk_fma_f32 v[20:21], v[20:21], v[170:171], v[168:169] op_sel_hi:[1,0,0]
    v_pk_fma_f32 v[22:23], v[22:23], v[170:171], v[168:169] op_sel_hi:[1,0,0]
    v_pk_fma_f32 v[24:25], v[24:25], v[170:171], v[168:169] op_sel_hi:[1,0,0]
    buffer_load_dwordx4 a[200:203], v254, s[12:15], s96 offen offset:2048 sc1
    v_pk_fma_f32 v[26:27], v[26:27], v[170:171], v[168:169] op_sel_hi:[1,0,0]
    v_pk_fma_f32 v[28:29], v[28:29], v[170:171], v[168:169] op_sel_hi:[1,0,0]
    v_pk_fma_f32 v[30:31], v[30:31], v[170:171], v[168:169] op_sel_hi:[1,0,0]
    v_pk_fma_f32 v[0:1], v[0:1], v[128:129], v[96:97]
    buffer_load_dwordx4 a[204:207], v254, s[12:15], s97 offen offset:2048 sc1
    v_pk_fma_f32 v[2:3], v[2:3], v[130:131], v[98:99]
    v_pk_fma_f32 v[4:5], v[4:5], v[132:133], v[100:101]
    v_pk_fma_f32 v[6:7], v[6:7], v[134:135], v[102:103]
    v_pk_fma_f32 v[8:9], v[8:9], v[136:137], v[104:105]
    buffer_load_dwordx4 a[216:219], v254, s[12:15], s52 offen offset:2048 sc1
    v_pk_fma_f32 v[10:11], v[10:11], v[138:139], v[106:107]
    v_pk_fma_f32 v[12:13], v[12:13], v[140:141], v[108:109]
    v_pk_fma_f32 v[14:15], v[14:15], v[142:143], v[110:111]
    v_pk_fma_f32 v[16:17], v[16:17], v[144:145], v[112:113]
    buffer_load_dwordx4 a[220:223], v254, s[12:15], s53 offen offset:2048 sc1
    v_pk_fma_f32 v[18:19], v[18:19], v[146:147], v[114:115]
    v_pk_fma_f32 v[20:21], v[20:21], v[148:149], v[116:117]
    v_pk_fma_f32 v[22:23], v[22:23], v[150:151], v[118:119]
    v_pk_fma_f32 v[24:25], v[24:25], v[152:153], v[120:121]
    buffer_load_dwordx4 a[232:235], v254, s[12:15], s96 offen offset:3072 sc1
    v_pk_fma_f32 v[26:27], v[26:27], v[154:155], v[122:123]
    v_pk_fma_f32 v[28:29], v[28:29], v[156:157], v[124:125]
    v_pk_fma_f32 v[30:31], v[30:31], v[158:159], v[126:127]
    v_pk_add_f32 v[160:161], v[0:1], v[2:3]
    buffer_load_dwordx4 a[236:239], v254, s[12:15], s97 offen offset:3072 sc1
    v_pk_mul_f32 v[162:163], v[0:1], v[0:1]
    v_pk_fma_f32 v[162:163], v[2:3], v[2:3], v[162:163]
    v_pk_add_f32 v[160:161], v[160:161], v[4:5]
    v_pk_fma_f32 v[162:163], v[4:5], v[4:5], v[162:163]
    buffer_load_dwordx4 a[248:251], v254, s[12:15], s52 offen offset:3072 sc1
    v_pk_add_f32 v[160:161], v[160:161], v[6:7]
    v_pk_fma_f32 v[162:163], v[6:7], v[6:7], v[162:163]
    v_pk_add_f32 v[160:161], v[160:161], v[8:9]
    v_pk_fma_f32 v[162:163], v[8:9], v[8:9], v[162:163]
    buffer_load_dwordx4 a[252:255], v254, s[12:15], s53 offen offset:3072 sc1
    v_pk_add_f32 v[160:161], v[160:161], v[10:11]
    v_pk_fma_f32 v[162:163], v[10:11], v[10:11], v[162:163]
    v_pk_add_f32 v[160:161], v[160:161], v[12:13]
    v_pk_fma_f32 v[162:163], v[12:13], v[12:13], v[162:163]
    s_add_u32 s96, s96, 4096
    s_add_u32 s97, s97, 4096
    s_add_u32 s52, s52, 4096
    s_add_u32 s53, s53, 4096
    buffer_load_dwordx4 a[0:3], v254, s[12:15], s96 offen offset:0 sc1
    v_pk_add_f32 v[160:161], v[160:161], v[14:15]
    v_pk_fma_f32 v[162:163], v[14:15], v[14:15], v[162:163]
    v_pk_add_f32 v[160:161], v[160:161], v[16:17]
    v_pk_fma_f32 v[162:163], v[16:17], v[16:17], v[162:163]
    buffer_load_dwordx4 a[4:7], v254, s[12:15], s97 offen offset:0 sc1
    v_pk_add_f32 v[160:161], v[160:161], v[18:19]
    v_pk_fma_f32 v[162:163], v[18:19], v[18:19], v[162:163]
    v_pk_add_f32 v[160:161], v[160:161], v[20:21]
    v_pk_fma_f32 v[162:163], v[20:21], v[20:21], v[162:163]
    buffer_load_dwordx4 a[16:19], v254, s[12:15], s52 offen offset:0 sc1
    v_pk_add_f32 v[160:161], v[160:161], v[22:23]
    v_pk_fma_f32 v[162:163], v[22:23], v[22:23], v[162:163]
    v_pk_add_f32 v[160:161], v[160:161], v[24:25]
    v_pk_fma_f32 v[162:163], v[24:25], v[24:25], v[162:163]
    buffer_load_dwordx4 a[20:23], v254, s[12:15], s53 offen offset:0 sc1
    v_pk_add_f32 v[160:161], v[160:161], v[26:27]
    v_pk_fma_f32 v[162:163], v[26:27], v[26:27], v[162:163]
    v_pk_add_f32 v[160:161], v[160:161], v[28:29]
    v_pk_fma_f32 v[162:163], v[28:29], v[28:29], v[162:163]
    buffer_load_dwordx4 a[32:35], v254, s[12:15], s96 offen offset:1024 sc1
    v_pk_add_f32 v[160:161], v[160:161], v[30:31]
    v_pk_fma_f32 v[162:163], v[30:31], v[30:31], v[162:163]
    v_add_f32 v160, v160, v161
    v_add_f32 v161, v162, v163
    buffer_load_dwordx4 a[36:39], v254, s[12:15], s97 offen offset:1024 sc1
    v_mov_b32 v162, v160
    v_mov_b32 v163, v161
    s_nop 1
    v_permlane32_swap_b32 v160, v162
    v_permlane32_swap_b32 v161, v163
    buffer_load_dwordx4 a[48:51], v254, s[12:15], s52 offen offset:1024 sc1
    s_nop 1
    v_add_f32 v160, v160, v162
    v_add_f32 v161, v161, v163
    v_mov_b32 v162, v160
    v_mov_b32 v163, v161
    buffer_load_dwordx4 a[52:55], v254, s[12:15], s53 offen offset:1024 sc1
    s_nop 1
    v_permlane16_swap_b32 v160, v162
    v_permlane16_swap_b32 v161, v163
    s_nop 1
    v_add_f32 v160, v160, v162
    v_add_f32 v161, v161, v163
    buffer_load_dwordx4 a[64:67], v254, s[12:15], s96 offen offset:2048 sc1
    ds_write_b64 v215, v[160:161] offset:2048
    v_cvt_pk_bf16_f32 v80, v0, v1
    v_cvt_pk_bf16_f32 v81, v2, v3
    v_cvt_pk_bf16_f32 v82, v4, v5
    v_cvt_pk_bf16_f32 v83, v6, v7
    buffer_load_dwordx4 a[68:71], v254, s[12:15], s97 offen offset:2048 sc1
    v_cvt_pk_bf16_f32 v84, v8, v9
    v_cvt_pk_bf16_f32 v85, v10, v11
    v_cvt_pk_bf16_f32 v86, v12, v13
    v_cvt_pk_bf16_f32 v87, v14, v15
    buffer_load_dwordx4 a[80:83], v254, s[12:15], s52 offen offset:2048 sc1
    v_cvt_pk_bf16_f32 v88, v16, v17
    v_cvt_pk_bf16_f32 v89, v18, v19
    v_cvt_pk_bf16_f32 v90, v20, v21
    v_cvt_pk_bf16_f32 v91, v22, v23
    buffer_load_dwordx4 a[84:87], v254, s[12:15], s53 offen offset:2048 sc1
    v_cvt_pk_bf16_f32 v92, v24, v25
    v_cvt_pk_bf16_f32 v93, v26, v27
    v_cvt_pk_bf16_f32 v94, v28, v29
    v_cvt_pk_bf16_f32 v95, v30, v31
    buffer_load_dwordx4 a[96:99], v254, s[12:15], s96 offen offset:3072 sc1
    s_waitcnt lgkmcnt(0)
    s_barrier
    ds_read_b64 v[32:33], v216 offset:2048
    ds_read_b64 v[34:35], v216 offset:2560
    ds_read_b64 v[36:37], v216 offset:3072
    ds_read_b64 v[38:39], v216 offset:3584
    s_waitcnt lgkmcnt(0)
    v_pk_add_f32 v[160:161], v[32:33], v[34:35]
    v_pk_add_f32 v[160:161], v[160:161], v[36:37]
    v_pk_add_f32 v[160:161], v[160:161], v[38:39]
    v_mul_f32 v168, 0xbb124925, v160
    buffer_load_dwordx4 a[100:103], v254, s[12:15], s97 offen offset:3072 sc1
    v_mov_b32 v169, 0x3727c5ac
    v_fmac_f32 v169, 0x3b124925, v161
    v_fma_f32 v169, -v168, v168, v169
    v_max_f32 v169, 0x3727c5ac, v169
    buffer_load_dwordx4 a[112:115], v254, s[12:15], s52 offen offset:3072 sc1
    v_rsq_f32 v170, v169
    s_nop 0
    v_mul_f32 v168, v168, v170
    v_pk_fma_f32 v[0:1], v[0:1], v[170:171], v[168:169] op_sel_hi:[1,0,0]
    v_pk_fma_f32 v[2:3], v[2:3], v[170:171], v[168:169] op_sel_hi:[1,0,0]
    buffer_load_dwordx4 a[116:119], v254, s[12:15], s53 offen offset:3072 sc1
    v_pk_fma_f32 v[4:5], v[4:5], v[170:171], v[168:169] op_sel_hi:[1,0,0]
    v_pk_fma_f32 v[6:7], v[6:7], v[170:171], v[168:169] op_sel_hi:[1,0,0]
    v_pk_fma_f32 v[8:9], v[8:9], v[170:171], v[168:169] op_sel_hi:[1,0,0]
    v_pk_fma_f32 v[10:11], v[10:11], v[170:171], v[168:169] op_sel_hi:[1,0,0]
    s_add_u32 s96, s96, 4096
    s_add_u32 s97, s97, 4096
    s_add_u32 s52, s52, 4096
    s_add_u32 s53, s53, 4096
    buffer_load_dwordx4 a[128:131], v254, s[12:15], s96 offen offset:0 sc1
    v_pk_fma_f32 v[12:13], v[12:13], v[170:171], v[168:169] op_sel_hi:[1,0,0]
    v_pk_fma_f32 v[14:15], v[14:15], v[170:171], v[168:169] op_sel_hi:[1,0,0]
    v_pk_fma_f32 v[16:17], v[16:17], v[170:171], v[168:169] op_sel_hi:[1,0,0]
    v_pk_fma_f32 v[18:19], v[18:19], v[170:171], v[168:169] op_sel_hi:[1,0,0]
    buffer_load_dwordx4 a[132:135], v254, s[12:15], s97 offen offset:0 sc1
    v_pk_fma_f32 v[20:21], v[20:21], v[170:171], v[168:169] op_sel_hi:[1,0,0]
    v_pk_fma_f32 v[22:23], v[22:23], v[170:171], v[168:169] op_sel_hi:[1,0,0]
    v_pk_fma_f32 v[24:25], v[24:25], v[170:171], v[168:169] op_sel_hi:[1,0,0]
    v_pk_fma_f32 v[26:27], v[26:27], v[170:171], v[168:169] op_sel_hi:[1,0,0]
    buffer_load_dwordx4 a[144:147], v254, s[12:15], s52 offen offset:0 sc1
    v_pk_fma_f32 v[28:29], v[28:29], v[170:171], v[168:169] op_sel_hi:[1,0,0]
    v_pk_fma_f32 v[30:31], v[30:31], v[170:171], v[168:169] op_sel_hi:[1,0,0]
    v_cvt_pk_bf16_f32 v192, v0, v1
    v_cvt_pk_bf16_f32 v193, v2, v3
    buffer_load_dwordx4 a[148:151], v254, s[12:15], s53 offen offset:0 sc1
    v_cvt_pk_bf16_f32 v194, v4, v5
    v_cvt_pk_bf16_f32 v195, v6, v7
    v_cvt_pk_bf16_f32 v196, v8, v9
    v_cvt_pk_bf16_f32 v197, v10, v11
    buffer_load_dwordx4 a[160:163], v254, s[12:15], s96 offen offset:1024 sc1
    v_cvt_pk_bf16_f32 v198, v12, v13
    v_cvt_pk_bf16_f32 v199, v14, v15
    v_cvt_pk_bf16_f32 v200, v16, v17
    v_cvt_pk_bf16_f32 v201, v18, v19
    buffer_load_dwordx4 a[164:167], v254, s[12:15], s97 offen offset:1024 sc1
    v_cvt_pk_bf16_f32 v202, v20, v21
    v_cvt_pk_bf16_f32 v203, v22, v23
    v_cvt_pk_bf16_f32 v204, v24, v25
    v_cvt_pk_bf16_f32 v205, v26, v27
    buffer_load_dwordx4 a[176:179], v254, s[12:15], s52 offen offset:1024 sc1
    v_cvt_pk_bf16_f32 v206, v28, v29
    v_cvt_pk_bf16_f32 v207, v30, v31
    ds_write_b128 v217, v[192:195] offset:0
    ds_write_b128 v217, v[196:199] offset:1024
    ds_write_b128 v217, v[200:203] offset:2048
    ds_write_b128 v218, v[204:207]
    s_cmp_eq_u32 s45, 0
    s_cselect_b64 vcc, -1, 0
    v_cndmask_b32 v64, v80, v64, vcc
    v_cndmask_b32 v65, v81, v65, vcc
    buffer_load_dwordx4 a[180:183], v254, s[12:15], s53 offen offset:1024 sc1
    v_cndmask_b32 v66, v82, v66, vcc
    v_cndmask_b32 v67, v83, v67, vcc
    v_cndmask_b32 v68, v84, v68, vcc
    v_cndmask_b32 v69, v85, v69, vcc
    v_cndmask_b32 v70, v86, v70, vcc
    v_cndmask_b32 v71, v87, v71, vcc
    v_cndmask_b32 v72, v88, v72, vcc
    v_cndmask_b32 v73, v89, v73, vcc
    v_cndmask_b32 v74, v90, v74, vcc
    v_cndmask_b32 v75, v91, v75, vcc
    v_cndmask_b32 v76, v92, v76, vcc
    v_cndmask_b32 v77, v93, v77, vcc
    v_cndmask_b32 v78, v94, v78, vcc
    v_cndmask_b32 v79, v95, v79, vcc
    s_branch L_m1_join
L_m1_chain1:
    s_nop 5
    v_pk_fma_f32 v[0:1], v[0:1], v[64:65], v[32:33]
    v_pk_fma_f32 v[2:3], v[2:3], v[66:67], v[34:35]
    v_pk_fma_f32 v[4:5], v[4:5], v[68:69], v[36:37]
    v_pk_fma_f32 v[6:7], v[6:7], v[70:71], v[38:39]
    v_pk_fma_f32 v[8:9], v[8:9], v[72:73], v[40:41]
    v_pk_fma_f32 v[10:11], v[10:11], v[74:75], v[42:43]
    v_pk_fma_f32 v[12:13], v[12:13], v[76:77], v[44:45]
    v_pk_fma_f32 v[14:15], v[14:15], v[78:79], v[46:47]
    s_add_u32 s96, s96, 4096
    s_add_u32 s97, s97, 4096
    s_add_u32 s52, s52, 4096
    s_add_u32 s53, s53, 4096
    buffer_load_dwordx4 a[0:3], v254, s[12:15], s96 offen offset:0 sc1
    v_pk_fma_f32 v[16:17], v[16:17], v[80:81], v[48:49]
    v_pk_fma_f32 v[18:19], v[18:19], v[82:83], v[50:51]
    v_pk_fma_f32 v[20:21], v[20:21], v[84:85], v[52:53]
    v_pk_fma_f32 v[22:23], v[22:23], v[86:87], v[54:55]
    v_pk_fma_f32 v[24:25], v[24:25], v[88:89], v[56:57]
    v_pk_fma_f32 v[26:27], v[26:27], v[90:91], v[58:59]
    v_pk_fma_f32 v[28:29], v[28:29], v[92:93], v[60:61]
    v_pk_fma_f32 v[30:31], v[30:31], v[94:95], v[62:63]
    buffer_load_dwordx4 a[4:7], v254, s[12:15], s97 offen offset:0 sc1
    v_pk_add_f32 v[160:161], v[0:1], v[2:3]
    v_pk_mul_f32 v[162:163], v[0:1], v[0:1]
    v_pk_fma_f32 v[162:163], v[2:3], v[2:3], v[162:163]
    v_pk_add_f32 v[160:161], v[160:161], v[4:5]
    v_pk_fma_f32 v[162:163], v[4:5], v[4:5], v[162:163]
    v_pk_add_f32 v[160:161], v[160:161], v[6:7]
    v_pk_fma_f32 v[162:163], v[6:7], v[6:7], v[162:163]
    v_pk_add_f32 v[160:161], v[160:161], v[8:9]
    buffer_load_dwordx4 a[16:19], v254, s[12:15], s52 offen offset:0 sc1
    v_pk_fma_f32 v[162:163], v[8:9], v[8:9], v[162:163]
    v_pk_add_f32 v[160:161], v[160:161], v[10:11]
    v_pk_fma_f32 v[162:163], v[10:11], v[10:11], v[162:163]
    v_pk_add_f32 v[160:161], v[160:161], v[12:13]
    v_pk_fma_f32 v[162:163], v[12:13], v[12:13], v[162:163]
    v_pk_add_f32 v[160:161], v[160:161], v[14:15]
    v_pk_fma_f32 v[162:163], v[14:15], v[14:15], v[162:163]
    v_pk_add_f32 v[160:161], v[160:161], v[16:17]
    buffer_load_dwordx4 a[20:23], v254, s[12:15], s53 offen offset:0 sc1
    v_pk_fma_f32 v[162:163], v[16:17], v[16:17], v[162:163]
    v_pk_add_f32 v[160:161], v[160:161], v[18:19]
    v_pk_fma_f32 v[162:163], v[18:19], v[18:19], v[162:163]
    v_pk_add_f32 v[160:161], v[160:161], v[20:21]
    v_pk_fma_f32 v[162:163], v[20:21], v[20:21], v[162:163]
    v_pk_add_f32 v[160:161], v[160:161], v[22:23]
    v_pk_fma_f32 v[162:163], v[22:23], v[22:23], v[162:163]
    v_pk_add_f32 v[160:161], v[160:161], v[24:25]
    buffer_load_dwordx4 a[32:35], v254, s[12:15], s96 offen offset:1024 sc1
    v_pk_fma_f32 v[162:163], v[24:25], v[24:25], v[162:163]
    v_pk_add_f32 v[160:161], v[160:161], v[26:27]
    v_pk_fma_f32 v[162:163], v[26:27], v[26:27], v[162:163]
    v_pk_add_f32 v[160:161], v[160:161], v[28:29]
    v_pk_fma_f32 v[162:163], v[28:29], v[28:29], v[162:163]
    v_pk_add_f32 v[160:161], v[160:161], v[30:31]
    v_pk_fma_f32 v[162:163], v[30:31], v[30:31], v[162:163]
    v_add_f32 v160, v160, v161
    buffer_load_dwordx4 a[36:39], v254, s[12:15], s97 offen offset:1024 sc1
    v_add_f32 v161, v162, v163
    v_mov_b32 v162, v160
    v_mov_b32 v163, v161
    s_nop 1
    v_permlane32_swap_b32 v160, v162
    v_permlane32_swap_b32 v161, v163
    s_nop 1
    v_add_f32 v160, v160, v162
    v_add_f32 v161, v161, v163
    v_mov_b32 v162, v160
    buffer_load_dwordx4 a[48:51], v254, s[12:15], s52 offen offset:1024 sc1
    v_mov_b32 v163, v161
    s_nop 1
    v_permlane16_swap_b32 v160, v162
    v_permlane16_swap_b32 v161, v163
    s_nop 1
    v_add_f32 v160, v160, v162
    v_add_f32 v161, v161, v163
    ds_write_b64 v215, v[160:161] offset:0
    v_cvt_pk_bf16_f32 v64, v0, v1
    v_cvt_pk_bf16_f32 v65, v2, v3
    v_cvt_pk_bf16_f32 v66, v4, v5
    buffer_load_dwordx4 a[52:55], v254, s[12:15], s53 offen offset:1024 sc1
    v_cvt_pk_bf16_f32 v67, v6, v7
    v_cvt_pk_bf16_f32 v68, v8, v9
    v_cvt_pk_bf16_f32 v69, v10, v11
    v_cvt_pk_bf16_f32 v70, v12, v13
    v_cvt_pk_bf16_f32 v71, v14, v15
    v_cvt_pk_bf16_f32 v72, v16, v17
    v_cvt_pk_bf16_f32 v73, v18, v19
    v_cvt_pk_bf16_f32 v74, v20, v21
    buffer_load_dwordx4 a[64:67], v254, s[12:15], s96 offen offset:2048 sc1
    v_cvt_pk_bf16_f32 v75, v22, v23
    v_cvt_pk_bf16_f32 v76, v24, v25
    v_cvt_pk_bf16_f32 v77, v26, v27
    v_cvt_pk_bf16_f32 v78, v28, v29
    v_cvt_pk_bf16_f32 v79, v30, v31
    s_waitcnt lgkmcnt(0)
    s_barrier
    ds_read_b64 v[32:33], v216 offset:0
    ds_read_b64 v[34:35], v216 offset:512
    ds_read_b64 v[36:37], v216 offset:1024
    ds_read_b64 v[38:39], v216 offset:1536
    s_waitcnt lgkmcnt(0)
    v_pk_add_f32 v[160:161], v[32:33], v[34:35]
    v_pk_add_f32 v[160:161], v[160:161], v[36:37]
    v_pk_add_f32 v[160:161], v[160:161], v[38:39]
    buffer_load_dwordx4 a[68:71], v254, s[12:15], s97 offen offset:2048 sc1
    v_mul_f32 v168, 0xbb124925, v160
    v_mov_b32 v169, 0x3727c5ac
    v_fmac_f32 v169, 0x3b124925, v161
    v_fma_f32 v169, -v168, v168, v169
    v_max_f32 v169, 0x3727c5ac, v169
    v_rsq_f32 v170, v169
    s_nop 0
    v_mul_f32 v168, v168, v170
    v_pk_fma_f32 v[0:1], v[0:1], v[170:171], v[168:169] op_sel_hi:[1,0,0]
    buffer_load_dwordx4 a[80:83], v254, s[12:15], s52 offen offset:2048 sc1
    v_pk_fma_f32 v[2:3], v[2:3], v[170:171], v[168:169] op_sel_hi:[1,0,0]
    v_pk_fma_f32 v[4:5], v[4:5], v[170:171], v[168:169] op_sel_hi:[1,0,0]
    v_pk_fma_f32 v[6:7], v[6:7], v[170:171], v[168:169] op_sel_hi:[1,0,0]
    v_pk_fma_f32 v[8:9], v[8:9], v[170:171], v[168:169] op_sel_hi:[1,0,0]
    v_pk_fma_f32 v[10:11], v[10:11], v[170:171], v[168:169] op_sel_hi:[1,0,0]
    v_pk_fma_f32 v[12:13], v[12:13], v[170:171], v[168:169] op_sel_hi:[1,0,0]
    v_pk_fma_f32 v[14:15], v[14:15], v[170:171], v[168:169] op_sel_hi:[1,0,0]
    v_pk_fma_f32 v[16:17], v[16:17], v[170:171], v[168:169] op_sel_hi:[1,0,0]
    buffer_load_dwordx4 a[84:87], v254, s[12:15], s53 offen offset:2048 sc1
    v_pk_fma_f32 v[18:19], v[18:19], v[170:171], v[168:169] op_sel_hi:[1,0,0]
    v_pk_fma_f32 v[20:21], v[20:21], v[170:171], v[168:169] op_sel_hi:[1,0,0]
    v_pk_fma_f32 v[22:23], v[22:23], v[170:171], v[168:169] op_sel_hi:[1,0,0]
    v_pk_fma_f32 v[24:25], v[24:25], v[170:171], v[168:169] op_sel_hi:[1,0,0]
    v_pk_fma_f32 v[26:27], v[26:27], v[170:171], v[168:169] op_sel_hi:[1,0,0]
    v_pk_fma_f32 v[28:29], v[28:29], v[170:171], v[168:169] op_sel_hi:[1,0,0]
    v_pk_fma_f32 v[30:31], v[30:31], v[170:171], v[168:169] op_sel_hi:[1,0,0]
    v_pk_fma_f32 v[0:1], v[0:1], v[128:129], v[96:97]
    buffer_load_dwordx4 a[96:99], v254, s[12:15], s96 offen offset:3072 sc1
    v_pk_fma_f32 v[2:3], v[2:3], v[130:131], v[98:99]
    v_pk_fma_f32 v[4:5], v[4:5], v[132:133], v[100:101]
    v_pk_fma_f32 v[6:7], v[6:7], v[134:135], v[102:103]
    v_pk_fma_f32 v[8:9], v[8:9], v[136:137], v[104:105]
    v_pk_fma_f32 v[10:11], v[10:11], v[138:139], v[106:107]
    v_pk_fma_f32 v[12:13], v[12:13], v[140:141], v[108:109]
    v_pk_fma_f32 v[14:15], v[14:15], v[142:143], v[110:111]
    v_pk_fma_f32 v[16:17], v[16:17], v[144:145], v[112:113]
    buffer_load_dwordx4 a[100:103], v254, s[12:15], s97 offen offset:3072 sc1
    v_pk_fma_f32 v[18:19], v[18:19], v[146:147], v[114:115]
    v_pk_fma_f32 v[20:21], v[20:21], v[148:149], v[116:117]
    v_pk_fma_f32 v[22:23], v[22:23], v[150:151], v[118:119]
    v_pk_fma_f32 v[24:25], v[24:25], v[152:153], v[120:121]
    v_pk_fma_f32 v[26:27], v[26:27], v[154:155], v[122:123]
    v_pk_fma_f32 v[28:29], v[28:29], v[156:157], v[124:125]
    v_pk_fma_f32 v[30:31], v[30:31], v[158:159], v[126:127]
    v_pk_add_f32 v[160:161], v[0:1], v[2:3]
    buffer_load_dwordx4 a[112:115], v254, s[12:15], s52 offen offset:3072 sc1
    v_pk_mul_f32 v[162:163], v[0:1], v[0:1]
    v_pk_fma_f32 v[162:163], v[2:3], v[2:3], v[162:163]
    v_pk_add_f32 v[160:161], v[160:161], v[4:5]
    v_pk_fma_f32 v[162:163], v[4:5], v[4:5], v[162:163]
    v_pk_add_f32 v[160:161], v[160:161], v[6:7]
    v_pk_fma_f32 v[162:163], v[6:7], v[6:7], v[162:163]
    v_pk_add_f32 v[160:161], v[160:161], v[8:9]
    v_pk_fma_f32 v[162:163], v[8:9], v[8:9], v[162:163]
    buffer_load_dwordx4 a[116:119], v254, s[12:15], s53 offen offset:3072 sc1
    v_pk_add_f32 v[160:161], v[160:161], v[10:11]
    v_pk_fma_f32 v[162:163], v[10:11], v[10:11], v[162:163]
    v_pk_add_f32 v[160:161], v[160:161], v[12:13]
    v_pk_fma_f32 v[162:163], v[12:13], v[12:13], v[162:163]
    v_pk_add_f32 v[160:161], v[160:161], v[14:15]
    v_pk_fma_f32 v[162:163], v[14:15], v[14:15], v[162:163]
    v_pk_add_f32 v[160:161], v[160:161], v[16:17]
    v_pk_fma_f32 v[162:163], v[16:17], v[16:17], v[162:163]
    s_add_u32 s96, s96, 4096
    s_add_u32 s97, s97, 4096
    s_add_u32 s52, s52, 4096
    s_add_u32 s53, s53, 4096
    buffer_load_dwordx4 a[128:131], v254, s[12:15], s96 offen offset:0 sc1
    v_pk_add_f32 v[160:161], v[160:161], v[18:19]
    v_pk_fma_f32 v[162:163], v[18:19], v[18:19], v[162:163]
    v_pk_add_f32 v[160:161], v[160:161], v[20:21]
    v_pk_fma_f32 v[162:163], v[20:21], v[20:21], v[162:163]
    v_pk_add_f32 v[160:161], v[160:161], v[22:23]
    v_pk_fma_f32 v[162:163], v[22:23], v[22:23], v[162:163]
    v_pk_add_f32 v[160:161], v[160:161], v[24:25]
    v_pk_fma_f32 v[162:163], v[24:25], v[24:25], v[162:163]
    buffer_load_dwordx4 a[132:135], v254, s[12:15], s97 offen offset:0 sc1
    v_pk_add_f32 v[160:161], v[160:161], v[26:27]
    v_pk_fma_f32 v[162:163], v[26:27], v[26:27], v[162:163]
    v_pk_add_f32 v[160:161], v[160:161], v[28:29]
    v_pk_fma_f32 v[162:163], v[28:29], v[28:29], v[162:163]
    v_pk_add_f32 v[160:161], v[160:161], v[30:31]
    v_pk_fma_f32 v[162:163], v[30:31], v[30:31], v[162:163]
    v_add_f32 v160, v160, v161
    v_add_f32 v161, v162, v163
    buffer_load_dwordx4 a[144:147], v254, s[12:15], s52 offen offset:0 sc1
    v_mov_b32 v162, v160
    v_mov_b32 v163, v161
    s_nop 1
    v_permlane32_swap_b32 v160, v162
    v_permlane32_swap_b32 v161, v163
    s_nop 1
    v_add_f32 v160, v160, v162
    v_add_f32 v161, v161, v163
    v_mov_b32 v162, v160
    v_mov_b32 v163, v161
    buffer_load_dwordx4 a[148:151], v254, s[12:15], s53 offen offset:0 sc1
    s_nop 1
    v_permlane16_swap_b32 v160, v162
    v_permlane16_swap_b32 v161, v163
    s_nop 1
    v_add_f32 v160, v160, v162
    v_add_f32 v161, v161, v163
    ds_write_b64 v215, v[160:161] offset:2048
    v_cvt_pk_bf16_f32 v80, v0, v1
    v_cvt_pk_bf16_f32 v81, v2, v3
    v_cvt_pk_bf16_f32 v82, v4, v5
    v_cvt_pk_bf16_f32 v83, v6, v7
    buffer_load_dwordx4 a[160:163], v254, s[12:15], s96 offen offset:1024 sc1
    v_cvt_pk_bf16_f32 v84, v8, v9
    v_cvt_pk_bf16_f32 v85, v10, v11
    v_cvt_pk_bf16_f32 v86, v12, v13
    v_cvt_pk_bf16_f32 v87, v14, v15
    v_cvt_pk_bf16_f32 v88, v16, v17
    v_cvt_pk_bf16_f32 v89, v18, v19
    v_cvt_pk_bf16_f32 v90, v20, v21
    v_cvt_pk_bf16_f32 v91, v22, v23
    buffer_load_dwordx4 a[164:167], v254, s[12:15], s97 offen offset:1024 sc1
    v_cvt_pk_bf16_f32 v92, v24, v25
    v_cvt_pk_bf16_f32 v93, v26, v27
    v_cvt_pk_bf16_f32 v94, v28, v29
    v_cvt_pk_bf16_f32 v95, v30, v31
    s_waitcnt lgkmcnt(0)
    s_barrier
    ds_read_b64 v[32:33], v216 offset:2048
    ds_read_b64 v[34:35], v216 offset:2560
    ds_read_b64 v[36:37], v216 offset:3072
    ds_read_b64 v[38:39], v216 offset:3584
    s_waitcnt lgkmcnt(0)
    v_pk_add_f32 v[160:161], v[32:33], v[34:35]
    v_pk_add_f32 v[160:161], v[160:161], v[36:37]
    v_pk_add_f32 v[160:161], v[160:161], v[38:39]
    v_mul_f32 v168, 0xbb124925, v160
    buffer_load_dwordx4 a[176:179], v254, s[12:15], s52 offen offset:1024 sc1
    v_mov_b32 v169, 0x3727c5ac
    v_fmac_f32 v169, 0x3b124925, v161
    v_fma_f32 v169, -v168, v168, v169
    v_max_f32 v169, 0x3727c5ac, v169
    v_rsq_f32 v170, v169
    s_nop 0
    v_mul_f32 v168, v168, v170
    v_pk_fma_f32 v[0:1], v[0:1], v[170:171], v[168:169] op_sel_hi:[1,0,0]
    v_pk_fma_f32 v[2:3], v[2:3], v[170:171], v[168:169] op_sel_hi:[1,0,0]
    buffer_load_dwordx4 a[180:183], v254, s[12:15], s53 offen offset:1024 sc1
    v_pk_fma_f32 v[4:5], v[4:5], v[170:171], v[168:169] op_sel_hi:[1,0,0]
    v_pk_fma_f32 v[6:7], v[6:7], v[170:171], v[168:169] op_sel_hi:[1,0,0]
    v_pk_fma_f32 v[8:9], v[8:9], v[170:171], v[168:169] op_sel_hi:[1,0,0]
    v_pk_fma_f32 v[10:11], v[10:11], v[170:171], v[168:169] op_sel_hi:[1,0,0]
    v_pk_fma_f32 v[12:13], v[12:13], v[170:171], v[168:169] op_sel_hi:[1,0,0]
    v_pk_fma_f32 v[14:15], v[14:15], v[170:171], v[168:169] op_sel_hi:[1,0,0]
    v_pk_fma_f32 v[16:17], v[16:17], v[170:171], v[168:169] op_sel_hi:[1,0,0]
    v_pk_fma_f32 v[18:19], v[18:19], v[170:171], v[168:169] op_sel_hi:[1,0,0]
    v_pk_fma_f32 v[20:21], v[20:21], v[170:171], v[168:169] op_sel_hi:[1,0,0]
    v_pk_fma_f32 v[22:23], v[22:23], v[170:171], v[168:169] op_sel_hi:[1,0,0]
    v_pk_fma_f32 v[24:25], v[24:25], v[170:171], v[168:169] op_sel_hi:[1,0,0]
    v_pk_fma_f32 v[26:27], v[26:27], v[170:171], v[168:169] op_sel_hi:[1,0,0]
    v_pk_fma_f32 v[28:29], v[28:29], v[170:171], v[168:169] op_sel_hi:[1,0,0]
    v_pk_fma_f32 v[30:31], v[30:31], v[170:171], v[168:169] op_sel_hi:[1,0,0]
    v_cvt_pk_bf16_f32 v192, v0, v1
    v_cvt_pk_bf16_f32 v193, v2, v3
    v_cvt_pk_bf16_f32 v194, v4, v5
    v_cvt_pk_bf16_f32 v195, v6, v7
    v_cvt_pk_bf16_f32 v196, v8, v9
    v_cvt_pk_bf16_f32 v197, v10, v11
    v_cvt_pk_bf16_f32 v198, v12, v13
    v_cvt_pk_bf16_f32 v199, v14, v15
    v_cvt_pk_bf16_f32 v200, v16, v17
    v_cvt_pk_bf16_f32 v201, v18, v19
    v_cvt_pk_bf16_f32 v202, v20, v21
    v_cvt_pk_bf16_f32 v203, v22, v23
    v_cvt_pk_bf16_f32 v204, v24, v25
    v_cvt_pk_bf16_f32 v205, v26, v27
    v_cvt_pk_bf16_f32 v206, v28, v29
    v_cvt_pk_bf16_f32 v207, v30, v31
    ds_write_b128 v217, v[192:195] offset:0
    ds_write_b128 v217, v[196:199] offset:1024
    ds_write_b128 v217, v[200:203] offset:2048
    ds_write_b128 v218, v[204:207]
    s_cmp_eq_u32 s45, 0
    s_cselect_b64 vcc, -1, 0
    v_cndmask_b32 v64, v80, v64, vcc
    v_cndmask_b32 v65, v81, v65, vcc
    v_cndmask_b32 v66, v82, v66, vcc
    v_cndmask_b32 v67, v83, v67, vcc
    v_cndmask_b32 v68, v84, v68, vcc
    v_cndmask_b32 v69, v85, v69, vcc
    v_cndmask_b32 v70, v86, v70, vcc
    v_cndmask_b32 v71, v87, v71, vcc
    v_cndmask_b32 v72, v88, v72, vcc
    v_cndmask_b32 v73, v89, v73, vcc
    v_cndmask_b32 v74, v90, v74, vcc
    v_cndmask_b32 v75, v91, v75, vcc
    v_cndmask_b32 v76, v92, v76, vcc
    v_cndmask_b32 v77, v93, v77, vcc
    v_cndmask_b32 v78, v94, v78, vcc
    v_cndmask_b32 v79, v95, v79, vcc
L_m1_join:
    s_waitcnt lgkmcnt(0)
    s_barrier
    ds_read_b128 v[96:99], v254 offset:0
    ds_read_b128 v[100:103], v254 offset:1024
    ds_read_b128 v[104:107], v254 offset:2048
    ds_read_b128 v[108:111], v254 offset:3072
    ds_read_b128 v[112:115], v254 offset:4096
    ds_read_b128 v[116:119], v254 offset:5120
    ds_read_b128 v[120:123], v254 offset:6144
    ds_read_b128 v[124:127], v254 offset:7168
    ds_read_b128 v[128:131], v254 offset:8192
    ds_read_b128 v[132:135], v254 offset:9216
    ds_read_b128 v[136:139], v254 offset:10240
    ds_read_b128 v[140:143], v254 offset:11264
    ds_read_b128 v[144:147], v254 offset:12288
    ds_read_b128 v[148:151], v254 offset:13312
    s_lshr_b32 s62, s2, 3
    s_mul_hi_u32 s64, s62, 613566757
    s_mul_i32 s65, s64, 7
    s_sub_u32 s65, s62, s65
    s_lshl_b32 s63, s42, 2
    s_add_u32 s64, s64, s63
    s_bfe_u32 s66, s2, 0x30003
    s_lshr_b32 s67, s2, 6
    s_lshl_b32 s63, s42, 2
    s_add_u32 s67, s67, s63
    s_lshl_b32 s62, s65, 2
    s_add_u32 s62, s62, s40
    s_mul_i32 s62, s62, 14336
    s_add_u32 s62, s62, 401408
    v_add_u32 v225, s62, v254
    s_mul_i32 s75, s40, 14336
    s_add_u32 s75, s75, 98304
    s_waitcnt lgkmcnt(13)
    s_waitcnt vmcnt(48)
    v_mfma_f32_16x16x32_bf16 v[0:3], a[8:11], v[96:99], 0
    v_mfma_f32_16x16x32_bf16 v[4:7], a[12:15], v[96:99], 0
    v_mfma_f32_16x16x32_bf16 v[8:11], a[24:27], v[96:99], 0
    v_mfma_f32_16x16x32_bf16 v[12:15], a[28:31], v[96:99], 0
    s_waitcnt lgkmcnt(12)
    v_mfma_f32_16x16x32_bf16 v[0:3], a[40:43], v[100:103], v[0:3]
    v_mfma_f32_16x16x32_bf16 v[4:7], a[44:47], v[100:103], v[4:7]
    v_mfma_f32_16x16x32_bf16 v[8:11], a[56:59], v[100:103], v[8:11]
    v_mfma_f32_16x16x32_bf16 v[12:15], a[60:63], v[100:103], v[12:15]
    s_waitcnt lgkmcnt(11)
    s_waitcnt vmcnt(40)
    v_mfma_f32_16x16x32_bf16 v[0:3], a[72:75], v[104:107], v[0:3]
    v_mfma_f32_16x16x32_bf16 v[4:7], a[76:79], v[104:107], v[4:7]
    v_mfma_f32_16x16x32_bf16 v[8:11], a[88:91], v[104:107], v[8:11]
    v_mfma_f32_16x16x32_bf16 v[12:15], a[92:95], v[104:107], v[12:15]
    s_waitcnt lgkmcnt(10)
    v_mfma_f32_16x16x32_bf16 v[0:3], a[104:107], v[108:111], v[0:3]
    v_mfma_f32_16x16x32_bf16 v[4:7], a[108:111], v[108:111], v[4:7]
    v_mfma_f32_16x16x32_bf16 v[8:11], a[120:123], v[108:111], v[8:11]
    v_mfma_f32_16x16x32_bf16 v[12:15], a[124:127], v[108:111], v[12:15]
    s_waitcnt lgkmcnt(9)
    s_waitcnt vmcnt(32)
    v_mfma_f32_16x16x32_bf16 v[0:3], a[136:139], v[112:115], v[0:3]
    v_mfma_f32_16x16x32_bf16 v[4:7], a[140:143], v[112:115], v[4:7]
    v_mfma_f32_16x16x32_bf16 v[8:11], a[152:155], v[112:115], v[8:11]
    v_mfma_f32_16x16x32_bf16 v[12:15], a[156:159], v[112:115], v[12:15]
    s_waitcnt lgkmcnt(8)
    v_mfma_f32_16x16x32_bf16 v[0:3], a[168:171], v[116:119], v[0:3]
    v_mfma_f32_16x16x32_bf16 v[4:7], a[172:175], v[116:119], v[4:7]
    v_mfma_f32_16x16x32_bf16 v[8:11], a[184:187], v[116:119], v[8:11]
    v_mfma_f32_16x16x32_bf16 v[12:15], a[188:191], v[116:119], v[12:15]
    s_waitcnt lgkmcnt(7)
    s_waitcnt vmcnt(24)
    v_mfma_f32_16x16x32_bf16 v[0:3], a[200:203], v[120:123], v[0:3]
    v_mfma_f32_16x16x32_bf16 v[4:7], a[204:207], v[120:123], v[4:7]
    v_mfma_f32_16x16x32_bf16 v[8:11], a[216:219], v[120:123], v[8:11]
    v_mfma_f32_16x16x32_bf16 v[12:15], a[220:223], v[120:123], v[12:15]
    s_waitcnt lgkmcnt(6)
    v_mfma_f32_16x16x32_bf16 v[0:3], a[232:235], v[124:127], v[0:3]
    v_mfma_f32_16x16x32_bf16 v[4:7], a[236:239], v[124:127], v[4:7]
    v_mfma_f32_16x16x32_bf16 v[8:11], a[248:251], v[124:127], v[8:11]
    v_mfma_f32_16x16x32_bf16 v[12:15], a[252:255], v[124:127], v[12:15]
    s_waitcnt lgkmcnt(5)
    s_waitcnt vmcnt(20)
    v_mfma_f32_16x16x32_bf16 v[0:3], a[0:3], v[128:131], v[0:3]
    v_mfma_f32_16x16x32_bf16 v[4:7], a[4:7], v[128:131], v[4:7]
    v_mfma_f32_16x16x32_bf16 v[8:11], a[16:19], v[128:131], v[8:11]
    v_mfma_f32_16x16x32_bf16 v[12:15], a[20:23], v[128:131], v[12:15]
    s_waitcnt lgkmcnt(4)
    s_waitcnt vmcnt(16)
    v_mfma_f32_16x16x32_bf16 v[0:3], a[32:35], v[132:135], v[0:3]
    v_mfma_f32_16x16x32_bf16 v[4:7], a[36:39], v[132:135], v[4:7]
    v_mfma_f32_16x16x32_bf16 v[8:11], a[48:51], v[132:135], v[8:11]
    v_mfma_f32_16x16x32_bf16 v[12:15], a[52:55], v[132:135], v[12:15]
    s_waitcnt lgkmcnt(3)
    s_waitcnt vmcnt(12)
    v_mfma_f32_16x16x32_bf16 v[0:3], a[64:67], v[136:139], v[0:3]
    buffer_store_dwordx4 v[64:67], v254, s[32:35], s47 offen offset:0 sc1
    v_mfma_f32_16x16x32_bf16 v[4:7], a[68:71], v[136:139], v[4:7]
    v_mfma_f32_16x16x32_bf16 v[8:11], a[80:83], v[136:139], v[8:11]
    v_mfma_f32_16x16x32_bf16 v[12:15], a[84:87], v[136:139], v[12:15]
    s_waitcnt lgkmcnt(2)
    s_waitcnt vmcnt(9)
    v_mfma_f32_16x16x32_bf16 v[0:3], a[96:99], v[140:143], v[0:3]
    buffer_store_dwordx4 v[68:71], v254, s[32:35], s47 offen offset:1024 sc1
    v_mfma_f32_16x16x32_bf16 v[4:7], a[100:103], v[140:143], v[4:7]
    v_mfma_f32_16x16x32_bf16 v[8:11], a[112:115], v[140:143], v[8:11]
    v_mfma_f32_16x16x32_bf16 v[12:15], a[116:119], v[140:143], v[12:15]
    s_waitcnt lgkmcnt(1)
    s_waitcnt vmcnt(6)
    v_mfma_f32_16x16x32_bf16 v[0:3], a[128:131], v[144:147], v[0:3]
    buffer_store_dwordx4 v[72:75], v254, s[32:35], s47 offen offset:2048 sc1
    v_mfma_f32_16x16x32_bf16 v[4:7], a[132:135], v[144:147], v[4:7]
    v_mfma_f32_16x16x32_bf16 v[8:11], a[144:147], v[144:147], v[8:11]
    v_mfma_f32_16x16x32_bf16 v[12:15], a[148:151], v[144:147], v[12:15]
    s_waitcnt lgkmcnt(0)
    s_waitcnt vmcnt(3)
    v_mfma_f32_16x16x32_bf16 v[0:3], a[160:163], v[148:151], v[0:3]
    buffer_store_dwordx4 v[76:79], v224, s[32:35], s47 offen sc1
    v_mfma_f32_16x16x32_bf16 v[4:7], a[164:167], v[148:151], v[4:7]
    v_mfma_f32_16x16x32_bf16 v[8:11], a[176:179], v[148:151], v[8:11]
    v_mfma_f32_16x16x32_bf16 v[12:15], a[180:183], v[148:151], v[12:15]
    v_mov_b32 v176, 0xc0135761
    v_mov_b32 v178, 0xbdd2d3e8
    s_mul_i32 s62, s44, 14
    s_mul_i32 s63, s45, 7
    s_add_u32 s62, s62, s63
    s_lshl_b32 s63, s40, 1
    s_add_u32 s62, s62, s63
    s_lshl_b32 s62, s62, 10
    s_add_u32 s63, s62, 1024
    s_cmp_eq_u32 s40, 3
    s_cselect_b32 s63, 1879048192, s63
    v_pk_mul_f32 v[160:161], v[0:1], v[0:1]
    v_pk_mul_f32 v[162:163], v[2:3], v[2:3]
    v_pk_mul_f32 v[164:165], v[4:5], v[4:5]
    s_add_u32 m0, s75, 0
    s_nop 0
    buffer_load_dwordx4 v225, s[12:15], 0 offen offset:0 sc1 lds
    v_pk_mul_f32 v[166:167], v[6:7], v[6:7]
    v_pk_mul_f32 v[168:169], v[8:9], v[8:9]
    v_pk_mul_f32 v[170:171], v[10:11], v[10:11]
    v_pk_mul_f32 v[172:173], v[12:13], v[12:13]
    v_pk_mul_f32 v[174:175], v[14:15], v[14:15]
    buffer_load_dwordx4 v225, s[12:15], 0 offen offset:1024 sc1 lds
    v_pk_fma_f32 v[160:161], v[160:161], v[178:179], v[176:177] op_sel_hi:[1,0,0]
    v_pk_fma_f32 v[162:163], v[162:163], v[178:179], v[176:177] op_sel_hi:[1,0,0]
    v_pk_fma_f32 v[164:165], v[164:165], v[178:179], v[176:177] op_sel_hi:[1,0,0]
    v_pk_fma_f32 v[166:167], v[166:167], v[178:179], v[176:177] op_sel_hi:[1,0,0]
    v_pk_fma_f32 v[168:169], v[168:169], v[178:179], v[176:177] op_sel_hi:[1,0,0]
    buffer_load_dwordx4 v225, s[12:15], 0 offen offset:2048 sc1 lds
    v_pk_fma_f32 v[170:171], v[170:171], v[178:179], v[176:177] op_sel_hi:[1,0,0]
    v_pk_fma_f32 v[172:173], v[172:173], v[178:179], v[176:177] op_sel_hi:[1,0,0]
    v_pk_fma_f32 v[174:175], v[174:175], v[178:179], v[176:177] op_sel_hi:[1,0,0]
    v_pk_mul_f32 v[160:161], v[160:161], v[0:1]
    v_pk_mul_f32 v[162:163], v[162:163], v[2:3]
    buffer_load_dwordx4 v225, s[12:15], 0 offen offset:3072 sc1 lds
    v_pk_mul_f32 v[164:165], v[164:165], v[4:5]
    v_pk_mul_f32 v[166:167], v[166:167], v[6:7]
    v_pk_mul_f32 v[168:169], v[168:169], v[8:9]
    v_pk_mul_f32 v[170:171], v[170:171], v[10:11]
    v_pk_mul_f32 v[172:173], v[172:173], v[12:13]
    v_add_u32 v225, 4096, v225
    s_add_u32 m0, s75, 4096
    s_nop 0
    buffer_load_dwordx4 v225, s[12:15], 0 offen offset:0 sc1 lds
    v_pk_mul_f32 v[174:175], v[174:175], v[14:15]
    v_exp_f32 v160, v160
    v_exp_f32 v161, v161
    v_exp_f32 v162, v162
    v_exp_f32 v163, v163
    buffer_load_dwordx4 v225, s[12:15], 0 offen offset:1024 sc1 lds
    v_exp_f32 v164, v164
    v_exp_f32 v165, v165
    v_exp_f32 v166, v166
    v_exp_f32 v167, v167
    v_exp_f32 v168, v168
    buffer_load_dwordx4 v225, s[12:15], 0 offen offset:2048 sc1 lds
    v_exp_f32 v169, v169
    v_exp_f32 v170, v170
    v_exp_f32 v171, v171
    v_exp_f32 v172, v172
    v_exp_f32 v173, v173
    buffer_load_dwordx4 v225, s[12:15], 0 offen offset:3072 sc1 lds
    v_exp_f32 v174, v174
    v_exp_f32 v175, v175
    v_add_f32 v160, 1.0, v160
    v_add_f32 v161, 1.0, v161
    v_add_f32 v162, 1.0, v162
    v_add_u32 v225, 4096, v225
    s_add_u32 m0, s75, 8192
    s_nop 0
    buffer_load_dwordx4 v225, s[12:15], 0 offen offset:0 sc1 lds
    v_add_f32 v163, 1.0, v163
    v_add_f32 v164, 1.0, v164
    v_add_f32 v165, 1.0, v165
    v_add_f32 v166, 1.0, v166
    v_add_f32 v167, 1.0, v167
    buffer_load_dwordx4 v225, s[12:15], 0 offen offset:1024 sc1 lds
    v_add_f32 v168, 1.0, v168
    v_add_f32 v169, 1.0, v169
    v_add_f32 v170, 1.0, v170
    v_add_f32 v171, 1.0, v171
    v_add_f32 v172, 1.0, v172
    buffer_load_dwordx4 v225, s[12:15], 0 offen offset:2048 sc1 lds
    v_add_f32 v173, 1.0, v173
    v_add_f32 v174, 1.0, v174
    v_add_f32 v175, 1.0, v175
    v_rcp_f32 v160, v160
    v_rcp_f32 v161, v161
    buffer_load_dwordx4 v225, s[12:15], 0 offen offset:3072 sc1 lds
    v_rcp_f32 v162, v162
    v_rcp_f32 v163, v163
    v_rcp_f32 v164, v164
    v_rcp_f32 v165, v165
    v_rcp_f32 v166, v166
    v_add_u32 v225, 4096, v225
    s_add_u32 m0, s75, 12288
    s_nop 0
    buffer_load_dwordx4 v225, s[12:15], 0 offen offset:0 sc1 lds
    v_rcp_f32 v167, v167
    v_rcp_f32 v168, v168
    v_rcp_f32 v169, v169
    v_rcp_f32 v170, v170
    v_rcp_f32 v171, v171
    buffer_load_dwordx4 v225, s[12:15], 0 offen offset:1024 sc1 lds
    v_rcp_f32 v172, v172
    v_rcp_f32 v173, v173
    v_rcp_f32 v174, v174
    v_rcp_f32 v175, v175
    v_pk_mul_f32 v[0:1], v[0:1], v[160:161]
    v_pk_mul_f32 v[2:3], v[2:3], v[162:163]
    v_pk_mul_f32 v[4:5], v[4:5], v[164:165]
    v_pk_mul_f32 v[6:7], v[6:7], v[166:167]
    v_pk_mul_f32 v[8:9], v[8:9], v[168:169]
    v_pk_mul_f32 v[10:11], v[10:11], v[170:171]
    v_pk_mul_f32 v[12:13], v[12:13], v[172:173]
    v_pk_mul_f32 v[14:15], v[14:15], v[174:175]
    v_cvt_pk_bf16_f32 v192, v0, v1
    v_cvt_pk_bf16_f32 v193, v2, v3
    v_cvt_pk_bf16_f32 v194, v4, v5
    v_cvt_pk_bf16_f32 v195, v6, v7
    v_cvt_pk_bf16_f32 v196, v8, v9
    v_cvt_pk_bf16_f32 v197, v10, v11
    v_cvt_pk_bf16_f32 v198, v12, v13
    v_cvt_pk_bf16_f32 v199, v14, v15
    buffer_store_dwordx4 v[192:195], v254, s[36:39], s62 offen sc1
    buffer_store_dwordx4 v[196:199], v254, s[36:39], s63 offen sc1
    s_add_u32 s24, s86, 37568512
    s_addc_u32 s25, s87, 0
    s_mov_b32 s26, 3211264
    s_mov_b32 s27, 0x20000
    s_lshl_b32 s74, s40, 2
    s_mul_i32 s62, s66, 14
    s_add_u32 s62, s62, s74
    s_mul_i32 s68, s62, 14336
    s_add_u32 s69, s68, 14336
    s_add_u32 s70, s69, 14336
    s_add_u32 s71, s70, 14336
    s_cmp_eq_u32 s40, 3
    s_cselect_b32 s70, 1879048192, s70
    s_cselect_b32 s71, 1879048192, s71
    buffer_load_dwordx4 a[0:3], v254, s[24:27], s68 offen offset:0 sc1
    buffer_load_dwordx4 a[4:7], v254, s[24:27], s69 offen offset:0 sc1
    buffer_load_dwordx4 a[8:11], v254, s[24:27], s70 offen offset:0 sc1
    buffer_load_dwordx4 a[12:15], v254, s[24:27], s71 offen offset:0 sc1
    buffer_load_dwordx4 a[16:19], v254, s[24:27], s68 offen offset:1024 sc1
    buffer_load_dwordx4 a[20:23], v254, s[24:27], s69 offen offset:1024 sc1
    buffer_load_dwordx4 a[24:27], v254, s[24:27], s70 offen offset:1024 sc1
    buffer_load_dwordx4 a[28:31], v254, s[24:27], s71 offen offset:1024 sc1
    v_lshrrev_b32 v8, 4, v254
    v_and_b32 v9, 15, v8
    v_and_b32 v10, 48, v8
    s_lshl_b32 s62, s64, 6
    s_lshl_b32 s63, s40, 4
    s_add_u32 s62, s62, s63
    v_add_u32 v11, s62, v9
    v_mov_b32 v15, 1835008
    v_add_u32 v12, -1, v11
    v_lshrrev_b32 v13, 4, v12
    v_and_b32 v13, 0xff, v13
    v_mul_u32_u24 v13, 14336, v13
    v_and_b32 v14, 15, v12
    v_add_u32 v14, v14, v10
    v_cmp_gt_i32 vcc, 0, v12
    v_lshl_add_u32 v13, v14, 4, v13
    s_nop 0
    v_cndmask_b32 v0, v13, v15, vcc
    v_add_u32 v12, 1, v11
    v_lshrrev_b32 v13, 4, v12
    v_and_b32 v13, 0xff, v13
    v_mul_u32_u24 v13, 14336, v13
    v_and_b32 v14, 15, v12
    v_add_u32 v14, v14, v10
    v_cmp_gt_i32 vcc, 0, v12
    v_lshl_add_u32 v13, v14, 4, v13
    s_nop 0
    v_cndmask_b32 v1, v13, v15, vcc
    v_add_u32 v12, -2, v11
    v_lshrrev_b32 v13, 4, v12
    v_and_b32 v13, 0xff, v13
    v_mul_u32_u24 v13, 14336, v13
    v_and_b32 v14, 15, v12
    v_add_u32 v14, v14, v10
    v_cmp_gt_i32 vcc, 0, v12
    v_lshl_add_u32 v13, v14, 4, v13
    s_nop 0
    v_cndmask_b32 v2, v13, v15, vcc
    v_add_u32 v12, 2, v11
    v_lshrrev_b32 v13, 4, v12
    v_and_b32 v13, 0xff, v13
    v_mul_u32_u24 v13, 14336, v13
    v_and_b32 v14, 15, v12
    v_add_u32 v14, v14, v10
    v_cmp_gt_i32 vcc, 0, v12
    v_lshl_add_u32 v13, v14, 4, v13
    s_nop 0
    v_cndmask_b32 v3, v13, v15, vcc
    s_lshl_b32 s62, s64, 2
    s_sub_u32 s62, s62, 1
    v_lshrrev_b32 v12, 1, v8
    v_add_u32 v12, s62, v12
    v_cmp_gt_u32 vcc, 128, v12
    v_cmp_gt_u32 s[44:45], 12, v8
    v_and_b32 v13, 15, v12
    v_and_b32 v14, 1, v8
    v_lshl_add_u32 v13, v13, 1, v14
    v_bfe_u32 v12, v12, 4, 3
    v_lshl_add_u32 v13, v13, 3, v12
    v_lshlrev_b32 v4, 7, v13
    s_and_b64 s[44:45], s[44:45], vcc
    s_mov_b32 s56, 0
    s_mov_b32 s57, 4096
    s_mov_b32 s58, 8192
    s_mov_b32 s59, 12288
    s_add_u32 s4, s86, 18415616
    s_addc_u32 s5, s87, 0
    s_mov_b32 s6, 1835008
    s_mov_b32 s7, 0x20000
    s_add_u32 s8, s86, 16580608
    s_addc_u32 s9, s87, 0
    s_mov_b32 s10, 1835008
    s_mov_b32 s11, 0x20000
    s_add_u32 s32, s86, 20250624
    s_addc_u32 s33, s87, 0
    s_mov_b32 s34, 1835008
    s_mov_b32 s35, 0x20000
    s_add_u32 s36, s86, 40779776
    s_addc_u32 s37, s87, 0
    s_mov_b32 s38, 229376
    s_mov_b32 s39, 0x20000
    s_lshr_b32 s47, s40, 1
    s_and_b32 s48, s40, 1
    s_lshl_b32 s62, s64, 1
    s_add_u32 s62, s62, s47
    s_mul_i32 s62, s62, 28
    s_lshl_b32 s63, s65, 1
    s_add_u32 s63, s63, s48
    s_add_u32 s62, s62, s63
    s_lshl_b32 s60, s62, 10
    s_add_u32 s61, s60, 14336
    s_lshl_b32 s49, s63, 9
    s_mul_i32 s62, s64, 7168
    s_add_u32 s49, s49, s62
    s_lshl_b32 s62, s47, 8
    s_add_u32 s49, s49, s62
    s_lshl_b32 s47, s47, 15
    v_add_u32 v6, s47, v254
    s_mul_i32 s48, s48, 28672
    s_add_u32 s48, s48, 98304
    v_add_u32 v7, s48, v254
    s_lshl_b32 s46, s40, 14
    s_waitcnt vmcnt(8)
    s_barrier
    s_cmp_lg_u32 s40, 0
    s_cbranch_scc1 L_m2_nf
    v_mov_b32 v252, 0
    v_mov_b32 v253, 1
    s_lshl_b32 s62, s2, 7
    buffer_store_dword v253, v252, s[16:19], s62 offen offset:4 sc1
L_m2_nf:
    buffer_load_dwordx4 a[32:35], v254, s[24:27], s68 offen offset:2048 sc1
    buffer_load_dwordx4 a[36:39], v254, s[24:27], s69 offen offset:2048 sc1
    buffer_load_dwordx4 a[40:43], v254, s[24:27], s70 offen offset:2048 sc1
    buffer_load_dwordx4 a[44:47], v254, s[24:27], s71 offen offset:2048 sc1
    buffer_load_dwordx4 a[48:51], v254, s[24:27], s68 offen offset:3072 sc1
    buffer_load_dwordx4 a[52:55], v254, s[24:27], s69 offen offset:3072 sc1
    buffer_load_dwordx4 a[56:59], v254, s[24:27], s70 offen offset:3072 sc1
    buffer_load_dwordx4 a[60:63], v254, s[24:27], s71 offen offset:3072 sc1
    s_add_u32 s68, s68, 4096
    s_add_u32 s69, s69, 4096
    s_add_u32 s70, s70, 4096
    s_add_u32 s71, s71, 4096
    buffer_load_dwordx4 a[64:67], v254, s[24:27], s68 offen offset:0 sc1
    buffer_load_dwordx4 a[68:71], v254, s[24:27], s69 offen offset:0 sc1
    buffer_load_dwordx4 a[72:75], v254, s[24:27], s70 offen offset:0 sc1
    buffer_load_dwordx4 a[76:79], v254, s[24:27], s71 offen offset:0 sc1
    buffer_load_dwordx4 a[80:83], v254, s[24:27], s68 offen offset:1024 sc1
    buffer_load_dwordx4 a[84:87], v254, s[24:27], s69 offen offset:1024 sc1
    buffer_load_dwordx4 a[88:91], v254, s[24:27], s70 offen offset:1024 sc1
    buffer_load_dwordx4 a[92:95], v254, s[24:27], s71 offen offset:1024 sc1
    buffer_load_dwordx4 a[96:99], v254, s[24:27], s68 offen offset:2048 sc1
    buffer_load_dwordx4 a[100:103], v254, s[24:27], s69 offen offset:2048 sc1
    buffer_load_dwordx4 a[104:107], v254, s[24:27], s70 offen offset:2048 sc1
    buffer_load_dwordx4 a[108:111], v254, s[24:27], s71 offen offset:2048 sc1
    s_cmp_ge_u32 s2, 224
    s_cbranch_scc1 L_m2_cs
    s_cmp_lg_u32 s40, 1
    s_cbranch_scc1 L_m2_ok
    s_mov_b32 s50, 0
L_m2_p:
    buffer_load_dword v248, v4, s[16:19], 0 offen offset:4 sc1
    s_waitcnt vmcnt(0)
    v_cmp_ne_u32 vcc, 0, v248
    s_add_u32 s50, s50, 1
    s_and_b64 vcc, vcc, s[44:45]
    s_cmp_eq_u64 vcc, s[44:45]
    s_cbranch_scc1 L_m2_ok
    s_cmp_lt_u32 s50, 0x200000
    s_cbranch_scc1 L_m2_p
L_m2_ok:
    s_waitcnt vmcnt(0)
    s_barrier
    s_add_u32 m0, s46, 0
    s_nop 0
    buffer_load_dwordx4 v0, s[4:7], s56 offen offset:0 sc1 lds
    buffer_load_dwordx4 v0, s[4:7], s56 offen offset:1024 sc1 lds
    buffer_load_dwordx4 v0, s[4:7], s56 offen offset:2048 sc1 lds
    buffer_load_dwordx4 v0, s[4:7], s56 offen offset:3072 sc1 lds
    s_add_u32 m0, s46, 11264
    s_nop 0
    buffer_load_dwordx4 v1, s[4:7], s56 offen offset:3072 sc1 lds
    s_add_u32 m0, s46, 4096
    s_nop 0
    buffer_load_dwordx4 v1, s[4:7], s57 offen offset:0 sc1 lds
    buffer_load_dwordx4 v1, s[4:7], s57 offen offset:1024 sc1 lds
    buffer_load_dwordx4 v1, s[4:7], s57 offen offset:2048 sc1 lds
    buffer_load_dwordx4 v2, s[4:7], s57 offen offset:3072 sc1 lds
    s_add_u32 m0, s46, 8192
    s_nop 0
    buffer_load_dwordx4 v2, s[4:7], s58 offen offset:0 sc1 lds
    buffer_load_dwordx4 v2, s[4:7], s58 offen offset:1024 sc1 lds
    buffer_load_dwordx4 v2, s[4:7], s58 offen offset:2048 sc1 lds
    buffer_load_dwordx4 v3, s[4:7], s58 offen offset:3072 sc1 lds
    s_add_u32 m0, s46, 13312
    s_nop 0
    buffer_load_dwordx4 v3, s[4:7], s58 offen offset:2048 sc1 lds
    s_add_u32 m0, s46, 12288
    s_nop 0
    buffer_load_dwordx4 v3, s[4:7], s59 offen offset:0 sc1 lds
    buffer_load_dwordx4 v3, s[4:7], s59 offen offset:1024 sc1 lds
    buffer_load_dwordx4 v[16:19], v254, s[8:11], s60 offen sc1
    buffer_load_dwordx4 v[20:23], v254, s[8:11], s61 offen sc1
    s_waitcnt vmcnt(9)
    s_barrier
    ds_read_b128 v[24:27], v7 offset:0
    ds_read_b128 v[28:31], v7 offset:14336
    ds_read_b128 v[48:51], v6 offset:0
    ds_read_b128 v[52:55], v6 offset:16384
    ds_read_b128 v[32:35], v7 offset:1024
    ds_read_b128 v[36:39], v7 offset:15360
    ds_read_b128 v[56:59], v6 offset:1024
    ds_read_b128 v[60:63], v6 offset:17408
    ds_read_b128 v[40:43], v7 offset:2048
    ds_read_b128 v[44:47], v7 offset:16384
    ds_read_b128 v[64:67], v6 offset:2048
    ds_read_b128 v[68:71], v6 offset:18432
    s_waitcnt lgkmcnt(8)
    v_mfma_f32_16x16x32_bf16 v[72:75], v[24:27], v[48:51], 0
    v_mfma_f32_16x16x32_bf16 v[80:83], v[24:27], v[52:55], 0
    v_mfma_f32_16x16x32_bf16 v[76:79], v[28:31], v[48:51], 0
    v_mfma_f32_16x16x32_bf16 v[84:87], v[28:31], v[52:55], 0
    ds_read_b128 v[24:27], v7 offset:3072
    ds_read_b128 v[28:31], v7 offset:17408
    ds_read_b64 v[48:49], v6 offset:3072
    ds_read_b64 v[50:51], v6 offset:14344
    ds_read_b64 v[52:53], v6 offset:19456
    ds_read_b64 v[54:55], v6 offset:30728
    s_waitcnt lgkmcnt(10)
    v_mfma_f32_16x16x32_bf16 v[72:75], v[32:35], v[56:59], v[72:75]
    v_mfma_f32_16x16x32_bf16 v[80:83], v[32:35], v[60:63], v[80:83]
    v_mfma_f32_16x16x32_bf16 v[76:79], v[36:39], v[56:59], v[76:79]
    v_mfma_f32_16x16x32_bf16 v[84:87], v[36:39], v[60:63], v[84:87]
    ds_read_b128 v[32:35], v7 offset:4096
    ds_read_b128 v[36:39], v7 offset:18432
    ds_read_b128 v[56:59], v6 offset:4096
    ds_read_b128 v[60:63], v6 offset:20480
    s_waitcnt lgkmcnt(10)
    v_mfma_f32_16x16x32_bf16 v[72:75], v[40:43], v[64:67], v[72:75]
    v_mfma_f32_16x16x32_bf16 v[80:83], v[40:43], v[68:71], v[80:83]
    v_mfma_f32_16x16x32_bf16 v[76:79], v[44:47], v[64:67], v[76:79]
    v_mfma_f32_16x16x32_bf16 v[84:87], v[44:47], v[68:71], v[84:87]
    ds_read_b128 v[40:43], v7 offset:5120
    ds_read_b128 v[44:47], v7 offset:19456
    ds_read_b128 v[64:67], v6 offset:5120
    ds_read_b128 v[68:71], v6 offset:21504
    s_waitcnt lgkmcnt(8)
    v_mfma_f32_16x16x32_bf16 v[72:75], v[24:27], v[48:51], v[72:75]
    v_mfma_f32_16x16x32_bf16 v[80:83], v[24:27], v[52:55], v[80:83]
    v_mfma_f32_16x16x32_bf16 v[76:79], v[28:31], v[48:51], v[76:79]
    v_mfma_f32_16x16x32_bf16 v[84:87], v[28:31], v[52:55], v[84:87]
    ds_read_b128 v[24:27], v7 offset:6144
    ds_read_b128 v[28:31], v7 offset:20480
    ds_read_b128 v[48:51], v6 offset:6144
    ds_read_b128 v[52:55], v6 offset:22528
    s_waitcnt lgkmcnt(8)
    v_mfma_f32_16x16x32_bf16 v[72:75], v[32:35], v[56:59], v[72:75]
    v_mfma_f32_16x16x32_bf16 v[80:83], v[32:35], v[60:63], v[80:83]
    v_mfma_f32_16x16x32_bf16 v[76:79], v[36:39], v[56:59], v[76:79]
    v_mfma_f32_16x16x32_bf16 v[84:87], v[36:39], v[60:63], v[84:87]
    ds_read_b128 v[32:35], v7 offset:7168
    ds_read_b128 v[36:39], v7 offset:21504
    ds_read_b128 v[56:59], v6 offset:7168
    ds_read_b128 v[60:63], v6 offset:23552
    s_waitcnt lgkmcnt(8)
    v_mfma_f32_16x16x32_bf16 v[72:75], v[40:43], v[64:67], v[72:75]
    v_mfma_f32_16x16x32_bf16 v[80:83], v[40:43], v[68:71], v[80:83]
    v_mfma_f32_16x16x32_bf16 v[76:79], v[44:47], v[64:67], v[76:79]
    v_mfma_f32_16x16x32_bf16 v[84:87], v[44:47], v[68:71], v[84:87]
    s_waitcnt vmcnt(0)
    s_barrier
    ds_read_b128 v[40:43], v7 offset:8192
    ds_read_b128 v[44:47], v7 offset:22528
    ds_read_b128 v[64:67], v6 offset:8192
    ds_read_b128 v[68:71], v6 offset:24576
    s_waitcnt lgkmcnt(8)
    v_mfma_f32_16x16x32_bf16 v[72:75], v[24:27], v[48:51], v[72:75]
    v_mfma_f32_16x16x32_bf16 v[80:83], v[24:27], v[52:55], v[80:83]
    v_mfma_f32_16x16x32_bf16 v[76:79], v[28:31], v[48:51], v[76:79]
    v_mfma_f32_16x16x32_bf16 v[84:87], v[28:31], v[52:55], v[84:87]
    ds_read_b128 v[24:27], v7 offset:9216
    ds_read_b128 v[28:31], v7 offset:23552
    ds_read_b128 v[48:51], v6 offset:9216
    ds_read_b128 v[52:55], v6 offset:25600
    s_waitcnt lgkmcnt(8)
    v_mfma_f32_16x16x32_bf16 v[72:75], v[32:35], v[56:59], v[72:75]
    v_mfma_f32_16x16x32_bf16 v[80:83], v[32:35], v[60:63], v[80:83]
    v_mfma_f32_16x16x32_bf16 v[76:79], v[36:39], v[56:59], v[76:79]
    v_mfma_f32_16x16x32_bf16 v[84:87], v[36:39], v[60:63], v[84:87]
    ds_read_b128 v[32:35], v7 offset:10240
    ds_read_b128 v[36:39], v7 offset:24576
    ds_read_b64 v[56:57], v6 offset:10240
    ds_read_b64 v[58:59], v6 offset:15368
    ds_read_b64 v[60:61], v6 offset:26624
    ds_read_b64 v[62:63], v6 offset:31752
    s_waitcnt lgkmcnt(10)
    v_mfma_f32_16x16x32_bf16 v[72:75], v[40:43], v[64:67], v[72:75]
    v_mfma_f32_16x16x32_bf16 v[80:83], v[40:43], v[68:71], v[80:83]
    v_mfma_f32_16x16x32_bf16 v[76:79], v[44:47], v[64:67], v[76:79]
    v_mfma_f32_16x16x32_bf16 v[84:87], v[44:47], v[68:71], v[84:87]
    ds_read_b128 v[40:43], v7 offset:11264
    ds_read_b128 v[44:47], v7 offset:25600
    ds_read_b128 v[64:67], v6 offset:11264
    ds_read_b128 v[68:71], v6 offset:27648
    s_waitcnt lgkmcnt(10)
    v_mfma_f32_16x16x32_bf16 v[72:75], v[24:27], v[48:51], v[72:75]
    v_mfma_f32_16x16x32_bf16 v[80:83], v[24:27], v[52:55], v[80:83]
    v_mfma_f32_16x16x32_bf16 v[76:79], v[28:31], v[48:51], v[76:79]
    v_mfma_f32_16x16x32_bf16 v[84:87], v[28:31], v[52:55], v[84:87]
    ds_read_b128 v[24:27], v7 offset:12288
    ds_read_b128 v[28:31], v7 offset:26624
    ds_read_b128 v[48:51], v6 offset:12288
    ds_read_b128 v[52:55], v6 offset:28672
    s_waitcnt lgkmcnt(8)
    v_mfma_f32_16x16x32_bf16 v[72:75], v[32:35], v[56:59], v[72:75]
    v_mfma_f32_16x16x32_bf16 v[80:83], v[32:35], v[60:63], v[80:83]
    v_mfma_f32_16x16x32_bf16 v[76:79], v[36:39], v[56:59], v[76:79]
    v_mfma_f32_16x16x32_bf16 v[84:87], v[36:39], v[60:63], v[84:87]
    ds_read_b128 v[32:35], v7 offset:13312
    ds_read_b128 v[36:39], v7 offset:27648
    ds_read_b128 v[56:59], v6 offset:13312
    ds_read_b128 v[60:63], v6 offset:29696
    s_waitcnt lgkmcnt(8)
    v_mfma_f32_16x16x32_bf16 v[72:75], v[40:43], v[64:67], v[72:75]
    v_mfma_f32_16x16x32_bf16 v[80:83], v[40:43], v[68:71], v[80:83]
    v_mfma_f32_16x16x32_bf16 v[76:79], v[44:47], v[64:67], v[76:79]
    v_mfma_f32_16x16x32_bf16 v[84:87], v[44:47], v[68:71], v[84:87]
    s_waitcnt lgkmcnt(4)
    v_mfma_f32_16x16x32_bf16 v[72:75], v[24:27], v[48:51], v[72:75]
    v_mfma_f32_16x16x32_bf16 v[80:83], v[24:27], v[52:55], v[80:83]
    v_mfma_f32_16x16x32_bf16 v[76:79], v[28:31], v[48:51], v[76:79]
    v_mfma_f32_16x16x32_bf16 v[84:87], v[28:31], v[52:55], v[84:87]
    s_waitcnt lgkmcnt(0)
    v_mfma_f32_16x16x32_bf16 v[72:75], v[32:35], v[56:59], v[72:75]
    v_mfma_f32_16x16x32_bf16 v[80:83], v[32:35], v[60:63], v[80:83]
    v_mfma_f32_16x16x32_bf16 v[76:79], v[36:39], v[56:59], v[76:79]
    v_mfma_f32_16x16x32_bf16 v[84:87], v[36:39], v[60:63], v[84:87]
    v_lshlrev_b32 v24, 16, v16
    v_and_b32 v25, 0xffff0000, v16
    v_lshlrev_b32 v26, 16, v17
    v_and_b32 v27, 0xffff0000, v17
    v_lshlrev_b32 v28, 16, v18
    v_and_b32 v29, 0xffff0000, v18
    v_lshlrev_b32 v30, 16, v19
    v_and_b32 v31, 0xffff0000, v19
    v_lshlrev_b32 v32, 16, v20
    v_and_b32 v33, 0xffff0000, v20
    v_lshlrev_b32 v34, 16, v21
    v_and_b32 v35, 0xffff0000, v21
    v_lshlrev_b32 v36, 16, v22
    v_and_b32 v37, 0xffff0000, v22
    v_lshlrev_b32 v38, 16, v23
    v_and_b32 v39, 0xffff0000, v23
    v_pk_add_f32 v[72:73], v[72:73], v[24:25]
    v_pk_add_f32 v[74:75], v[74:75], v[26:27]
    v_pk_add_f32 v[76:77], v[76:77], v[28:29]
    v_pk_add_f32 v[78:79], v[78:79], v[30:31]
    v_pk_add_f32 v[80:81], v[80:81], v[32:33]
    v_pk_add_f32 v[82:83], v[82:83], v[34:35]
    v_pk_add_f32 v[84:85], v[84:85], v[36:37]
    v_pk_add_f32 v[86:87], v[86:87], v[38:39]
    v_cvt_pk_bf16_f32 v16, v72, v73
    v_cvt_pk_bf16_f32 v17, v74, v75
    v_cvt_pk_bf16_f32 v18, v76, v77
    v_cvt_pk_bf16_f32 v19, v78, v79
    v_cvt_pk_bf16_f32 v20, v80, v81
    v_cvt_pk_bf16_f32 v21, v82, v83
    v_cvt_pk_bf16_f32 v22, v84, v85
    v_cvt_pk_bf16_f32 v23, v86, v87
    buffer_store_dwordx4 v[16:19], v254, s[32:35], s60 offen sc1
    buffer_store_dwordx4 v[20:23], v254, s[32:35], s61 offen sc1
    s_lshr_b32 s62, s40, 1
    s_lshl_b32 s62, s62, 12
    s_and_b32 s63, s40, 1
    s_lshl_b32 s63, s63, 10
    s_add_u32 s62, s62, s63
    s_add_u32 s62, s62, 155648
    v_add_u32 v10, s62, v254
    ds_write_b128 v10, v[16:19] offset:0
    ds_write_b128 v10, v[20:23] offset:2048
    v_pk_add_f32 v[48:49], v[72:73], v[74:75]
    v_pk_mul_f32 v[50:51], v[72:73], v[72:73]
    v_pk_fma_f32 v[50:51], v[74:75], v[74:75], v[50:51]
    v_pk_add_f32 v[48:49], v[48:49], v[76:77]
    v_pk_fma_f32 v[50:51], v[76:77], v[76:77], v[50:51]
    v_pk_add_f32 v[48:49], v[48:49], v[78:79]
    v_pk_fma_f32 v[50:51], v[78:79], v[78:79], v[50:51]
    v_add_f32 v48, v48, v49
    v_add_f32 v49, v50, v51
    v_pk_add_f32 v[52:53], v[80:81], v[82:83]
    v_pk_mul_f32 v[54:55], v[80:81], v[80:81]
    v_pk_fma_f32 v[54:55], v[82:83], v[82:83], v[54:55]
    v_pk_add_f32 v[52:53], v[52:53], v[84:85]
    v_pk_fma_f32 v[54:55], v[84:85], v[84:85], v[54:55]
    v_pk_add_f32 v[52:53], v[52:53], v[86:87]
    v_pk_fma_f32 v[54:55], v[86:87], v[86:87], v[54:55]
    v_add_f32 v52, v52, v53
    v_add_f32 v53, v54, v55
    v_mov_b32 v50, v48
    v_mov_b32 v51, v49
    v_mov_b32 v54, v52
    v_mov_b32 v55, v53
    s_nop 1
    v_permlane32_swap_b32 v48, v50
    v_permlane32_swap_b32 v49, v51
    v_permlane32_swap_b32 v52, v54
    v_permlane32_swap_b32 v53, v55
    s_nop 1
    v_add_f32 v48, v48, v50
    v_add_f32 v49, v49, v51
    v_add_f32 v52, v52, v54
    v_add_f32 v53, v53, v55
    v_mov_b32 v50, v48
    v_mov_b32 v51, v49
    v_mov_b32 v54, v52
    v_mov_b32 v55, v53
    s_nop 1
    v_permlane16_swap_b32 v48, v50
    v_permlane16_swap_b32 v49, v51
    v_permlane16_swap_b32 v52, v54
    v_permlane16_swap_b32 v53, v55
    s_nop 1
    v_add_f32 v48, v48, v50
    v_add_f32 v49, v49, v51
    v_add_f32 v52, v52, v54
    v_add_f32 v53, v53, v55
    v_lshlrev_b32 v9, 3, v9
    buffer_store_dwordx2 v[48:49], v9, s[36:39], s49 offen offset:0 sc1
    buffer_store_dwordx2 v[52:53], v9, s[36:39], s49 offen offset:128 sc1
    s_branch L_m2_end
L_m2_cs:
    s_sub_u32 s62, s2, 224
    s_lshl_b32 s62, s62, 2
    s_add_u32 s62, s62, s40
    s_mul_i32 s44, s62, 14336
    s_lshl_b32 s45, s62, 6
    s_add_u32 s4, s86, 37568512
    s_addc_u32 s5, s87, 0
    s_mov_b32 s6, 1605632
    s_mov_b32 s7, 0x20000
    s_add_u32 s32, s86, 20480
    s_addc_u32 s33, s87, 0
    s_mov_b32 s34, 7168
    s_mov_b32 s35, 0x20000
    buffer_load_dwordx4 v[16:19], v254, s[4:7], s44 offen offset:0 sc1
    buffer_load_dwordx4 v[20:23], v254, s[4:7], s44 offen offset:1024 sc1
    buffer_load_dwordx4 v[24:27], v254, s[4:7], s44 offen offset:2048 sc1
    buffer_load_dwordx4 v[28:31], v254, s[4:7], s44 offen offset:3072 sc1
    s_add_u32 s44, s44, 4096
    buffer_load_dwordx4 v[32:35], v254, s[4:7], s44 offen offset:0 sc1
    buffer_load_dwordx4 v[36:39], v254, s[4:7], s44 offen offset:1024 sc1
    buffer_load_dwordx4 v[40:43], v254, s[4:7], s44 offen offset:2048 sc1
    buffer_load_dwordx4 v[44:47], v254, s[4:7], s44 offen offset:3072 sc1
    s_add_u32 s44, s44, 4096
    buffer_load_dwordx4 v[48:51], v254, s[4:7], s44 offen offset:0 sc1
    buffer_load_dwordx4 v[52:55], v254, s[4:7], s44 offen offset:1024 sc1
    buffer_load_dwordx4 v[56:59], v254, s[4:7], s44 offen offset:2048 sc1
    buffer_load_dwordx4 v[60:63], v254, s[4:7], s44 offen offset:3072 sc1
    s_add_u32 s44, s44, 4096
    buffer_load_dwordx4 v[64:67], v254, s[4:7], s44 offen offset:0 sc1
    buffer_load_dwordx4 v[68:71], v254, s[4:7], s44 offen offset:1024 sc1
    v_mov_b32 v4, 0x3f803f80
    v_mov_b32 v5, 0x3f803f80
    v_mov_b32 v6, 0x3f803f80
    v_mov_b32 v7, 0x3f803f80
    v_lshrrev_b32 v12, 4, v8
    v_lshlrev_b32 v12, 4, v12
    s_waitcnt vmcnt(0)
    v_mfma_f32_16x16x32_bf16 v[0:3], v[16:19], v[4:7], 0
    v_mfma_f32_16x16x32_bf16 v[0:3], v[20:23], v[4:7], v[0:3]
    v_mfma_f32_16x16x32_bf16 v[0:3], v[24:27], v[4:7], v[0:3]
    v_mfma_f32_16x16x32_bf16 v[0:3], v[28:31], v[4:7], v[0:3]
    v_mfma_f32_16x16x32_bf16 v[0:3], v[32:35], v[4:7], v[0:3]
    v_mfma_f32_16x16x32_bf16 v[0:3], v[36:39], v[4:7], v[0:3]
    v_mfma_f32_16x16x32_bf16 v[0:3], v[40:43], v[4:7], v[0:3]
    v_mfma_f32_16x16x32_bf16 v[0:3], v[44:47], v[4:7], v[0:3]
    v_mfma_f32_16x16x32_bf16 v[0:3], v[48:51], v[4:7], v[0:3]
    v_mfma_f32_16x16x32_bf16 v[0:3], v[52:55], v[4:7], v[0:3]
    v_mfma_f32_16x16x32_bf16 v[0:3], v[56:59], v[4:7], v[0:3]
    v_mfma_f32_16x16x32_bf16 v[0:3], v[60:63], v[4:7], v[0:3]
    v_mfma_f32_16x16x32_bf16 v[0:3], v[64:67], v[4:7], v[0:3]
    v_mfma_f32_16x16x32_bf16 v[0:3], v[68:71], v[4:7], v[0:3]
    s_nop 7
    buffer_store_dwordx4 v[0:3], v12, s[32:35], s45 offen sc1
L_m2_end:
    buffer_load_dwordx4 a[112:115], v254, s[24:27], s68 offen offset:3072 sc1
    buffer_load_dwordx4 a[116:119], v254, s[24:27], s69 offen offset:3072 sc1
    buffer_load_dwordx4 a[120:123], v254, s[24:27], s70 offen offset:3072 sc1
    buffer_load_dwordx4 a[124:127], v254, s[24:27], s71 offen offset:3072 sc1
    s_add_u32 s68, s68, 4096
    s_add_u32 s69, s69, 4096
    s_add_u32 s70, s70, 4096
    s_add_u32 s71, s71, 4096
    buffer_load_dwordx4 a[128:131], v254, s[24:27], s68 offen offset:0 sc1
    buffer_load_dwordx4 a[132:135], v254, s[24:27], s69 offen offset:0 sc1
    buffer_load_dwordx4 a[136:139], v254, s[24:27], s70 offen offset:0 sc1
    buffer_load_dwordx4 a[140:143], v254, s[24:27], s71 offen offset:0 sc1
    s_and_b32 s47, s40, 1
    s_mul_i32 s46, s40, 7
    s_add_u32 s48, s46, s47
    s_mul_i32 s56, s48, 57344
    s_mul_i32 s62, s66, 7168
    s_add_u32 s62, s62, 1605632
    s_add_u32 s56, s56, s62
    s_add_u32 s57, s56, 57344
    s_add_u32 s58, s57, 57344
    s_add_u32 s59, s58, 57344
    s_add_u32 s60, s59, 57344
    s_add_u32 s61, s60, 57344
    s_add_u32 s49, s46, 6
    s_cmp_eq_u32 s47, 1
    s_cselect_b32 s49, s46, s49
    s_mul_i32 s52, s49, 57344
    s_add_u32 s52, s52, s62
    s_lshl_b32 s62, s65, 2
    s_add_u32 s62, s62, s40
    s_mul_i32 s56, s62, 57344
    s_add_u32 s56, s56, 1605632
    v_add_u32 v10, 4096, v254
    v_lshrrev_b32 v140, 4, v254
    s_and_b32 s62, s67, 3
    s_mul_i32 s62, s62, 7
    v_add_u32 v141, s62, v140
    s_lshr_b32 s62, s67, 2
    v_lshl_add_u32 v141, v141, 3, s62
    v_add_u32 v142, 217, v140
    v_cmp_gt_u32 vcc, 7, v140
    v_cmp_gt_u32 s[44:45], 35, v140
    v_and_b32 v143, 15, v140
    v_cndmask_b32 v141, v142, v141, vcc
    v_lshlrev_b32 v0, 7, v141
    s_add_u32 s4, s86, 20250624
    s_addc_u32 s5, s87, 0
    s_mov_b32 s6, 1835008
    s_mov_b32 s7, 0x20000
    s_add_u32 s8, s86, 20480
    s_addc_u32 s9, s87, 0
    s_mov_b32 s10, 7168
    s_mov_b32 s11, 0x20000
    s_mul_i32 s62, s67, 7168
    s_add_u32 s62, s62, 40779776
    s_add_u32 s32, s86, s62
    s_addc_u32 s33, s87, 0
    s_mov_b32 s34, 7168
    s_mov_b32 s35, 0x20000
    s_lshl_b32 s62, s67, 3
    s_add_u32 s62, s62, s66
    s_mul_i32 s62, s62, 28672
    s_add_u32 s62, s62, 22085632
    s_add_u32 s36, s86, s62
    s_addc_u32 s37, s87, 0
    s_mov_b32 s38, 28672
    s_mov_b32 s39, 0x20000
    s_lshl_b32 s57, s40, 13
    s_add_u32 s58, s57, 4096
    v_lshrrev_b32 v144, 4, v140
    v_lshlrev_b32 v2, 4, v144
    v_lshrrev_b32 v3, 1, v254
    s_lshl_b32 s62, s40, 9
    s_add_u32 s62, s62, 94208
    v_add_u32 v4, s62, v3
    v_lshlrev_b32 v143, 3, v143
    v_add_u32 v5, s62, v143
    v_add_u32 v3, 86016, v3
    s_add_u32 s62, s74, 0
    s_and_b32 s63, s62, 1
    s_lshr_b32 s62, s62, 1
    s_lshl_b32 s62, s62, 12
    s_lshl_b32 s63, s63, 3
    s_add_u32 s62, s62, s63
    s_add_u32 s62, s62, 57344
    v_add_u32 v6, s62, v254
    s_add_u32 s62, s74, 1
    s_and_b32 s63, s62, 1
    s_lshr_b32 s62, s62, 1
    s_lshl_b32 s62, s62, 12
    s_lshl_b32 s63, s63, 3
    s_add_u32 s62, s62, s63
    s_add_u32 s62, s62, 57344
    v_add_u32 v7, s62, v254
    s_add_u32 s62, s74, 2
    s_and_b32 s63, s62, 1
    s_lshr_b32 s62, s62, 1
    s_lshl_b32 s62, s62, 12
    s_lshl_b32 s63, s63, 3
    s_add_u32 s62, s62, s63
    s_add_u32 s62, s62, 57344
    v_add_u32 v8, s62, v254
    s_add_u32 s62, s74, 3
    s_and_b32 s63, s62, 1
    s_lshr_b32 s62, s62, 1
    s_lshl_b32 s62, s62, 12
    s_lshl_b32 s63, s63, 3
    s_add_u32 s62, s62, s63
    s_add_u32 s62, s62, 57344
    s_cmp_ge_u32 s40, 2
    s_cselect_b32 s62, 98304, s62
    v_add_u32 v9, s62, v254
    s_mul_i32 s62, s67, 4
    s_add_u32 s62, s62, s40
    s_mul_i32 s51, s62, 14336
    s_mul_i32 s62, s66, 14
    s_add_u32 s62, s62, s74
    s_lshl_b32 s53, s62, 6
    s_waitcnt vmcnt(8)
    s_barrier
    s_cmp_lg_u32 s40, 0
    s_cbranch_scc1 L_m3_nf
    v_mov_b32 v252, 0
    v_mov_b32 v253, 1
    s_lshl_b32 s62, s2, 7
    buffer_store_dword v253, v252, s[16:19], s62 offen offset:8 sc1
L_m3_nf:
    buffer_load_dwordx4 a[144:147], v254, s[24:27], s68 offen offset:1024 sc1
    buffer_load_dwordx4 a[148:151], v254, s[24:27], s69 offen offset:1024 sc1
    buffer_load_dwordx4 a[152:155], v254, s[24:27], s70 offen offset:1024 sc1
    buffer_load_dwordx4 a[156:159], v254, s[24:27], s71 offen offset:1024 sc1
    buffer_load_dwordx4 a[160:163], v254, s[24:27], s68 offen offset:2048 sc1
    buffer_load_dwordx4 a[164:167], v254, s[24:27], s69 offen offset:2048 sc1
    buffer_load_dwordx4 a[168:171], v254, s[24:27], s70 offen offset:2048 sc1
    buffer_load_dwordx4 a[172:175], v254, s[24:27], s71 offen offset:2048 sc1
    buffer_load_dwordx4 a[176:179], v254, s[24:27], s68 offen offset:3072 sc1
    buffer_load_dwordx4 a[180:183], v254, s[24:27], s69 offen offset:3072 sc1
    buffer_load_dwordx4 a[184:187], v254, s[24:27], s70 offen offset:3072 sc1
    buffer_load_dwordx4 a[188:191], v254, s[24:27], s71 offen offset:3072 sc1
    s_add_u32 s68, s68, 4096
    s_add_u32 s69, s69, 4096
    s_add_u32 s70, s70, 4096
    s_add_u32 s71, s71, 4096
    buffer_load_dwordx4 a[192:195], v254, s[24:27], s68 offen offset:0 sc1
    buffer_load_dwordx4 a[196:199], v254, s[24:27], s69 offen offset:0 sc1
    buffer_load_dwordx4 a[200:203], v254, s[24:27], s70 offen offset:0 sc1
    buffer_load_dwordx4 a[204:207], v254, s[24:27], s71 offen offset:0 sc1
    buffer_load_dwordx4 a[208:211], v254, s[24:27], s68 offen offset:1024 sc1
    buffer_load_dwordx4 a[212:215], v254, s[24:27], s69 offen offset:1024 sc1
    buffer_load_dwordx4 a[216:219], v254, s[24:27], s70 offen offset:1024 sc1
    buffer_load_dwordx4 a[220:223], v254, s[24:27], s71 offen offset:1024 sc1
    buffer_load_dwordx4 a[224:227], v254, s[24:27], s56 offen offset:0 sc1
    buffer_load_dwordx4 a[228:231], v254, s[24:27], s56 offen offset:1024 sc1
    buffer_load_dwordx4 a[232:235], v254, s[24:27], s56 offen offset:2048 sc1
    buffer_load_dwordx4 a[236:239], v254, s[24:27], s56 offen offset:3072 sc1
    s_add_u32 s56, s56, 4096
    buffer_load_dwordx4 a[240:243], v254, s[24:27], s56 offen offset:0 sc1
    buffer_load_dwordx4 a[244:247], v254, s[24:27], s56 offen offset:1024 sc1
    buffer_load_dwordx4 a[248:251], v254, s[24:27], s56 offen offset:2048 sc1
    buffer_load_dwordx4 a[252:255], v254, s[24:27], s56 offen offset:3072 sc1
    s_add_u32 s56, s56, 4096
    s_cmp_lg_u32 s40, 1
    s_cbranch_scc1 L_m3_ok
    s_mov_b32 s50, 0
L_m3_p:
    buffer_load_dword v248, v0, s[16:19], 0 offen offset:8 sc1
    s_waitcnt vmcnt(0)
    v_cmp_ne_u32 vcc, 0, v248
    s_add_u32 s50, s50, 1
    s_and_b64 vcc, vcc, s[44:45]
    s_cmp_eq_u64 vcc, s[44:45]
    s_cbranch_scc1 L_m3_ok
    s_cmp_lt_u32 s50, 0x200000
    s_cbranch_scc1 L_m3_p
L_m3_ok:
    s_waitcnt vmcnt(0)
    s_barrier
    s_lshl_b32 s46, s40, 10
    s_add_u32 m0, s46, 0
    s_nop 0
    buffer_load_dwordx4 v254, s[4:7], s51 offen offset:0 sc1 lds
    s_add_u32 m0, s46, 3072
    s_nop 0
    buffer_load_dwordx4 v254, s[4:7], s51 offen offset:1024 sc1 lds
    s_add_u32 m0, s46, 6144
    s_nop 0
    buffer_load_dwordx4 v254, s[4:7], s51 offen offset:2048 sc1 lds
    s_add_u32 m0, s46, 9216
    s_nop 0
    buffer_load_dwordx4 v254, s[4:7], s51 offen offset:3072 sc1 lds
    s_add_u32 s51, s51, 4096
    s_add_u32 m0, s46, 16384
    s_nop 0
    buffer_load_dwordx4 v254, s[4:7], s51 offen offset:0 sc1 lds
    s_add_u32 m0, s46, 19456
    s_nop 0
    buffer_load_dwordx4 v254, s[4:7], s51 offen offset:1024 sc1 lds
    s_add_u32 m0, s46, 22528
    s_nop 0
    buffer_load_dwordx4 v254, s[4:7], s51 offen offset:2048 sc1 lds
    s_add_u32 m0, s46, 25600
    s_nop 0
    buffer_load_dwordx4 v254, s[4:7], s51 offen offset:3072 sc1 lds
    s_add_u32 s51, s51, 4096
    s_add_u32 m0, s46, 32768
    s_nop 0
    buffer_load_dwordx4 v254, s[4:7], s51 offen offset:0 sc1 lds
    s_add_u32 m0, s46, 35840
    s_nop 0
    buffer_load_dwordx4 v254, s[4:7], s51 offen offset:1024 sc1 lds
    s_add_u32 m0, s46, 38912
    s_nop 0
    buffer_load_dwordx4 v254, s[4:7], s51 offen offset:2048 sc1 lds
    s_add_u32 m0, s46, 41984
    s_nop 0
    buffer_load_dwordx4 v254, s[4:7], s51 offen offset:3072 sc1 lds
    s_add_u32 s51, s51, 4096
    s_add_u32 m0, s46, 49152
    s_nop 0
    buffer_load_dwordx4 v254, s[4:7], s51 offen offset:0 sc1 lds
    s_add_u32 m0, s46, 52224
    s_nop 0
    buffer_load_dwordx4 v254, s[4:7], s51 offen offset:1024 sc1 lds
    s_lshl_b32 s62, s40, 11
    s_add_u32 m0, s62, 86016
    s_nop 0
    buffer_load_dwordx4 v254, s[32:35], s62 offen offset:0 sc1 lds
    buffer_load_dwordx4 v254, s[32:35], s62 offen offset:1024 sc1 lds
    buffer_load_dwordx4 v[108:111], v2, s[8:11], s53 offen offset:0 sc1
    buffer_load_dwordx4 v[112:115], v2, s[8:11], s53 offen offset:64 sc1
    buffer_load_dwordx4 v[116:119], v2, s[8:11], s53 offen offset:128 sc1
    buffer_load_dwordx4 v[120:123], v2, s[8:11], s53 offen offset:192 sc1
    s_waitcnt vmcnt(13)
    s_barrier
    ds_read_b128 v[12:15], v254 offset:0
    ds_read_b128 v[16:19], v254 offset:1024
    ds_read_b128 v[20:23], v254 offset:2048
    ds_read_b128 v[24:27], v254 offset:3072
    s_waitcnt lgkmcnt(0)
    v_mfma_f32_16x16x32_bf16 v[44:47], a[0:3], v[12:15], 0
    ds_read_b128 v[28:31], v254 offset:4096
    ds_read_b128 v[32:35], v254 offset:5120
    v_mfma_f32_16x16x32_bf16 v[48:51], a[0:3], v[16:19], 0
    ds_read_b128 v[36:39], v254 offset:6144
    ds_read_b128 v[40:43], v254 offset:7168
    v_mfma_f32_16x16x32_bf16 v[52:55], a[0:3], v[20:23], 0
    v_mfma_f32_16x16x32_bf16 v[56:59], a[0:3], v[24:27], 0
    v_mfma_f32_16x16x32_bf16 v[60:63], a[4:7], v[12:15], 0
    v_mfma_f32_16x16x32_bf16 v[64:67], a[4:7], v[16:19], 0
    v_mfma_f32_16x16x32_bf16 v[68:71], a[4:7], v[20:23], 0
    v_mfma_f32_16x16x32_bf16 v[72:75], a[4:7], v[24:27], 0
    v_mfma_f32_16x16x32_bf16 v[76:79], a[8:11], v[12:15], 0
    v_mfma_f32_16x16x32_bf16 v[80:83], a[8:11], v[16:19], 0
    v_mfma_f32_16x16x32_bf16 v[84:87], a[8:11], v[20:23], 0
    v_mfma_f32_16x16x32_bf16 v[88:91], a[8:11], v[24:27], 0
    v_mfma_f32_16x16x32_bf16 v[92:95], a[12:15], v[12:15], 0
    v_mfma_f32_16x16x32_bf16 v[96:99], a[12:15], v[16:19], 0
    v_mfma_f32_16x16x32_bf16 v[100:103], a[12:15], v[20:23], 0
    v_mfma_f32_16x16x32_bf16 v[104:107], a[12:15], v[24:27], 0
    s_waitcnt lgkmcnt(0)
    v_mfma_f32_16x16x32_bf16 v[44:47], a[16:19], v[28:31], v[44:47]
    ds_read_b128 v[12:15], v254 offset:8192
    ds_read_b128 v[16:19], v254 offset:9216
    v_mfma_f32_16x16x32_bf16 v[48:51], a[16:19], v[32:35], v[48:51]
    buffer_load_dwordx4 a[0:3], v254, s[24:27], s56 offen offset:0 sc1
    v_mfma_f32_16x16x32_bf16 v[52:55], a[16:19], v[36:39], v[52:55]
    ds_read_b128 v[20:23], v254 offset:10240
    ds_read_b128 v[24:27], v254 offset:11264
    v_mfma_f32_16x16x32_bf16 v[56:59], a[16:19], v[40:43], v[56:59]
    v_mfma_f32_16x16x32_bf16 v[60:63], a[20:23], v[28:31], v[60:63]
    v_mfma_f32_16x16x32_bf16 v[64:67], a[20:23], v[32:35], v[64:67]
    buffer_load_dwordx4 a[4:7], v254, s[24:27], s56 offen offset:1024 sc1
    v_mfma_f32_16x16x32_bf16 v[68:71], a[20:23], v[36:39], v[68:71]
    v_mfma_f32_16x16x32_bf16 v[72:75], a[20:23], v[40:43], v[72:75]
    v_mfma_f32_16x16x32_bf16 v[76:79], a[24:27], v[28:31], v[76:79]
    v_mfma_f32_16x16x32_bf16 v[80:83], a[24:27], v[32:35], v[80:83]
    buffer_load_dwordx4 a[8:11], v254, s[24:27], s56 offen offset:2048 sc1
    v_mfma_f32_16x16x32_bf16 v[84:87], a[24:27], v[36:39], v[84:87]
    v_mfma_f32_16x16x32_bf16 v[88:91], a[24:27], v[40:43], v[88:91]
    v_mfma_f32_16x16x32_bf16 v[92:95], a[28:31], v[28:31], v[92:95]
    v_mfma_f32_16x16x32_bf16 v[96:99], a[28:31], v[32:35], v[96:99]
    buffer_load_dwordx4 a[12:15], v254, s[24:27], s56 offen offset:3072 sc1
    v_mfma_f32_16x16x32_bf16 v[100:103], a[28:31], v[36:39], v[100:103]
    s_add_u32 s56, s56, 4096
    v_mfma_f32_16x16x32_bf16 v[104:107], a[28:31], v[40:43], v[104:107]
    s_waitcnt lgkmcnt(0)
    v_mfma_f32_16x16x32_bf16 v[44:47], a[32:35], v[12:15], v[44:47]
    ds_read_b128 v[28:31], v254 offset:12288
    ds_read_b128 v[32:35], v254 offset:13312
    v_mfma_f32_16x16x32_bf16 v[48:51], a[32:35], v[16:19], v[48:51]
    buffer_load_dwordx4 a[16:19], v254, s[24:27], s56 offen offset:0 sc1
    v_mfma_f32_16x16x32_bf16 v[52:55], a[32:35], v[20:23], v[52:55]
    ds_read_b128 v[36:39], v254 offset:14336
    ds_read_b128 v[40:43], v254 offset:15360
    v_mfma_f32_16x16x32_bf16 v[56:59], a[32:35], v[24:27], v[56:59]
    v_mfma_f32_16x16x32_bf16 v[60:63], a[36:39], v[12:15], v[60:63]
    v_mfma_f32_16x16x32_bf16 v[64:67], a[36:39], v[16:19], v[64:67]
    buffer_load_dwordx4 a[20:23], v254, s[24:27], s56 offen offset:1024 sc1
    v_mfma_f32_16x16x32_bf16 v[68:71], a[36:39], v[20:23], v[68:71]
    v_mfma_f32_16x16x32_bf16 v[72:75], a[36:39], v[24:27], v[72:75]
    v_mfma_f32_16x16x32_bf16 v[76:79], a[40:43], v[12:15], v[76:79]
    v_mfma_f32_16x16x32_bf16 v[80:83], a[40:43], v[16:19], v[80:83]
    buffer_load_dwordx4 a[24:27], v254, s[24:27], s56 offen offset:2048 sc1
    v_mfma_f32_16x16x32_bf16 v[84:87], a[40:43], v[20:23], v[84:87]
    v_mfma_f32_16x16x32_bf16 v[88:91], a[40:43], v[24:27], v[88:91]
    v_mfma_f32_16x16x32_bf16 v[92:95], a[44:47], v[12:15], v[92:95]
    v_mfma_f32_16x16x32_bf16 v[96:99], a[44:47], v[16:19], v[96:99]
    buffer_load_dwordx4 a[28:31], v254, s[24:27], s56 offen offset:3072 sc1
    v_mfma_f32_16x16x32_bf16 v[100:103], a[44:47], v[20:23], v[100:103]
    s_add_u32 s56, s56, 4096
    v_mfma_f32_16x16x32_bf16 v[104:107], a[44:47], v[24:27], v[104:107]
    s_waitcnt lgkmcnt(0)
    v_mfma_f32_16x16x32_bf16 v[44:47], a[48:51], v[28:31], v[44:47]
    ds_read_b128 v[12:15], v254 offset:16384
    ds_read_b128 v[16:19], v254 offset:17408
    v_mfma_f32_16x16x32_bf16 v[48:51], a[48:51], v[32:35], v[48:51]
    buffer_load_dwordx4 a[32:35], v254, s[24:27], s56 offen offset:0 sc1
    v_mfma_f32_16x16x32_bf16 v[52:55], a[48:51], v[36:39], v[52:55]
    ds_read_b128 v[20:23], v254 offset:18432
    ds_read_b128 v[24:27], v254 offset:19456
    v_mfma_f32_16x16x32_bf16 v[56:59], a[48:51], v[40:43], v[56:59]
    v_mfma_f32_16x16x32_bf16 v[60:63], a[52:55], v[28:31], v[60:63]
    v_mfma_f32_16x16x32_bf16 v[64:67], a[52:55], v[32:35], v[64:67]
    buffer_load_dwordx4 a[36:39], v254, s[24:27], s56 offen offset:1024 sc1
    v_mfma_f32_16x16x32_bf16 v[68:71], a[52:55], v[36:39], v[68:71]
    v_mfma_f32_16x16x32_bf16 v[72:75], a[52:55], v[40:43], v[72:75]
    v_mfma_f32_16x16x32_bf16 v[76:79], a[56:59], v[28:31], v[76:79]
    v_mfma_f32_16x16x32_bf16 v[80:83], a[56:59], v[32:35], v[80:83]
    buffer_load_dwordx4 a[40:43], v254, s[24:27], s56 offen offset:2048 sc1
    v_mfma_f32_16x16x32_bf16 v[84:87], a[56:59], v[36:39], v[84:87]
    v_mfma_f32_16x16x32_bf16 v[88:91], a[56:59], v[40:43], v[88:91]
    v_mfma_f32_16x16x32_bf16 v[92:95], a[60:63], v[28:31], v[92:95]
    v_mfma_f32_16x16x32_bf16 v[96:99], a[60:63], v[32:35], v[96:99]
    buffer_load_dwordx4 a[44:47], v254, s[24:27], s56 offen offset:3072 sc1
    v_mfma_f32_16x16x32_bf16 v[100:103], a[60:63], v[36:39], v[100:103]
    s_add_u32 s56, s56, 4096
    v_mfma_f32_16x16x32_bf16 v[104:107], a[60:63], v[40:43], v[104:107]
    s_waitcnt lgkmcnt(0)
    v_mfma_f32_16x16x32_bf16 v[44:47], a[64:67], v[12:15], v[44:47]
    ds_read_b128 v[28:31], v254 offset:20480
    ds_read_b128 v[32:35], v254 offset:21504
    v_mfma_f32_16x16x32_bf16 v[48:51], a[64:67], v[16:19], v[48:51]
    buffer_load_dwordx4 a[48:51], v254, s[24:27], s56 offen offset:0 sc1
    v_mfma_f32_16x16x32_bf16 v[52:55], a[64:67], v[20:23], v[52:55]
    ds_read_b128 v[36:39], v254 offset:22528
    ds_read_b128 v[40:43], v254 offset:23552
    v_mfma_f32_16x16x32_bf16 v[56:59], a[64:67], v[24:27], v[56:59]
    v_mfma_f32_16x16x32_bf16 v[60:63], a[68:71], v[12:15], v[60:63]
    v_mfma_f32_16x16x32_bf16 v[64:67], a[68:71], v[16:19], v[64:67]
    buffer_load_dwordx4 a[52:55], v254, s[24:27], s56 offen offset:1024 sc1
    v_mfma_f32_16x16x32_bf16 v[68:71], a[68:71], v[20:23], v[68:71]
    v_mfma_f32_16x16x32_bf16 v[72:75], a[68:71], v[24:27], v[72:75]
    v_mfma_f32_16x16x32_bf16 v[76:79], a[72:75], v[12:15], v[76:79]
    v_mfma_f32_16x16x32_bf16 v[80:83], a[72:75], v[16:19], v[80:83]
    buffer_load_dwordx4 a[56:59], v254, s[24:27], s56 offen offset:2048 sc1
    v_mfma_f32_16x16x32_bf16 v[84:87], a[72:75], v[20:23], v[84:87]
    v_mfma_f32_16x16x32_bf16 v[88:91], a[72:75], v[24:27], v[88:91]
    v_mfma_f32_16x16x32_bf16 v[92:95], a[76:79], v[12:15], v[92:95]
    v_mfma_f32_16x16x32_bf16 v[96:99], a[76:79], v[16:19], v[96:99]
    buffer_load_dwordx4 a[60:63], v254, s[24:27], s56 offen offset:3072 sc1
    v_mfma_f32_16x16x32_bf16 v[100:103], a[76:79], v[20:23], v[100:103]
    s_add_u32 s56, s56, 4096
    v_mfma_f32_16x16x32_bf16 v[104:107], a[76:79], v[24:27], v[104:107]
    s_waitcnt vmcnt(20)
    s_barrier
    s_waitcnt lgkmcnt(0)
    v_mfma_f32_16x16x32_bf16 v[44:47], a[80:83], v[28:31], v[44:47]
    ds_read_b128 v[12:15], v254 offset:24576
    ds_read_b128 v[16:19], v254 offset:25600
    v_mfma_f32_16x16x32_bf16 v[48:51], a[80:83], v[32:35], v[48:51]
    buffer_load_dwordx4 a[64:67], v254, s[24:27], s56 offen offset:0 sc1
    v_mfma_f32_16x16x32_bf16 v[52:55], a[80:83], v[36:39], v[52:55]
    ds_read_b128 v[20:23], v254 offset:26624
    ds_read_b128 v[24:27], v254 offset:27648
    v_mfma_f32_16x16x32_bf16 v[56:59], a[80:83], v[40:43], v[56:59]
    ds_read_b64 v[144:145], v3 offset:0
    ds_read_b64 v[146:147], v3 offset:512
    v_mfma_f32_16x16x32_bf16 v[60:63], a[84:87], v[28:31], v[60:63]
    ds_read_b64 v[148:149], v3 offset:1024
    ds_read_b64 v[150:151], v3 offset:1536
    v_mfma_f32_16x16x32_bf16 v[64:67], a[84:87], v[32:35], v[64:67]
    buffer_load_dwordx4 a[68:71], v254, s[24:27], s56 offen offset:1024 sc1
    v_mfma_f32_16x16x32_bf16 v[68:71], a[84:87], v[36:39], v[68:71]
    ds_read_b64 v[152:153], v3 offset:2048
    ds_read_b64 v[154:155], v3 offset:2560
    v_mfma_f32_16x16x32_bf16 v[72:75], a[84:87], v[40:43], v[72:75]
    ds_read_b64 v[156:157], v3 offset:3072
    v_mfma_f32_16x16x32_bf16 v[76:79], a[88:91], v[28:31], v[76:79]
    v_mfma_f32_16x16x32_bf16 v[80:83], a[88:91], v[32:35], v[80:83]
    buffer_load_dwordx4 a[72:75], v254, s[24:27], s56 offen offset:2048 sc1
    v_mfma_f32_16x16x32_bf16 v[84:87], a[88:91], v[36:39], v[84:87]
    v_mfma_f32_16x16x32_bf16 v[88:91], a[88:91], v[40:43], v[88:91]
    v_mfma_f32_16x16x32_bf16 v[92:95], a[92:95], v[28:31], v[92:95]
    v_mfma_f32_16x16x32_bf16 v[96:99], a[92:95], v[32:35], v[96:99]
    buffer_load_dwordx4 a[76:79], v254, s[24:27], s56 offen offset:3072 sc1
    v_mfma_f32_16x16x32_bf16 v[100:103], a[92:95], v[36:39], v[100:103]
    s_add_u32 s56, s56, 4096
    v_mfma_f32_16x16x32_bf16 v[104:107], a[92:95], v[40:43], v[104:107]
    s_waitcnt lgkmcnt(7)
    v_mfma_f32_16x16x32_bf16 v[44:47], a[96:99], v[12:15], v[44:47]
    ds_read_b128 v[28:31], v254 offset:28672
    ds_read_b128 v[32:35], v254 offset:29696
    v_mfma_f32_16x16x32_bf16 v[48:51], a[96:99], v[16:19], v[48:51]
    buffer_load_dwordx4 a[80:83], v254, s[24:27], s56 offen offset:0 sc1
    v_mfma_f32_16x16x32_bf16 v[52:55], a[96:99], v[20:23], v[52:55]
    ds_read_b128 v[36:39], v254 offset:30720
    ds_read_b128 v[40:43], v254 offset:31744
    v_mfma_f32_16x16x32_bf16 v[56:59], a[96:99], v[24:27], v[56:59]
    ds_read_b64 v[158:159], v3 offset:3584
    ds_read_b64 v[160:161], v3 offset:4096
    v_mfma_f32_16x16x32_bf16 v[60:63], a[100:103], v[12:15], v[60:63]
    ds_read_b64 v[162:163], v3 offset:4608
    ds_read_b64 v[164:165], v3 offset:5120
    v_mfma_f32_16x16x32_bf16 v[64:67], a[100:103], v[16:19], v[64:67]
    buffer_load_dwordx4 a[84:87], v254, s[24:27], s56 offen offset:1024 sc1
    v_mfma_f32_16x16x32_bf16 v[68:71], a[100:103], v[20:23], v[68:71]
    ds_read_b64 v[166:167], v3 offset:5632
    ds_read_b64 v[168:169], v3 offset:6144
    v_mfma_f32_16x16x32_bf16 v[72:75], a[100:103], v[24:27], v[72:75]
    ds_read_b64 v[170:171], v3 offset:6656
    v_mfma_f32_16x16x32_bf16 v[76:79], a[104:107], v[12:15], v[76:79]
    v_mfma_f32_16x16x32_bf16 v[80:83], a[104:107], v[16:19], v[80:83]
    buffer_load_dwordx4 a[88:91], v254, s[24:27], s56 offen offset:2048 sc1
    v_mfma_f32_16x16x32_bf16 v[84:87], a[104:107], v[20:23], v[84:87]
    v_mfma_f32_16x16x32_bf16 v[88:91], a[104:107], v[24:27], v[88:91]
    v_mfma_f32_16x16x32_bf16 v[92:95], a[108:111], v[12:15], v[92:95]
    v_mfma_f32_16x16x32_bf16 v[96:99], a[108:111], v[16:19], v[96:99]
    buffer_load_dwordx4 a[92:95], v254, s[24:27], s56 offen offset:3072 sc1
    v_mfma_f32_16x16x32_bf16 v[100:103], a[108:111], v[20:23], v[100:103]
    s_add_u32 s56, s56, 4096
    v_mfma_f32_16x16x32_bf16 v[104:107], a[108:111], v[24:27], v[104:107]
    s_waitcnt lgkmcnt(7)
    v_mfma_f32_16x16x32_bf16 v[44:47], a[112:115], v[28:31], v[44:47]
    ds_read_b128 v[12:15], v254 offset:32768
    ds_read_b128 v[16:19], v254 offset:33792
    v_mfma_f32_16x16x32_bf16 v[48:51], a[112:115], v[32:35], v[48:51]
    buffer_load_dwordx4 a[96:99], v254, s[24:27], s56 offen offset:0 sc1
    v_mfma_f32_16x16x32_bf16 v[52:55], a[112:115], v[36:39], v[52:55]
    ds_read_b128 v[20:23], v254 offset:34816
    ds_read_b128 v[24:27], v254 offset:35840
    v_mfma_f32_16x16x32_bf16 v[56:59], a[112:115], v[40:43], v[56:59]
    v_mfma_f32_16x16x32_bf16 v[60:63], a[116:119], v[28:31], v[60:63]
    v_mfma_f32_16x16x32_bf16 v[64:67], a[116:119], v[32:35], v[64:67]
    buffer_load_dwordx4 a[100:103], v254, s[24:27], s56 offen offset:1024 sc1
    v_mfma_f32_16x16x32_bf16 v[68:71], a[116:119], v[36:39], v[68:71]
    v_mfma_f32_16x16x32_bf16 v[72:75], a[116:119], v[40:43], v[72:75]
    v_mfma_f32_16x16x32_bf16 v[76:79], a[120:123], v[28:31], v[76:79]
    v_mfma_f32_16x16x32_bf16 v[80:83], a[120:123], v[32:35], v[80:83]
    buffer_load_dwordx4 a[104:107], v254, s[24:27], s56 offen offset:2048 sc1
    v_mfma_f32_16x16x32_bf16 v[84:87], a[120:123], v[36:39], v[84:87]
    v_mfma_f32_16x16x32_bf16 v[88:91], a[120:123], v[40:43], v[88:91]
    v_mfma_f32_16x16x32_bf16 v[92:95], a[124:127], v[28:31], v[92:95]
    v_mfma_f32_16x16x32_bf16 v[96:99], a[124:127], v[32:35], v[96:99]
    buffer_load_dwordx4 a[108:111], v254, s[24:27], s56 offen offset:3072 sc1
    v_mfma_f32_16x16x32_bf16 v[100:103], a[124:127], v[36:39], v[100:103]
    s_add_u32 s56, s56, 4096
    v_mfma_f32_16x16x32_bf16 v[104:107], a[124:127], v[40:43], v[104:107]
    s_waitcnt lgkmcnt(0)
    v_mfma_f32_16x16x32_bf16 v[44:47], a[128:131], v[12:15], v[44:47]
    ds_read_b128 v[28:31], v254 offset:36864
    ds_read_b128 v[32:35], v254 offset:37888
    v_mfma_f32_16x16x32_bf16 v[48:51], a[128:131], v[16:19], v[48:51]
    buffer_load_dwordx4 a[112:115], v254, s[24:27], s56 offen offset:0 sc1
    v_mfma_f32_16x16x32_bf16 v[52:55], a[128:131], v[20:23], v[52:55]
    ds_read_b128 v[36:39], v254 offset:38912
    ds_read_b128 v[40:43], v254 offset:39936
    v_mfma_f32_16x16x32_bf16 v[56:59], a[128:131], v[24:27], v[56:59]
    v_add_f32 v140, v144, v146
    v_mfma_f32_16x16x32_bf16 v[60:63], a[132:135], v[12:15], v[60:63]
    v_add_f32 v141, v145, v147
    v_add_f32 v140, v140, v148
    v_mfma_f32_16x16x32_bf16 v[64:67], a[132:135], v[16:19], v[64:67]
    buffer_load_dwordx4 a[116:119], v254, s[24:27], s56 offen offset:1024 sc1
    v_mfma_f32_16x16x32_bf16 v[68:71], a[132:135], v[20:23], v[68:71]
    v_add_f32 v141, v141, v149
    v_add_f32 v140, v140, v150
    v_mfma_f32_16x16x32_bf16 v[72:75], a[132:135], v[24:27], v[72:75]
    v_add_f32 v141, v141, v151
    v_add_f32 v140, v140, v152
    v_mfma_f32_16x16x32_bf16 v[76:79], a[136:139], v[12:15], v[76:79]
    v_add_f32 v141, v141, v153
    v_add_f32 v140, v140, v154
    v_mfma_f32_16x16x32_bf16 v[80:83], a[136:139], v[16:19], v[80:83]
    buffer_load_dwordx4 a[120:123], v254, s[24:27], s56 offen offset:2048 sc1
    v_mfma_f32_16x16x32_bf16 v[84:87], a[136:139], v[20:23], v[84:87]
    v_add_f32 v141, v141, v155
    v_add_f32 v140, v140, v156
    v_mfma_f32_16x16x32_bf16 v[88:91], a[136:139], v[24:27], v[88:91]
    v_mfma_f32_16x16x32_bf16 v[92:95], a[140:143], v[12:15], v[92:95]
    v_mfma_f32_16x16x32_bf16 v[96:99], a[140:143], v[16:19], v[96:99]
    buffer_load_dwordx4 a[124:127], v254, s[24:27], s56 offen offset:3072 sc1
    v_mfma_f32_16x16x32_bf16 v[100:103], a[140:143], v[20:23], v[100:103]
    s_add_u32 s56, s56, 4096
    v_mfma_f32_16x16x32_bf16 v[104:107], a[140:143], v[24:27], v[104:107]
    s_waitcnt lgkmcnt(0)
    v_mfma_f32_16x16x32_bf16 v[44:47], a[144:147], v[28:31], v[44:47]
    ds_read_b128 v[12:15], v254 offset:40960
    ds_read_b128 v[16:19], v254 offset:41984
    v_mfma_f32_16x16x32_bf16 v[48:51], a[144:147], v[32:35], v[48:51]
    buffer_load_dwordx4 a[128:131], v254, s[24:27], s56 offen offset:0 sc1
    v_mfma_f32_16x16x32_bf16 v[52:55], a[144:147], v[36:39], v[52:55]
    ds_read_b128 v[20:23], v254 offset:43008
    ds_read_b128 v[24:27], v254 offset:44032
    v_mfma_f32_16x16x32_bf16 v[56:59], a[144:147], v[40:43], v[56:59]
    v_add_f32 v141, v141, v157
    v_add_f32 v140, v140, v158
    v_mfma_f32_16x16x32_bf16 v[60:63], a[148:151], v[28:31], v[60:63]
    v_add_f32 v141, v141, v159
    v_add_f32 v140, v140, v160
    v_mfma_f32_16x16x32_bf16 v[64:67], a[148:151], v[32:35], v[64:67]
    buffer_load_dwordx4 a[132:135], v254, s[24:27], s56 offen offset:1024 sc1
    v_mfma_f32_16x16x32_bf16 v[68:71], a[148:151], v[36:39], v[68:71]
    v_add_f32 v141, v141, v161
    v_add_f32 v140, v140, v162
    v_mfma_f32_16x16x32_bf16 v[72:75], a[148:151], v[40:43], v[72:75]
    v_add_f32 v141, v141, v163
    v_add_f32 v140, v140, v164
    v_mfma_f32_16x16x32_bf16 v[76:79], a[152:155], v[28:31], v[76:79]
    v_add_f32 v141, v141, v165
    v_add_f32 v140, v140, v166
    v_mfma_f32_16x16x32_bf16 v[80:83], a[152:155], v[32:35], v[80:83]
    buffer_load_dwordx4 a[136:139], v254, s[24:27], s56 offen offset:2048 sc1
    v_mfma_f32_16x16x32_bf16 v[84:87], a[152:155], v[36:39], v[84:87]
    v_add_f32 v141, v141, v167
    v_add_f32 v140, v140, v168
    v_mfma_f32_16x16x32_bf16 v[88:91], a[152:155], v[40:43], v[88:91]
    v_mfma_f32_16x16x32_bf16 v[92:95], a[156:159], v[28:31], v[92:95]
    v_mfma_f32_16x16x32_bf16 v[96:99], a[156:159], v[32:35], v[96:99]
    buffer_load_dwordx4 a[140:143], v254, s[24:27], s56 offen offset:3072 sc1
    v_mfma_f32_16x16x32_bf16 v[100:103], a[156:159], v[36:39], v[100:103]
    s_add_u32 s56, s56, 4096
    v_mfma_f32_16x16x32_bf16 v[104:107], a[156:159], v[40:43], v[104:107]
    s_waitcnt lgkmcnt(0)
    v_mfma_f32_16x16x32_bf16 v[44:47], a[160:163], v[12:15], v[44:47]
    ds_read_b128 v[28:31], v254 offset:45056
    ds_read_b128 v[32:35], v254 offset:46080
    v_mfma_f32_16x16x32_bf16 v[48:51], a[160:163], v[16:19], v[48:51]
    buffer_load_dwordx4 a[144:147], v254, s[24:27], s56 offen offset:0 sc1
    v_mfma_f32_16x16x32_bf16 v[52:55], a[160:163], v[20:23], v[52:55]
    ds_read_b128 v[36:39], v254 offset:47104
    ds_read_b128 v[40:43], v254 offset:48128
    v_mfma_f32_16x16x32_bf16 v[56:59], a[160:163], v[24:27], v[56:59]
    v_add_f32 v141, v141, v169
    v_add_f32 v140, v140, v170
    v_mfma_f32_16x16x32_bf16 v[60:63], a[164:167], v[12:15], v[60:63]
    v_add_f32 v141, v141, v171
    v_mul_f32 v142, 0xbb124925, v140
    v_mfma_f32_16x16x32_bf16 v[64:67], a[164:167], v[16:19], v[64:67]
    buffer_load_dwordx4 a[148:151], v254, s[24:27], s56 offen offset:1024 sc1
    v_mfma_f32_16x16x32_bf16 v[68:71], a[164:167], v[20:23], v[68:71]
    v_mov_b32 v143, 0x3727c5ac
    v_fmac_f32 v143, 0x3b124925, v141
    v_mfma_f32_16x16x32_bf16 v[72:75], a[164:167], v[24:27], v[72:75]
    v_fma_f32 v143, -v142, v142, v143
    v_max_f32 v143, 0x3727c5ac, v143
    v_mfma_f32_16x16x32_bf16 v[76:79], a[168:171], v[12:15], v[76:79]
    v_rsq_f32 v140, v143
    s_nop 0
    v_mfma_f32_16x16x32_bf16 v[80:83], a[168:171], v[16:19], v[80:83]
    buffer_load_dwordx4 a[152:155], v254, s[24:27], s56 offen offset:2048 sc1
    v_mfma_f32_16x16x32_bf16 v[84:87], a[168:171], v[20:23], v[84:87]
    v_mul_f32 v141, v142, v140
    ds_write_b64 v4, v[140:141]
    v_mfma_f32_16x16x32_bf16 v[88:91], a[168:171], v[24:27], v[88:91]
    v_mfma_f32_16x16x32_bf16 v[92:95], a[172:175], v[12:15], v[92:95]
    v_mfma_f32_16x16x32_bf16 v[96:99], a[172:175], v[16:19], v[96:99]
    buffer_load_dwordx4 a[156:159], v254, s[24:27], s56 offen offset:3072 sc1
    v_mfma_f32_16x16x32_bf16 v[100:103], a[172:175], v[20:23], v[100:103]
    s_add_u32 s56, s56, 4096
    v_mfma_f32_16x16x32_bf16 v[104:107], a[172:175], v[24:27], v[104:107]
    s_waitcnt lgkmcnt(1)
    v_mfma_f32_16x16x32_bf16 v[44:47], a[176:179], v[28:31], v[44:47]
    ds_read_b128 v[12:15], v254 offset:49152
    ds_read_b128 v[16:19], v254 offset:50176
    v_mfma_f32_16x16x32_bf16 v[48:51], a[176:179], v[32:35], v[48:51]
    buffer_load_dwordx4 a[160:163], v254, s[24:27], s56 offen offset:0 sc1
    v_mfma_f32_16x16x32_bf16 v[52:55], a[176:179], v[36:39], v[52:55]
    ds_read_b128 v[20:23], v254 offset:51200
    ds_read_b128 v[24:27], v254 offset:52224
    v_mfma_f32_16x16x32_bf16 v[56:59], a[176:179], v[40:43], v[56:59]
    v_mfma_f32_16x16x32_bf16 v[60:63], a[180:183], v[28:31], v[60:63]
    v_mfma_f32_16x16x32_bf16 v[64:67], a[180:183], v[32:35], v[64:67]
    buffer_load_dwordx4 a[164:167], v254, s[24:27], s56 offen offset:1024 sc1
    v_mfma_f32_16x16x32_bf16 v[68:71], a[180:183], v[36:39], v[68:71]
    v_mfma_f32_16x16x32_bf16 v[72:75], a[180:183], v[40:43], v[72:75]
    v_mfma_f32_16x16x32_bf16 v[76:79], a[184:187], v[28:31], v[76:79]
    v_mfma_f32_16x16x32_bf16 v[80:83], a[184:187], v[32:35], v[80:83]
    buffer_load_dwordx4 a[168:171], v254, s[24:27], s56 offen offset:2048 sc1
    v_mfma_f32_16x16x32_bf16 v[84:87], a[184:187], v[36:39], v[84:87]
    v_mfma_f32_16x16x32_bf16 v[88:91], a[184:187], v[40:43], v[88:91]
    v_mfma_f32_16x16x32_bf16 v[92:95], a[188:191], v[28:31], v[92:95]
    v_mfma_f32_16x16x32_bf16 v[96:99], a[188:191], v[32:35], v[96:99]
    buffer_load_dwordx4 a[172:175], v254, s[24:27], s56 offen offset:3072 sc1
    v_mfma_f32_16x16x32_bf16 v[100:103], a[188:191], v[36:39], v[100:103]
    s_add_u32 s56, s56, 4096
    v_mfma_f32_16x16x32_bf16 v[104:107], a[188:191], v[40:43], v[104:107]
    s_waitcnt lgkmcnt(0)
    v_mfma_f32_16x16x32_bf16 v[44:47], a[192:195], v[12:15], v[44:47]
    ds_read_b128 v[28:31], v254 offset:53248
    ds_read_b128 v[32:35], v254 offset:54272
    v_mfma_f32_16x16x32_bf16 v[48:51], a[192:195], v[16:19], v[48:51]
    buffer_load_dwordx4 a[176:179], v254, s[24:27], s56 offen offset:0 sc1
    v_mfma_f32_16x16x32_bf16 v[52:55], a[192:195], v[20:23], v[52:55]
    ds_read_b128 v[36:39], v254 offset:55296
    ds_read_b128 v[40:43], v254 offset:56320
    v_mfma_f32_16x16x32_bf16 v[56:59], a[192:195], v[24:27], v[56:59]
    ds_read_b64 v[124:125], v5 offset:0
    v_mfma_f32_16x16x32_bf16 v[60:63], a[196:199], v[12:15], v[60:63]
    ds_read_b64 v[126:127], v5 offset:128
    ds_read_b64 v[128:129], v5 offset:256
    v_mfma_f32_16x16x32_bf16 v[64:67], a[196:199], v[16:19], v[64:67]
    buffer_load_dwordx4 a[180:183], v254, s[24:27], s56 offen offset:1024 sc1
    v_mfma_f32_16x16x32_bf16 v[68:71], a[196:199], v[20:23], v[68:71]
    ds_read_b64 v[130:131], v5 offset:384
    v_mfma_f32_16x16x32_bf16 v[72:75], a[196:199], v[24:27], v[72:75]
    v_mfma_f32_16x16x32_bf16 v[76:79], a[200:203], v[12:15], v[76:79]
    v_mfma_f32_16x16x32_bf16 v[80:83], a[200:203], v[16:19], v[80:83]
    buffer_load_dwordx4 a[184:187], v254, s[24:27], s56 offen offset:2048 sc1
    v_mfma_f32_16x16x32_bf16 v[84:87], a[200:203], v[20:23], v[84:87]
    v_mfma_f32_16x16x32_bf16 v[88:91], a[200:203], v[24:27], v[88:91]
    v_mfma_f32_16x16x32_bf16 v[92:95], a[204:207], v[12:15], v[92:95]
    v_mfma_f32_16x16x32_bf16 v[96:99], a[204:207], v[16:19], v[96:99]
    buffer_load_dwordx4 a[188:191], v254, s[24:27], s56 offen offset:3072 sc1
    v_mfma_f32_16x16x32_bf16 v[100:103], a[204:207], v[20:23], v[100:103]
    s_add_u32 s56, s56, 4096
    v_mfma_f32_16x16x32_bf16 v[104:107], a[204:207], v[24:27], v[104:107]
    s_waitcnt lgkmcnt(4)
    v_mfma_f32_16x16x32_bf16 v[44:47], a[208:211], v[28:31], v[44:47]
    v_mfma_f32_16x16x32_bf16 v[48:51], a[208:211], v[32:35], v[48:51]
    v_mfma_f32_16x16x32_bf16 v[52:55], a[208:211], v[36:39], v[52:55]
    v_mfma_f32_16x16x32_bf16 v[56:59], a[208:211], v[40:43], v[56:59]
    v_mfma_f32_16x16x32_bf16 v[60:63], a[212:215], v[28:31], v[60:63]
    v_mfma_f32_16x16x32_bf16 v[64:67], a[212:215], v[32:35], v[64:67]
    v_mfma_f32_16x16x32_bf16 v[68:71], a[212:215], v[36:39], v[68:71]
    v_mfma_f32_16x16x32_bf16 v[72:75], a[212:215], v[40:43], v[72:75]
    v_mfma_f32_16x16x32_bf16 v[76:79], a[216:219], v[28:31], v[76:79]
    v_mfma_f32_16x16x32_bf16 v[80:83], a[216:219], v[32:35], v[80:83]
    v_mfma_f32_16x16x32_bf16 v[84:87], a[216:219], v[36:39], v[84:87]
    v_mfma_f32_16x16x32_bf16 v[88:91], a[216:219], v[40:43], v[88:91]
    v_mfma_f32_16x16x32_bf16 v[92:95], a[220:223], v[28:31], v[92:95]
    v_mfma_f32_16x16x32_bf16 v[96:99], a[220:223], v[32:35], v[96:99]
    v_mfma_f32_16x16x32_bf16 v[100:103], a[220:223], v[36:39], v[100:103]
    v_mfma_f32_16x16x32_bf16 v[104:107], a[220:223], v[40:43], v[104:107]
    s_waitcnt lgkmcnt(0)
    s_waitcnt vmcnt(48)
    v_mov_b32 v12, 0xc0135761
    v_mov_b32 v14, 0xbdd2d3e8
    v_mov_b32 v132, v125
    v_mov_b32 v134, v127
    v_mov_b32 v136, v129
    v_mov_b32 v138, v131
    v_pk_mul_f32 v[44:45], v[44:45], v[124:125] op_sel_hi:[1,0]
    v_pk_mul_f32 v[46:47], v[46:47], v[124:125] op_sel_hi:[1,0]
    v_pk_mul_f32 v[48:49], v[48:49], v[126:127] op_sel_hi:[1,0]
    v_pk_mul_f32 v[50:51], v[50:51], v[126:127] op_sel_hi:[1,0]
    v_pk_mul_f32 v[52:53], v[52:53], v[128:129] op_sel_hi:[1,0]
    v_pk_mul_f32 v[54:55], v[54:55], v[128:129] op_sel_hi:[1,0]
    v_pk_mul_f32 v[56:57], v[56:57], v[130:131] op_sel_hi:[1,0]
    v_pk_mul_f32 v[58:59], v[58:59], v[130:131] op_sel_hi:[1,0]
    v_pk_mul_f32 v[60:61], v[60:61], v[124:125] op_sel_hi:[1,0]
    v_pk_mul_f32 v[62:63], v[62:63], v[124:125] op_sel_hi:[1,0]
    v_pk_mul_f32 v[64:65], v[64:65], v[126:127] op_sel_hi:[1,0]
    v_pk_mul_f32 v[66:67], v[66:67], v[126:127] op_sel_hi:[1,0]
    v_pk_mul_f32 v[68:69], v[68:69], v[128:129] op_sel_hi:[1,0]
    v_pk_mul_f32 v[70:71], v[70:71], v[128:129] op_sel_hi:[1,0]
    v_pk_mul_f32 v[72:73], v[72:73], v[130:131] op_sel_hi:[1,0]
    v_pk_mul_f32 v[74:75], v[74:75], v[130:131] op_sel_hi:[1,0]
    v_pk_fma_f32 v[44:45], v[108:109], v[132:133], v[44:45] op_sel_hi:[1,0,1]
    v_pk_fma_f32 v[46:47], v[110:111], v[132:133], v[46:47] op_sel_hi:[1,0,1]
    v_pk_fma_f32 v[48:49], v[108:109], v[134:135], v[48:49] op_sel_hi:[1,0,1]
    v_pk_fma_f32 v[50:51], v[110:111], v[134:135], v[50:51] op_sel_hi:[1,0,1]
    v_pk_fma_f32 v[52:53], v[108:109], v[136:137], v[52:53] op_sel_hi:[1,0,1]
    v_pk_fma_f32 v[54:55], v[110:111], v[136:137], v[54:55] op_sel_hi:[1,0,1]
    v_pk_fma_f32 v[56:57], v[108:109], v[138:139], v[56:57] op_sel_hi:[1,0,1]
    v_pk_fma_f32 v[58:59], v[110:111], v[138:139], v[58:59] op_sel_hi:[1,0,1]
    v_pk_fma_f32 v[60:61], v[112:113], v[132:133], v[60:61] op_sel_hi:[1,0,1]
    v_pk_fma_f32 v[62:63], v[114:115], v[132:133], v[62:63] op_sel_hi:[1,0,1]
    v_pk_fma_f32 v[64:65], v[112:113], v[134:135], v[64:65] op_sel_hi:[1,0,1]
    v_pk_fma_f32 v[66:67], v[114:115], v[134:135], v[66:67] op_sel_hi:[1,0,1]
    v_pk_fma_f32 v[68:69], v[112:113], v[136:137], v[68:69] op_sel_hi:[1,0,1]
    v_pk_fma_f32 v[70:71], v[114:115], v[136:137], v[70:71] op_sel_hi:[1,0,1]
    v_pk_fma_f32 v[72:73], v[112:113], v[138:139], v[72:73] op_sel_hi:[1,0,1]
    v_pk_fma_f32 v[74:75], v[114:115], v[138:139], v[74:75] op_sel_hi:[1,0,1]
    v_pk_mul_f32 v[140:141], v[44:45], v[44:45]
    v_pk_mul_f32 v[142:143], v[46:47], v[46:47]
    v_pk_mul_f32 v[144:145], v[48:49], v[48:49]
    v_pk_mul_f32 v[146:147], v[50:51], v[50:51]
    v_pk_mul_f32 v[148:149], v[52:53], v[52:53]
    v_pk_mul_f32 v[150:151], v[54:55], v[54:55]
    v_pk_mul_f32 v[152:153], v[56:57], v[56:57]
    v_pk_mul_f32 v[154:155], v[58:59], v[58:59]
    v_pk_mul_f32 v[156:157], v[60:61], v[60:61]
    v_pk_mul_f32 v[158:159], v[62:63], v[62:63]
    v_pk_mul_f32 v[160:161], v[64:65], v[64:65]
    v_pk_mul_f32 v[162:163], v[66:67], v[66:67]
    v_pk_mul_f32 v[164:165], v[68:69], v[68:69]
    v_pk_mul_f32 v[166:167], v[70:71], v[70:71]
    v_pk_mul_f32 v[168:169], v[72:73], v[72:73]
    v_pk_mul_f32 v[170:171], v[74:75], v[74:75]
    v_pk_fma_f32 v[140:141], v[140:141], v[14:15], v[12:13] op_sel_hi:[1,0,0]
    v_pk_fma_f32 v[142:143], v[142:143], v[14:15], v[12:13] op_sel_hi:[1,0,0]
    v_pk_fma_f32 v[144:145], v[144:145], v[14:15], v[12:13] op_sel_hi:[1,0,0]
    v_pk_fma_f32 v[146:147], v[146:147], v[14:15], v[12:13] op_sel_hi:[1,0,0]
    v_pk_fma_f32 v[148:149], v[148:149], v[14:15], v[12:13] op_sel_hi:[1,0,0]
    v_pk_fma_f32 v[150:151], v[150:151], v[14:15], v[12:13] op_sel_hi:[1,0,0]
    v_pk_fma_f32 v[152:153], v[152:153], v[14:15], v[12:13] op_sel_hi:[1,0,0]
    v_pk_fma_f32 v[154:155], v[154:155], v[14:15], v[12:13] op_sel_hi:[1,0,0]
    v_pk_fma_f32 v[156:157], v[156:157], v[14:15], v[12:13] op_sel_hi:[1,0,0]
    v_pk_fma_f32 v[158:159], v[158:159], v[14:15], v[12:13] op_sel_hi:[1,0,0]
    v_pk_fma_f32 v[160:161], v[160:161], v[14:15], v[12:13] op_sel_hi:[1,0,0]
    v_pk_fma_f32 v[162:163], v[162:163], v[14:15], v[12:13] op_sel_hi:[1,0,0]
    v_pk_fma_f32 v[164:165], v[164:165], v[14:15], v[12:13] op_sel_hi:[1,0,0]
    v_pk_fma_f32 v[166:167], v[166:167], v[14:15], v[12:13] op_sel_hi:[1,0,0]
    v_pk_fma_f32 v[168:169], v[168:169], v[14:15], v[12:13] op_sel_hi:[1,0,0]
    v_pk_fma_f32 v[170:171], v[170:171], v[14:15], v[12:13] op_sel_hi:[1,0,0]
    v_pk_mul_f32 v[140:141], v[140:141], v[44:45]
    v_pk_mul_f32 v[142:143], v[142:143], v[46:47]
    v_pk_mul_f32 v[144:145], v[144:145], v[48:49]
    v_pk_mul_f32 v[146:147], v[146:147], v[50:51]
    v_pk_mul_f32 v[148:149], v[148:149], v[52:53]
    v_pk_mul_f32 v[150:151], v[150:151], v[54:55]
    v_pk_mul_f32 v[152:153], v[152:153], v[56:57]
    v_pk_mul_f32 v[154:155], v[154:155], v[58:59]
    v_pk_mul_f32 v[156:157], v[156:157], v[60:61]
    v_pk_mul_f32 v[158:159], v[158:159], v[62:63]
    v_pk_mul_f32 v[160:161], v[160:161], v[64:65]
    v_pk_mul_f32 v[162:163], v[162:163], v[66:67]
    v_pk_mul_f32 v[164:165], v[164:165], v[68:69]
    v_pk_mul_f32 v[166:167], v[166:167], v[70:71]
    v_pk_mul_f32 v[168:169], v[168:169], v[72:73]
    v_pk_mul_f32 v[170:171], v[170:171], v[74:75]
    v_exp_f32 v140, v140
    v_exp_f32 v141, v141
    v_exp_f32 v142, v142
    v_exp_f32 v143, v143
    v_exp_f32 v144, v144
    v_exp_f32 v145, v145
    v_exp_f32 v146, v146
    v_exp_f32 v147, v147
    v_exp_f32 v148, v148
    v_exp_f32 v149, v149
    v_exp_f32 v150, v150
    v_exp_f32 v151, v151
    v_exp_f32 v152, v152
    v_exp_f32 v153, v153
    v_exp_f32 v154, v154
    v_exp_f32 v155, v155
    v_exp_f32 v156, v156
    v_exp_f32 v157, v157
    v_exp_f32 v158, v158
    v_exp_f32 v159, v159
    v_exp_f32 v160, v160
    v_exp_f32 v161, v161
    v_exp_f32 v162, v162
    v_exp_f32 v163, v163
    v_exp_f32 v164, v164
    v_exp_f32 v165, v165
    v_exp_f32 v166, v166
    v_exp_f32 v167, v167
    v_exp_f32 v168, v168
    v_exp_f32 v169, v169
    v_exp_f32 v170, v170
    v_exp_f32 v171, v171
    v_mov_b32 v16, 1.0
    v_pk_add_f32 v[140:141], v[140:141], v[16:17] op_sel_hi:[1,0]
    v_pk_add_f32 v[142:143], v[142:143], v[16:17] op_sel_hi:[1,0]
    v_pk_add_f32 v[144:145], v[144:145], v[16:17] op_sel_hi:[1,0]
    v_pk_add_f32 v[146:147], v[146:147], v[16:17] op_sel_hi:[1,0]
    v_pk_add_f32 v[148:149], v[148:149], v[16:17] op_sel_hi:[1,0]
    v_pk_add_f32 v[150:151], v[150:151], v[16:17] op_sel_hi:[1,0]
    v_pk_add_f32 v[152:153], v[152:153], v[16:17] op_sel_hi:[1,0]
    v_pk_add_f32 v[154:155], v[154:155], v[16:17] op_sel_hi:[1,0]
    v_pk_add_f32 v[156:157], v[156:157], v[16:17] op_sel_hi:[1,0]
    v_pk_add_f32 v[158:159], v[158:159], v[16:17] op_sel_hi:[1,0]
    v_pk_add_f32 v[160:161], v[160:161], v[16:17] op_sel_hi:[1,0]
    v_pk_add_f32 v[162:163], v[162:163], v[16:17] op_sel_hi:[1,0]
    v_pk_add_f32 v[164:165], v[164:165], v[16:17] op_sel_hi:[1,0]
    v_pk_add_f32 v[166:167], v[166:167], v[16:17] op_sel_hi:[1,0]
    v_pk_add_f32 v[168:169], v[168:169], v[16:17] op_sel_hi:[1,0]
    v_pk_add_f32 v[170:171], v[170:171], v[16:17] op_sel_hi:[1,0]
    v_rcp_f32 v140, v140
    v_rcp_f32 v141, v141
    v_rcp_f32 v142, v142
    v_rcp_f32 v143, v143
    v_rcp_f32 v144, v144
    v_rcp_f32 v145, v145
    v_rcp_f32 v146, v146
    v_rcp_f32 v147, v147
    v_rcp_f32 v148, v148
    v_rcp_f32 v149, v149
    v_rcp_f32 v150, v150
    v_rcp_f32 v151, v151
    v_rcp_f32 v152, v152
    v_rcp_f32 v153, v153
    v_rcp_f32 v154, v154
    v_rcp_f32 v155, v155
    v_rcp_f32 v156, v156
    v_rcp_f32 v157, v157
    v_rcp_f32 v158, v158
    v_rcp_f32 v159, v159
    v_rcp_f32 v160, v160
    v_rcp_f32 v161, v161
    v_rcp_f32 v162, v162
    v_rcp_f32 v163, v163
    v_rcp_f32 v164, v164
    v_rcp_f32 v165, v165
    v_rcp_f32 v166, v166
    v_rcp_f32 v167, v167
    v_rcp_f32 v168, v168
    v_rcp_f32 v169, v169
    v_rcp_f32 v170, v170
    v_rcp_f32 v171, v171
    v_pk_mul_f32 v[44:45], v[44:45], v[140:141]
    v_pk_mul_f32 v[46:47], v[46:47], v[142:143]
    v_pk_mul_f32 v[48:49], v[48:49], v[144:145]
    v_pk_mul_f32 v[50:51], v[50:51], v[146:147]
    v_pk_mul_f32 v[52:53], v[52:53], v[148:149]
    v_pk_mul_f32 v[54:55], v[54:55], v[150:151]
    v_pk_mul_f32 v[56:57], v[56:57], v[152:153]
    v_pk_mul_f32 v[58:59], v[58:59], v[154:155]
    v_pk_mul_f32 v[60:61], v[60:61], v[156:157]
    v_pk_mul_f32 v[62:63], v[62:63], v[158:159]
    v_pk_mul_f32 v[64:65], v[64:65], v[160:161]
    v_pk_mul_f32 v[66:67], v[66:67], v[162:163]
    v_pk_mul_f32 v[68:69], v[68:69], v[164:165]
    v_pk_mul_f32 v[70:71], v[70:71], v[166:167]
    v_pk_mul_f32 v[72:73], v[72:73], v[168:169]
    v_pk_mul_f32 v[74:75], v[74:75], v[170:171]
    v_cvt_pk_bf16_f32 v172, v44, v45
    v_cvt_pk_bf16_f32 v173, v46, v47
    v_cvt_pk_bf16_f32 v174, v60, v61
    v_cvt_pk_bf16_f32 v175, v62, v63
    buffer_store_dwordx4 v[172:175], v254, s[36:39], s57 offen offset:0 sc1
    v_cvt_pk_bf16_f32 v176, v48, v49
    v_cvt_pk_bf16_f32 v177, v50, v51
    v_cvt_pk_bf16_f32 v178, v64, v65
    v_cvt_pk_bf16_f32 v179, v66, v67
    buffer_store_dwordx4 v[176:179], v254, s[36:39], s57 offen offset:1024 sc1
    v_cvt_pk_bf16_f32 v180, v52, v53
    v_cvt_pk_bf16_f32 v181, v54, v55
    v_cvt_pk_bf16_f32 v182, v68, v69
    v_cvt_pk_bf16_f32 v183, v70, v71
    buffer_store_dwordx4 v[180:183], v254, s[36:39], s57 offen offset:2048 sc1
    v_cvt_pk_bf16_f32 v184, v56, v57
    v_cvt_pk_bf16_f32 v185, v58, v59
    v_cvt_pk_bf16_f32 v186, v72, v73
    v_cvt_pk_bf16_f32 v187, v74, v75
    buffer_store_dwordx4 v[184:187], v254, s[36:39], s57 offen offset:3072 sc1
    v_pk_mul_f32 v[76:77], v[76:77], v[124:125] op_sel_hi:[1,0]
    v_pk_mul_f32 v[78:79], v[78:79], v[124:125] op_sel_hi:[1,0]
    v_pk_mul_f32 v[80:81], v[80:81], v[126:127] op_sel_hi:[1,0]
    v_pk_mul_f32 v[82:83], v[82:83], v[126:127] op_sel_hi:[1,0]
    v_pk_mul_f32 v[84:85], v[84:85], v[128:129] op_sel_hi:[1,0]
    v_pk_mul_f32 v[86:87], v[86:87], v[128:129] op_sel_hi:[1,0]
    v_pk_mul_f32 v[88:89], v[88:89], v[130:131] op_sel_hi:[1,0]
    v_pk_mul_f32 v[90:91], v[90:91], v[130:131] op_sel_hi:[1,0]
    v_pk_mul_f32 v[92:93], v[92:93], v[124:125] op_sel_hi:[1,0]
    v_pk_mul_f32 v[94:95], v[94:95], v[124:125] op_sel_hi:[1,0]
    v_pk_mul_f32 v[96:97], v[96:97], v[126:127] op_sel_hi:[1,0]
    v_pk_mul_f32 v[98:99], v[98:99], v[126:127] op_sel_hi:[1,0]
    v_pk_mul_f32 v[100:101], v[100:101], v[128:129] op_sel_hi:[1,0]
    v_pk_mul_f32 v[102:103], v[102:103], v[128:129] op_sel_hi:[1,0]
    v_pk_mul_f32 v[104:105], v[104:105], v[130:131] op_sel_hi:[1,0]
    v_pk_mul_f32 v[106:107], v[106:107], v[130:131] op_sel_hi:[1,0]
    v_pk_fma_f32 v[76:77], v[116:117], v[132:133], v[76:77] op_sel_hi:[1,0,1]
    v_pk_fma_f32 v[78:79], v[118:119], v[132:133], v[78:79] op_sel_hi:[1,0,1]
    v_pk_fma_f32 v[80:81], v[116:117], v[134:135], v[80:81] op_sel_hi:[1,0,1]
    v_pk_fma_f32 v[82:83], v[118:119], v[134:135], v[82:83] op_sel_hi:[1,0,1]
    v_pk_fma_f32 v[84:85], v[116:117], v[136:137], v[84:85] op_sel_hi:[1,0,1]
    v_pk_fma_f32 v[86:87], v[118:119], v[136:137], v[86:87] op_sel_hi:[1,0,1]
    v_pk_fma_f32 v[88:89], v[116:117], v[138:139], v[88:89] op_sel_hi:[1,0,1]
    v_pk_fma_f32 v[90:91], v[118:119], v[138:139], v[90:91] op_sel_hi:[1,0,1]
    v_pk_fma_f32 v[92:93], v[120:121], v[132:133], v[92:93] op_sel_hi:[1,0,1]
    v_pk_fma_f32 v[94:95], v[122:123], v[132:133], v[94:95] op_sel_hi:[1,0,1]
    v_pk_fma_f32 v[96:97], v[120:121], v[134:135], v[96:97] op_sel_hi:[1,0,1]
    v_pk_fma_f32 v[98:99], v[122:123], v[134:135], v[98:99] op_sel_hi:[1,0,1]
    v_pk_fma_f32 v[100:101], v[120:121], v[136:137], v[100:101] op_sel_hi:[1,0,1]
    v_pk_fma_f32 v[102:103], v[122:123], v[136:137], v[102:103] op_sel_hi:[1,0,1]
    v_pk_fma_f32 v[104:105], v[120:121], v[138:139], v[104:105] op_sel_hi:[1,0,1]
    v_pk_fma_f32 v[106:107], v[122:123], v[138:139], v[106:107] op_sel_hi:[1,0,1]
    v_pk_mul_f32 v[140:141], v[76:77], v[76:77]
    v_pk_mul_f32 v[142:143], v[78:79], v[78:79]
    v_pk_mul_f32 v[144:145], v[80:81], v[80:81]
    v_pk_mul_f32 v[146:147], v[82:83], v[82:83]
    v_pk_mul_f32 v[148:149], v[84:85], v[84:85]
    v_pk_mul_f32 v[150:151], v[86:87], v[86:87]
    v_pk_mul_f32 v[152:153], v[88:89], v[88:89]
    v_pk_mul_f32 v[154:155], v[90:91], v[90:91]
    v_pk_mul_f32 v[156:157], v[92:93], v[92:93]
    v_pk_mul_f32 v[158:159], v[94:95], v[94:95]
    v_pk_mul_f32 v[160:161], v[96:97], v[96:97]
    v_pk_mul_f32 v[162:163], v[98:99], v[98:99]
    v_pk_mul_f32 v[164:165], v[100:101], v[100:101]
    v_pk_mul_f32 v[166:167], v[102:103], v[102:103]
    v_pk_mul_f32 v[168:169], v[104:105], v[104:105]
    v_pk_mul_f32 v[170:171], v[106:107], v[106:107]
    v_pk_fma_f32 v[140:141], v[140:141], v[14:15], v[12:13] op_sel_hi:[1,0,0]
    v_pk_fma_f32 v[142:143], v[142:143], v[14:15], v[12:13] op_sel_hi:[1,0,0]
    v_pk_fma_f32 v[144:145], v[144:145], v[14:15], v[12:13] op_sel_hi:[1,0,0]
    v_pk_fma_f32 v[146:147], v[146:147], v[14:15], v[12:13] op_sel_hi:[1,0,0]
    v_pk_fma_f32 v[148:149], v[148:149], v[14:15], v[12:13] op_sel_hi:[1,0,0]
    v_pk_fma_f32 v[150:151], v[150:151], v[14:15], v[12:13] op_sel_hi:[1,0,0]
    v_pk_fma_f32 v[152:153], v[152:153], v[14:15], v[12:13] op_sel_hi:[1,0,0]
    v_pk_fma_f32 v[154:155], v[154:155], v[14:15], v[12:13] op_sel_hi:[1,0,0]
    v_pk_fma_f32 v[156:157], v[156:157], v[14:15], v[12:13] op_sel_hi:[1,0,0]
    v_pk_fma_f32 v[158:159], v[158:159], v[14:15], v[12:13] op_sel_hi:[1,0,0]
    v_pk_fma_f32 v[160:161], v[160:161], v[14:15], v[12:13] op_sel_hi:[1,0,0]
    v_pk_fma_f32 v[162:163], v[162:163], v[14:15], v[12:13] op_sel_hi:[1,0,0]
    v_pk_fma_f32 v[164:165], v[164:165], v[14:15], v[12:13] op_sel_hi:[1,0,0]
    v_pk_fma_f32 v[166:167], v[166:167], v[14:15], v[12:13] op_sel_hi:[1,0,0]
    v_pk_fma_f32 v[168:169], v[168:169], v[14:15], v[12:13] op_sel_hi:[1,0,0]
    v_pk_fma_f32 v[170:171], v[170:171], v[14:15], v[12:13] op_sel_hi:[1,0,0]
    v_pk_mul_f32 v[140:141], v[140:141], v[76:77]
    v_pk_mul_f32 v[142:143], v[142:143], v[78:79]
    v_pk_mul_f32 v[144:145], v[144:145], v[80:81]
    v_pk_mul_f32 v[146:147], v[146:147], v[82:83]
    v_pk_mul_f32 v[148:149], v[148:149], v[84:85]
    v_pk_mul_f32 v[150:151], v[150:151], v[86:87]
    v_pk_mul_f32 v[152:153], v[152:153], v[88:89]
    v_pk_mul_f32 v[154:155], v[154:155], v[90:91]
    v_pk_mul_f32 v[156:157], v[156:157], v[92:93]
    v_pk_mul_f32 v[158:159], v[158:159], v[94:95]
    v_pk_mul_f32 v[160:161], v[160:161], v[96:97]
    v_pk_mul_f32 v[162:163], v[162:163], v[98:99]
    v_pk_mul_f32 v[164:165], v[164:165], v[100:101]
    v_pk_mul_f32 v[166:167], v[166:167], v[102:103]
    v_pk_mul_f32 v[168:169], v[168:169], v[104:105]
    v_pk_mul_f32 v[170:171], v[170:171], v[106:107]
    v_exp_f32 v140, v140
    v_exp_f32 v141, v141
    v_exp_f32 v142, v142
    v_exp_f32 v143, v143
    v_exp_f32 v144, v144
    v_exp_f32 v145, v145
    v_exp_f32 v146, v146
    v_exp_f32 v147, v147
    v_exp_f32 v148, v148
    v_exp_f32 v149, v149
    v_exp_f32 v150, v150
    v_exp_f32 v151, v151
    v_exp_f32 v152, v152
    v_exp_f32 v153, v153
    v_exp_f32 v154, v154
    v_exp_f32 v155, v155
    v_exp_f32 v156, v156
    v_exp_f32 v157, v157
    v_exp_f32 v158, v158
    v_exp_f32 v159, v159
    v_exp_f32 v160, v160
    v_exp_f32 v161, v161
    v_exp_f32 v162, v162
    v_exp_f32 v163, v163
    v_exp_f32 v164, v164
    v_exp_f32 v165, v165
    v_exp_f32 v166, v166
    v_exp_f32 v167, v167
    v_exp_f32 v168, v168
    v_exp_f32 v169, v169
    v_exp_f32 v170, v170
    v_exp_f32 v171, v171
    v_mov_b32 v16, 1.0
    v_pk_add_f32 v[140:141], v[140:141], v[16:17] op_sel_hi:[1,0]
    v_pk_add_f32 v[142:143], v[142:143], v[16:17] op_sel_hi:[1,0]
    v_pk_add_f32 v[144:145], v[144:145], v[16:17] op_sel_hi:[1,0]
    v_pk_add_f32 v[146:147], v[146:147], v[16:17] op_sel_hi:[1,0]
    v_pk_add_f32 v[148:149], v[148:149], v[16:17] op_sel_hi:[1,0]
    v_pk_add_f32 v[150:151], v[150:151], v[16:17] op_sel_hi:[1,0]
    v_pk_add_f32 v[152:153], v[152:153], v[16:17] op_sel_hi:[1,0]
    v_pk_add_f32 v[154:155], v[154:155], v[16:17] op_sel_hi:[1,0]
    v_pk_add_f32 v[156:157], v[156:157], v[16:17] op_sel_hi:[1,0]
    v_pk_add_f32 v[158:159], v[158:159], v[16:17] op_sel_hi:[1,0]
    v_pk_add_f32 v[160:161], v[160:161], v[16:17] op_sel_hi:[1,0]
    v_pk_add_f32 v[162:163], v[162:163], v[16:17] op_sel_hi:[1,0]
    v_pk_add_f32 v[164:165], v[164:165], v[16:17] op_sel_hi:[1,0]
    v_pk_add_f32 v[166:167], v[166:167], v[16:17] op_sel_hi:[1,0]
    v_pk_add_f32 v[168:169], v[168:169], v[16:17] op_sel_hi:[1,0]
    v_pk_add_f32 v[170:171], v[170:171], v[16:17] op_sel_hi:[1,0]
    v_rcp_f32 v140, v140
    v_rcp_f32 v141, v141
    v_rcp_f32 v142, v142
    v_rcp_f32 v143, v143
    v_rcp_f32 v144, v144
    v_rcp_f32 v145, v145
    v_rcp_f32 v146, v146
    v_rcp_f32 v147, v147
    v_rcp_f32 v148, v148
    v_rcp_f32 v149, v149
    v_rcp_f32 v150, v150
    v_rcp_f32 v151, v151
    v_rcp_f32 v152, v152
    v_rcp_f32 v153, v153
    v_rcp_f32 v154, v154
    v_rcp_f32 v155, v155
    v_rcp_f32 v156, v156
    v_rcp_f32 v157, v157
    v_rcp_f32 v158, v158
    v_rcp_f32 v159, v159
    v_rcp_f32 v160, v160
    v_rcp_f32 v161, v161
    v_rcp_f32 v162, v162
    v_rcp_f32 v163, v163
    v_rcp_f32 v164, v164
    v_rcp_f32 v165, v165
    v_rcp_f32 v166, v166
    v_rcp_f32 v167, v167
    v_rcp_f32 v168, v168
    v_rcp_f32 v169, v169
    v_rcp_f32 v170, v170
    v_rcp_f32 v171, v171
    v_pk_mul_f32 v[76:77], v[76:77], v[140:141]
    v_pk_mul_f32 v[78:79], v[78:79], v[142:143]
    v_pk_mul_f32 v[80:81], v[80:81], v[144:145]
    v_pk_mul_f32 v[82:83], v[82:83], v[146:147]
    v_pk_mul_f32 v[84:85], v[84:85], v[148:149]
    v_pk_mul_f32 v[86:87], v[86:87], v[150:151]
    v_pk_mul_f32 v[88:89], v[88:89], v[152:153]
    v_pk_mul_f32 v[90:91], v[90:91], v[154:155]
    v_pk_mul_f32 v[92:93], v[92:93], v[156:157]
    v_pk_mul_f32 v[94:95], v[94:95], v[158:159]
    v_pk_mul_f32 v[96:97], v[96:97], v[160:161]
    v_pk_mul_f32 v[98:99], v[98:99], v[162:163]
    v_pk_mul_f32 v[100:101], v[100:101], v[164:165]
    v_pk_mul_f32 v[102:103], v[102:103], v[166:167]
    v_pk_mul_f32 v[104:105], v[104:105], v[168:169]
    v_pk_mul_f32 v[106:107], v[106:107], v[170:171]
    v_cvt_pk_bf16_f32 v188, v76, v77
    v_cvt_pk_bf16_f32 v189, v78, v79
    v_cvt_pk_bf16_f32 v190, v92, v93
    v_cvt_pk_bf16_f32 v191, v94, v95
    buffer_store_dwordx4 v[188:191], v254, s[36:39], s58 offen offset:0 sc1
    v_cvt_pk_bf16_f32 v192, v80, v81
    v_cvt_pk_bf16_f32 v193, v82, v83
    v_cvt_pk_bf16_f32 v194, v96, v97
    v_cvt_pk_bf16_f32 v195, v98, v99
    buffer_store_dwordx4 v[192:195], v254, s[36:39], s58 offen offset:1024 sc1
    v_cvt_pk_bf16_f32 v196, v84, v85
    v_cvt_pk_bf16_f32 v197, v86, v87
    v_cvt_pk_bf16_f32 v198, v100, v101
    v_cvt_pk_bf16_f32 v199, v102, v103
    buffer_store_dwordx4 v[196:199], v254, s[36:39], s58 offen offset:2048 sc1
    v_cvt_pk_bf16_f32 v200, v88, v89
    v_cvt_pk_bf16_f32 v201, v90, v91
    v_cvt_pk_bf16_f32 v202, v104, v105
    v_cvt_pk_bf16_f32 v203, v106, v107
    buffer_store_dwordx4 v[200:203], v254, s[36:39], s58 offen offset:3072 sc1
    s_load_dwordx2 s[72:73], s[0:1], 96
    v_lshrrev_b32 v96, 4, v254
    v_and_b32 v99, 15, v96
    v_lshrrev_b32 v98, 4, v96
    s_and_b32 s63, s64, 3
    s_lshl_b32 s63, s63, 6
    s_lshr_b32 s62, s64, 2
    s_add_u32 s62, s62, s63
    v_and_b32 v100, 7, v96
    v_lshlrev_b32 v100, 3, v100
    v_add_lshl_u32 v0, v100, s62, 7
    s_mov_b64 s[44:45], 0xff
    s_mul_i32 s62, s64, 229376
    s_add_u32 s62, s62, 22085632
    s_add_u32 s4, s86, s62
    s_addc_u32 s5, s87, 0
    s_mov_b32 s6, 229376
    s_mov_b32 s7, 0x20000
    s_add_u32 s8, s86, 14745600
    s_addc_u32 s9, s87, 0
    s_mov_b32 s10, 1835008
    s_mov_b32 s11, 0x20000
    s_add_u32 s32, s86, 8960
    s_addc_u32 s33, s87, 0
    s_mov_b32 s34, 1792
    s_mov_b32 s35, 0x20000
    s_mul_i32 s62, s64, 56
    s_lshl_b32 s63, s65, 1
    s_add_u32 s62, s62, s63
    s_lshr_b32 s63, s40, 1
    s_add_u32 s62, s62, s63
    s_lshl_b32 s62, s62, 10
    s_and_b32 s46, s40, 1
    s_lshl_b32 s46, s46, 3
    s_add_u32 s62, s62, s46
    v_add_u32 v2, s62, v254
    s_lshl_b32 s63, s63, 10
    s_add_u32 s63, s63, s46
    s_add_u32 s63, s63, 155648
    v_add_u32 v4, s63, v254
    s_lshl_b32 s62, s65, 8
    s_lshl_b32 s63, s40, 6
    s_add_u32 s62, s62, s63
    v_lshl_add_u32 v3, v98, 4, s62
    v_mul_u32_u24 v100, 144, v99
    v_lshl_add_u32 v100, v98, 3, v100
    s_lshl_b32 s62, s40, 5
    s_add_u32 s62, s62, 143360
    v_add_u32 v5, s62, v100
    s_lshl_b32 s62, s40, 3
    v_lshrrev_b32 v100, 3, v96
    v_add_u32 v100, s62, v100
    v_and_b32 v101, 7, v96
    v_lshlrev_b32 v101, 4, v101
    v_mul_u32_u24 v102, 144, v100
    v_add3_u32 v8, v102, v101, 0
    v_add_u32 v8, 143360, v8
    s_mul_i32 s62, s64, 57344
    s_lshl_b32 s63, s65, 7
    s_add_u32 s62, s62, s63
    v_mul_u32_u24 v102, 896, v100
    v_add3_u32 v6, v102, v101, s62
    v_add_u32 v7, 28672, v6
    v_mov_b32 v9, v254
    v_add_u32 v10, 57344, v254
    v_add_u32 v11, 114688, v254
    s_mul_i32 s46, s40, 7168
    s_mov_b32 s58, 0
    s_mov_b32 s59, 14336
    s_mov_b32 s60, 28672
    s_mov_b32 s61, 43008
    s_waitcnt lgkmcnt(0)
    s_waitcnt vmcnt(0)
    s_barrier
    s_cmp_lg_u32 s40, 0
    s_cbranch_scc1 L_m4_nf
    v_mov_b32 v252, 0
    v_mov_b32 v253, 1
    s_lshl_b32 s62, s2, 7
    buffer_store_dword v253, v252, s[16:19], s62 offen offset:12 sc1
L_m4_nf:
    s_cmp_ge_u32 s2, 224
    s_cbranch_scc1 L_k2_fin
    s_mov_b32 s24, s72
    s_mov_b32 s25, s73
    s_mov_b32 s26, 1835008
    s_mov_b32 s27, 0x20000
    buffer_load_dwordx2 v[12:13], v2, s[8:11], s58 offen sc1
    buffer_load_dwordx2 v[14:15], v2, s[8:11], s59 offen sc1
    buffer_load_dwordx2 v[16:17], v2, s[8:11], s60 offen sc1
    buffer_load_dwordx2 v[18:19], v2, s[8:11], s61 offen sc1
    buffer_load_dwordx4 v[20:23], v3, s[32:35], 0 offen sc1
    ds_read_b64 v[24:25], v4 offset:0
    ds_read_b64 v[26:27], v4 offset:2048
    ds_read_b64 v[28:29], v4 offset:4096
    ds_read_b64 v[30:31], v4 offset:6144
    s_cmp_lg_u32 s40, 1
    s_cbranch_scc1 L_m4_ok
    s_mov_b32 s50, 0
L_m4_p:
    buffer_load_dword v248, v0, s[16:19], 0 offen offset:12 sc1
    s_waitcnt vmcnt(0)
    v_cmp_ne_u32 vcc, 0, v248
    s_add_u32 s50, s50, 1
    s_and_b64 vcc, vcc, s[44:45]
    s_cmp_eq_u64 vcc, s[44:45]
    s_cbranch_scc1 L_m4_ok
    s_cmp_lt_u32 s50, 0x200000
    s_cbranch_scc1 L_m4_p
L_m4_ok:
    s_waitcnt vmcnt(0)
    s_barrier
    s_mov_b32 s47, s46
    s_add_u32 s48, s46, 4096
    s_add_u32 m0, s46, 0
    s_nop 0
    buffer_load_dwordx4 v254, s[4:7], s47 offen offset:0 sc1 lds
    buffer_load_dwordx4 v254, s[4:7], s47 offen offset:1024 sc1 lds
    buffer_load_dwordx4 v254, s[4:7], s47 offen offset:2048 sc1 lds
    buffer_load_dwordx4 v254, s[4:7], s47 offen offset:3072 sc1 lds
    s_add_u32 m0, s46, 4096
    s_nop 0
    buffer_load_dwordx4 v254, s[4:7], s48 offen offset:0 sc1 lds
    buffer_load_dwordx4 v254, s[4:7], s48 offen offset:1024 sc1 lds
    buffer_load_dwordx4 v254, s[4:7], s48 offen offset:2048 sc1 lds
    s_add_u32 s47, s47, 28672
    s_add_u32 s48, s48, 28672
    s_add_u32 m0, s46, 28672
    s_nop 0
    buffer_load_dwordx4 v254, s[4:7], s47 offen offset:0 sc1 lds
    buffer_load_dwordx4 v254, s[4:7], s47 offen offset:1024 sc1 lds
    buffer_load_dwordx4 v254, s[4:7], s47 offen offset:2048 sc1 lds
    buffer_load_dwordx4 v254, s[4:7], s47 offen offset:3072 sc1 lds
    s_add_u32 m0, s46, 32768
    s_nop 0
    buffer_load_dwordx4 v254, s[4:7], s48 offen offset:0 sc1 lds
    buffer_load_dwordx4 v254, s[4:7], s48 offen offset:1024 sc1 lds
    buffer_load_dwordx4 v254, s[4:7], s48 offen offset:2048 sc1 lds
    s_add_u32 s47, s47, 28672
    s_add_u32 s48, s48, 28672
    s_add_u32 m0, s46, 57344
    s_nop 0
    buffer_load_dwordx4 v254, s[4:7], s47 offen offset:0 sc1 lds
    buffer_load_dwordx4 v254, s[4:7], s47 offen offset:1024 sc1 lds
    buffer_load_dwordx4 v254, s[4:7], s47 offen offset:2048 sc1 lds
    buffer_load_dwordx4 v254, s[4:7], s47 offen offset:3072 sc1 lds
    s_add_u32 m0, s46, 61440
    s_nop 0
    buffer_load_dwordx4 v254, s[4:7], s48 offen offset:0 sc1 lds
    buffer_load_dwordx4 v254, s[4:7], s48 offen offset:1024 sc1 lds
    buffer_load_dwordx4 v254, s[4:7], s48 offen offset:2048 sc1 lds
    s_add_u32 s47, s47, 28672
    s_add_u32 s48, s48, 28672
    s_waitcnt lgkmcnt(0)
    v_lshlrev_b32 v96, 16, v24
    v_and_b32 v97, 0xffff0000, v24
    v_lshlrev_b32 v98, 16, v25
    v_and_b32 v99, 0xffff0000, v25
    v_lshlrev_b32 v100, 16, v26
    v_and_b32 v101, 0xffff0000, v26
    v_lshlrev_b32 v102, 16, v27
    v_and_b32 v103, 0xffff0000, v27
    v_lshlrev_b32 v104, 16, v28
    v_and_b32 v105, 0xffff0000, v28
    v_lshlrev_b32 v106, 16, v29
    v_and_b32 v107, 0xffff0000, v29
    v_lshlrev_b32 v108, 16, v30
    v_and_b32 v109, 0xffff0000, v30
    v_lshlrev_b32 v110, 16, v31
    v_and_b32 v111, 0xffff0000, v31
    v_lshlrev_b32 v112, 16, v12
    v_and_b32 v113, 0xffff0000, v12
    v_lshlrev_b32 v114, 16, v13
    v_and_b32 v115, 0xffff0000, v13
    v_lshlrev_b32 v116, 16, v14
    v_and_b32 v117, 0xffff0000, v14
    v_lshlrev_b32 v118, 16, v15
    v_and_b32 v119, 0xffff0000, v15
    v_lshlrev_b32 v120, 16, v16
    v_and_b32 v121, 0xffff0000, v16
    v_lshlrev_b32 v122, 16, v17
    v_and_b32 v123, 0xffff0000, v17
    v_lshlrev_b32 v124, 16, v18
    v_and_b32 v125, 0xffff0000, v18
    v_lshlrev_b32 v126, 16, v19
    v_and_b32 v127, 0xffff0000, v19
    s_waitcnt vmcnt(14)
    s_barrier
    ds_read_b128 v[48:51], v9 offset:0
    ds_read_b128 v[52:55], v9 offset:1024
    ds_read_b128 v[56:59], v9 offset:2048
    ds_read_b128 v[60:63], v9 offset:3072
    ds_read_b128 v[64:67], v9 offset:4096
    ds_read_b128 v[68:71], v9 offset:5120
    ds_read_b128 v[72:75], v9 offset:6144
    ds_read_b128 v[76:79], v9 offset:7168
    s_waitcnt lgkmcnt(4)
    v_mfma_f32_16x16x32_bf16 v[32:35], a[224:227], v[48:51], 0
    ds_read_b128 v[80:83], v9 offset:8192
    s_add_u32 m0, s46, 86016
    v_mfma_f32_16x16x32_bf16 v[36:39], a[224:227], v[52:55], 0
    buffer_load_dwordx4 v254, s[4:7], s47 offen offset:0 sc1 lds
    v_mfma_f32_16x16x32_bf16 v[40:43], a[224:227], v[56:59], 0
    ds_read_b128 v[84:87], v9 offset:9216
    ds_read_b128 v[88:91], v9 offset:10240
    v_mfma_f32_16x16x32_bf16 v[44:47], a[224:227], v[60:63], 0
    ds_read_b128 v[92:95], v9 offset:11264
    s_waitcnt lgkmcnt(4)
    v_mfma_f32_16x16x32_bf16 v[32:35], a[228:231], v[64:67], v[32:35]
    ds_read_b128 v[48:51], v9 offset:12288
    v_mfma_f32_16x16x32_bf16 v[36:39], a[228:231], v[68:71], v[36:39]
    buffer_load_dwordx4 v254, s[4:7], s47 offen offset:1024 sc1 lds
    v_mfma_f32_16x16x32_bf16 v[40:43], a[228:231], v[72:75], v[40:43]
    ds_read_b128 v[52:55], v9 offset:13312
    ds_read_b128 v[56:59], v9 offset:14336
    v_mfma_f32_16x16x32_bf16 v[44:47], a[228:231], v[76:79], v[44:47]
    ds_read_b128 v[60:63], v9 offset:15360
    s_waitcnt lgkmcnt(4)
    v_mfma_f32_16x16x32_bf16 v[32:35], a[232:235], v[80:83], v[32:35]
    ds_read_b128 v[64:67], v9 offset:16384
    v_mfma_f32_16x16x32_bf16 v[36:39], a[232:235], v[84:87], v[36:39]
    buffer_load_dwordx4 v254, s[4:7], s47 offen offset:2048 sc1 lds
    v_mfma_f32_16x16x32_bf16 v[40:43], a[232:235], v[88:91], v[40:43]
    ds_read_b128 v[68:71], v9 offset:17408
    ds_read_b128 v[72:75], v9 offset:18432
    v_mfma_f32_16x16x32_bf16 v[44:47], a[232:235], v[92:95], v[44:47]
    ds_read_b128 v[76:79], v9 offset:19456
    s_waitcnt lgkmcnt(4)
    v_mfma_f32_16x16x32_bf16 v[32:35], a[236:239], v[48:51], v[32:35]
    ds_read_b128 v[80:83], v9 offset:20480
    v_mfma_f32_16x16x32_bf16 v[36:39], a[236:239], v[52:55], v[36:39]
    buffer_load_dwordx4 v254, s[4:7], s47 offen offset:3072 sc1 lds
    v_mfma_f32_16x16x32_bf16 v[40:43], a[236:239], v[56:59], v[40:43]
    ds_read_b128 v[84:87], v9 offset:21504
    ds_read_b128 v[88:91], v9 offset:22528
    v_mfma_f32_16x16x32_bf16 v[44:47], a[236:239], v[60:63], v[44:47]
    ds_read_b128 v[92:95], v9 offset:23552
    s_waitcnt lgkmcnt(4)
    v_mfma_f32_16x16x32_bf16 v[32:35], a[240:243], v[64:67], v[32:35]
    ds_read_b128 v[48:51], v9 offset:24576
    s_add_u32 m0, s46, 90112
    v_mfma_f32_16x16x32_bf16 v[36:39], a[240:243], v[68:71], v[36:39]
    buffer_load_dwordx4 v254, s[4:7], s48 offen offset:0 sc1 lds
    v_mfma_f32_16x16x32_bf16 v[40:43], a[240:243], v[72:75], v[40:43]
    ds_read_b128 v[52:55], v9 offset:25600
    ds_read_b128 v[56:59], v9 offset:26624
    v_mfma_f32_16x16x32_bf16 v[44:47], a[240:243], v[76:79], v[44:47]
    ds_read_b128 v[60:63], v9 offset:27648
    s_waitcnt lgkmcnt(4)
    v_mfma_f32_16x16x32_bf16 v[32:35], a[244:247], v[80:83], v[32:35]
    v_mfma_f32_16x16x32_bf16 v[36:39], a[244:247], v[84:87], v[36:39]
    buffer_load_dwordx4 v254, s[4:7], s48 offen offset:1024 sc1 lds
    v_mfma_f32_16x16x32_bf16 v[40:43], a[244:247], v[88:91], v[40:43]
    v_mfma_f32_16x16x32_bf16 v[44:47], a[244:247], v[92:95], v[44:47]
    s_waitcnt lgkmcnt(0)
    v_mfma_f32_16x16x32_bf16 v[32:35], a[248:251], v[48:51], v[32:35]
    v_mfma_f32_16x16x32_bf16 v[36:39], a[248:251], v[52:55], v[36:39]
    buffer_load_dwordx4 v254, s[4:7], s48 offen offset:2048 sc1 lds
    v_mfma_f32_16x16x32_bf16 v[40:43], a[248:251], v[56:59], v[40:43]
    s_add_u32 s47, s47, 28672
    s_add_u32 s48, s48, 28672
    v_mfma_f32_16x16x32_bf16 v[44:47], a[248:251], v[60:63], v[44:47]
    s_waitcnt vmcnt(7)
    s_barrier
    ds_read_b128 v[64:67], v9 offset:28672
    ds_read_b128 v[68:71], v9 offset:29696
    ds_read_b128 v[72:75], v9 offset:30720
    ds_read_b128 v[76:79], v9 offset:31744
    ds_read_b128 v[80:83], v9 offset:32768
    ds_read_b128 v[84:87], v9 offset:33792
    ds_read_b128 v[88:91], v9 offset:34816
    ds_read_b128 v[92:95], v9 offset:35840
    s_waitcnt lgkmcnt(4)
    v_mfma_f32_16x16x32_bf16 v[32:35], a[252:255], v[64:67], v[32:35]
    ds_read_b128 v[48:51], v9 offset:36864
    s_add_u32 m0, s46, 114688
    v_mfma_f32_16x16x32_bf16 v[36:39], a[252:255], v[68:71], v[36:39]
    buffer_load_dwordx4 v254, s[4:7], s47 offen offset:0 sc1 lds
    v_mfma_f32_16x16x32_bf16 v[40:43], a[252:255], v[72:75], v[40:43]
    ds_read_b128 v[52:55], v9 offset:37888
    ds_read_b128 v[56:59], v9 offset:38912
    v_mfma_f32_16x16x32_bf16 v[44:47], a[252:255], v[76:79], v[44:47]
    ds_read_b128 v[60:63], v9 offset:39936
    s_waitcnt lgkmcnt(4)
    v_mfma_f32_16x16x32_bf16 v[32:35], a[0:3], v[80:83], v[32:35]
    ds_read_b128 v[64:67], v9 offset:40960
    v_mfma_f32_16x16x32_bf16 v[36:39], a[0:3], v[84:87], v[36:39]
    buffer_load_dwordx4 v254, s[4:7], s47 offen offset:1024 sc1 lds
    v_mfma_f32_16x16x32_bf16 v[40:43], a[0:3], v[88:91], v[40:43]
    ds_read_b128 v[68:71], v9 offset:41984
    ds_read_b128 v[72:75], v9 offset:43008
    v_mfma_f32_16x16x32_bf16 v[44:47], a[0:3], v[92:95], v[44:47]
    ds_read_b128 v[76:79], v9 offset:44032
    s_waitcnt lgkmcnt(4)
    v_mfma_f32_16x16x32_bf16 v[32:35], a[4:7], v[48:51], v[32:35]
    ds_read_b128 v[80:83], v9 offset:45056
    v_mfma_f32_16x16x32_bf16 v[36:39], a[4:7], v[52:55], v[36:39]
    buffer_load_dwordx4 v254, s[4:7], s47 offen offset:2048 sc1 lds
    v_mfma_f32_16x16x32_bf16 v[40:43], a[4:7], v[56:59], v[40:43]
    ds_read_b128 v[84:87], v9 offset:46080
    ds_read_b128 v[88:91], v9 offset:47104
    v_mfma_f32_16x16x32_bf16 v[44:47], a[4:7], v[60:63], v[44:47]
    ds_read_b128 v[92:95], v9 offset:48128
    s_waitcnt lgkmcnt(4)
    v_mfma_f32_16x16x32_bf16 v[32:35], a[8:11], v[64:67], v[32:35]
    ds_read_b128 v[48:51], v9 offset:49152
    v_mfma_f32_16x16x32_bf16 v[36:39], a[8:11], v[68:71], v[36:39]
    buffer_load_dwordx4 v254, s[4:7], s47 offen offset:3072 sc1 lds
    v_mfma_f32_16x16x32_bf16 v[40:43], a[8:11], v[72:75], v[40:43]
    ds_read_b128 v[52:55], v9 offset:50176
    ds_read_b128 v[56:59], v9 offset:51200
    v_mfma_f32_16x16x32_bf16 v[44:47], a[8:11], v[76:79], v[44:47]
    ds_read_b128 v[60:63], v9 offset:52224
    s_waitcnt lgkmcnt(4)
    v_mfma_f32_16x16x32_bf16 v[32:35], a[12:15], v[80:83], v[32:35]
    ds_read_b128 v[64:67], v9 offset:53248
    s_add_u32 m0, s46, 118784
    v_mfma_f32_16x16x32_bf16 v[36:39], a[12:15], v[84:87], v[36:39]
    buffer_load_dwordx4 v254, s[4:7], s48 offen offset:0 sc1 lds
    v_mfma_f32_16x16x32_bf16 v[40:43], a[12:15], v[88:91], v[40:43]
    ds_read_b128 v[68:71], v9 offset:54272
    ds_read_b128 v[72:75], v9 offset:55296
    v_mfma_f32_16x16x32_bf16 v[44:47], a[12:15], v[92:95], v[44:47]
    ds_read_b128 v[76:79], v9 offset:56320
    s_waitcnt lgkmcnt(4)
    v_mfma_f32_16x16x32_bf16 v[32:35], a[16:19], v[48:51], v[32:35]
    ds_read_b128 v[80:83], v10 offset:0
    v_mfma_f32_16x16x32_bf16 v[36:39], a[16:19], v[52:55], v[36:39]
    buffer_load_dwordx4 v254, s[4:7], s48 offen offset:1024 sc1 lds
    v_mfma_f32_16x16x32_bf16 v[40:43], a[16:19], v[56:59], v[40:43]
    ds_read_b128 v[84:87], v10 offset:1024
    ds_read_b128 v[88:91], v10 offset:2048
    v_mfma_f32_16x16x32_bf16 v[44:47], a[16:19], v[60:63], v[44:47]
    ds_read_b128 v[92:95], v10 offset:3072
    s_waitcnt lgkmcnt(4)
    v_mfma_f32_16x16x32_bf16 v[32:35], a[20:23], v[64:67], v[32:35]
    ds_read_b128 v[48:51], v10 offset:4096
    v_mfma_f32_16x16x32_bf16 v[36:39], a[20:23], v[68:71], v[36:39]
    buffer_load_dwordx4 v254, s[4:7], s48 offen offset:2048 sc1 lds
    v_mfma_f32_16x16x32_bf16 v[40:43], a[20:23], v[72:75], v[40:43]
    ds_read_b128 v[52:55], v10 offset:5120
    ds_read_b128 v[56:59], v10 offset:6144
    s_add_u32 s47, s47, 28672
    s_add_u32 s48, s48, 28672
    v_mfma_f32_16x16x32_bf16 v[44:47], a[20:23], v[76:79], v[44:47]
    ds_read_b128 v[60:63], v10 offset:7168
    s_waitcnt vmcnt(7)
    s_barrier
    s_waitcnt lgkmcnt(4)
    v_mfma_f32_16x16x32_bf16 v[32:35], a[24:27], v[80:83], v[32:35]
    ds_read_b128 v[64:67], v10 offset:8192
    s_add_u32 m0, s46, 0
    v_mfma_f32_16x16x32_bf16 v[36:39], a[24:27], v[84:87], v[36:39]
    buffer_load_dwordx4 v254, s[4:7], s47 offen offset:0 sc1 lds
    v_mfma_f32_16x16x32_bf16 v[40:43], a[24:27], v[88:91], v[40:43]
    ds_read_b128 v[68:71], v10 offset:9216
    ds_read_b128 v[72:75], v10 offset:10240
    v_mfma_f32_16x16x32_bf16 v[44:47], a[24:27], v[92:95], v[44:47]
    ds_read_b128 v[76:79], v10 offset:11264
    s_waitcnt lgkmcnt(4)
    v_mfma_f32_16x16x32_bf16 v[32:35], a[28:31], v[48:51], v[32:35]
    ds_read_b128 v[80:83], v10 offset:12288
    v_mfma_f32_16x16x32_bf16 v[36:39], a[28:31], v[52:55], v[36:39]
    buffer_load_dwordx4 v254, s[4:7], s47 offen offset:1024 sc1 lds
    v_mfma_f32_16x16x32_bf16 v[40:43], a[28:31], v[56:59], v[40:43]
    ds_read_b128 v[84:87], v10 offset:13312
    ds_read_b128 v[88:91], v10 offset:14336
    v_mfma_f32_16x16x32_bf16 v[44:47], a[28:31], v[60:63], v[44:47]
    ds_read_b128 v[92:95], v10 offset:15360
    s_waitcnt lgkmcnt(4)
    v_mfma_f32_16x16x32_bf16 v[32:35], a[32:35], v[64:67], v[32:35]
    ds_read_b128 v[48:51], v10 offset:16384
    v_mfma_f32_16x16x32_bf16 v[36:39], a[32:35], v[68:71], v[36:39]
    buffer_load_dwordx4 v254, s[4:7], s47 offen offset:2048 sc1 lds
    v_mfma_f32_16x16x32_bf16 v[40:43], a[32:35], v[72:75], v[40:43]
    ds_read_b128 v[52:55], v10 offset:17408
    ds_read_b128 v[56:59], v10 offset:18432
    v_mfma_f32_16x16x32_bf16 v[44:47], a[32:35], v[76:79], v[44:47]
    ds_read_b128 v[60:63], v10 offset:19456
    s_waitcnt lgkmcnt(4)
    v_mfma_f32_16x16x32_bf16 v[32:35], a[36:39], v[80:83], v[32:35]
    ds_read_b128 v[64:67], v10 offset:20480
    v_mfma_f32_16x16x32_bf16 v[36:39], a[36:39], v[84:87], v[36:39]
    buffer_load_dwordx4 v254, s[4:7], s47 offen offset:3072 sc1 lds
    v_mfma_f32_16x16x32_bf16 v[40:43], a[36:39], v[88:91], v[40:43]
    ds_read_b128 v[68:71], v10 offset:21504
    ds_read_b128 v[72:75], v10 offset:22528
    v_mfma_f32_16x16x32_bf16 v[44:47], a[36:39], v[92:95], v[44:47]
    ds_read_b128 v[76:79], v10 offset:23552
    s_waitcnt lgkmcnt(4)
    v_mfma_f32_16x16x32_bf16 v[32:35], a[40:43], v[48:51], v[32:35]
    ds_read_b128 v[80:83], v10 offset:24576
    s_add_u32 m0, s46, 4096
    v_mfma_f32_16x16x32_bf16 v[36:39], a[40:43], v[52:55], v[36:39]
    buffer_load_dwordx4 v254, s[4:7], s48 offen offset:0 sc1 lds
    v_mfma_f32_16x16x32_bf16 v[40:43], a[40:43], v[56:59], v[40:43]
    ds_read_b128 v[84:87], v10 offset:25600
    ds_read_b128 v[88:91], v10 offset:26624
    v_mfma_f32_16x16x32_bf16 v[44:47], a[40:43], v[60:63], v[44:47]
    ds_read_b128 v[92:95], v10 offset:27648
    s_waitcnt lgkmcnt(4)
    v_mfma_f32_16x16x32_bf16 v[32:35], a[44:47], v[64:67], v[32:35]
    ds_read_b128 v[48:51], v10 offset:28672
    v_mfma_f32_16x16x32_bf16 v[36:39], a[44:47], v[68:71], v[36:39]
    buffer_load_dwordx4 v254, s[4:7], s48 offen offset:1024 sc1 lds
    v_mfma_f32_16x16x32_bf16 v[40:43], a[44:47], v[72:75], v[40:43]
    ds_read_b128 v[52:55], v10 offset:29696
    ds_read_b128 v[56:59], v10 offset:30720
    v_mfma_f32_16x16x32_bf16 v[44:47], a[44:47], v[76:79], v[44:47]
    ds_read_b128 v[60:63], v10 offset:31744
    s_waitcnt lgkmcnt(4)
    v_mfma_f32_16x16x32_bf16 v[32:35], a[48:51], v[80:83], v[32:35]
    ds_read_b128 v[64:67], v10 offset:32768
    v_mfma_f32_16x16x32_bf16 v[36:39], a[48:51], v[84:87], v[36:39]
    buffer_load_dwordx4 v254, s[4:7], s48 offen offset:2048 sc1 lds
    v_mfma_f32_16x16x32_bf16 v[40:43], a[48:51], v[88:91], v[40:43]
    ds_read_b128 v[68:71], v10 offset:33792
    ds_read_b128 v[72:75], v10 offset:34816
    s_add_u32 s47, s47, 28672
    s_add_u32 s48, s48, 28672
    v_mfma_f32_16x16x32_bf16 v[44:47], a[48:51], v[92:95], v[44:47]
    ds_read_b128 v[76:79], v10 offset:35840
    s_waitcnt vmcnt(7)
    s_barrier
    s_waitcnt lgkmcnt(4)
    v_mfma_f32_16x16x32_bf16 v[32:35], a[52:55], v[48:51], v[32:35]
    ds_read_b128 v[80:83], v10 offset:36864
    s_add_u32 m0, s46, 28672
    v_mfma_f32_16x16x32_bf16 v[36:39], a[52:55], v[52:55], v[36:39]
    buffer_load_dwordx4 v254, s[4:7], s47 offen offset:0 sc1 lds
    v_mfma_f32_16x16x32_bf16 v[40:43], a[52:55], v[56:59], v[40:43]
    ds_read_b128 v[84:87], v10 offset:37888
    ds_read_b128 v[88:91], v10 offset:38912
    v_mfma_f32_16x16x32_bf16 v[44:47], a[52:55], v[60:63], v[44:47]
    ds_read_b128 v[92:95], v10 offset:39936
    s_waitcnt lgkmcnt(4)
    v_mfma_f32_16x16x32_bf16 v[32:35], a[56:59], v[64:67], v[32:35]
    ds_read_b128 v[48:51], v10 offset:40960
    v_mfma_f32_16x16x32_bf16 v[36:39], a[56:59], v[68:71], v[36:39]
    buffer_load_dwordx4 v254, s[4:7], s47 offen offset:1024 sc1 lds
    v_mfma_f32_16x16x32_bf16 v[40:43], a[56:59], v[72:75], v[40:43]
    ds_read_b128 v[52:55], v10 offset:41984
    ds_read_b128 v[56:59], v10 offset:43008
    v_mfma_f32_16x16x32_bf16 v[44:47], a[56:59], v[76:79], v[44:47]
    ds_read_b128 v[60:63], v10 offset:44032
    s_waitcnt lgkmcnt(4)
    v_mfma_f32_16x16x32_bf16 v[32:35], a[60:63], v[80:83], v[32:35]
    ds_read_b128 v[64:67], v10 offset:45056
    v_mfma_f32_16x16x32_bf16 v[36:39], a[60:63], v[84:87], v[36:39]
    buffer_load_dwordx4 v254, s[4:7], s47 offen offset:2048 sc1 lds
    v_mfma_f32_16x16x32_bf16 v[40:43], a[60:63], v[88:91], v[40:43]
    ds_read_b128 v[68:71], v10 offset:46080
    ds_read_b128 v[72:75], v10 offset:47104
    v_mfma_f32_16x16x32_bf16 v[44:47], a[60:63], v[92:95], v[44:47]
    ds_read_b128 v[76:79], v10 offset:48128
    s_waitcnt lgkmcnt(4)
    v_mfma_f32_16x16x32_bf16 v[32:35], a[64:67], v[48:51], v[32:35]
    ds_read_b128 v[80:83], v10 offset:49152
    v_mfma_f32_16x16x32_bf16 v[36:39], a[64:67], v[52:55], v[36:39]
    buffer_load_dwordx4 v254, s[4:7], s47 offen offset:3072 sc1 lds
    v_mfma_f32_16x16x32_bf16 v[40:43], a[64:67], v[56:59], v[40:43]
    ds_read_b128 v[84:87], v10 offset:50176
    ds_read_b128 v[88:91], v10 offset:51200
    v_mfma_f32_16x16x32_bf16 v[44:47], a[64:67], v[60:63], v[44:47]
    ds_read_b128 v[92:95], v10 offset:52224
    s_waitcnt lgkmcnt(4)
    v_mfma_f32_16x16x32_bf16 v[32:35], a[68:71], v[64:67], v[32:35]
    ds_read_b128 v[48:51], v10 offset:53248
    s_add_u32 m0, s46, 32768
    v_mfma_f32_16x16x32_bf16 v[36:39], a[68:71], v[68:71], v[36:39]
    buffer_load_dwordx4 v254, s[4:7], s48 offen offset:0 sc1 lds
    v_mfma_f32_16x16x32_bf16 v[40:43], a[68:71], v[72:75], v[40:43]
    ds_read_b128 v[52:55], v10 offset:54272
    ds_read_b128 v[56:59], v10 offset:55296
    v_mfma_f32_16x16x32_bf16 v[44:47], a[68:71], v[76:79], v[44:47]
    ds_read_b128 v[60:63], v10 offset:56320
    s_waitcnt lgkmcnt(4)
    v_mfma_f32_16x16x32_bf16 v[32:35], a[72:75], v[80:83], v[32:35]
    ds_read_b128 v[64:67], v11 offset:0
    v_mfma_f32_16x16x32_bf16 v[36:39], a[72:75], v[84:87], v[36:39]
    buffer_load_dwordx4 v254, s[4:7], s48 offen offset:1024 sc1 lds
    v_mfma_f32_16x16x32_bf16 v[40:43], a[72:75], v[88:91], v[40:43]
    ds_read_b128 v[68:71], v11 offset:1024
    ds_read_b128 v[72:75], v11 offset:2048
    v_mfma_f32_16x16x32_bf16 v[44:47], a[72:75], v[92:95], v[44:47]
    ds_read_b128 v[76:79], v11 offset:3072
    s_waitcnt lgkmcnt(4)
    v_mfma_f32_16x16x32_bf16 v[32:35], a[76:79], v[48:51], v[32:35]
    ds_read_b128 v[80:83], v11 offset:4096
    v_mfma_f32_16x16x32_bf16 v[36:39], a[76:79], v[52:55], v[36:39]
    buffer_load_dwordx4 v254, s[4:7], s48 offen offset:2048 sc1 lds
    v_mfma_f32_16x16x32_bf16 v[40:43], a[76:79], v[56:59], v[40:43]
    ds_read_b128 v[84:87], v11 offset:5120
    ds_read_b128 v[88:91], v11 offset:6144
    s_add_u32 s47, s47, 28672
    s_add_u32 s48, s48, 28672
    v_mfma_f32_16x16x32_bf16 v[44:47], a[76:79], v[60:63], v[44:47]
    ds_read_b128 v[92:95], v11 offset:7168
    s_waitcnt vmcnt(7)
    s_barrier
    s_waitcnt lgkmcnt(4)
    v_mfma_f32_16x16x32_bf16 v[32:35], a[80:83], v[64:67], v[32:35]
    ds_read_b128 v[48:51], v11 offset:8192
    s_add_u32 m0, s46, 57344
    v_mfma_f32_16x16x32_bf16 v[36:39], a[80:83], v[68:71], v[36:39]
    buffer_load_dwordx4 v254, s[4:7], s47 offen offset:0 sc1 lds
    v_mfma_f32_16x16x32_bf16 v[40:43], a[80:83], v[72:75], v[40:43]
    ds_read_b128 v[52:55], v11 offset:9216
    ds_read_b128 v[56:59], v11 offset:10240
    v_mfma_f32_16x16x32_bf16 v[44:47], a[80:83], v[76:79], v[44:47]
    ds_read_b128 v[60:63], v11 offset:11264
    s_waitcnt lgkmcnt(4)
    v_mfma_f32_16x16x32_bf16 v[32:35], a[84:87], v[80:83], v[32:35]
    ds_read_b128 v[64:67], v11 offset:12288
    v_mfma_f32_16x16x32_bf16 v[36:39], a[84:87], v[84:87], v[36:39]
    buffer_load_dwordx4 v254, s[4:7], s47 offen offset:1024 sc1 lds
    v_mfma_f32_16x16x32_bf16 v[40:43], a[84:87], v[88:91], v[40:43]
    ds_read_b128 v[68:71], v11 offset:13312
    ds_read_b128 v[72:75], v11 offset:14336
    v_mfma_f32_16x16x32_bf16 v[44:47], a[84:87], v[92:95], v[44:47]
    ds_read_b128 v[76:79], v11 offset:15360
    s_waitcnt lgkmcnt(4)
    v_mfma_f32_16x16x32_bf16 v[32:35], a[88:91], v[48:51], v[32:35]
    ds_read_b128 v[80:83], v11 offset:16384
    v_mfma_f32_16x16x32_bf16 v[36:39], a[88:91], v[52:55], v[36:39]
    buffer_load_dwordx4 v254, s[4:7], s47 offen offset:2048 sc1 lds
    v_mfma_f32_16x16x32_bf16 v[40:43], a[88:91], v[56:59], v[40:43]
    ds_read_b128 v[84:87], v11 offset:17408
    ds_read_b128 v[88:91], v11 offset:18432
    v_mfma_f32_16x16x32_bf16 v[44:47], a[88:91], v[60:63], v[44:47]
    ds_read_b128 v[92:95], v11 offset:19456
    s_waitcnt lgkmcnt(4)
    v_mfma_f32_16x16x32_bf16 v[32:35], a[92:95], v[64:67], v[32:35]
    ds_read_b128 v[48:51], v11 offset:20480
    v_mfma_f32_16x16x32_bf16 v[36:39], a[92:95], v[68:71], v[36:39]
    buffer_load_dwordx4 v254, s[4:7], s47 offen offset:3072 sc1 lds
    v_mfma_f32_16x16x32_bf16 v[40:43], a[92:95], v[72:75], v[40:43]
    ds_read_b128 v[52:55], v11 offset:21504
    ds_read_b128 v[56:59], v11 offset:22528
    v_mfma_f32_16x16x32_bf16 v[44:47], a[92:95], v[76:79], v[44:47]
    ds_read_b128 v[60:63], v11 offset:23552
    s_waitcnt lgkmcnt(4)
    v_mfma_f32_16x16x32_bf16 v[32:35], a[96:99], v[80:83], v[32:35]
    ds_read_b128 v[64:67], v11 offset:24576
    s_add_u32 m0, s46, 61440
    v_mfma_f32_16x16x32_bf16 v[36:39], a[96:99], v[84:87], v[36:39]
    buffer_load_dwordx4 v254, s[4:7], s48 offen offset:0 sc1 lds
    v_mfma_f32_16x16x32_bf16 v[40:43], a[96:99], v[88:91], v[40:43]
    ds_read_b128 v[68:71], v11 offset:25600
    ds_read_b128 v[72:75], v11 offset:26624
    v_mfma_f32_16x16x32_bf16 v[44:47], a[96:99], v[92:95], v[44:47]
    ds_read_b128 v[76:79], v11 offset:27648
    s_waitcnt lgkmcnt(4)
    v_mfma_f32_16x16x32_bf16 v[32:35], a[100:103], v[48:51], v[32:35]
    ds_read_b128 v[80:83], v9 offset:0
    v_mfma_f32_16x16x32_bf16 v[36:39], a[100:103], v[52:55], v[36:39]
    buffer_load_dwordx4 v254, s[4:7], s48 offen offset:1024 sc1 lds
    v_mfma_f32_16x16x32_bf16 v[40:43], a[100:103], v[56:59], v[40:43]
    ds_read_b128 v[84:87], v9 offset:1024
    ds_read_b128 v[88:91], v9 offset:2048
    v_mfma_f32_16x16x32_bf16 v[44:47], a[100:103], v[60:63], v[44:47]
    ds_read_b128 v[92:95], v9 offset:3072
    s_waitcnt lgkmcnt(4)
    v_mfma_f32_16x16x32_bf16 v[32:35], a[104:107], v[64:67], v[32:35]
    ds_read_b128 v[48:51], v9 offset:4096
    v_mfma_f32_16x16x32_bf16 v[36:39], a[104:107], v[68:71], v[36:39]
    buffer_load_dwordx4 v254, s[4:7], s48 offen offset:2048 sc1 lds
    v_mfma_f32_16x16x32_bf16 v[40:43], a[104:107], v[72:75], v[40:43]
    ds_read_b128 v[52:55], v9 offset:5120
    ds_read_b128 v[56:59], v9 offset:6144
    s_add_u32 s47, s47, 28672
    s_add_u32 s48, s48, 28672
    v_mfma_f32_16x16x32_bf16 v[44:47], a[104:107], v[76:79], v[44:47]
    ds_read_b128 v[60:63], v9 offset:7168
    s_waitcnt vmcnt(7)
    s_barrier
    s_waitcnt lgkmcnt(4)
    v_mfma_f32_16x16x32_bf16 v[32:35], a[108:111], v[80:83], v[32:35]
    ds_read_b128 v[64:67], v9 offset:8192
    v_mfma_f32_16x16x32_bf16 v[36:39], a[108:111], v[84:87], v[36:39]
    ds_read_b128 v[68:71], v9 offset:9216
    v_mfma_f32_16x16x32_bf16 v[40:43], a[108:111], v[88:91], v[40:43]
    ds_read_b128 v[72:75], v9 offset:10240
    v_mfma_f32_16x16x32_bf16 v[44:47], a[108:111], v[92:95], v[44:47]
    ds_read_b128 v[76:79], v9 offset:11264
    s_waitcnt lgkmcnt(4)
    v_mfma_f32_16x16x32_bf16 v[32:35], a[112:115], v[48:51], v[32:35]
    ds_read_b128 v[80:83], v9 offset:12288
    v_mfma_f32_16x16x32_bf16 v[36:39], a[112:115], v[52:55], v[36:39]
    ds_read_b128 v[84:87], v9 offset:13312
    v_mfma_f32_16x16x32_bf16 v[40:43], a[112:115], v[56:59], v[40:43]
    ds_read_b128 v[88:91], v9 offset:14336
    v_mfma_f32_16x16x32_bf16 v[44:47], a[112:115], v[60:63], v[44:47]
    ds_read_b128 v[92:95], v9 offset:15360
    s_waitcnt lgkmcnt(4)
    v_mfma_f32_16x16x32_bf16 v[32:35], a[116:119], v[64:67], v[32:35]
    ds_read_b128 v[48:51], v9 offset:16384
    v_mfma_f32_16x16x32_bf16 v[36:39], a[116:119], v[68:71], v[36:39]
    ds_read_b128 v[52:55], v9 offset:17408
    v_mfma_f32_16x16x32_bf16 v[40:43], a[116:119], v[72:75], v[40:43]
    ds_read_b128 v[56:59], v9 offset:18432
    v_mfma_f32_16x16x32_bf16 v[44:47], a[116:119], v[76:79], v[44:47]
    ds_read_b128 v[60:63], v9 offset:19456
    s_waitcnt lgkmcnt(4)
    v_mfma_f32_16x16x32_bf16 v[32:35], a[120:123], v[80:83], v[32:35]
    ds_read_b128 v[64:67], v9 offset:20480
    v_mfma_f32_16x16x32_bf16 v[36:39], a[120:123], v[84:87], v[36:39]
    ds_read_b128 v[68:71], v9 offset:21504
    v_mfma_f32_16x16x32_bf16 v[40:43], a[120:123], v[88:91], v[40:43]
    ds_read_b128 v[72:75], v9 offset:22528
    v_mfma_f32_16x16x32_bf16 v[44:47], a[120:123], v[92:95], v[44:47]
    ds_read_b128 v[76:79], v9 offset:23552
    s_waitcnt lgkmcnt(4)
    v_mfma_f32_16x16x32_bf16 v[32:35], a[124:127], v[48:51], v[32:35]
    ds_read_b128 v[80:83], v9 offset:24576
    v_mfma_f32_16x16x32_bf16 v[36:39], a[124:127], v[52:55], v[36:39]
    ds_read_b128 v[84:87], v9 offset:25600
    v_mfma_f32_16x16x32_bf16 v[40:43], a[124:127], v[56:59], v[40:43]
    ds_read_b128 v[88:91], v9 offset:26624
    v_mfma_f32_16x16x32_bf16 v[44:47], a[124:127], v[60:63], v[44:47]
    ds_read_b128 v[92:95], v9 offset:27648
    s_waitcnt lgkmcnt(4)
    v_mfma_f32_16x16x32_bf16 v[32:35], a[128:131], v[64:67], v[32:35]
    ds_read_b128 v[48:51], v9 offset:28672
    v_mfma_f32_16x16x32_bf16 v[36:39], a[128:131], v[68:71], v[36:39]
    ds_read_b128 v[52:55], v9 offset:29696
    v_mfma_f32_16x16x32_bf16 v[40:43], a[128:131], v[72:75], v[40:43]
    ds_read_b128 v[56:59], v9 offset:30720
    v_mfma_f32_16x16x32_bf16 v[44:47], a[128:131], v[76:79], v[44:47]
    ds_read_b128 v[60:63], v9 offset:31744
    s_waitcnt lgkmcnt(4)
    v_mfma_f32_16x16x32_bf16 v[32:35], a[132:135], v[80:83], v[32:35]
    ds_read_b128 v[64:67], v9 offset:32768
    v_mfma_f32_16x16x32_bf16 v[36:39], a[132:135], v[84:87], v[36:39]
    ds_read_b128 v[68:71], v9 offset:33792
    v_mfma_f32_16x16x32_bf16 v[40:43], a[132:135], v[88:91], v[40:43]
    ds_read_b128 v[72:75], v9 offset:34816
    v_mfma_f32_16x16x32_bf16 v[44:47], a[132:135], v[92:95], v[44:47]
    ds_read_b128 v[76:79], v9 offset:35840
    s_waitcnt vmcnt(0)
    s_barrier
    s_waitcnt lgkmcnt(4)
    v_mfma_f32_16x16x32_bf16 v[32:35], a[136:139], v[48:51], v[32:35]
    ds_read_b128 v[80:83], v9 offset:36864
    v_mfma_f32_16x16x32_bf16 v[36:39], a[136:139], v[52:55], v[36:39]
    ds_read_b128 v[84:87], v9 offset:37888
    v_mfma_f32_16x16x32_bf16 v[40:43], a[136:139], v[56:59], v[40:43]
    ds_read_b128 v[88:91], v9 offset:38912
    v_mfma_f32_16x16x32_bf16 v[44:47], a[136:139], v[60:63], v[44:47]
    ds_read_b128 v[92:95], v9 offset:39936
    s_waitcnt lgkmcnt(4)
    v_mfma_f32_16x16x32_bf16 v[32:35], a[140:143], v[64:67], v[32:35]
    ds_read_b128 v[48:51], v9 offset:40960
    v_mfma_f32_16x16x32_bf16 v[36:39], a[140:143], v[68:71], v[36:39]
    ds_read_b128 v[52:55], v9 offset:41984
    v_mfma_f32_16x16x32_bf16 v[40:43], a[140:143], v[72:75], v[40:43]
    ds_read_b128 v[56:59], v9 offset:43008
    v_mfma_f32_16x16x32_bf16 v[44:47], a[140:143], v[76:79], v[44:47]
    ds_read_b128 v[60:63], v9 offset:44032
    s_waitcnt lgkmcnt(4)
    v_mfma_f32_16x16x32_bf16 v[32:35], a[144:147], v[80:83], v[32:35]
    ds_read_b128 v[64:67], v9 offset:45056
    v_mfma_f32_16x16x32_bf16 v[36:39], a[144:147], v[84:87], v[36:39]
    ds_read_b128 v[68:71], v9 offset:46080
    v_mfma_f32_16x16x32_bf16 v[40:43], a[144:147], v[88:91], v[40:43]
    ds_read_b128 v[72:75], v9 offset:47104
    v_mfma_f32_16x16x32_bf16 v[44:47], a[144:147], v[92:95], v[44:47]
    ds_read_b128 v[76:79], v9 offset:48128
    s_waitcnt lgkmcnt(4)
    v_mfma_f32_16x16x32_bf16 v[32:35], a[148:151], v[48:51], v[32:35]
    ds_read_b128 v[80:83], v9 offset:49152
    v_mfma_f32_16x16x32_bf16 v[36:39], a[148:151], v[52:55], v[36:39]
    ds_read_b128 v[84:87], v9 offset:50176
    v_mfma_f32_16x16x32_bf16 v[40:43], a[148:151], v[56:59], v[40:43]
    ds_read_b128 v[88:91], v9 offset:51200
    v_mfma_f32_16x16x32_bf16 v[44:47], a[148:151], v[60:63], v[44:47]
    ds_read_b128 v[92:95], v9 offset:52224
    s_waitcnt lgkmcnt(4)
    v_mfma_f32_16x16x32_bf16 v[32:35], a[152:155], v[64:67], v[32:35]
    ds_read_b128 v[48:51], v9 offset:53248
    v_mfma_f32_16x16x32_bf16 v[36:39], a[152:155], v[68:71], v[36:39]
    ds_read_b128 v[52:55], v9 offset:54272
    v_mfma_f32_16x16x32_bf16 v[40:43], a[152:155], v[72:75], v[40:43]
    ds_read_b128 v[56:59], v9 offset:55296
    v_mfma_f32_16x16x32_bf16 v[44:47], a[152:155], v[76:79], v[44:47]
    ds_read_b128 v[60:63], v9 offset:56320
    s_waitcnt lgkmcnt(4)
    v_mfma_f32_16x16x32_bf16 v[32:35], a[156:159], v[80:83], v[32:35]
    ds_read_b128 v[64:67], v10 offset:0
    v_mfma_f32_16x16x32_bf16 v[36:39], a[156:159], v[84:87], v[36:39]
    ds_read_b128 v[68:71], v10 offset:1024
    v_mfma_f32_16x16x32_bf16 v[40:43], a[156:159], v[88:91], v[40:43]
    ds_read_b128 v[72:75], v10 offset:2048
    v_mfma_f32_16x16x32_bf16 v[44:47], a[156:159], v[92:95], v[44:47]
    ds_read_b128 v[76:79], v10 offset:3072
    s_waitcnt lgkmcnt(4)
    v_mfma_f32_16x16x32_bf16 v[32:35], a[160:163], v[48:51], v[32:35]
    ds_read_b128 v[80:83], v10 offset:4096
    v_mfma_f32_16x16x32_bf16 v[36:39], a[160:163], v[52:55], v[36:39]
    ds_read_b128 v[84:87], v10 offset:5120
    v_mfma_f32_16x16x32_bf16 v[40:43], a[160:163], v[56:59], v[40:43]
    ds_read_b128 v[88:91], v10 offset:6144
    v_mfma_f32_16x16x32_bf16 v[44:47], a[160:163], v[60:63], v[44:47]
    ds_read_b128 v[92:95], v10 offset:7168
    s_barrier
    s_waitcnt lgkmcnt(4)
    v_mfma_f32_16x16x32_bf16 v[32:35], a[164:167], v[64:67], v[32:35]
    ds_read_b128 v[48:51], v10 offset:8192
    v_mfma_f32_16x16x32_bf16 v[36:39], a[164:167], v[68:71], v[36:39]
    ds_read_b128 v[52:55], v10 offset:9216
    v_mfma_f32_16x16x32_bf16 v[40:43], a[164:167], v[72:75], v[40:43]
    ds_read_b128 v[56:59], v10 offset:10240
    v_mfma_f32_16x16x32_bf16 v[44:47], a[164:167], v[76:79], v[44:47]
    ds_read_b128 v[60:63], v10 offset:11264
    s_waitcnt lgkmcnt(4)
    v_mfma_f32_16x16x32_bf16 v[32:35], a[168:171], v[80:83], v[32:35]
    ds_read_b128 v[64:67], v10 offset:12288
    v_mfma_f32_16x16x32_bf16 v[36:39], a[168:171], v[84:87], v[36:39]
    ds_read_b128 v[68:71], v10 offset:13312
    v_mfma_f32_16x16x32_bf16 v[40:43], a[168:171], v[88:91], v[40:43]
    ds_read_b128 v[72:75], v10 offset:14336
    v_mfma_f32_16x16x32_bf16 v[44:47], a[168:171], v[92:95], v[44:47]
    ds_read_b128 v[76:79], v10 offset:15360
    s_waitcnt lgkmcnt(4)
    v_mfma_f32_16x16x32_bf16 v[32:35], a[172:175], v[48:51], v[32:35]
    ds_read_b128 v[80:83], v10 offset:16384
    v_mfma_f32_16x16x32_bf16 v[36:39], a[172:175], v[52:55], v[36:39]
    ds_read_b128 v[84:87], v10 offset:17408
    v_mfma_f32_16x16x32_bf16 v[40:43], a[172:175], v[56:59], v[40:43]
    ds_read_b128 v[88:91], v10 offset:18432
    v_mfma_f32_16x16x32_bf16 v[44:47], a[172:175], v[60:63], v[44:47]
    ds_read_b128 v[92:95], v10 offset:19456
    s_waitcnt lgkmcnt(4)
    v_mfma_f32_16x16x32_bf16 v[32:35], a[176:179], v[64:67], v[32:35]
    ds_read_b128 v[48:51], v10 offset:20480
    v_mfma_f32_16x16x32_bf16 v[36:39], a[176:179], v[68:71], v[36:39]
    ds_read_b128 v[52:55], v10 offset:21504
    v_mfma_f32_16x16x32_bf16 v[40:43], a[176:179], v[72:75], v[40:43]
    ds_read_b128 v[56:59], v10 offset:22528
    v_mfma_f32_16x16x32_bf16 v[44:47], a[176:179], v[76:79], v[44:47]
    ds_read_b128 v[60:63], v10 offset:23552
    s_waitcnt lgkmcnt(4)
    v_mfma_f32_16x16x32_bf16 v[32:35], a[180:183], v[80:83], v[32:35]
    ds_read_b128 v[64:67], v10 offset:24576
    v_mfma_f32_16x16x32_bf16 v[36:39], a[180:183], v[84:87], v[36:39]
    ds_read_b128 v[68:71], v10 offset:25600
    v_mfma_f32_16x16x32_bf16 v[40:43], a[180:183], v[88:91], v[40:43]
    ds_read_b128 v[72:75], v10 offset:26624
    v_mfma_f32_16x16x32_bf16 v[44:47], a[180:183], v[92:95], v[44:47]
    ds_read_b128 v[76:79], v10 offset:27648
    s_waitcnt lgkmcnt(4)
    v_mfma_f32_16x16x32_bf16 v[32:35], a[184:187], v[48:51], v[32:35]
    v_mfma_f32_16x16x32_bf16 v[36:39], a[184:187], v[52:55], v[36:39]
    v_mfma_f32_16x16x32_bf16 v[40:43], a[184:187], v[56:59], v[40:43]
    v_mfma_f32_16x16x32_bf16 v[44:47], a[184:187], v[60:63], v[44:47]
    s_waitcnt lgkmcnt(0)
    v_mfma_f32_16x16x32_bf16 v[32:35], a[188:191], v[64:67], v[32:35]
    v_mfma_f32_16x16x32_bf16 v[36:39], a[188:191], v[68:71], v[36:39]
    v_mfma_f32_16x16x32_bf16 v[40:43], a[188:191], v[72:75], v[40:43]
    v_mfma_f32_16x16x32_bf16 v[44:47], a[188:191], v[76:79], v[44:47]
    s_nop 7
    v_pk_add_f32 v[32:33], v[32:33], v[96:97]
    v_pk_add_f32 v[34:35], v[34:35], v[98:99]
    v_pk_add_f32 v[36:37], v[36:37], v[100:101]
    v_pk_add_f32 v[38:39], v[38:39], v[102:103]
    v_pk_add_f32 v[40:41], v[40:41], v[104:105]
    v_pk_add_f32 v[42:43], v[42:43], v[106:107]
    v_pk_add_f32 v[44:45], v[44:45], v[108:109]
    v_pk_add_f32 v[46:47], v[46:47], v[110:111]
    v_pk_fma_f32 v[32:33], v[32:33], v[20:21], v[112:113]
    v_pk_fma_f32 v[34:35], v[34:35], v[22:23], v[114:115]
    v_pk_fma_f32 v[36:37], v[36:37], v[20:21], v[116:117]
    v_pk_fma_f32 v[38:39], v[38:39], v[22:23], v[118:119]
    v_pk_fma_f32 v[40:41], v[40:41], v[20:21], v[120:121]
    v_pk_fma_f32 v[42:43], v[42:43], v[22:23], v[122:123]
    v_pk_fma_f32 v[44:45], v[44:45], v[20:21], v[124:125]
    v_pk_fma_f32 v[46:47], v[46:47], v[22:23], v[126:127]
    v_cvt_pk_bf16_f32 v48, v32, v33
    v_cvt_pk_bf16_f32 v49, v34, v35
    v_cvt_pk_bf16_f32 v50, v36, v37
    v_cvt_pk_bf16_f32 v51, v38, v39
    v_cvt_pk_bf16_f32 v52, v40, v41
    v_cvt_pk_bf16_f32 v53, v42, v43
    v_cvt_pk_bf16_f32 v54, v44, v45
    v_cvt_pk_bf16_f32 v55, v46, v47
    ds_write_b64 v5, v[48:49] offset:0
    ds_write_b64 v5, v[50:51] offset:2304
    ds_write_b64 v5, v[52:53] offset:4608
    ds_write_b64 v5, v[54:55] offset:6912
    s_waitcnt lgkmcnt(0)
    s_barrier
    ds_read_b128 v[32:35], v8 offset:0
    ds_read_b128 v[36:39], v8 offset:4608
    s_waitcnt lgkmcnt(0)
    buffer_store_dwordx4 v[32:35], v6, s[24:27], 0 offen
    buffer_store_dwordx4 v[36:39], v7, s[24:27], 0 offen
L_k2_fin:
    s_waitcnt vmcnt(0)
L_k2_done:
    s_endpgm
L_stub0:
    s_call_b64 s[72:73], L_rare1
    s_branch L_back0
L_stub1:
    s_call_b64 s[72:73], L_rare0
    s_branch L_back1
L_stub2:
    s_call_b64 s[72:73], L_rare1
    s_branch L_back2
L_stub3:
    s_call_b64 s[72:73], L_rare0
    s_branch L_back3
L_stub4:
    s_call_b64 s[72:73], L_rare1
    s_branch L_back4
L_stub5:
    s_call_b64 s[72:73], L_rare0
    s_branch L_back5
L_stub6:
    s_call_b64 s[72:73], L_rare1
    s_branch L_back6
L_side_issue:
    v_mbcnt_lo_u32_b32 v208, -1, 0
    v_mbcnt_hi_u32_b32 v208, -1, v208
    v_lshrrev_b32 v209, 3, v208
    v_and_b32 v210, 0x70, v222
    v_mul_lo_u32 v209, v209, s101
    s_add_u32 m0, s52, 131072
    v_add_u32 v209, v209, v210
    buffer_load_dwordx4 v209, s[32:35], s64 offen offset:0 nt lds
    buffer_load_dwordx4 v209, s[32:35], s65 offen offset:1024 nt lds
    buffer_load_dwordx4 v209, s[32:35], s66 offen offset:2048 nt lds
    buffer_load_dwordx4 v209, s[32:35], s67 offen offset:3072 nt lds
    s_lshl_b32 s62, s41, 2
    s_add_u32 s62, s62, s40
    s_min_u32 s62, s62, 111
    s_mul_hi_u32 s55, s62, 613566757
    s_mul_i32 s63, s55, 7
    s_sub_u32 s63, s62, s63
    v_lshrrev_b32 v209, 3, v208
    v_mul_u32_u24 v209, 896, v209
    s_mul_i32 s55, s55, 28672
    s_lshl_b32 s63, s63, 7
    s_add_u32 s55, s55, s63
    s_add_u32 m0, s52, 147456
    v_add_u32 v209, v209, v210
    buffer_load_dwordx4 v209, s[16:19], s55 offen offset:0 nt lds
    s_add_u32 s55, s55, 6144
    buffer_load_dwordx4 v209, s[16:19], s55 offen offset:1024 nt lds
    s_add_u32 s55, s55, 6144
    buffer_load_dwordx4 v209, s[16:19], s55 offen offset:2048 nt lds
    s_add_u32 s55, s55, 6144
    buffer_load_dwordx4 v209, s[16:19], s55 offen offset:3072 nt lds
    s_add_u32 s55, s55, 6144
    s_sub_u32 s43, s43, 1
    s_branch L_k2_special
L_side_finish:
    s_lshr_b32 s55, s40, 1
    s_lshl_b32 s55, s55, 14
    s_sub_u32 s62, s52, s55
    s_add_u32 s62, s62, 65536
    v_add_u32 v208, s62, v218
    v_add_u32 v209, s62, v219
    v_add_u32 v210, s62, v220
    v_add_u32 v211, s62, v221
    ds_read_b64_tr_b16 v[160:161], v208 offset:0
    ds_read_b64_tr_b16 v[162:163], v208 offset:2048
    ds_read_b64_tr_b16 v[164:165], v209 offset:0
    ds_read_b64_tr_b16 v[166:167], v209 offset:2048
    ds_read_b64_tr_b16 v[168:169], v210 offset:0
    ds_read_b64_tr_b16 v[170:171], v210 offset:2048
    ds_read_b64_tr_b16 v[172:173], v211 offset:0
    ds_read_b64_tr_b16 v[174:175], v211 offset:2048
    v_mbcnt_lo_u32_b32 v212, -1, 0
    v_mbcnt_hi_u32_b32 v212, -1, v212
    v_lshlrev_b32 v212, 4, v212
    s_waitcnt lgkmcnt(0)
    buffer_store_dwordx4 v[160:163], v212, s[36:39], s68 offen sc1
    buffer_store_dwordx4 v[164:167], v212, s[36:39], s69 offen sc1
    buffer_store_dwordx4 v[168:171], v212, s[36:39], s70 offen sc1
    buffer_store_dwordx4 v[172:175], v212, s[36:39], s71 offen sc1
    s_nop 1
    ds_read_b64_tr_b16 v[160:161], v208 offset:16384
    ds_read_b64_tr_b16 v[162:163], v208 offset:18432
    ds_read_b64_tr_b16 v[164:165], v209 offset:16384
    ds_read_b64_tr_b16 v[166:167], v209 offset:18432
    ds_read_b64_tr_b16 v[168:169], v210 offset:16384
    ds_read_b64_tr_b16 v[170:171], v210 offset:18432
    ds_read_b64_tr_b16 v[172:173], v211 offset:16384
    ds_read_b64_tr_b16 v[174:175], v211 offset:18432
    s_lshl_b32 s62, s41, 2
    s_add_u32 s62, s62, s40
    s_min_u32 s62, s62, 111
    s_mul_hi_u32 s55, s62, 613566757
    s_mul_i32 s63, s55, 7
    s_sub_u32 s63, s62, s63
    s_lshl_b32 s63, s63, 16
    s_lshl_b32 s55, s55, 10
    s_add_u32 s55, s55, s63
    s_mul_i32 s62, s42, 458752
    s_add_u32 s62, s62, 41009152
    s_add_u32 s16, s86, s62
    s_addc_u32 s17, s87, 0
    s_mov_b32 s18, 458752
    s_mov_b32 s19, 0x20000
    s_waitcnt lgkmcnt(0)
    buffer_store_dwordx4 v[160:163], v212, s[16:19], s55 offen sc1
    s_add_u32 s55, s55, 16384
    buffer_store_dwordx4 v[164:167], v212, s[16:19], s55 offen sc1
    s_add_u32 s55, s55, 16384
    buffer_store_dwordx4 v[168:171], v212, s[16:19], s55 offen sc1
    s_add_u32 s55, s55, 16384
    buffer_store_dwordx4 v[172:175], v212, s[16:19], s55 offen sc1
    s_add_u32 s55, s55, 16384
    s_sub_u32 s43, s43, 1
    s_branch L_k2_special
L_side_publish:
    s_cmp_lg_u32 s40, 0
    s_cbranch_scc1 L_side_back
    v_mov_b32 v208, 0
    v_mov_b32 v209, 1
    s_nop 7
    s_mov_b64 exec, 1
    buffer_atomic_add v209, v208, s[20:23], 0 offen offset:128 sc1
    s_mov_b64 exec, -1
    s_nop 3
    s_branch L_side_back
.p2align 6
L_k2_special:
    s_waitcnt vmcnt(16)
    s_barrier
    s_waitcnt lgkmcnt(2)
    v_mfma_f32_16x16x32_bf16 v[128:131], v[192:195], v[0:3], v[224:227]
    v_mfma_f32_16x16x32_bf16 v[132:135], v[192:195], v[32:35], v[228:231]
    buffer_load_dword v255, v254, s[8:11], s97 offen
    v_mfma_f32_16x16x32_bf16 v[136:139], v[192:195], v[64:67], v[232:235]
    v_add_f32 v240, v240, v244
    v_mfma_f32_16x16x32_bf16 v[140:143], v[192:195], v[96:99], v[236:239]
    ds_read_b128 v[192:195], v216 offset:8192
    v_mfma_f32_16x16x32_bf16 v[128:131], v[196:199], v[4:7], v[128:131]
    s_add_u32 s97, s97, 65536
    s_add_u32 m0, s52, 65536
    v_mfma_f32_16x16x32_bf16 v[132:135], v[196:199], v[36:39], v[132:135]
    buffer_load_dwordx4 v223, s[8:11], s44 offen offset:0 lds
    v_mfma_f32_16x16x32_bf16 v[136:139], v[196:199], v[68:71], v[136:139]
    v_add_f32 v241, v241, v245
    v_mfma_f32_16x16x32_bf16 v[140:143], v[196:199], v[100:103], v[140:143]
    ds_read_b128 v[196:199], v217 offset:8192
    s_waitcnt lgkmcnt(2)
    v_mfma_f32_16x16x32_bf16 v[128:131], v[200:203], v[8:11], v[128:131]
    v_mfma_f32_16x16x32_bf16 v[132:135], v[200:203], v[40:43], v[132:135]
    buffer_load_dwordx4 v223, s[8:11], s45 offen offset:1024 lds
    v_mfma_f32_16x16x32_bf16 v[136:139], v[200:203], v[72:75], v[136:139]
    v_add_f32 v242, v242, v246
    v_mfma_f32_16x16x32_bf16 v[140:143], v[200:203], v[104:107], v[140:143]
    ds_read_b128 v[200:203], v216 offset:12288
    v_mfma_f32_16x16x32_bf16 v[128:131], v[204:207], v[12:15], v[128:131]
    v_mfma_f32_16x16x32_bf16 v[132:135], v[204:207], v[44:47], v[132:135]
    buffer_load_dwordx4 v223, s[8:11], s46 offen offset:2048 lds
    v_mfma_f32_16x16x32_bf16 v[136:139], v[204:207], v[76:79], v[136:139]
    v_add_f32 v243, v243, v247
    v_mfma_f32_16x16x32_bf16 v[140:143], v[204:207], v[108:111], v[140:143]
    ds_read_b128 v[204:207], v217 offset:12288
    s_waitcnt lgkmcnt(2)
    v_mfma_f32_16x16x32_bf16 v[128:131], v[192:195], v[16:19], v[128:131]
    v_mfma_f32_16x16x32_bf16 v[132:135], v[192:195], v[48:51], v[132:135]
    buffer_load_dwordx4 v223, s[8:11], s47 offen offset:3072 lds
    v_mfma_f32_16x16x32_bf16 v[136:139], v[192:195], v[80:83], v[136:139]
    v_mfma_f32_16x16x32_bf16 v[140:143], v[192:195], v[112:115], v[140:143]
    ds_read_b128 v[192:195], v216 offset:2048
    v_mfma_f32_16x16x32_bf16 v[128:131], v[196:199], v[20:23], v[128:131]
    s_add_u32 m0, s52, 81920
    v_mfma_f32_16x16x32_bf16 v[132:135], v[196:199], v[52:55], v[132:135]
    buffer_load_dwordx4 v223, s[8:11], s48 offen offset:0 lds
    v_mfma_f32_16x16x32_bf16 v[136:139], v[196:199], v[84:87], v[136:139]
    v_mfma_f32_16x16x32_bf16 v[140:143], v[196:199], v[116:119], v[140:143]
    ds_read_b128 v[196:199], v217 offset:2048
    s_waitcnt lgkmcnt(2)
    v_mfma_f32_16x16x32_bf16 v[128:131], v[200:203], v[24:27], v[128:131]
    v_mfma_f32_16x16x32_bf16 v[132:135], v[200:203], v[56:59], v[132:135]
    buffer_load_dwordx4 v223, s[8:11], s49 offen offset:1024 lds
    v_mfma_f32_16x16x32_bf16 v[136:139], v[200:203], v[88:91], v[136:139]
    v_mfma_f32_16x16x32_bf16 v[140:143], v[200:203], v[120:123], v[140:143]
    ds_read_b128 v[200:203], v216 offset:6144
    v_mfma_f32_16x16x32_bf16 v[128:131], v[204:207], v[28:31], v[128:131]
    v_mfma_f32_16x16x32_bf16 v[132:135], v[204:207], v[60:63], v[132:135]
    buffer_load_dwordx4 v223, s[8:11], s50 offen offset:2048 lds
    v_mfma_f32_16x16x32_bf16 v[136:139], v[204:207], v[92:95], v[136:139]
    v_mfma_f32_16x16x32_bf16 v[140:143], v[204:207], v[124:127], v[140:143]
    ds_read_b128 v[204:207], v217 offset:6144
    s_waitcnt lgkmcnt(2)
    v_mfma_f32_16x16x32_bf16 v[144:147], v[192:195], v[0:3], v[224:227]
    v_mfma_f32_16x16x32_bf16 v[148:151], v[192:195], v[32:35], v[228:231]
    buffer_load_dwordx4 v223, s[8:11], s51 offen offset:3072 lds
    v_mfma_f32_16x16x32_bf16 v[152:155], v[192:195], v[64:67], v[232:235]
    v_exp_f32 v248, v128
    v_mfma_f32_16x16x32_bf16 v[156:159], v[192:195], v[96:99], v[236:239]
    ds_read_b128 v[192:195], v216 offset:10240
    v_mfma_f32_16x16x32_bf16 v[144:147], v[196:199], v[4:7], v[144:147]
    v_add_u32 v223, 0x8000, v223
    v_mfma_f32_16x16x32_bf16 v[148:151], v[196:199], v[36:39], v[148:151]
    v_exp_f32 v249, v129
    v_mfma_f32_16x16x32_bf16 v[152:155], v[196:199], v[68:71], v[152:155]
    v_cvt_pk_bf16_f32 v160, v248, v249
    v_add_f32 v244, v248, v249
    v_mfma_f32_16x16x32_bf16 v[156:159], v[196:199], v[100:103], v[156:159]
    ds_read_b128 v[196:199], v217 offset:10240
    s_waitcnt lgkmcnt(2)
    v_mfma_f32_16x16x32_bf16 v[144:147], v[200:203], v[8:11], v[144:147]
    v_exp_f32 v250, v130
    v_mfma_f32_16x16x32_bf16 v[148:151], v[200:203], v[40:43], v[148:151]
    v_exp_f32 v251, v131
    v_mfma_f32_16x16x32_bf16 v[152:155], v[200:203], v[72:75], v[152:155]
    v_cvt_pk_bf16_f32 v161, v250, v251
    v_add_f32 v244, v244, v250
    v_mfma_f32_16x16x32_bf16 v[156:159], v[200:203], v[104:107], v[156:159]
    ds_read_b128 v[200:203], v216 offset:14336
    v_add_f32 v244, v244, v251
    v_mfma_f32_16x16x32_bf16 v[144:147], v[204:207], v[12:15], v[144:147]
    v_exp_f32 v208, v132
    v_mfma_f32_16x16x32_bf16 v[148:151], v[204:207], v[44:47], v[148:151]
    v_exp_f32 v209, v133
    v_mfma_f32_16x16x32_bf16 v[152:155], v[204:207], v[76:79], v[152:155]
    v_cvt_pk_bf16_f32 v164, v208, v209
    v_add_f32 v245, v208, v209
    v_mfma_f32_16x16x32_bf16 v[156:159], v[204:207], v[108:111], v[156:159]
    ds_read_b128 v[204:207], v217 offset:14336
    s_waitcnt lgkmcnt(2)
    v_mfma_f32_16x16x32_bf16 v[144:147], v[192:195], v[16:19], v[144:147]
    v_exp_f32 v210, v134
    v_mfma_f32_16x16x32_bf16 v[148:151], v[192:195], v[48:51], v[148:151]
    v_exp_f32 v211, v135
    v_mfma_f32_16x16x32_bf16 v[152:155], v[192:195], v[80:83], v[152:155]
    v_cvt_pk_bf16_f32 v165, v210, v211
    v_add_f32 v245, v245, v210
    v_mfma_f32_16x16x32_bf16 v[156:159], v[192:195], v[112:115], v[156:159]
    ds_read_b64_tr_b16 v[192:193], v218 offset:32768
    ds_read_b64_tr_b16 v[194:195], v218 offset:34816
    v_mfma_f32_16x16x32_bf16 v[144:147], v[196:199], v[20:23], v[144:147]
    v_add_f32 v245, v245, v211
    v_mfma_f32_16x16x32_bf16 v[148:151], v[196:199], v[52:55], v[148:151]
    v_exp_f32 v212, v136
    v_mfma_f32_16x16x32_bf16 v[152:155], v[196:199], v[84:87], v[152:155]
    s_waitcnt lgkmcnt(2)
    v_mfma_f32_16x16x32_bf16 v[156:159], v[196:199], v[116:119], v[156:159]
    ds_read_b64_tr_b16 v[196:197], v219 offset:32768
    ds_read_b64_tr_b16 v[198:199], v219 offset:34816
    v_mfma_f32_16x16x32_bf16 v[144:147], v[200:203], v[24:27], v[144:147]
    v_exp_f32 v213, v137
    v_mfma_f32_16x16x32_bf16 v[148:151], v[200:203], v[56:59], v[148:151]
    v_cvt_pk_bf16_f32 v168, v212, v213
    v_add_f32 v246, v212, v213
    v_mfma_f32_16x16x32_bf16 v[152:155], v[200:203], v[88:91], v[152:155]
    v_exp_f32 v214, v138
    v_mfma_f32_16x16x32_bf16 v[156:159], v[200:203], v[120:123], v[156:159]
    ds_read_b64_tr_b16 v[200:201], v220 offset:32768
    ds_read_b64_tr_b16 v[202:203], v220 offset:34816
    v_mfma_f32_16x16x32_bf16 v[144:147], v[204:207], v[28:31], v[144:147]
    v_exp_f32 v215, v139
    v_mfma_f32_16x16x32_bf16 v[148:151], v[204:207], v[60:63], v[148:151]
    v_cvt_pk_bf16_f32 v169, v214, v215
    v_add_f32 v246, v246, v214
    v_mfma_f32_16x16x32_bf16 v[152:155], v[204:207], v[92:95], v[152:155]
    v_add_f32 v246, v246, v215
    v_mfma_f32_16x16x32_bf16 v[156:159], v[204:207], v[124:127], v[156:159]
    ds_read_b64_tr_b16 v[204:205], v221 offset:32768
    ds_read_b64_tr_b16 v[206:207], v221 offset:34816
    s_waitcnt vmcnt(17)
    s_barrier
    s_waitcnt lgkmcnt(4)
    v_mfma_f32_16x16x32_bf16 a[0:3], v[192:195], v[176:179], a[0:3]
    s_add_u32 m0, s52, 0
    v_mfma_f32_16x16x32_bf16 a[4:7], v[192:195], v[180:183], a[4:7]
    buffer_load_dwordx4 v222, s[4:7], s44 offen offset:0 lds
    v_mfma_f32_16x16x32_bf16 a[8:11], v[192:195], v[184:187], a[8:11]
    v_exp_f32 v248, v140
    v_mfma_f32_16x16x32_bf16 a[12:15], v[192:195], v[188:191], a[12:15]
    ds_read_b64_tr_b16 v[192:193], v218 offset:36864
    ds_read_b64_tr_b16 v[194:195], v218 offset:38912
    v_mfma_f32_16x16x32_bf16 a[16:19], v[196:199], v[176:179], a[16:19]
    v_exp_f32 v249, v141
    v_mfma_f32_16x16x32_bf16 a[20:23], v[196:199], v[180:183], a[20:23]
    buffer_load_dwordx4 v222, s[4:7], s45 offen offset:1024 lds
    v_mfma_f32_16x16x32_bf16 a[24:27], v[196:199], v[184:187], a[24:27]
    v_cvt_pk_bf16_f32 v172, v248, v249
    s_waitcnt lgkmcnt(2)
    v_mfma_f32_16x16x32_bf16 a[28:31], v[196:199], v[188:191], a[28:31]
    ds_read_b64_tr_b16 v[196:197], v219 offset:36864
    ds_read_b64_tr_b16 v[198:199], v219 offset:38912
    v_mfma_f32_16x16x32_bf16 a[32:35], v[200:203], v[176:179], a[32:35]
    v_add_f32 v247, v248, v249
    v_mfma_f32_16x16x32_bf16 a[36:39], v[200:203], v[180:183], a[36:39]
    buffer_load_dwordx4 v222, s[4:7], s46 offen offset:2048 lds
    v_mfma_f32_16x16x32_bf16 a[40:43], v[200:203], v[184:187], a[40:43]
    v_exp_f32 v250, v142
    v_mfma_f32_16x16x32_bf16 a[44:47], v[200:203], v[188:191], a[44:47]
    ds_read_b64_tr_b16 v[200:201], v220 offset:36864
    ds_read_b64_tr_b16 v[202:203], v220 offset:38912
    v_add_f32 v247, v247, v250
    v_mfma_f32_16x16x32_bf16 a[48:51], v[204:207], v[176:179], a[48:51]
    v_exp_f32 v251, v143
    v_mfma_f32_16x16x32_bf16 a[52:55], v[204:207], v[180:183], a[52:55]
    buffer_load_dwordx4 v222, s[4:7], s47 offen offset:3072 lds
    v_mfma_f32_16x16x32_bf16 a[56:59], v[204:207], v[184:187], a[56:59]
    v_cvt_pk_bf16_f32 v173, v250, v251
    s_waitcnt lgkmcnt(2)
    v_mfma_f32_16x16x32_bf16 a[60:63], v[204:207], v[188:191], a[60:63]
    ds_read_b64_tr_b16 v[204:205], v221 offset:36864
    ds_read_b64_tr_b16 v[206:207], v221 offset:38912
    v_mfma_f32_16x16x32_bf16 a[64:67], v[192:195], v[176:179], a[64:67]
    s_add_u32 m0, s52, 16384
    v_add_f32 v247, v247, v251
    v_mfma_f32_16x16x32_bf16 a[68:71], v[192:195], v[180:183], a[68:71]
    buffer_load_dwordx4 v222, s[4:7], s48 offen offset:0 lds
    v_mfma_f32_16x16x32_bf16 a[72:75], v[192:195], v[184:187], a[72:75]
    v_exp_f32 v208, v144
    v_mfma_f32_16x16x32_bf16 a[76:79], v[192:195], v[188:191], a[76:79]
    ds_read_b64_tr_b16 v[192:193], v218 offset:40960
    ds_read_b64_tr_b16 v[194:195], v218 offset:43008
    v_mfma_f32_16x16x32_bf16 a[80:83], v[196:199], v[176:179], a[80:83]
    v_exp_f32 v209, v145
    v_mfma_f32_16x16x32_bf16 a[84:87], v[196:199], v[180:183], a[84:87]
    buffer_load_dwordx4 v222, s[4:7], s49 offen offset:1024 lds
    v_mfma_f32_16x16x32_bf16 a[88:91], v[196:199], v[184:187], a[88:91]
    v_cvt_pk_bf16_f32 v162, v208, v209
    s_waitcnt lgkmcnt(2)
    v_mfma_f32_16x16x32_bf16 a[92:95], v[196:199], v[188:191], a[92:95]
    ds_read_b64_tr_b16 v[196:197], v219 offset:40960
    ds_read_b64_tr_b16 v[198:199], v219 offset:43008
    v_mfma_f32_16x16x32_bf16 a[96:99], v[200:203], v[176:179], a[96:99]
    v_add_f32 v244, v244, v208
    v_add_f32 v244, v244, v209
    v_mfma_f32_16x16x32_bf16 a[100:103], v[200:203], v[180:183], a[100:103]
    buffer_load_dwordx4 v222, s[4:7], s50 offen offset:2048 lds
    v_mfma_f32_16x16x32_bf16 a[104:107], v[200:203], v[184:187], a[104:107]
    v_exp_f32 v210, v146
    v_mfma_f32_16x16x32_bf16 a[108:111], v[200:203], v[188:191], a[108:111]
    ds_read_b64_tr_b16 v[200:201], v220 offset:40960
    ds_read_b64_tr_b16 v[202:203], v220 offset:43008
    v_mfma_f32_16x16x32_bf16 a[112:115], v[204:207], v[176:179], a[112:115]
    v_exp_f32 v211, v147
    v_mfma_f32_16x16x32_bf16 a[116:119], v[204:207], v[180:183], a[116:119]
    buffer_load_dwordx4 v222, s[4:7], s51 offen offset:3072 lds
    v_mfma_f32_16x16x32_bf16 a[120:123], v[204:207], v[184:187], a[120:123]
    v_cvt_pk_bf16_f32 v163, v210, v211
    s_waitcnt lgkmcnt(2)
    v_mfma_f32_16x16x32_bf16 a[124:127], v[204:207], v[188:191], a[124:127]
    ds_read_b64_tr_b16 v[204:205], v221 offset:40960
    ds_read_b64_tr_b16 v[206:207], v221 offset:43008
    v_mfma_f32_16x16x32_bf16 a[128:131], v[192:195], v[176:179], a[128:131]
    v_add_u32 v222, 0x8000, v222
    v_add_f32 v244, v244, v210
    v_mfma_f32_16x16x32_bf16 a[132:135], v[192:195], v[180:183], a[132:135]
    v_add_f32 v244, v244, v211
    v_mfma_f32_16x16x32_bf16 a[136:139], v[192:195], v[184:187], a[136:139]
    v_exp_f32 v212, v148
    v_mfma_f32_16x16x32_bf16 a[140:143], v[192:195], v[188:191], a[140:143]
    ds_read_b64_tr_b16 v[192:193], v218 offset:45056
    ds_read_b64_tr_b16 v[194:195], v218 offset:47104
    v_add_f32 v245, v245, v212
    v_mfma_f32_16x16x32_bf16 a[144:147], v[196:199], v[176:179], a[144:147]
    v_exp_f32 v213, v149
    v_mfma_f32_16x16x32_bf16 a[148:151], v[196:199], v[180:183], a[148:151]
    v_cvt_pk_bf16_f32 v166, v212, v213
    v_add_f32 v245, v245, v213
    v_mfma_f32_16x16x32_bf16 a[152:155], v[196:199], v[184:187], a[152:155]
    s_waitcnt lgkmcnt(2)
    v_mfma_f32_16x16x32_bf16 a[156:159], v[196:199], v[188:191], a[156:159]
    ds_read_b64_tr_b16 v[196:197], v219 offset:45056
    ds_read_b64_tr_b16 v[198:199], v219 offset:47104
    v_mfma_f32_16x16x32_bf16 a[160:163], v[200:203], v[176:179], a[160:163]
    v_exp_f32 v214, v150
    v_mfma_f32_16x16x32_bf16 a[164:167], v[200:203], v[180:183], a[164:167]
    v_exp_f32 v215, v151
    v_add_f32 v245, v245, v214
    v_mfma_f32_16x16x32_bf16 a[168:171], v[200:203], v[184:187], a[168:171]
    v_cvt_pk_bf16_f32 v167, v214, v215
    v_add_f32 v245, v245, v215
    v_mfma_f32_16x16x32_bf16 a[172:175], v[200:203], v[188:191], a[172:175]
    ds_read_b64_tr_b16 v[200:201], v220 offset:45056
    ds_read_b64_tr_b16 v[202:203], v220 offset:47104
    v_mfma_f32_16x16x32_bf16 a[176:179], v[204:207], v[176:179], a[176:179]
    v_exp_f32 v248, v152
    v_mfma_f32_16x16x32_bf16 a[180:183], v[204:207], v[180:183], a[180:183]
    v_exp_f32 v249, v153
    v_mfma_f32_16x16x32_bf16 a[184:187], v[204:207], v[184:187], a[184:187]
    v_cvt_pk_bf16_f32 v170, v248, v249
    s_waitcnt lgkmcnt(2)
    v_mfma_f32_16x16x32_bf16 a[188:191], v[204:207], v[188:191], a[188:191]
    ds_read_b64_tr_b16 v[204:205], v221 offset:45056
    ds_read_b64_tr_b16 v[206:207], v221 offset:47104
    v_mfma_f32_16x16x32_bf16 a[192:195], v[192:195], v[176:179], a[192:195]
    v_add_f32 v246, v246, v248
    v_add_f32 v246, v246, v249
    v_mfma_f32_16x16x32_bf16 a[196:199], v[192:195], v[180:183], a[196:199]
    v_exp_f32 v250, v154
    v_mfma_f32_16x16x32_bf16 a[200:203], v[192:195], v[184:187], a[200:203]
    v_exp_f32 v251, v155
    v_mfma_f32_16x16x32_bf16 a[204:207], v[192:195], v[188:191], a[204:207]
    ds_read_b128 v[192:195], v216 offset:32768
    v_cvt_pk_bf16_f32 v171, v250, v251
    v_mfma_f32_16x16x32_bf16 a[208:211], v[196:199], v[176:179], a[208:211]
    v_add_f32 v246, v246, v250
    v_add_f32 v246, v246, v251
    v_mfma_f32_16x16x32_bf16 a[212:215], v[196:199], v[180:183], a[212:215]
    v_exp_f32 v208, v156
    v_mfma_f32_16x16x32_bf16 a[216:219], v[196:199], v[184:187], a[216:219]
    v_exp_f32 v209, v157
    v_mfma_f32_16x16x32_bf16 a[220:223], v[196:199], v[188:191], a[220:223]
    ds_read_b128 v[196:199], v217 offset:32768
    s_waitcnt lgkmcnt(2)
    v_mfma_f32_16x16x32_bf16 a[224:227], v[200:203], v[176:179], a[224:227]
    v_cvt_pk_bf16_f32 v174, v208, v209
    v_add_f32 v247, v247, v208
    v_mfma_f32_16x16x32_bf16 a[228:231], v[200:203], v[180:183], a[228:231]
    v_add_f32 v247, v247, v209
    v_max3_f32 v252, v244, v245, v246
    v_mfma_f32_16x16x32_bf16 a[232:235], v[200:203], v[184:187], a[232:235]
    v_exp_f32 v210, v158
    v_mfma_f32_16x16x32_bf16 a[236:239], v[200:203], v[188:191], a[236:239]
    ds_read_b128 v[200:203], v216 offset:36864
    v_add_f32 v247, v247, v210
    v_mfma_f32_16x16x32_bf16 a[240:243], v[204:207], v[176:179], a[240:243]
    v_exp_f32 v211, v159
    v_mfma_f32_16x16x32_bf16 a[244:247], v[204:207], v[180:183], a[244:247]
    v_cvt_pk_bf16_f32 v175, v210, v211
    v_add_f32 v247, v247, v211
    v_mfma_f32_16x16x32_bf16 a[248:251], v[204:207], v[184:187], a[248:251]
    v_max_f32 v252, v252, v247
    v_cmp_nge_f32 vcc, s53, v252
    v_mfma_f32_16x16x32_bf16 a[252:255], v[204:207], v[188:191], a[252:255]
    ds_read_b128 v[204:207], v217 offset:36864
    s_cbranch_vccnz L_stub3
L_back3:
    s_waitcnt vmcnt(8)
    s_barrier
    s_waitcnt lgkmcnt(2)
    v_mfma_f32_16x16x32_bf16 v[128:131], v[192:195], v[0:3], v[224:227]
    v_mfma_f32_16x16x32_bf16 v[132:135], v[192:195], v[32:35], v[228:231]
    buffer_load_dword v255, v254, s[4:7], s96 offen
    v_mfma_f32_16x16x32_bf16 v[136:139], v[192:195], v[64:67], v[232:235]
    v_add_f32 v240, v240, v244
    v_mfma_f32_16x16x32_bf16 v[140:143], v[192:195], v[96:99], v[236:239]
    ds_read_b128 v[192:195], v216 offset:40960
    v_mfma_f32_16x16x32_bf16 v[128:131], v[196:199], v[4:7], v[128:131]
    s_add_u32 s96, s96, 65536
    s_add_u32 m0, s52, 98304
    v_mfma_f32_16x16x32_bf16 v[132:135], v[196:199], v[36:39], v[132:135]
    buffer_load_dwordx4 v223, s[8:11], s44 offen offset:0 lds
    v_mfma_f32_16x16x32_bf16 v[136:139], v[196:199], v[68:71], v[136:139]
    v_add_f32 v241, v241, v245
    v_mfma_f32_16x16x32_bf16 v[140:143], v[196:199], v[100:103], v[140:143]
    ds_read_b128 v[196:199], v217 offset:40960
    s_waitcnt lgkmcnt(2)
    v_mfma_f32_16x16x32_bf16 v[128:131], v[200:203], v[8:11], v[128:131]
    v_mfma_f32_16x16x32_bf16 v[132:135], v[200:203], v[40:43], v[132:135]
    buffer_load_dwordx4 v223, s[8:11], s45 offen offset:1024 lds
    v_mfma_f32_16x16x32_bf16 v[136:139], v[200:203], v[72:75], v[136:139]
    v_add_f32 v242, v242, v246
    v_mfma_f32_16x16x32_bf16 v[140:143], v[200:203], v[104:107], v[140:143]
    ds_read_b128 v[200:203], v216 offset:45056
    v_mfma_f32_16x16x32_bf16 v[128:131], v[204:207], v[12:15], v[128:131]
    v_mfma_f32_16x16x32_bf16 v[132:135], v[204:207], v[44:47], v[132:135]
    buffer_load_dwordx4 v223, s[8:11], s46 offen offset:2048 lds
    v_mfma_f32_16x16x32_bf16 v[136:139], v[204:207], v[76:79], v[136:139]
    v_add_f32 v243, v243, v247
    v_mfma_f32_16x16x32_bf16 v[140:143], v[204:207], v[108:111], v[140:143]
    ds_read_b128 v[204:207], v217 offset:45056
    s_waitcnt lgkmcnt(2)
    v_mfma_f32_16x16x32_bf16 v[128:131], v[192:195], v[16:19], v[128:131]
    v_mfma_f32_16x16x32_bf16 v[132:135], v[192:195], v[48:51], v[132:135]
    buffer_load_dwordx4 v223, s[8:11], s47 offen offset:3072 lds
    v_mfma_f32_16x16x32_bf16 v[136:139], v[192:195], v[80:83], v[136:139]
    v_mfma_f32_16x16x32_bf16 v[140:143], v[192:195], v[112:115], v[140:143]
    ds_read_b128 v[192:195], v216 offset:34816
    v_mfma_f32_16x16x32_bf16 v[128:131], v[196:199], v[20:23], v[128:131]
    s_add_u32 m0, s52, 114688
    v_mfma_f32_16x16x32_bf16 v[132:135], v[196:199], v[52:55], v[132:135]
    buffer_load_dwordx4 v223, s[8:11], s48 offen offset:0 lds
    v_mfma_f32_16x16x32_bf16 v[136:139], v[196:199], v[84:87], v[136:139]
    v_mfma_f32_16x16x32_bf16 v[140:143], v[196:199], v[116:119], v[140:143]
    ds_read_b128 v[196:199], v217 offset:34816
    s_waitcnt lgkmcnt(2)
    v_mfma_f32_16x16x32_bf16 v[128:131], v[200:203], v[24:27], v[128:131]
    v_mfma_f32_16x16x32_bf16 v[132:135], v[200:203], v[56:59], v[132:135]
    buffer_load_dwordx4 v223, s[8:11], s49 offen offset:1024 lds
    v_mfma_f32_16x16x32_bf16 v[136:139], v[200:203], v[88:91], v[136:139]
    v_mfma_f32_16x16x32_bf16 v[140:143], v[200:203], v[120:123], v[140:143]
    ds_read_b128 v[200:203], v216 offset:38912
    v_mfma_f32_16x16x32_bf16 v[128:131], v[204:207], v[28:31], v[128:131]
    v_mfma_f32_16x16x32_bf16 v[132:135], v[204:207], v[60:63], v[132:135]
    buffer_load_dwordx4 v223, s[8:11], s50 offen offset:2048 lds
    v_mfma_f32_16x16x32_bf16 v[136:139], v[204:207], v[92:95], v[136:139]
    v_mfma_f32_16x16x32_bf16 v[140:143], v[204:207], v[124:127], v[140:143]
    ds_read_b128 v[204:207], v217 offset:38912
    s_waitcnt lgkmcnt(2)
    v_mfma_f32_16x16x32_bf16 v[144:147], v[192:195], v[0:3], v[224:227]
    v_mfma_f32_16x16x32_bf16 v[148:151], v[192:195], v[32:35], v[228:231]
    buffer_load_dwordx4 v223, s[8:11], s51 offen offset:3072 lds
    v_mfma_f32_16x16x32_bf16 v[152:155], v[192:195], v[64:67], v[232:235]
    v_exp_f32 v248, v128
    v_mfma_f32_16x16x32_bf16 v[156:159], v[192:195], v[96:99], v[236:239]
    ds_read_b128 v[192:195], v216 offset:43008
    v_mfma_f32_16x16x32_bf16 v[144:147], v[196:199], v[4:7], v[144:147]
    v_add_u32 v223, 0x8000, v223
    v_mfma_f32_16x16x32_bf16 v[148:151], v[196:199], v[36:39], v[148:151]
    v_exp_f32 v249, v129
    v_mfma_f32_16x16x32_bf16 v[152:155], v[196:199], v[68:71], v[152:155]
    v_cvt_pk_bf16_f32 v176, v248, v249
    v_add_f32 v244, v248, v249
    v_mfma_f32_16x16x32_bf16 v[156:159], v[196:199], v[100:103], v[156:159]
    ds_read_b128 v[196:199], v217 offset:43008
    s_waitcnt lgkmcnt(2)
    v_mfma_f32_16x16x32_bf16 v[144:147], v[200:203], v[8:11], v[144:147]
    v_exp_f32 v250, v130
    v_mfma_f32_16x16x32_bf16 v[148:151], v[200:203], v[40:43], v[148:151]
    v_exp_f32 v251, v131
    v_mfma_f32_16x16x32_bf16 v[152:155], v[200:203], v[72:75], v[152:155]
    v_cvt_pk_bf16_f32 v177, v250, v251
    v_add_f32 v244, v244, v250
    v_mfma_f32_16x16x32_bf16 v[156:159], v[200:203], v[104:107], v[156:159]
    ds_read_b128 v[200:203], v216 offset:47104
    v_add_f32 v244, v244, v251
    v_mfma_f32_16x16x32_bf16 v[144:147], v[204:207], v[12:15], v[144:147]
    v_exp_f32 v208, v132
    v_mfma_f32_16x16x32_bf16 v[148:151], v[204:207], v[44:47], v[148:151]
    v_exp_f32 v209, v133
    v_mfma_f32_16x16x32_bf16 v[152:155], v[204:207], v[76:79], v[152:155]
    v_cvt_pk_bf16_f32 v180, v208, v209
    v_add_f32 v245, v208, v209
    v_mfma_f32_16x16x32_bf16 v[156:159], v[204:207], v[108:111], v[156:159]
    ds_read_b128 v[204:207], v217 offset:47104
    s_waitcnt lgkmcnt(2)
    v_mfma_f32_16x16x32_bf16 v[144:147], v[192:195], v[16:19], v[144:147]
    v_exp_f32 v210, v134
    v_mfma_f32_16x16x32_bf16 v[148:151], v[192:195], v[48:51], v[148:151]
    v_exp_f32 v211, v135
    v_mfma_f32_16x16x32_bf16 v[152:155], v[192:195], v[80:83], v[152:155]
    v_cvt_pk_bf16_f32 v181, v210, v211
    v_add_f32 v245, v245, v210
    v_mfma_f32_16x16x32_bf16 v[156:159], v[192:195], v[112:115], v[156:159]
    ds_read_b64_tr_b16 v[192:193], v218 offset:0
    ds_read_b64_tr_b16 v[194:195], v218 offset:2048
    v_mfma_f32_16x16x32_bf16 v[144:147], v[196:199], v[20:23], v[144:147]
    v_add_f32 v245, v245, v211
    v_mfma_f32_16x16x32_bf16 v[148:151], v[196:199], v[52:55], v[148:151]
    v_exp_f32 v212, v136
    v_mfma_f32_16x16x32_bf16 v[152:155], v[196:199], v[84:87], v[152:155]
    s_waitcnt lgkmcnt(2)
    v_mfma_f32_16x16x32_bf16 v[156:159], v[196:199], v[116:119], v[156:159]
    ds_read_b64_tr_b16 v[196:197], v219 offset:0
    ds_read_b64_tr_b16 v[198:199], v219 offset:2048
    v_mfma_f32_16x16x32_bf16 v[144:147], v[200:203], v[24:27], v[144:147]
    v_exp_f32 v213, v137
    v_mfma_f32_16x16x32_bf16 v[148:151], v[200:203], v[56:59], v[148:151]
    v_cvt_pk_bf16_f32 v184, v212, v213
    v_add_f32 v246, v212, v213
    v_mfma_f32_16x16x32_bf16 v[152:155], v[200:203], v[88:91], v[152:155]
    v_exp_f32 v214, v138
    v_mfma_f32_16x16x32_bf16 v[156:159], v[200:203], v[120:123], v[156:159]
    ds_read_b64_tr_b16 v[200:201], v220 offset:0
    ds_read_b64_tr_b16 v[202:203], v220 offset:2048
    v_mfma_f32_16x16x32_bf16 v[144:147], v[204:207], v[28:31], v[144:147]
    v_exp_f32 v215, v139
    v_mfma_f32_16x16x32_bf16 v[148:151], v[204:207], v[60:63], v[148:151]
    v_cvt_pk_bf16_f32 v185, v214, v215
    v_add_f32 v246, v246, v214
    v_mfma_f32_16x16x32_bf16 v[152:155], v[204:207], v[92:95], v[152:155]
    v_add_f32 v246, v246, v215
    v_mfma_f32_16x16x32_bf16 v[156:159], v[204:207], v[124:127], v[156:159]
    ds_read_b64_tr_b16 v[204:205], v221 offset:0
    ds_read_b64_tr_b16 v[206:207], v221 offset:2048
    s_waitcnt vmcnt(9)
    s_barrier
    s_waitcnt lgkmcnt(4)
    v_mfma_f32_16x16x32_bf16 a[0:3], v[192:195], v[160:163], a[0:3]
    s_add_u32 m0, s52, 32768
    v_mfma_f32_16x16x32_bf16 a[4:7], v[192:195], v[164:167], a[4:7]
    buffer_load_dwordx4 v222, s[4:7], s44 offen offset:0 lds
    v_mfma_f32_16x16x32_bf16 a[8:11], v[192:195], v[168:171], a[8:11]
    v_exp_f32 v248, v140
    v_mfma_f32_16x16x32_bf16 a[12:15], v[192:195], v[172:175], a[12:15]
    ds_read_b64_tr_b16 v[192:193], v218 offset:4096
    ds_read_b64_tr_b16 v[194:195], v218 offset:6144
    v_mfma_f32_16x16x32_bf16 a[16:19], v[196:199], v[160:163], a[16:19]
    v_exp_f32 v249, v141
    v_mfma_f32_16x16x32_bf16 a[20:23], v[196:199], v[164:167], a[20:23]
    buffer_load_dwordx4 v222, s[4:7], s45 offen offset:1024 lds
    v_mfma_f32_16x16x32_bf16 a[24:27], v[196:199], v[168:171], a[24:27]
    v_cvt_pk_bf16_f32 v188, v248, v249
    s_waitcnt lgkmcnt(2)
    v_mfma_f32_16x16x32_bf16 a[28:31], v[196:199], v[172:175], a[28:31]
    ds_read_b64_tr_b16 v[196:197], v219 offset:4096
    ds_read_b64_tr_b16 v[198:199], v219 offset:6144
    v_mfma_f32_16x16x32_bf16 a[32:35], v[200:203], v[160:163], a[32:35]
    v_add_f32 v247, v248, v249
    v_mfma_f32_16x16x32_bf16 a[36:39], v[200:203], v[164:167], a[36:39]
    buffer_load_dwordx4 v222, s[4:7], s46 offen offset:2048 lds
    v_mfma_f32_16x16x32_bf16 a[40:43], v[200:203], v[168:171], a[40:43]
    v_exp_f32 v250, v142
    v_mfma_f32_16x16x32_bf16 a[44:47], v[200:203], v[172:175], a[44:47]
    ds_read_b64_tr_b16 v[200:201], v220 offset:4096
    ds_read_b64_tr_b16 v[202:203], v220 offset:6144
    v_add_f32 v247, v247, v250
    v_mfma_f32_16x16x32_bf16 a[48:51], v[204:207], v[160:163], a[48:51]
    v_exp_f32 v251, v143
    v_mfma_f32_16x16x32_bf16 a[52:55], v[204:207], v[164:167], a[52:55]
    buffer_load_dwordx4 v222, s[4:7], s47 offen offset:3072 lds
    v_mfma_f32_16x16x32_bf16 a[56:59], v[204:207], v[168:171], a[56:59]
    v_cvt_pk_bf16_f32 v189, v250, v251
    s_waitcnt lgkmcnt(2)
    v_mfma_f32_16x16x32_bf16 a[60:63], v[204:207], v[172:175], a[60:63]
    ds_read_b64_tr_b16 v[204:205], v221 offset:4096
    ds_read_b64_tr_b16 v[206:207], v221 offset:6144
    v_mfma_f32_16x16x32_bf16 a[64:67], v[192:195], v[160:163], a[64:67]
    s_add_u32 m0, s52, 49152
    v_add_f32 v247, v247, v251
    v_mfma_f32_16x16x32_bf16 a[68:71], v[192:195], v[164:167], a[68:71]
    buffer_load_dwordx4 v222, s[4:7], s48 offen offset:0 lds
    v_mfma_f32_16x16x32_bf16 a[72:75], v[192:195], v[168:171], a[72:75]
    v_exp_f32 v208, v144
    v_mfma_f32_16x16x32_bf16 a[76:79], v[192:195], v[172:175], a[76:79]
    ds_read_b64_tr_b16 v[192:193], v218 offset:8192
    ds_read_b64_tr_b16 v[194:195], v218 offset:10240
    v_mfma_f32_16x16x32_bf16 a[80:83], v[196:199], v[160:163], a[80:83]
    v_exp_f32 v209, v145
    v_mfma_f32_16x16x32_bf16 a[84:87], v[196:199], v[164:167], a[84:87]
    buffer_load_dwordx4 v222, s[4:7], s49 offen offset:1024 lds
    v_mfma_f32_16x16x32_bf16 a[88:91], v[196:199], v[168:171], a[88:91]
    v_cvt_pk_bf16_f32 v178, v208, v209
    s_waitcnt lgkmcnt(2)
    v_mfma_f32_16x16x32_bf16 a[92:95], v[196:199], v[172:175], a[92:95]
    ds_read_b64_tr_b16 v[196:197], v219 offset:8192
    ds_read_b64_tr_b16 v[198:199], v219 offset:10240
    v_mfma_f32_16x16x32_bf16 a[96:99], v[200:203], v[160:163], a[96:99]
    v_add_f32 v244, v244, v208
    v_add_f32 v244, v244, v209
    v_mfma_f32_16x16x32_bf16 a[100:103], v[200:203], v[164:167], a[100:103]
    buffer_load_dwordx4 v222, s[4:7], s50 offen offset:2048 lds
    v_mfma_f32_16x16x32_bf16 a[104:107], v[200:203], v[168:171], a[104:107]
    v_exp_f32 v210, v146
    v_mfma_f32_16x16x32_bf16 a[108:111], v[200:203], v[172:175], a[108:111]
    ds_read_b64_tr_b16 v[200:201], v220 offset:8192
    ds_read_b64_tr_b16 v[202:203], v220 offset:10240
    v_mfma_f32_16x16x32_bf16 a[112:115], v[204:207], v[160:163], a[112:115]
    v_exp_f32 v211, v147
    v_mfma_f32_16x16x32_bf16 a[116:119], v[204:207], v[164:167], a[116:119]
    buffer_load_dwordx4 v222, s[4:7], s51 offen offset:3072 lds
    v_mfma_f32_16x16x32_bf16 a[120:123], v[204:207], v[168:171], a[120:123]
    v_cvt_pk_bf16_f32 v179, v210, v211
    s_waitcnt lgkmcnt(2)
    v_mfma_f32_16x16x32_bf16 a[124:127], v[204:207], v[172:175], a[124:127]
    ds_read_b64_tr_b16 v[204:205], v221 offset:8192
    ds_read_b64_tr_b16 v[206:207], v221 offset:10240
    v_mfma_f32_16x16x32_bf16 a[128:131], v[192:195], v[160:163], a[128:131]
    v_add_u32 v222, 0x8000, v222
    v_add_f32 v244, v244, v210
    v_mfma_f32_16x16x32_bf16 a[132:135], v[192:195], v[164:167], a[132:135]
    v_add_f32 v244, v244, v211
    v_mfma_f32_16x16x32_bf16 a[136:139], v[192:195], v[168:171], a[136:139]
    v_exp_f32 v212, v148
    v_mfma_f32_16x16x32_bf16 a[140:143], v[192:195], v[172:175], a[140:143]
    ds_read_b64_tr_b16 v[192:193], v218 offset:12288
    ds_read_b64_tr_b16 v[194:195], v218 offset:14336
    v_add_f32 v245, v245, v212
    v_mfma_f32_16x16x32_bf16 a[144:147], v[196:199], v[160:163], a[144:147]
    v_exp_f32 v213, v149
    v_mfma_f32_16x16x32_bf16 a[148:151], v[196:199], v[164:167], a[148:151]
    v_cvt_pk_bf16_f32 v182, v212, v213
    v_add_f32 v245, v245, v213
    v_mfma_f32_16x16x32_bf16 a[152:155], v[196:199], v[168:171], a[152:155]
    s_waitcnt lgkmcnt(2)
    v_mfma_f32_16x16x32_bf16 a[156:159], v[196:199], v[172:175], a[156:159]
    ds_read_b64_tr_b16 v[196:197], v219 offset:12288
    ds_read_b64_tr_b16 v[198:199], v219 offset:14336
    v_mfma_f32_16x16x32_bf16 a[160:163], v[200:203], v[160:163], a[160:163]
    v_exp_f32 v214, v150
    v_mfma_f32_16x16x32_bf16 a[164:167], v[200:203], v[164:167], a[164:167]
    v_exp_f32 v215, v151
    v_add_f32 v245, v245, v214
    v_mfma_f32_16x16x32_bf16 a[168:171], v[200:203], v[168:171], a[168:171]
    v_cvt_pk_bf16_f32 v183, v214, v215
    v_add_f32 v245, v245, v215
    v_mfma_f32_16x16x32_bf16 a[172:175], v[200:203], v[172:175], a[172:175]
    ds_read_b64_tr_b16 v[200:201], v220 offset:12288
    ds_read_b64_tr_b16 v[202:203], v220 offset:14336
    v_mfma_f32_16x16x32_bf16 a[176:179], v[204:207], v[160:163], a[176:179]
    v_exp_f32 v248, v152
    v_mfma_f32_16x16x32_bf16 a[180:183], v[204:207], v[164:167], a[180:183]
    v_exp_f32 v249, v153
    v_mfma_f32_16x16x32_bf16 a[184:187], v[204:207], v[168:171], a[184:187]
    v_cvt_pk_bf16_f32 v186, v248, v249
    s_waitcnt lgkmcnt(2)
    v_mfma_f32_16x16x32_bf16 a[188:191], v[204:207], v[172:175], a[188:191]
    ds_read_b64_tr_b16 v[204:205], v221 offset:12288
    ds_read_b64_tr_b16 v[206:207], v221 offset:14336
    v_mfma_f32_16x16x32_bf16 a[192:195], v[192:195], v[160:163], a[192:195]
    v_add_f32 v246, v246, v248
    v_add_f32 v246, v246, v249
    v_mfma_f32_16x16x32_bf16 a[196:199], v[192:195], v[164:167], a[196:199]
    v_exp_f32 v250, v154
    v_mfma_f32_16x16x32_bf16 a[200:203], v[192:195], v[168:171], a[200:203]
    v_exp_f32 v251, v155
    v_mfma_f32_16x16x32_bf16 a[204:207], v[192:195], v[172:175], a[204:207]
    ds_read_b128 v[192:195], v216 offset:0
    v_cvt_pk_bf16_f32 v187, v250, v251
    v_mfma_f32_16x16x32_bf16 a[208:211], v[196:199], v[160:163], a[208:211]
    v_add_f32 v246, v246, v250
    v_add_f32 v246, v246, v251
    v_mfma_f32_16x16x32_bf16 a[212:215], v[196:199], v[164:167], a[212:215]
    v_exp_f32 v208, v156
    v_mfma_f32_16x16x32_bf16 a[216:219], v[196:199], v[168:171], a[216:219]
    v_exp_f32 v209, v157
    v_mfma_f32_16x16x32_bf16 a[220:223], v[196:199], v[172:175], a[220:223]
    ds_read_b128 v[196:199], v217 offset:0
    s_waitcnt lgkmcnt(2)
    v_mfma_f32_16x16x32_bf16 a[224:227], v[200:203], v[160:163], a[224:227]
    v_cvt_pk_bf16_f32 v190, v208, v209
    v_add_f32 v247, v247, v208
    v_mfma_f32_16x16x32_bf16 a[228:231], v[200:203], v[164:167], a[228:231]
    v_add_f32 v247, v247, v209
    v_max3_f32 v252, v244, v245, v246
    v_mfma_f32_16x16x32_bf16 a[232:235], v[200:203], v[168:171], a[232:235]
    v_exp_f32 v210, v158
    v_mfma_f32_16x16x32_bf16 a[236:239], v[200:203], v[172:175], a[236:239]
    ds_read_b128 v[200:203], v216 offset:4096
    v_add_f32 v247, v247, v210
    v_mfma_f32_16x16x32_bf16 a[240:243], v[204:207], v[160:163], a[240:243]
    v_exp_f32 v211, v159
    v_mfma_f32_16x16x32_bf16 a[244:247], v[204:207], v[164:167], a[244:247]
    v_cvt_pk_bf16_f32 v191, v210, v211
    v_add_f32 v247, v247, v211
    v_mfma_f32_16x16x32_bf16 a[248:251], v[204:207], v[168:171], a[248:251]
    v_max_f32 v252, v252, v247
    v_cmp_nge_f32 vcc, s53, v252
    v_mfma_f32_16x16x32_bf16 a[252:255], v[204:207], v[172:175], a[252:255]
    ds_read_b128 v[204:207], v217 offset:4096
    s_cbranch_vccnz L_stub4
L_back4:
    s_branch L_k2_bottom
L_rare0:
    s_nop 7
    v_max3_f32 v208, v128, v129, v130
    v_max3_f32 v208, v208, v131, v144
    v_max3_f32 v208, v208, v145, v146
    v_max_f32 v208, v208, v147
    v_max3_f32 v209, v132, v133, v134
    v_max3_f32 v209, v209, v135, v148
    v_max3_f32 v209, v209, v149, v150
    v_max_f32 v209, v209, v151
    v_max3_f32 v210, v136, v137, v138
    v_max3_f32 v210, v210, v139, v152
    v_max3_f32 v210, v210, v153, v154
    v_max_f32 v210, v210, v155
    v_max3_f32 v211, v140, v141, v142
    v_max3_f32 v211, v211, v143, v156
    v_max3_f32 v211, v211, v157, v158
    v_max_f32 v211, v211, v159
    v_mov_b32 v212, v208
    v_mov_b32 v213, v209
    v_mov_b32 v214, v210
    v_mov_b32 v215, v211
    s_nop 1
    v_permlane32_swap_b32 v208, v212
    v_permlane32_swap_b32 v209, v213
    v_permlane32_swap_b32 v210, v214
    v_permlane32_swap_b32 v211, v215
    s_nop 1
    v_max_f32 v208, v208, v212
    v_max_f32 v209, v209, v213
    v_max_f32 v210, v210, v214
    v_max_f32 v211, v211, v215
    v_mov_b32 v212, v208
    v_mov_b32 v213, v209
    v_mov_b32 v214, v210
    v_mov_b32 v215, v211
    s_nop 1
    v_permlane16_swap_b32 v208, v212
    v_permlane16_swap_b32 v209, v213
    v_permlane16_swap_b32 v210, v214
    v_permlane16_swap_b32 v211, v215
    s_nop 1
    v_max_f32 v208, v208, v212
    v_max_f32 v209, v209, v213
    v_max_f32 v210, v210, v214
    v_max_f32 v211, v211, v215
    v_add_f32 v208, 0x42c80000, v208
    v_add_f32 v209, 0x42c80000, v209
    v_add_f32 v210, 0x42c80000, v210
    v_add_f32 v211, 0x42c80000, v211
    v_max_f32 v208, 0, v208
    v_max_f32 v209, 0, v209
    v_max_f32 v210, 0, v210
    v_max_f32 v211, 0, v211
    v_ceil_f32 v208, v208
    v_ceil_f32 v209, v209
    v_ceil_f32 v210, v210
    v_ceil_f32 v211, v211
    v_sub_f32 v224, v224, v208
    v_sub_f32 v225, v225, v208
    v_sub_f32 v226, v226, v208
    v_sub_f32 v227, v227, v208
    v_sub_f32 v228, v228, v209
    v_sub_f32 v229, v229, v209
    v_sub_f32 v230, v230, v209
    v_sub_f32 v231, v231, v209
    v_sub_f32 v232, v232, v210
    v_sub_f32 v233, v233, v210
    v_sub_f32 v234, v234, v210
    v_sub_f32 v235, v235, v210
    v_sub_f32 v236, v236, v211
    v_sub_f32 v237, v237, v211
    v_sub_f32 v238, v238, v211
    v_sub_f32 v239, v239, v211
    v_cvt_i32_f32 v212, -v208
    v_cvt_i32_f32 v213, -v209
    v_cvt_i32_f32 v214, -v210
    v_cvt_i32_f32 v215, -v211
    s_setreg_imm32_b32 hwreg(HW_REG_MODE, 4, 2), 3
    s_nop 1
    v_ldexp_f32 v240, v240, v212
    v_ldexp_f32 v241, v241, v213
    v_ldexp_f32 v242, v242, v214
    v_ldexp_f32 v243, v243, v215
    v_accvgpr_read_b32 v248, a0
    v_accvgpr_read_b32 v249, a1
    v_accvgpr_read_b32 v250, a2
    v_accvgpr_read_b32 v251, a3
    v_ldexp_f32 v248, v248, v212
    v_ldexp_f32 v249, v249, v212
    v_ldexp_f32 v250, v250, v212
    v_ldexp_f32 v251, v251, v212
    v_accvgpr_write_b32 a0, v248
    v_accvgpr_write_b32 a1, v249
    v_accvgpr_write_b32 a2, v250
    v_accvgpr_write_b32 a3, v251
    v_accvgpr_read_b32 v248, a4
    v_accvgpr_read_b32 v249, a5
    v_accvgpr_read_b32 v250, a6
    v_accvgpr_read_b32 v251, a7
    v_ldexp_f32 v248, v248, v213
    v_ldexp_f32 v249, v249, v213
    v_ldexp_f32 v250, v250, v213
    v_ldexp_f32 v251, v251, v213
    v_accvgpr_write_b32 a4, v248
    v_accvgpr_write_b32 a5, v249
    v_accvgpr_write_b32 a6, v250
    v_accvgpr_write_b32 a7, v251
    v_accvgpr_read_b32 v248, a8
    v_accvgpr_read_b32 v249, a9
    v_accvgpr_read_b32 v250, a10
    v_accvgpr_read_b32 v251, a11
    v_ldexp_f32 v248, v248, v214
    v_ldexp_f32 v249, v249, v214
    v_ldexp_f32 v250, v250, v214
    v_ldexp_f32 v251, v251, v214
    v_accvgpr_write_b32 a8, v248
    v_accvgpr_write_b32 a9, v249
    v_accvgpr_write_b32 a10, v250
    v_accvgpr_write_b32 a11, v251
    v_accvgpr_read_b32 v248, a12
    v_accvgpr_read_b32 v249, a13
    v_accvgpr_read_b32 v250, a14
    v_accvgpr_read_b32 v251, a15
    v_ldexp_f32 v248, v248, v215
    v_ldexp_f32 v249, v249, v215
    v_ldexp_f32 v250, v250, v215
    v_ldexp_f32 v251, v251, v215
    v_accvgpr_write_b32 a12, v248
    v_accvgpr_write_b32 a13, v249
    v_accvgpr_write_b32 a14, v250
    v_accvgpr_write_b32 a15, v251
    v_accvgpr_read_b32 v248, a16
    v_accvgpr_read_b32 v249, a17
    v_accvgpr_read_b32 v250, a18
    v_accvgpr_read_b32 v251, a19
    v_ldexp_f32 v248, v248, v212
    v_ldexp_f32 v249, v249, v212
    v_ldexp_f32 v250, v250, v212
    v_ldexp_f32 v251, v251, v212
    v_accvgpr_write_b32 a16, v248
    v_accvgpr_write_b32 a17, v249
    v_accvgpr_write_b32 a18, v250
    v_accvgpr_write_b32 a19, v251
    v_accvgpr_read_b32 v248, a20
    v_accvgpr_read_b32 v249, a21
    v_accvgpr_read_b32 v250, a22
    v_accvgpr_read_b32 v251, a23
    v_ldexp_f32 v248, v248, v213
    v_ldexp_f32 v249, v249, v213
    v_ldexp_f32 v250, v250, v213
    v_ldexp_f32 v251, v251, v213
    v_accvgpr_write_b32 a20, v248
    v_accvgpr_write_b32 a21, v249
    v_accvgpr_write_b32 a22, v250
    v_accvgpr_write_b32 a23, v251
    v_accvgpr_read_b32 v248, a24
    v_accvgpr_read_b32 v249, a25
    v_accvgpr_read_b32 v250, a26
    v_accvgpr_read_b32 v251, a27
    v_ldexp_f32 v248, v248, v214
    v_ldexp_f32 v249, v249, v214
    v_ldexp_f32 v250, v250, v214
    v_ldexp_f32 v251, v251, v214
    v_accvgpr_write_b32 a24, v248
    v_accvgpr_write_b32 a25, v249
    v_accvgpr_write_b32 a26, v250
    v_accvgpr_write_b32 a27, v251
    v_accvgpr_read_b32 v248, a28
    v_accvgpr_read_b32 v249, a29
    v_accvgpr_read_b32 v250, a30
    v_accvgpr_read_b32 v251, a31
    v_ldexp_f32 v248, v248, v215
    v_ldexp_f32 v249, v249, v215
    v_ldexp_f32 v250, v250, v215
    v_ldexp_f32 v251, v251, v215
    v_accvgpr_write_b32 a28, v248
    v_accvgpr_write_b32 a29, v249
    v_accvgpr_write_b32 a30, v250
    v_accvgpr_write_b32 a31, v251
    v_accvgpr_read_b32 v248, a32
    v_accvgpr_read_b32 v249, a33
    v_accvgpr_read_b32 v250, a34
    v_accvgpr_read_b32 v251, a35
    v_ldexp_f32 v248, v248, v212
    v_ldexp_f32 v249, v249, v212
    v_ldexp_f32 v250, v250, v212
    v_ldexp_f32 v251, v251, v212
    v_accvgpr_write_b32 a32, v248
    v_accvgpr_write_b32 a33, v249
    v_accvgpr_write_b32 a34, v250
    v_accvgpr_write_b32 a35, v251
    v_accvgpr_read_b32 v248, a36
    v_accvgpr_read_b32 v249, a37
    v_accvgpr_read_b32 v250, a38
    v_accvgpr_read_b32 v251, a39
    v_ldexp_f32 v248, v248, v213
    v_ldexp_f32 v249, v249, v213
    v_ldexp_f32 v250, v250, v213
    v_ldexp_f32 v251, v251, v213
    v_accvgpr_write_b32 a36, v248
    v_accvgpr_write_b32 a37, v249
    v_accvgpr_write_b32 a38, v250
    v_accvgpr_write_b32 a39, v251
    v_accvgpr_read_b32 v248, a40
    v_accvgpr_read_b32 v249, a41
    v_accvgpr_read_b32 v250, a42
    v_accvgpr_read_b32 v251, a43
    v_ldexp_f32 v248, v248, v214
    v_ldexp_f32 v249, v249, v214
    v_ldexp_f32 v250, v250, v214
    v_ldexp_f32 v251, v251, v214
    v_accvgpr_write_b32 a40, v248
    v_accvgpr_write_b32 a41, v249
    v_accvgpr_write_b32 a42, v250
    v_accvgpr_write_b32 a43, v251
    v_accvgpr_read_b32 v248, a44
    v_accvgpr_read_b32 v249, a45
    v_accvgpr_read_b32 v250, a46
    v_accvgpr_read_b32 v251, a47
    v_ldexp_f32 v248, v248, v215
    v_ldexp_f32 v249, v249, v215
    v_ldexp_f32 v250, v250, v215
    v_ldexp_f32 v251, v251, v215
    v_accvgpr_write_b32 a44, v248
    v_accvgpr_write_b32 a45, v249
    v_accvgpr_write_b32 a46, v250
    v_accvgpr_write_b32 a47, v251
    v_accvgpr_read_b32 v248, a48
    v_accvgpr_read_b32 v249, a49
    v_accvgpr_read_b32 v250, a50
    v_accvgpr_read_b32 v251, a51
    v_ldexp_f32 v248, v248, v212
    v_ldexp_f32 v249, v249, v212
    v_ldexp_f32 v250, v250, v212
    v_ldexp_f32 v251, v251, v212
    v_accvgpr_write_b32 a48, v248
    v_accvgpr_write_b32 a49, v249
    v_accvgpr_write_b32 a50, v250
    v_accvgpr_write_b32 a51, v251
    v_accvgpr_read_b32 v248, a52
    v_accvgpr_read_b32 v249, a53
    v_accvgpr_read_b32 v250, a54
    v_accvgpr_read_b32 v251, a55
    v_ldexp_f32 v248, v248, v213
    v_ldexp_f32 v249, v249, v213
    v_ldexp_f32 v250, v250, v213
    v_ldexp_f32 v251, v251, v213
    v_accvgpr_write_b32 a52, v248
    v_accvgpr_write_b32 a53, v249
    v_accvgpr_write_b32 a54, v250
    v_accvgpr_write_b32 a55, v251
    v_accvgpr_read_b32 v248, a56
    v_accvgpr_read_b32 v249, a57
    v_accvgpr_read_b32 v250, a58
    v_accvgpr_read_b32 v251, a59
    v_ldexp_f32 v248, v248, v214
    v_ldexp_f32 v249, v249, v214
    v_ldexp_f32 v250, v250, v214
    v_ldexp_f32 v251, v251, v214
    v_accvgpr_write_b32 a56, v248
    v_accvgpr_write_b32 a57, v249
    v_accvgpr_write_b32 a58, v250
    v_accvgpr_write_b32 a59, v251
    v_accvgpr_read_b32 v248, a60
    v_accvgpr_read_b32 v249, a61
    v_accvgpr_read_b32 v250, a62
    v_accvgpr_read_b32 v251, a63
    v_ldexp_f32 v248, v248, v215
    v_ldexp_f32 v249, v249, v215
    v_ldexp_f32 v250, v250, v215
    v_ldexp_f32 v251, v251, v215
    v_accvgpr_write_b32 a60, v248
    v_accvgpr_write_b32 a61, v249
    v_accvgpr_write_b32 a62, v250
    v_accvgpr_write_b32 a63, v251
    v_accvgpr_read_b32 v248, a64
    v_accvgpr_read_b32 v249, a65
    v_accvgpr_read_b32 v250, a66
    v_accvgpr_read_b32 v251, a67
    v_ldexp_f32 v248, v248, v212
    v_ldexp_f32 v249, v249, v212
    v_ldexp_f32 v250, v250, v212
    v_ldexp_f32 v251, v251, v212
    v_accvgpr_write_b32 a64, v248
    v_accvgpr_write_b32 a65, v249
    v_accvgpr_write_b32 a66, v250
    v_accvgpr_write_b32 a67, v251
    v_accvgpr_read_b32 v248, a68
    v_accvgpr_read_b32 v249, a69
    v_accvgpr_read_b32 v250, a70
    v_accvgpr_read_b32 v251, a71
    v_ldexp_f32 v248, v248, v213
    v_ldexp_f32 v249, v249, v213
    v_ldexp_f32 v250, v250, v213
    v_ldexp_f32 v251, v251, v213
    v_accvgpr_write_b32 a68, v248
    v_accvgpr_write_b32 a69, v249
    v_accvgpr_write_b32 a70, v250
    v_accvgpr_write_b32 a71, v251
    v_accvgpr_read_b32 v248, a72
    v_accvgpr_read_b32 v249, a73
    v_accvgpr_read_b32 v250, a74
    v_accvgpr_read_b32 v251, a75
    v_ldexp_f32 v248, v248, v214
    v_ldexp_f32 v249, v249, v214
    v_ldexp_f32 v250, v250, v214
    v_ldexp_f32 v251, v251, v214
    v_accvgpr_write_b32 a72, v248
    v_accvgpr_write_b32 a73, v249
    v_accvgpr_write_b32 a74, v250
    v_accvgpr_write_b32 a75, v251
    v_accvgpr_read_b32 v248, a76
    v_accvgpr_read_b32 v249, a77
    v_accvgpr_read_b32 v250, a78
    v_accvgpr_read_b32 v251, a79
    v_ldexp_f32 v248, v248, v215
    v_ldexp_f32 v249, v249, v215
    v_ldexp_f32 v250, v250, v215
    v_ldexp_f32 v251, v251, v215
    v_accvgpr_write_b32 a76, v248
    v_accvgpr_write_b32 a77, v249
    v_accvgpr_write_b32 a78, v250
    v_accvgpr_write_b32 a79, v251
    v_accvgpr_read_b32 v248, a80
    v_accvgpr_read_b32 v249, a81
    v_accvgpr_read_b32 v250, a82
    v_accvgpr_read_b32 v251, a83
    v_ldexp_f32 v248, v248, v212
    v_ldexp_f32 v249, v249, v212
    v_ldexp_f32 v250, v250, v212
    v_ldexp_f32 v251, v251, v212
    v_accvgpr_write_b32 a80, v248
    v_accvgpr_write_b32 a81, v249
    v_accvgpr_write_b32 a82, v250
    v_accvgpr_write_b32 a83, v251
    v_accvgpr_read_b32 v248, a84
    v_accvgpr_read_b32 v249, a85
    v_accvgpr_read_b32 v250, a86
    v_accvgpr_read_b32 v251, a87
    v_ldexp_f32 v248, v248, v213
    v_ldexp_f32 v249, v249, v213
    v_ldexp_f32 v250, v250, v213
    v_ldexp_f32 v251, v251, v213
    v_accvgpr_write_b32 a84, v248
    v_accvgpr_write_b32 a85, v249
    v_accvgpr_write_b32 a86, v250
    v_accvgpr_write_b32 a87, v251
    v_accvgpr_read_b32 v248, a88
    v_accvgpr_read_b32 v249, a89
    v_accvgpr_read_b32 v250, a90
    v_accvgpr_read_b32 v251, a91
    v_ldexp_f32 v248, v248, v214
    v_ldexp_f32 v249, v249, v214
    v_ldexp_f32 v250, v250, v214
    v_ldexp_f32 v251, v251, v214
    v_accvgpr_write_b32 a88, v248
    v_accvgpr_write_b32 a89, v249
    v_accvgpr_write_b32 a90, v250
    v_accvgpr_write_b32 a91, v251
    v_accvgpr_read_b32 v248, a92
    v_accvgpr_read_b32 v249, a93
    v_accvgpr_read_b32 v250, a94
    v_accvgpr_read_b32 v251, a95
    v_ldexp_f32 v248, v248, v215
    v_ldexp_f32 v249, v249, v215
    v_ldexp_f32 v250, v250, v215
    v_ldexp_f32 v251, v251, v215
    v_accvgpr_write_b32 a92, v248
    v_accvgpr_write_b32 a93, v249
    v_accvgpr_write_b32 a94, v250
    v_accvgpr_write_b32 a95, v251
    v_accvgpr_read_b32 v248, a96
    v_accvgpr_read_b32 v249, a97
    v_accvgpr_read_b32 v250, a98
    v_accvgpr_read_b32 v251, a99
    v_ldexp_f32 v248, v248, v212
    v_ldexp_f32 v249, v249, v212
    v_ldexp_f32 v250, v250, v212
    v_ldexp_f32 v251, v251, v212
    v_accvgpr_write_b32 a96, v248
    v_accvgpr_write_b32 a97, v249
    v_accvgpr_write_b32 a98, v250
    v_accvgpr_write_b32 a99, v251
    v_accvgpr_read_b32 v248, a100
    v_accvgpr_read_b32 v249, a101
    v_accvgpr_read_b32 v250, a102
    v_accvgpr_read_b32 v251, a103
    v_ldexp_f32 v248, v248, v213
    v_ldexp_f32 v249, v249, v213
    v_ldexp_f32 v250, v250, v213
    v_ldexp_f32 v251, v251, v213
    v_accvgpr_write_b32 a100, v248
    v_accvgpr_write_b32 a101, v249
    v_accvgpr_write_b32 a102, v250
    v_accvgpr_write_b32 a103, v251
    v_accvgpr_read_b32 v248, a104
    v_accvgpr_read_b32 v249, a105
    v_accvgpr_read_b32 v250, a106
    v_accvgpr_read_b32 v251, a107
    v_ldexp_f32 v248, v248, v214
    v_ldexp_f32 v249, v249, v214
    v_ldexp_f32 v250, v250, v214
    v_ldexp_f32 v251, v251, v214
    v_accvgpr_write_b32 a104, v248
    v_accvgpr_write_b32 a105, v249
    v_accvgpr_write_b32 a106, v250
    v_accvgpr_write_b32 a107, v251
    v_accvgpr_read_b32 v248, a108
    v_accvgpr_read_b32 v249, a109
    v_accvgpr_read_b32 v250, a110
    v_accvgpr_read_b32 v251, a111
    v_ldexp_f32 v248, v248, v215
    v_ldexp_f32 v249, v249, v215
    v_ldexp_f32 v250, v250, v215
    v_ldexp_f32 v251, v251, v215
    v_accvgpr_write_b32 a108, v248
    v_accvgpr_write_b32 a109, v249
    v_accvgpr_write_b32 a110, v250
    v_accvgpr_write_b32 a111, v251
    v_accvgpr_read_b32 v248, a112
    v_accvgpr_read_b32 v249, a113
    v_accvgpr_read_b32 v250, a114
    v_accvgpr_read_b32 v251, a115
    v_ldexp_f32 v248, v248, v212
    v_ldexp_f32 v249, v249, v212
    v_ldexp_f32 v250, v250, v212
    v_ldexp_f32 v251, v251, v212
    v_accvgpr_write_b32 a112, v248
    v_accvgpr_write_b32 a113, v249
    v_accvgpr_write_b32 a114, v250
    v_accvgpr_write_b32 a115, v251
    v_accvgpr_read_b32 v248, a116
    v_accvgpr_read_b32 v249, a117
    v_accvgpr_read_b32 v250, a118
    v_accvgpr_read_b32 v251, a119
    v_ldexp_f32 v248, v248, v213
    v_ldexp_f32 v249, v249, v213
    v_ldexp_f32 v250, v250, v213
    v_ldexp_f32 v251, v251, v213
    v_accvgpr_write_b32 a116, v248
    v_accvgpr_write_b32 a117, v249
    v_accvgpr_write_b32 a118, v250
    v_accvgpr_write_b32 a119, v251
    v_accvgpr_read_b32 v248, a120
    v_accvgpr_read_b32 v249, a121
    v_accvgpr_read_b32 v250, a122
    v_accvgpr_read_b32 v251, a123
    v_ldexp_f32 v248, v248, v214
    v_ldexp_f32 v249, v249, v214
    v_ldexp_f32 v250, v250, v214
    v_ldexp_f32 v251, v251, v214
    v_accvgpr_write_b32 a120, v248
    v_accvgpr_write_b32 a121, v249
    v_accvgpr_write_b32 a122, v250
    v_accvgpr_write_b32 a123, v251
    v_accvgpr_read_b32 v248, a124
    v_accvgpr_read_b32 v249, a125
    v_accvgpr_read_b32 v250, a126
    v_accvgpr_read_b32 v251, a127
    v_ldexp_f32 v248, v248, v215
    v_ldexp_f32 v249, v249, v215
    v_ldexp_f32 v250, v250, v215
    v_ldexp_f32 v251, v251, v215
    v_accvgpr_write_b32 a124, v248
    v_accvgpr_write_b32 a125, v249
    v_accvgpr_write_b32 a126, v250
    v_accvgpr_write_b32 a127, v251
    v_accvgpr_read_b32 v248, a128
    v_accvgpr_read_b32 v249, a129
    v_accvgpr_read_b32 v250, a130
    v_accvgpr_read_b32 v251, a131
    v_ldexp_f32 v248, v248, v212
    v_ldexp_f32 v249, v249, v212
    v_ldexp_f32 v250, v250, v212
    v_ldexp_f32 v251, v251, v212
    v_accvgpr_write_b32 a128, v248
    v_accvgpr_write_b32 a129, v249
    v_accvgpr_write_b32 a130, v250
    v_accvgpr_write_b32 a131, v251
    v_accvgpr_read_b32 v248, a132
    v_accvgpr_read_b32 v249, a133
    v_accvgpr_read_b32 v250, a134
    v_accvgpr_read_b32 v251, a135
    v_ldexp_f32 v248, v248, v213
    v_ldexp_f32 v249, v249, v213
    v_ldexp_f32 v250, v250, v213
    v_ldexp_f32 v251, v251, v213
    v_accvgpr_write_b32 a132, v248
    v_accvgpr_write_b32 a133, v249
    v_accvgpr_write_b32 a134, v250
    v_accvgpr_write_b32 a135, v251
    v_accvgpr_read_b32 v248, a136
    v_accvgpr_read_b32 v249, a137
    v_accvgpr_read_b32 v250, a138
    v_accvgpr_read_b32 v251, a139
    v_ldexp_f32 v248, v248, v214
    v_ldexp_f32 v249, v249, v214
    v_ldexp_f32 v250, v250, v214
    v_ldexp_f32 v251, v251, v214
    v_accvgpr_write_b32 a136, v248
    v_accvgpr_write_b32 a137, v249
    v_accvgpr_write_b32 a138, v250
    v_accvgpr_write_b32 a139, v251
    v_accvgpr_read_b32 v248, a140
    v_accvgpr_read_b32 v249, a141
    v_accvgpr_read_b32 v250, a142
    v_accvgpr_read_b32 v251, a143
    v_ldexp_f32 v248, v248, v215
    v_ldexp_f32 v249, v249, v215
    v_ldexp_f32 v250, v250, v215
    v_ldexp_f32 v251, v251, v215
    v_accvgpr_write_b32 a140, v248
    v_accvgpr_write_b32 a141, v249
    v_accvgpr_write_b32 a142, v250
    v_accvgpr_write_b32 a143, v251
    v_accvgpr_read_b32 v248, a144
    v_accvgpr_read_b32 v249, a145
    v_accvgpr_read_b32 v250, a146
    v_accvgpr_read_b32 v251, a147
    v_ldexp_f32 v248, v248, v212
    v_ldexp_f32 v249, v249, v212
    v_ldexp_f32 v250, v250, v212
    v_ldexp_f32 v251, v251, v212
    v_accvgpr_write_b32 a144, v248
    v_accvgpr_write_b32 a145, v249
    v_accvgpr_write_b32 a146, v250
    v_accvgpr_write_b32 a147, v251
    v_accvgpr_read_b32 v248, a148
    v_accvgpr_read_b32 v249, a149
    v_accvgpr_read_b32 v250, a150
    v_accvgpr_read_b32 v251, a151
    v_ldexp_f32 v248, v248, v213
    v_ldexp_f32 v249, v249, v213
    v_ldexp_f32 v250, v250, v213
    v_ldexp_f32 v251, v251, v213
    v_accvgpr_write_b32 a148, v248
    v_accvgpr_write_b32 a149, v249
    v_accvgpr_write_b32 a150, v250
    v_accvgpr_write_b32 a151, v251
    v_accvgpr_read_b32 v248, a152
    v_accvgpr_read_b32 v249, a153
    v_accvgpr_read_b32 v250, a154
    v_accvgpr_read_b32 v251, a155
    v_ldexp_f32 v248, v248, v214
    v_ldexp_f32 v249, v249, v214
    v_ldexp_f32 v250, v250, v214
    v_ldexp_f32 v251, v251, v214
    v_accvgpr_write_b32 a152, v248
    v_accvgpr_write_b32 a153, v249
    v_accvgpr_write_b32 a154, v250
    v_accvgpr_write_b32 a155, v251
    v_accvgpr_read_b32 v248, a156
    v_accvgpr_read_b32 v249, a157
    v_accvgpr_read_b32 v250, a158
    v_accvgpr_read_b32 v251, a159
    v_ldexp_f32 v248, v248, v215
    v_ldexp_f32 v249, v249, v215
    v_ldexp_f32 v250, v250, v215
    v_ldexp_f32 v251, v251, v215
    v_accvgpr_write_b32 a156, v248
    v_accvgpr_write_b32 a157, v249
    v_accvgpr_write_b32 a158, v250
    v_accvgpr_write_b32 a159, v251
    v_accvgpr_read_b32 v248, a160
    v_accvgpr_read_b32 v249, a161
    v_accvgpr_read_b32 v250, a162
    v_accvgpr_read_b32 v251, a163
    v_ldexp_f32 v248, v248, v212
    v_ldexp_f32 v249, v249, v212
    v_ldexp_f32 v250, v250, v212
    v_ldexp_f32 v251, v251, v212
    v_accvgpr_write_b32 a160, v248
    v_accvgpr_write_b32 a161, v249
    v_accvgpr_write_b32 a162, v250
    v_accvgpr_write_b32 a163, v251
    v_accvgpr_read_b32 v248, a164
    v_accvgpr_read_b32 v249, a165
    v_accvgpr_read_b32 v250, a166
    v_accvgpr_read_b32 v251, a167
    v_ldexp_f32 v248, v248, v213
    v_ldexp_f32 v249, v249, v213
    v_ldexp_f32 v250, v250, v213
    v_ldexp_f32 v251, v251, v213
    v_accvgpr_write_b32 a164, v248
    v_accvgpr_write_b32 a165, v249
    v_accvgpr_write_b32 a166, v250
    v_accvgpr_write_b32 a167, v251
    v_accvgpr_read_b32 v248, a168
    v_accvgpr_read_b32 v249, a169
    v_accvgpr_read_b32 v250, a170
    v_accvgpr_read_b32 v251, a171
    v_ldexp_f32 v248, v248, v214
    v_ldexp_f32 v249, v249, v214
    v_ldexp_f32 v250, v250, v214
    v_ldexp_f32 v251, v251, v214
    v_accvgpr_write_b32 a168, v248
    v_accvgpr_write_b32 a169, v249
    v_accvgpr_write_b32 a170, v250
    v_accvgpr_write_b32 a171, v251
    v_accvgpr_read_b32 v248, a172
    v_accvgpr_read_b32 v249, a173
    v_accvgpr_read_b32 v250, a174
    v_accvgpr_read_b32 v251, a175
    v_ldexp_f32 v248, v248, v215
    v_ldexp_f32 v249, v249, v215
    v_ldexp_f32 v250, v250, v215
    v_ldexp_f32 v251, v251, v215
    v_accvgpr_write_b32 a172, v248
    v_accvgpr_write_b32 a173, v249
    v_accvgpr_write_b32 a174, v250
    v_accvgpr_write_b32 a175, v251
    v_accvgpr_read_b32 v248, a176
    v_accvgpr_read_b32 v249, a177
    v_accvgpr_read_b32 v250, a178
    v_accvgpr_read_b32 v251, a179
    v_ldexp_f32 v248, v248, v212
    v_ldexp_f32 v249, v249, v212
    v_ldexp_f32 v250, v250, v212
    v_ldexp_f32 v251, v251, v212
    v_accvgpr_write_b32 a176, v248
    v_accvgpr_write_b32 a177, v249
    v_accvgpr_write_b32 a178, v250
    v_accvgpr_write_b32 a179, v251
    v_accvgpr_read_b32 v248, a180
    v_accvgpr_read_b32 v249, a181
    v_accvgpr_read_b32 v250, a182
    v_accvgpr_read_b32 v251, a183
    v_ldexp_f32 v248, v248, v213
    v_ldexp_f32 v249, v249, v213
    v_ldexp_f32 v250, v250, v213
    v_ldexp_f32 v251, v251, v213
    v_accvgpr_write_b32 a180, v248
    v_accvgpr_write_b32 a181, v249
    v_accvgpr_write_b32 a182, v250
    v_accvgpr_write_b32 a183, v251
    v_accvgpr_read_b32 v248, a184
    v_accvgpr_read_b32 v249, a185
    v_accvgpr_read_b32 v250, a186
    v_accvgpr_read_b32 v251, a187
    v_ldexp_f32 v248, v248, v214
    v_ldexp_f32 v249, v249, v214
    v_ldexp_f32 v250, v250, v214
    v_ldexp_f32 v251, v251, v214
    v_accvgpr_write_b32 a184, v248
    v_accvgpr_write_b32 a185, v249
    v_accvgpr_write_b32 a186, v250
    v_accvgpr_write_b32 a187, v251
    v_accvgpr_read_b32 v248, a188
    v_accvgpr_read_b32 v249, a189
    v_accvgpr_read_b32 v250, a190
    v_accvgpr_read_b32 v251, a191
    v_ldexp_f32 v248, v248, v215
    v_ldexp_f32 v249, v249, v215
    v_ldexp_f32 v250, v250, v215
    v_ldexp_f32 v251, v251, v215
    v_accvgpr_write_b32 a188, v248
    v_accvgpr_write_b32 a189, v249
    v_accvgpr_write_b32 a190, v250
    v_accvgpr_write_b32 a191, v251
    v_accvgpr_read_b32 v248, a192
    v_accvgpr_read_b32 v249, a193
    v_accvgpr_read_b32 v250, a194
    v_accvgpr_read_b32 v251, a195
    v_ldexp_f32 v248, v248, v212
    v_ldexp_f32 v249, v249, v212
    v_ldexp_f32 v250, v250, v212
    v_ldexp_f32 v251, v251, v212
    v_accvgpr_write_b32 a192, v248
    v_accvgpr_write_b32 a193, v249
    v_accvgpr_write_b32 a194, v250
    v_accvgpr_write_b32 a195, v251
    v_accvgpr_read_b32 v248, a196
    v_accvgpr_read_b32 v249, a197
    v_accvgpr_read_b32 v250, a198
    v_accvgpr_read_b32 v251, a199
    v_ldexp_f32 v248, v248, v213
    v_ldexp_f32 v249, v249, v213
    v_ldexp_f32 v250, v250, v213
    v_ldexp_f32 v251, v251, v213
    v_accvgpr_write_b32 a196, v248
    v_accvgpr_write_b32 a197, v249
    v_accvgpr_write_b32 a198, v250
    v_accvgpr_write_b32 a199, v251
    v_accvgpr_read_b32 v248, a200
    v_accvgpr_read_b32 v249, a201
    v_accvgpr_read_b32 v250, a202
    v_accvgpr_read_b32 v251, a203
    v_ldexp_f32 v248, v248, v214
    v_ldexp_f32 v249, v249, v214
    v_ldexp_f32 v250, v250, v214
    v_ldexp_f32 v251, v251, v214
    v_accvgpr_write_b32 a200, v248
    v_accvgpr_write_b32 a201, v249
    v_accvgpr_write_b32 a202, v250
    v_accvgpr_write_b32 a203, v251
    v_accvgpr_read_b32 v248, a204
    v_accvgpr_read_b32 v249, a205
    v_accvgpr_read_b32 v250, a206
    v_accvgpr_read_b32 v251, a207
    v_ldexp_f32 v248, v248, v215
    v_ldexp_f32 v249, v249, v215
    v_ldexp_f32 v250, v250, v215
    v_ldexp_f32 v251, v251, v215
    v_accvgpr_write_b32 a204, v248
    v_accvgpr_write_b32 a205, v249
    v_accvgpr_write_b32 a206, v250
    v_accvgpr_write_b32 a207, v251
    v_accvgpr_read_b32 v248, a208
    v_accvgpr_read_b32 v249, a209
    v_accvgpr_read_b32 v250, a210
    v_accvgpr_read_b32 v251, a211
    v_ldexp_f32 v248, v248, v212
    v_ldexp_f32 v249, v249, v212
    v_ldexp_f32 v250, v250, v212
    v_ldexp_f32 v251, v251, v212
    v_accvgpr_write_b32 a208, v248
    v_accvgpr_write_b32 a209, v249
    v_accvgpr_write_b32 a210, v250
    v_accvgpr_write_b32 a211, v251
    v_accvgpr_read_b32 v248, a212
    v_accvgpr_read_b32 v249, a213
    v_accvgpr_read_b32 v250, a214
    v_accvgpr_read_b32 v251, a215
    v_ldexp_f32 v248, v248, v213
    v_ldexp_f32 v249, v249, v213
    v_ldexp_f32 v250, v250, v213
    v_ldexp_f32 v251, v251, v213
    v_accvgpr_write_b32 a212, v248
    v_accvgpr_write_b32 a213, v249
    v_accvgpr_write_b32 a214, v250
    v_accvgpr_write_b32 a215, v251
    v_accvgpr_read_b32 v248, a216
    v_accvgpr_read_b32 v249, a217
    v_accvgpr_read_b32 v250, a218
    v_accvgpr_read_b32 v251, a219
    v_ldexp_f32 v248, v248, v214
    v_ldexp_f32 v249, v249, v214
    v_ldexp_f32 v250, v250, v214
    v_ldexp_f32 v251, v251, v214
    v_accvgpr_write_b32 a216, v248
    v_accvgpr_write_b32 a217, v249
    v_accvgpr_write_b32 a218, v250
    v_accvgpr_write_b32 a219, v251
    v_accvgpr_read_b32 v248, a220
    v_accvgpr_read_b32 v249, a221
    v_accvgpr_read_b32 v250, a222
    v_accvgpr_read_b32 v251, a223
    v_ldexp_f32 v248, v248, v215
    v_ldexp_f32 v249, v249, v215
    v_ldexp_f32 v250, v250, v215
    v_ldexp_f32 v251, v251, v215
    v_accvgpr_write_b32 a220, v248
    v_accvgpr_write_b32 a221, v249
    v_accvgpr_write_b32 a222, v250
    v_accvgpr_write_b32 a223, v251
    v_accvgpr_read_b32 v248, a224
    v_accvgpr_read_b32 v249, a225
    v_accvgpr_read_b32 v250, a226
    v_accvgpr_read_b32 v251, a227
    v_ldexp_f32 v248, v248, v212
    v_ldexp_f32 v249, v249, v212
    v_ldexp_f32 v250, v250, v212
    v_ldexp_f32 v251, v251, v212
    v_accvgpr_write_b32 a224, v248
    v_accvgpr_write_b32 a225, v249
    v_accvgpr_write_b32 a226, v250
    v_accvgpr_write_b32 a227, v251
    v_accvgpr_read_b32 v248, a228
    v_accvgpr_read_b32 v249, a229
    v_accvgpr_read_b32 v250, a230
    v_accvgpr_read_b32 v251, a231
    v_ldexp_f32 v248, v248, v213
    v_ldexp_f32 v249, v249, v213
    v_ldexp_f32 v250, v250, v213
    v_ldexp_f32 v251, v251, v213
    v_accvgpr_write_b32 a228, v248
    v_accvgpr_write_b32 a229, v249
    v_accvgpr_write_b32 a230, v250
    v_accvgpr_write_b32 a231, v251
    v_accvgpr_read_b32 v248, a232
    v_accvgpr_read_b32 v249, a233
    v_accvgpr_read_b32 v250, a234
    v_accvgpr_read_b32 v251, a235
    v_ldexp_f32 v248, v248, v214
    v_ldexp_f32 v249, v249, v214
    v_ldexp_f32 v250, v250, v214
    v_ldexp_f32 v251, v251, v214
    v_accvgpr_write_b32 a232, v248
    v_accvgpr_write_b32 a233, v249
    v_accvgpr_write_b32 a234, v250
    v_accvgpr_write_b32 a235, v251
    v_accvgpr_read_b32 v248, a236
    v_accvgpr_read_b32 v249, a237
    v_accvgpr_read_b32 v250, a238
    v_accvgpr_read_b32 v251, a239
    v_ldexp_f32 v248, v248, v215
    v_ldexp_f32 v249, v249, v215
    v_ldexp_f32 v250, v250, v215
    v_ldexp_f32 v251, v251, v215
    v_accvgpr_write_b32 a236, v248
    v_accvgpr_write_b32 a237, v249
    v_accvgpr_write_b32 a238, v250
    v_accvgpr_write_b32 a239, v251
    v_accvgpr_read_b32 v248, a240
    v_accvgpr_read_b32 v249, a241
    v_accvgpr_read_b32 v250, a242
    v_accvgpr_read_b32 v251, a243
    v_ldexp_f32 v248, v248, v212
    v_ldexp_f32 v249, v249, v212
    v_ldexp_f32 v250, v250, v212
    v_ldexp_f32 v251, v251, v212
    v_accvgpr_write_b32 a240, v248
    v_accvgpr_write_b32 a241, v249
    v_accvgpr_write_b32 a242, v250
    v_accvgpr_write_b32 a243, v251
    v_accvgpr_read_b32 v248, a244
    v_accvgpr_read_b32 v249, a245
    v_accvgpr_read_b32 v250, a246
    v_accvgpr_read_b32 v251, a247
    v_ldexp_f32 v248, v248, v213
    v_ldexp_f32 v249, v249, v213
    v_ldexp_f32 v250, v250, v213
    v_ldexp_f32 v251, v251, v213
    v_accvgpr_write_b32 a244, v248
    v_accvgpr_write_b32 a245, v249
    v_accvgpr_write_b32 a246, v250
    v_accvgpr_write_b32 a247, v251
    v_accvgpr_read_b32 v248, a248
    v_accvgpr_read_b32 v249, a249
    v_accvgpr_read_b32 v250, a250
    v_accvgpr_read_b32 v251, a251
    v_ldexp_f32 v248, v248, v214
    v_ldexp_f32 v249, v249, v214
    v_ldexp_f32 v250, v250, v214
    v_ldexp_f32 v251, v251, v214
    v_accvgpr_write_b32 a248, v248
    v_accvgpr_write_b32 a249, v249
    v_accvgpr_write_b32 a250, v250
    v_accvgpr_write_b32 a251, v251
    v_accvgpr_read_b32 v248, a252
    v_accvgpr_read_b32 v249, a253
    v_accvgpr_read_b32 v250, a254
    v_accvgpr_read_b32 v251, a255
    v_ldexp_f32 v248, v248, v215
    v_ldexp_f32 v249, v249, v215
    v_ldexp_f32 v250, v250, v215
    v_ldexp_f32 v251, v251, v215
    v_accvgpr_write_b32 a252, v248
    v_accvgpr_write_b32 a253, v249
    v_accvgpr_write_b32 a254, v250
    v_accvgpr_write_b32 a255, v251
    s_setreg_imm32_b32 hwreg(HW_REG_MODE, 4, 2), 0
    s_nop 1
    v_sub_f32 v248, v128, v208
    v_sub_f32 v249, v129, v208
    v_sub_f32 v250, v130, v208
    v_sub_f32 v251, v131, v208
    v_exp_f32 v248, v248
    v_exp_f32 v249, v249
    v_exp_f32 v250, v250
    v_exp_f32 v251, v251
    s_nop 0
    v_cvt_pk_bf16_f32 v160, v248, v249
    v_cvt_pk_bf16_f32 v161, v250, v251
    v_add_f32 v244, v248, v249
    v_add_f32 v244, v244, v250
    v_add_f32 v244, v244, v251
    v_sub_f32 v248, v144, v208
    v_sub_f32 v249, v145, v208
    v_sub_f32 v250, v146, v208
    v_sub_f32 v251, v147, v208
    v_exp_f32 v248, v248
    v_exp_f32 v249, v249
    v_exp_f32 v250, v250
    v_exp_f32 v251, v251
    s_nop 0
    v_cvt_pk_bf16_f32 v162, v248, v249
    v_cvt_pk_bf16_f32 v163, v250, v251
    v_add_f32 v244, v244, v248
    v_add_f32 v244, v244, v249
    v_add_f32 v244, v244, v250
    v_add_f32 v244, v244, v251
    v_sub_f32 v248, v132, v209
    v_sub_f32 v249, v133, v209
    v_sub_f32 v250, v134, v209
    v_sub_f32 v251, v135, v209
    v_exp_f32 v248, v248
    v_exp_f32 v249, v249
    v_exp_f32 v250, v250
    v_exp_f32 v251, v251
    s_nop 0
    v_cvt_pk_bf16_f32 v164, v248, v249
    v_cvt_pk_bf16_f32 v165, v250, v251
    v_add_f32 v245, v248, v249
    v_add_f32 v245, v245, v250
    v_add_f32 v245, v245, v251
    v_sub_f32 v248, v148, v209
    v_sub_f32 v249, v149, v209
    v_sub_f32 v250, v150, v209
    v_sub_f32 v251, v151, v209
    v_exp_f32 v248, v248
    v_exp_f32 v249, v249
    v_exp_f32 v250, v250
    v_exp_f32 v251, v251
    s_nop 0
    v_cvt_pk_bf16_f32 v166, v248, v249
    v_cvt_pk_bf16_f32 v167, v250, v251
    v_add_f32 v245, v245, v248
    v_add_f32 v245, v245, v249
    v_add_f32 v245, v245, v250
    v_add_f32 v245, v245, v251
    v_sub_f32 v248, v136, v210
    v_sub_f32 v249, v137, v210
    v_sub_f32 v250, v138, v210
    v_sub_f32 v251, v139, v210
    v_exp_f32 v248, v248
    v_exp_f32 v249, v249
    v_exp_f32 v250, v250
    v_exp_f32 v251, v251
    s_nop 0
    v_cvt_pk_bf16_f32 v168, v248, v249
    v_cvt_pk_bf16_f32 v169, v250, v251
    v_add_f32 v246, v248, v249
    v_add_f32 v246, v246, v250
    v_add_f32 v246, v246, v251
    v_sub_f32 v248, v152, v210
    v_sub_f32 v249, v153, v210
    v_sub_f32 v250, v154, v210
    v_sub_f32 v251, v155, v210
    v_exp_f32 v248, v248
    v_exp_f32 v249, v249
    v_exp_f32 v250, v250
    v_exp_f32 v251, v251
    s_nop 0
    v_cvt_pk_bf16_f32 v170, v248, v249
    v_cvt_pk_bf16_f32 v171, v250, v251
    v_add_f32 v246, v246, v248
    v_add_f32 v246, v246, v249
    v_add_f32 v246, v246, v250
    v_add_f32 v246, v246, v251
    v_sub_f32 v248, v140, v211
    v_sub_f32 v249, v141, v211
    v_sub_f32 v250, v142, v211
    v_sub_f32 v251, v143, v211
    v_exp_f32 v248, v248
    v_exp_f32 v249, v249
    v_exp_f32 v250, v250
    v_exp_f32 v251, v251
    s_nop 0
    v_cvt_pk_bf16_f32 v172, v248, v249
    v_cvt_pk_bf16_f32 v173, v250, v251
    v_add_f32 v247, v248, v249
    v_add_f32 v247, v247, v250
    v_add_f32 v247, v247, v251
    v_sub_f32 v248, v156, v211
    v_sub_f32 v249, v157, v211
    v_sub_f32 v250, v158, v211
    v_sub_f32 v251, v159, v211
    v_exp_f32 v248, v248
    v_exp_f32 v249, v249
    v_exp_f32 v250, v250
    v_exp_f32 v251, v251
    s_nop 0
    v_cvt_pk_bf16_f32 v174, v248, v249
    v_cvt_pk_bf16_f32 v175, v250, v251
    v_add_f32 v247, v247, v248
    v_add_f32 v247, v247, v249
    v_add_f32 v247, v247, v250
    v_add_f32 v247, v247, v251
    s_nop 1
    s_setpc_b64 s[72:73]
L_rare1:
    s_nop 7
    v_max3_f32 v208, v128, v129, v130
    v_max3_f32 v208, v208, v131, v144
    v_max3_f32 v208, v208, v145, v146
    v_max_f32 v208, v208, v147
    v_max3_f32 v209, v132, v133, v134
    v_max3_f32 v209, v209, v135, v148
    v_max3_f32 v209, v209, v149, v150
    v_max_f32 v209, v209, v151
    v_max3_f32 v210, v136, v137, v138
    v_max3_f32 v210, v210, v139, v152
    v_max3_f32 v210, v210, v153, v154
    v_max_f32 v210, v210, v155
    v_max3_f32 v211, v140, v141, v142
    v_max3_f32 v211, v211, v143, v156
    v_max3_f32 v211, v211, v157, v158
    v_max_f32 v211, v211, v159
    v_mov_b32 v212, v208
    v_mov_b32 v213, v209
    v_mov_b32 v214, v210
    v_mov_b32 v215, v211
    s_nop 1
    v_permlane32_swap_b32 v208, v212
    v_permlane32_swap_b32 v209, v213
    v_permlane32_swap_b32 v210, v214
    v_permlane32_swap_b32 v211, v215
    s_nop 1
    v_max_f32 v208, v208, v212
    v_max_f32 v209, v209, v213
    v_max_f32 v210, v210, v214
    v_max_f32 v211, v211, v215
    v_mov_b32 v212, v208
    v_mov_b32 v213, v209
    v_mov_b32 v214, v210
    v_mov_b32 v215, v211
    s_nop 1
    v_permlane16_swap_b32 v208, v212
    v_permlane16_swap_b32 v209, v213
    v_permlane16_swap_b32 v210, v214
    v_permlane16_swap_b32 v211, v215
    s_nop 1
    v_max_f32 v208, v208, v212
    v_max_f32 v209, v209, v213
    v_max_f32 v210, v210, v214
    v_max_f32 v211, v211, v215
    v_add_f32 v208, 0x42c80000, v208
    v_add_f32 v209, 0x42c80000, v209
    v_add_f32 v210, 0x42c80000, v210
    v_add_f32 v211, 0x42c80000, v211
    v_max_f32 v208, 0, v208
    v_max_f32 v209, 0, v209
    v_max_f32 v210, 0, v210
    v_max_f32 v211, 0, v211
    v_ceil_f32 v208, v208
    v_ceil_f32 v209, v209
    v_ceil_f32 v210, v210
    v_ceil_f32 v211, v211
    v_sub_f32 v224, v224, v208
    v_sub_f32 v225, v225, v208
    v_sub_f32 v226, v226, v208
    v_sub_f32 v227, v227, v208
    v_sub_f32 v228, v228, v209
    v_sub_f32 v229, v229, v209
    v_sub_f32 v230, v230, v209
    v_sub_f32 v231, v231, v209
    v_sub_f32 v232, v232, v210
    v_sub_f32 v233, v233, v210
    v_sub_f32 v234, v234, v210
    v_sub_f32 v235, v235, v210
    v_sub_f32 v236, v236, v211
    v_sub_f32 v237, v237, v211
    v_sub_f32 v238, v238, v211
    v_sub_f32 v239, v239, v211
    v_cvt_i32_f32 v212, -v208
    v_cvt_i32_f32 v213, -v209
    v_cvt_i32_f32 v214, -v210
    v_cvt_i32_f32 v215, -v211
    s_setreg_imm32_b32 hwreg(HW_REG_MODE, 4, 2), 3
    s_nop 1
    v_ldexp_f32 v240, v240, v212
    v_ldexp_f32 v241, v241, v213
    v_ldexp_f32 v242, v242, v214
    v_ldexp_f32 v243, v243, v215
    v_accvgpr_read_b32 v248, a0
    v_accvgpr_read_b32 v249, a1
    v_accvgpr_read_b32 v250, a2
    v_accvgpr_read_b32 v251, a3
    v_ldexp_f32 v248, v248, v212
    v_ldexp_f32 v249, v249, v212
    v_ldexp_f32 v250, v250, v212
    v_ldexp_f32 v251, v251, v212
    v_accvgpr_write_b32 a0, v248
    v_accvgpr_write_b32 a1, v249
    v_accvgpr_write_b32 a2, v250
    v_accvgpr_write_b32 a3, v251
    v_accvgpr_read_b32 v248, a4
    v_accvgpr_read_b32 v249, a5
    v_accvgpr_read_b32 v250, a6
    v_accvgpr_read_b32 v251, a7
    v_ldexp_f32 v248, v248, v213
    v_ldexp_f32 v249, v249, v213
    v_ldexp_f32 v250, v250, v213
    v_ldexp_f32 v251, v251, v213
    v_accvgpr_write_b32 a4, v248
    v_accvgpr_write_b32 a5, v249
    v_accvgpr_write_b32 a6, v250
    v_accvgpr_write_b32 a7, v251
    v_accvgpr_read_b32 v248, a8
    v_accvgpr_read_b32 v249, a9
    v_accvgpr_read_b32 v250, a10
    v_accvgpr_read_b32 v251, a11
    v_ldexp_f32 v248, v248, v214
    v_ldexp_f32 v249, v249, v214
    v_ldexp_f32 v250, v250, v214
    v_ldexp_f32 v251, v251, v214
    v_accvgpr_write_b32 a8, v248
    v_accvgpr_write_b32 a9, v249
    v_accvgpr_write_b32 a10, v250
    v_accvgpr_write_b32 a11, v251
    v_accvgpr_read_b32 v248, a12
    v_accvgpr_read_b32 v249, a13
    v_accvgpr_read_b32 v250, a14
    v_accvgpr_read_b32 v251, a15
    v_ldexp_f32 v248, v248, v215
    v_ldexp_f32 v249, v249, v215
    v_ldexp_f32 v250, v250, v215
    v_ldexp_f32 v251, v251, v215
    v_accvgpr_write_b32 a12, v248
    v_accvgpr_write_b32 a13, v249
    v_accvgpr_write_b32 a14, v250
    v_accvgpr_write_b32 a15, v251
    v_accvgpr_read_b32 v248, a16
    v_accvgpr_read_b32 v249, a17
    v_accvgpr_read_b32 v250, a18
    v_accvgpr_read_b32 v251, a19
    v_ldexp_f32 v248, v248, v212
    v_ldexp_f32 v249, v249, v212
    v_ldexp_f32 v250, v250, v212
    v_ldexp_f32 v251, v251, v212
    v_accvgpr_write_b32 a16, v248
    v_accvgpr_write_b32 a17, v249
    v_accvgpr_write_b32 a18, v250
    v_accvgpr_write_b32 a19, v251
    v_accvgpr_read_b32 v248, a20
    v_accvgpr_read_b32 v249, a21
    v_accvgpr_read_b32 v250, a22
    v_accvgpr_read_b32 v251, a23
    v_ldexp_f32 v248, v248, v213
    v_ldexp_f32 v249, v249, v213
    v_ldexp_f32 v250, v250, v213
    v_ldexp_f32 v251, v251, v213
    v_accvgpr_write_b32 a20, v248
    v_accvgpr_write_b32 a21, v249
    v_accvgpr_write_b32 a22, v250
    v_accvgpr_write_b32 a23, v251
    v_accvgpr_read_b32 v248, a24
    v_accvgpr_read_b32 v249, a25
    v_accvgpr_read_b32 v250, a26
    v_accvgpr_read_b32 v251, a27
    v_ldexp_f32 v248, v248, v214
    v_ldexp_f32 v249, v249, v214
    v_ldexp_f32 v250, v250, v214
    v_ldexp_f32 v251, v251, v214
    v_accvgpr_write_b32 a24, v248
    v_accvgpr_write_b32 a25, v249
    v_accvgpr_write_b32 a26, v250
    v_accvgpr_write_b32 a27, v251
    v_accvgpr_read_b32 v248, a28
    v_accvgpr_read_b32 v249, a29
    v_accvgpr_read_b32 v250, a30
    v_accvgpr_read_b32 v251, a31
    v_ldexp_f32 v248, v248, v215
    v_ldexp_f32 v249, v249, v215
    v_ldexp_f32 v250, v250, v215
    v_ldexp_f32 v251, v251, v215
    v_accvgpr_write_b32 a28, v248
    v_accvgpr_write_b32 a29, v249
    v_accvgpr_write_b32 a30, v250
    v_accvgpr_write_b32 a31, v251
    v_accvgpr_read_b32 v248, a32
    v_accvgpr_read_b32 v249, a33
    v_accvgpr_read_b32 v250, a34
    v_accvgpr_read_b32 v251, a35
    v_ldexp_f32 v248, v248, v212
    v_ldexp_f32 v249, v249, v212
    v_ldexp_f32 v250, v250, v212
    v_ldexp_f32 v251, v251, v212
    v_accvgpr_write_b32 a32, v248
    v_accvgpr_write_b32 a33, v249
    v_accvgpr_write_b32 a34, v250
    v_accvgpr_write_b32 a35, v251
    v_accvgpr_read_b32 v248, a36
    v_accvgpr_read_b32 v249, a37
    v_accvgpr_read_b32 v250, a38
    v_accvgpr_read_b32 v251, a39
    v_ldexp_f32 v248, v248, v213
    v_ldexp_f32 v249, v249, v213
    v_ldexp_f32 v250, v250, v213
    v_ldexp_f32 v251, v251, v213
    v_accvgpr_write_b32 a36, v248
    v_accvgpr_write_b32 a37, v249
    v_accvgpr_write_b32 a38, v250
    v_accvgpr_write_b32 a39, v251
    v_accvgpr_read_b32 v248, a40
    v_accvgpr_read_b32 v249, a41
    v_accvgpr_read_b32 v250, a42
    v_accvgpr_read_b32 v251, a43
    v_ldexp_f32 v248, v248, v214
    v_ldexp_f32 v249, v249, v214
    v_ldexp_f32 v250, v250, v214
    v_ldexp_f32 v251, v251, v214
    v_accvgpr_write_b32 a40, v248
    v_accvgpr_write_b32 a41, v249
    v_accvgpr_write_b32 a42, v250
    v_accvgpr_write_b32 a43, v251
    v_accvgpr_read_b32 v248, a44
    v_accvgpr_read_b32 v249, a45
    v_accvgpr_read_b32 v250, a46
    v_accvgpr_read_b32 v251, a47
    v_ldexp_f32 v248, v248, v215
    v_ldexp_f32 v249, v249, v215
    v_ldexp_f32 v250, v250, v215
    v_ldexp_f32 v251, v251, v215
    v_accvgpr_write_b32 a44, v248
    v_accvgpr_write_b32 a45, v249
    v_accvgpr_write_b32 a46, v250
    v_accvgpr_write_b32 a47, v251
    v_accvgpr_read_b32 v248, a48
    v_accvgpr_read_b32 v249, a49
    v_accvgpr_read_b32 v250, a50
    v_accvgpr_read_b32 v251, a51
    v_ldexp_f32 v248, v248, v212
    v_ldexp_f32 v249, v249, v212
    v_ldexp_f32 v250, v250, v212
    v_ldexp_f32 v251, v251, v212
    v_accvgpr_write_b32 a48, v248
    v_accvgpr_write_b32 a49, v249
    v_accvgpr_write_b32 a50, v250
    v_accvgpr_write_b32 a51, v251
    v_accvgpr_read_b32 v248, a52
    v_accvgpr_read_b32 v249, a53
    v_accvgpr_read_b32 v250, a54
    v_accvgpr_read_b32 v251, a55
    v_ldexp_f32 v248, v248, v213
    v_ldexp_f32 v249, v249, v213
    v_ldexp_f32 v250, v250, v213
    v_ldexp_f32 v251, v251, v213
    v_accvgpr_write_b32 a52, v248
    v_accvgpr_write_b32 a53, v249
    v_accvgpr_write_b32 a54, v250
    v_accvgpr_write_b32 a55, v251
    v_accvgpr_read_b32 v248, a56
    v_accvgpr_read_b32 v249, a57
    v_accvgpr_read_b32 v250, a58
    v_accvgpr_read_b32 v251, a59
    v_ldexp_f32 v248, v248, v214
    v_ldexp_f32 v249, v249, v214
    v_ldexp_f32 v250, v250, v214
    v_ldexp_f32 v251, v251, v214
    v_accvgpr_write_b32 a56, v248
    v_accvgpr_write_b32 a57, v249
    v_accvgpr_write_b32 a58, v250
    v_accvgpr_write_b32 a59, v251
    v_accvgpr_read_b32 v248, a60
    v_accvgpr_read_b32 v249, a61
    v_accvgpr_read_b32 v250, a62
    v_accvgpr_read_b32 v251, a63
    v_ldexp_f32 v248, v248, v215
    v_ldexp_f32 v249, v249, v215
    v_ldexp_f32 v250, v250, v215
    v_ldexp_f32 v251, v251, v215
    v_accvgpr_write_b32 a60, v248
    v_accvgpr_write_b32 a61, v249
    v_accvgpr_write_b32 a62, v250
    v_accvgpr_write_b32 a63, v251
    v_accvgpr_read_b32 v248, a64
    v_accvgpr_read_b32 v249, a65
    v_accvgpr_read_b32 v250, a66
    v_accvgpr_read_b32 v251, a67
    v_ldexp_f32 v248, v248, v212
    v_ldexp_f32 v249, v249, v212
    v_ldexp_f32 v250, v250, v212
    v_ldexp_f32 v251, v251, v212
    v_accvgpr_write_b32 a64, v248
    v_accvgpr_write_b32 a65, v249
    v_accvgpr_write_b32 a66, v250
    v_accvgpr_write_b32 a67, v251
    v_accvgpr_read_b32 v248, a68
    v_accvgpr_read_b32 v249, a69
    v_accvgpr_read_b32 v250, a70
    v_accvgpr_read_b32 v251, a71
    v_ldexp_f32 v248, v248, v213
    v_ldexp_f32 v249, v249, v213
    v_ldexp_f32 v250, v250, v213
    v_ldexp_f32 v251, v251, v213
    v_accvgpr_write_b32 a68, v248
    v_accvgpr_write_b32 a69, v249
    v_accvgpr_write_b32 a70, v250
    v_accvgpr_write_b32 a71, v251
    v_accvgpr_read_b32 v248, a72
    v_accvgpr_read_b32 v249, a73
    v_accvgpr_read_b32 v250, a74
    v_accvgpr_read_b32 v251, a75
    v_ldexp_f32 v248, v248, v214
    v_ldexp_f32 v249, v249, v214
    v_ldexp_f32 v250, v250, v214
    v_ldexp_f32 v251, v251, v214
    v_accvgpr_write_b32 a72, v248
    v_accvgpr_write_b32 a73, v249
    v_accvgpr_write_b32 a74, v250
    v_accvgpr_write_b32 a75, v251
    v_accvgpr_read_b32 v248, a76
    v_accvgpr_read_b32 v249, a77
    v_accvgpr_read_b32 v250, a78
    v_accvgpr_read_b32 v251, a79
    v_ldexp_f32 v248, v248, v215
    v_ldexp_f32 v249, v249, v215
    v_ldexp_f32 v250, v250, v215
    v_ldexp_f32 v251, v251, v215
    v_accvgpr_write_b32 a76, v248
    v_accvgpr_write_b32 a77, v249
    v_accvgpr_write_b32 a78, v250
    v_accvgpr_write_b32 a79, v251
    v_accvgpr_read_b32 v248, a80
    v_accvgpr_read_b32 v249, a81
    v_accvgpr_read_b32 v250, a82
    v_accvgpr_read_b32 v251, a83
    v_ldexp_f32 v248, v248, v212
    v_ldexp_f32 v249, v249, v212
    v_ldexp_f32 v250, v250, v212
    v_ldexp_f32 v251, v251, v212
    v_accvgpr_write_b32 a80, v248
    v_accvgpr_write_b32 a81, v249
    v_accvgpr_write_b32 a82, v250
    v_accvgpr_write_b32 a83, v251
    v_accvgpr_read_b32 v248, a84
    v_accvgpr_read_b32 v249, a85
    v_accvgpr_read_b32 v250, a86
    v_accvgpr_read_b32 v251, a87
    v_ldexp_f32 v248, v248, v213
    v_ldexp_f32 v249, v249, v213
    v_ldexp_f32 v250, v250, v213
    v_ldexp_f32 v251, v251, v213
    v_accvgpr_write_b32 a84, v248
    v_accvgpr_write_b32 a85, v249
    v_accvgpr_write_b32 a86, v250
    v_accvgpr_write_b32 a87, v251
    v_accvgpr_read_b32 v248, a88
    v_accvgpr_read_b32 v249, a89
    v_accvgpr_read_b32 v250, a90
    v_accvgpr_read_b32 v251, a91
    v_ldexp_f32 v248, v248, v214
    v_ldexp_f32 v249, v249, v214
    v_ldexp_f32 v250, v250, v214
    v_ldexp_f32 v251, v251, v214
    v_accvgpr_write_b32 a88, v248
    v_accvgpr_write_b32 a89, v249
    v_accvgpr_write_b32 a90, v250
    v_accvgpr_write_b32 a91, v251
    v_accvgpr_read_b32 v248, a92
    v_accvgpr_read_b32 v249, a93
    v_accvgpr_read_b32 v250, a94
    v_accvgpr_read_b32 v251, a95
    v_ldexp_f32 v248, v248, v215
    v_ldexp_f32 v249, v249, v215
    v_ldexp_f32 v250, v250, v215
    v_ldexp_f32 v251, v251, v215
    v_accvgpr_write_b32 a92, v248
    v_accvgpr_write_b32 a93, v249
    v_accvgpr_write_b32 a94, v250
    v_accvgpr_write_b32 a95, v251
    v_accvgpr_read_b32 v248, a96
    v_accvgpr_read_b32 v249, a97
    v_accvgpr_read_b32 v250, a98
    v_accvgpr_read_b32 v251, a99
    v_ldexp_f32 v248, v248, v212
    v_ldexp_f32 v249, v249, v212
    v_ldexp_f32 v250, v250, v212
    v_ldexp_f32 v251, v251, v212
    v_accvgpr_write_b32 a96, v248
    v_accvgpr_write_b32 a97, v249
    v_accvgpr_write_b32 a98, v250
    v_accvgpr_write_b32 a99, v251
    v_accvgpr_read_b32 v248, a100
    v_accvgpr_read_b32 v249, a101
    v_accvgpr_read_b32 v250, a102
    v_accvgpr_read_b32 v251, a103
    v_ldexp_f32 v248, v248, v213
    v_ldexp_f32 v249, v249, v213
    v_ldexp_f32 v250, v250, v213
    v_ldexp_f32 v251, v251, v213
    v_accvgpr_write_b32 a100, v248
    v_accvgpr_write_b32 a101, v249
    v_accvgpr_write_b32 a102, v250
    v_accvgpr_write_b32 a103, v251
    v_accvgpr_read_b32 v248, a104
    v_accvgpr_read_b32 v249, a105
    v_accvgpr_read_b32 v250, a106
    v_accvgpr_read_b32 v251, a107
    v_ldexp_f32 v248, v248, v214
    v_ldexp_f32 v249, v249, v214
    v_ldexp_f32 v250, v250, v214
    v_ldexp_f32 v251, v251, v214
    v_accvgpr_write_b32 a104, v248
    v_accvgpr_write_b32 a105, v249
    v_accvgpr_write_b32 a106, v250
    v_accvgpr_write_b32 a107, v251
    v_accvgpr_read_b32 v248, a108
    v_accvgpr_read_b32 v249, a109
    v_accvgpr_read_b32 v250, a110
    v_accvgpr_read_b32 v251, a111
    v_ldexp_f32 v248, v248, v215
    v_ldexp_f32 v249, v249, v215
    v_ldexp_f32 v250, v250, v215
    v_ldexp_f32 v251, v251, v215
    v_accvgpr_write_b32 a108, v248
    v_accvgpr_write_b32 a109, v249
    v_accvgpr_write_b32 a110, v250
    v_accvgpr_write_b32 a111, v251
    v_accvgpr_read_b32 v248, a112
    v_accvgpr_read_b32 v249, a113
    v_accvgpr_read_b32 v250, a114
    v_accvgpr_read_b32 v251, a115
    v_ldexp_f32 v248, v248, v212
    v_ldexp_f32 v249, v249, v212
    v_ldexp_f32 v250, v250, v212
    v_ldexp_f32 v251, v251, v212
    v_accvgpr_write_b32 a112, v248
    v_accvgpr_write_b32 a113, v249
    v_accvgpr_write_b32 a114, v250
    v_accvgpr_write_b32 a115, v251
    v_accvgpr_read_b32 v248, a116
    v_accvgpr_read_b32 v249, a117
    v_accvgpr_read_b32 v250, a118
    v_accvgpr_read_b32 v251, a119
    v_ldexp_f32 v248, v248, v213
    v_ldexp_f32 v249, v249, v213
    v_ldexp_f32 v250, v250, v213
    v_ldexp_f32 v251, v251, v213
    v_accvgpr_write_b32 a116, v248
    v_accvgpr_write_b32 a117, v249
    v_accvgpr_write_b32 a118, v250
    v_accvgpr_write_b32 a119, v251
    v_accvgpr_read_b32 v248, a120
    v_accvgpr_read_b32 v249, a121
    v_accvgpr_read_b32 v250, a122
    v_accvgpr_read_b32 v251, a123
    v_ldexp_f32 v248, v248, v214
    v_ldexp_f32 v249, v249, v214
    v_ldexp_f32 v250, v250, v214
    v_ldexp_f32 v251, v251, v214
    v_accvgpr_write_b32 a120, v248
    v_accvgpr_write_b32 a121, v249
    v_accvgpr_write_b32 a122, v250
    v_accvgpr_write_b32 a123, v251
    v_accvgpr_read_b32 v248, a124
    v_accvgpr_read_b32 v249, a125
    v_accvgpr_read_b32 v250, a126
    v_accvgpr_read_b32 v251, a127
    v_ldexp_f32 v248, v248, v215
    v_ldexp_f32 v249, v249, v215
    v_ldexp_f32 v250, v250, v215
    v_ldexp_f32 v251, v251, v215
    v_accvgpr_write_b32 a124, v248
    v_accvgpr_write_b32 a125, v249
    v_accvgpr_write_b32 a126, v250
    v_accvgpr_write_b32 a127, v251
    v_accvgpr_read_b32 v248, a128
    v_accvgpr_read_b32 v249, a129
    v_accvgpr_read_b32 v250, a130
    v_accvgpr_read_b32 v251, a131
    v_ldexp_f32 v248, v248, v212
    v_ldexp_f32 v249, v249, v212
    v_ldexp_f32 v250, v250, v212
    v_ldexp_f32 v251, v251, v212
    v_accvgpr_write_b32 a128, v248
    v_accvgpr_write_b32 a129, v249
    v_accvgpr_write_b32 a130, v250
    v_accvgpr_write_b32 a131, v251
    v_accvgpr_read_b32 v248, a132
    v_accvgpr_read_b32 v249, a133
    v_accvgpr_read_b32 v250, a134
    v_accvgpr_read_b32 v251, a135
    v_ldexp_f32 v248, v248, v213
    v_ldexp_f32 v249, v249, v213
    v_ldexp_f32 v250, v250, v213
    v_ldexp_f32 v251, v251, v213
    v_accvgpr_write_b32 a132, v248
    v_accvgpr_write_b32 a133, v249
    v_accvgpr_write_b32 a134, v250
    v_accvgpr_write_b32 a135, v251
    v_accvgpr_read_b32 v248, a136
    v_accvgpr_read_b32 v249, a137
    v_accvgpr_read_b32 v250, a138
    v_accvgpr_read_b32 v251, a139
    v_ldexp_f32 v248, v248, v214
    v_ldexp_f32 v249, v249, v214
    v_ldexp_f32 v250, v250, v214
    v_ldexp_f32 v251, v251, v214
    v_accvgpr_write_b32 a136, v248
    v_accvgpr_write_b32 a137, v249
    v_accvgpr_write_b32 a138, v250
    v_accvgpr_write_b32 a139, v251
    v_accvgpr_read_b32 v248, a140
    v_accvgpr_read_b32 v249, a141
    v_accvgpr_read_b32 v250, a142
    v_accvgpr_read_b32 v251, a143
    v_ldexp_f32 v248, v248, v215
    v_ldexp_f32 v249, v249, v215
    v_ldexp_f32 v250, v250, v215
    v_ldexp_f32 v251, v251, v215
    v_accvgpr_write_b32 a140, v248
    v_accvgpr_write_b32 a141, v249
    v_accvgpr_write_b32 a142, v250
    v_accvgpr_write_b32 a143, v251
    v_accvgpr_read_b32 v248, a144
    v_accvgpr_read_b32 v249, a145
    v_accvgpr_read_b32 v250, a146
    v_accvgpr_read_b32 v251, a147
    v_ldexp_f32 v248, v248, v212
    v_ldexp_f32 v249, v249, v212
    v_ldexp_f32 v250, v250, v212
    v_ldexp_f32 v251, v251, v212
    v_accvgpr_write_b32 a144, v248
    v_accvgpr_write_b32 a145, v249
    v_accvgpr_write_b32 a146, v250
    v_accvgpr_write_b32 a147, v251
    v_accvgpr_read_b32 v248, a148
    v_accvgpr_read_b32 v249, a149
    v_accvgpr_read_b32 v250, a150
    v_accvgpr_read_b32 v251, a151
    v_ldexp_f32 v248, v248, v213
    v_ldexp_f32 v249, v249, v213
    v_ldexp_f32 v250, v250, v213
    v_ldexp_f32 v251, v251, v213
    v_accvgpr_write_b32 a148, v248
    v_accvgpr_write_b32 a149, v249
    v_accvgpr_write_b32 a150, v250
    v_accvgpr_write_b32 a151, v251
    v_accvgpr_read_b32 v248, a152
    v_accvgpr_read_b32 v249, a153
    v_accvgpr_read_b32 v250, a154
    v_accvgpr_read_b32 v251, a155
    v_ldexp_f32 v248, v248, v214
    v_ldexp_f32 v249, v249, v214
    v_ldexp_f32 v250, v250, v214
    v_ldexp_f32 v251, v251, v214
    v_accvgpr_write_b32 a152, v248
    v_accvgpr_write_b32 a153, v249
    v_accvgpr_write_b32 a154, v250
    v_accvgpr_write_b32 a155, v251
    v_accvgpr_read_b32 v248, a156
    v_accvgpr_read_b32 v249, a157
    v_accvgpr_read_b32 v250, a158
    v_accvgpr_read_b32 v251, a159
    v_ldexp_f32 v248, v248, v215
    v_ldexp_f32 v249, v249, v215
    v_ldexp_f32 v250, v250, v215
    v_ldexp_f32 v251, v251, v215
    v_accvgpr_write_b32 a156, v248
    v_accvgpr_write_b32 a157, v249
    v_accvgpr_write_b32 a158, v250
    v_accvgpr_write_b32 a159, v251
    v_accvgpr_read_b32 v248, a160
    v_accvgpr_read_b32 v249, a161
    v_accvgpr_read_b32 v250, a162
    v_accvgpr_read_b32 v251, a163
    v_ldexp_f32 v248, v248, v212
    v_ldexp_f32 v249, v249, v212
    v_ldexp_f32 v250, v250, v212
    v_ldexp_f32 v251, v251, v212
    v_accvgpr_write_b32 a160, v248
    v_accvgpr_write_b32 a161, v249
    v_accvgpr_write_b32 a162, v250
    v_accvgpr_write_b32 a163, v251
    v_accvgpr_read_b32 v248, a164
    v_accvgpr_read_b32 v249, a165
    v_accvgpr_read_b32 v250, a166
    v_accvgpr_read_b32 v251, a167
    v_ldexp_f32 v248, v248, v213
    v_ldexp_f32 v249, v249, v213
    v_ldexp_f32 v250, v250, v213
    v_ldexp_f32 v251, v251, v213
    v_accvgpr_write_b32 a164, v248
    v_accvgpr_write_b32 a165, v249
    v_accvgpr_write_b32 a166, v250
    v_accvgpr_write_b32 a167, v251
    v_accvgpr_read_b32 v248, a168
    v_accvgpr_read_b32 v249, a169
    v_accvgpr_read_b32 v250, a170
    v_accvgpr_read_b32 v251, a171
    v_ldexp_f32 v248, v248, v214
    v_ldexp_f32 v249, v249, v214
    v_ldexp_f32 v250, v250, v214
    v_ldexp_f32 v251, v251, v214
    v_accvgpr_write_b32 a168, v248
    v_accvgpr_write_b32 a169, v249
    v_accvgpr_write_b32 a170, v250
    v_accvgpr_write_b32 a171, v251
    v_accvgpr_read_b32 v248, a172
    v_accvgpr_read_b32 v249, a173
    v_accvgpr_read_b32 v250, a174
    v_accvgpr_read_b32 v251, a175
    v_ldexp_f32 v248, v248, v215
    v_ldexp_f32 v249, v249, v215
    v_ldexp_f32 v250, v250, v215
    v_ldexp_f32 v251, v251, v215
    v_accvgpr_write_b32 a172, v248
    v_accvgpr_write_b32 a173, v249
    v_accvgpr_write_b32 a174, v250
    v_accvgpr_write_b32 a175, v251
    v_accvgpr_read_b32 v248, a176
    v_accvgpr_read_b32 v249, a177
    v_accvgpr_read_b32 v250, a178
    v_accvgpr_read_b32 v251, a179
    v_ldexp_f32 v248, v248, v212
    v_ldexp_f32 v249, v249, v212
    v_ldexp_f32 v250, v250, v212
    v_ldexp_f32 v251, v251, v212
    v_accvgpr_write_b32 a176, v248
    v_accvgpr_write_b32 a177, v249
    v_accvgpr_write_b32 a178, v250
    v_accvgpr_write_b32 a179, v251
    v_accvgpr_read_b32 v248, a180
    v_accvgpr_read_b32 v249, a181
    v_accvgpr_read_b32 v250, a182
    v_accvgpr_read_b32 v251, a183
    v_ldexp_f32 v248, v248, v213
    v_ldexp_f32 v249, v249, v213
    v_ldexp_f32 v250, v250, v213
    v_ldexp_f32 v251, v251, v213
    v_accvgpr_write_b32 a180, v248
    v_accvgpr_write_b32 a181, v249
    v_accvgpr_write_b32 a182, v250
    v_accvgpr_write_b32 a183, v251
    v_accvgpr_read_b32 v248, a184
    v_accvgpr_read_b32 v249, a185
    v_accvgpr_read_b32 v250, a186
    v_accvgpr_read_b32 v251, a187
    v_ldexp_f32 v248, v248, v214
    v_ldexp_f32 v249, v249, v214
    v_ldexp_f32 v250, v250, v214
    v_ldexp_f32 v251, v251, v214
    v_accvgpr_write_b32 a184, v248
    v_accvgpr_write_b32 a185, v249
    v_accvgpr_write_b32 a186, v250
    v_accvgpr_write_b32 a187, v251
    v_accvgpr_read_b32 v248, a188
    v_accvgpr_read_b32 v249, a189
    v_accvgpr_read_b32 v250, a190
    v_accvgpr_read_b32 v251, a191
    v_ldexp_f32 v248, v248, v215
    v_ldexp_f32 v249, v249, v215
    v_ldexp_f32 v250, v250, v215
    v_ldexp_f32 v251, v251, v215
    v_accvgpr_write_b32 a188, v248
    v_accvgpr_write_b32 a189, v249
    v_accvgpr_write_b32 a190, v250
    v_accvgpr_write_b32 a191, v251
    v_accvgpr_read_b32 v248, a192
    v_accvgpr_read_b32 v249, a193
    v_accvgpr_read_b32 v250, a194
    v_accvgpr_read_b32 v251, a195
    v_ldexp_f32 v248, v248, v212
    v_ldexp_f32 v249, v249, v212
    v_ldexp_f32 v250, v250, v212
    v_ldexp_f32 v251, v251, v212
    v_accvgpr_write_b32 a192, v248
    v_accvgpr_write_b32 a193, v249
    v_accvgpr_write_b32 a194, v250
    v_accvgpr_write_b32 a195, v251
    v_accvgpr_read_b32 v248, a196
    v_accvgpr_read_b32 v249, a197
    v_accvgpr_read_b32 v250, a198
    v_accvgpr_read_b32 v251, a199
    v_ldexp_f32 v248, v248, v213
    v_ldexp_f32 v249, v249, v213
    v_ldexp_f32 v250, v250, v213
    v_ldexp_f32 v251, v251, v213
    v_accvgpr_write_b32 a196, v248
    v_accvgpr_write_b32 a197, v249
    v_accvgpr_write_b32 a198, v250
    v_accvgpr_write_b32 a199, v251
    v_accvgpr_read_b32 v248, a200
    v_accvgpr_read_b32 v249, a201
    v_accvgpr_read_b32 v250, a202
    v_accvgpr_read_b32 v251, a203
    v_ldexp_f32 v248, v248, v214
    v_ldexp_f32 v249, v249, v214
    v_ldexp_f32 v250, v250, v214
    v_ldexp_f32 v251, v251, v214
    v_accvgpr_write_b32 a200, v248
    v_accvgpr_write_b32 a201, v249
    v_accvgpr_write_b32 a202, v250
    v_accvgpr_write_b32 a203, v251
    v_accvgpr_read_b32 v248, a204
    v_accvgpr_read_b32 v249, a205
    v_accvgpr_read_b32 v250, a206
    v_accvgpr_read_b32 v251, a207
    v_ldexp_f32 v248, v248, v215
    v_ldexp_f32 v249, v249, v215
    v_ldexp_f32 v250, v250, v215
    v_ldexp_f32 v251, v251, v215
    v_accvgpr_write_b32 a204, v248
    v_accvgpr_write_b32 a205, v249
    v_accvgpr_write_b32 a206, v250
    v_accvgpr_write_b32 a207, v251
    v_accvgpr_read_b32 v248, a208
    v_accvgpr_read_b32 v249, a209
    v_accvgpr_read_b32 v250, a210
    v_accvgpr_read_b32 v251, a211
    v_ldexp_f32 v248, v248, v212
    v_ldexp_f32 v249, v249, v212
    v_ldexp_f32 v250, v250, v212
    v_ldexp_f32 v251, v251, v212
    v_accvgpr_write_b32 a208, v248
    v_accvgpr_write_b32 a209, v249
    v_accvgpr_write_b32 a210, v250
    v_accvgpr_write_b32 a211, v251
    v_accvgpr_read_b32 v248, a212
    v_accvgpr_read_b32 v249, a213
    v_accvgpr_read_b32 v250, a214
    v_accvgpr_read_b32 v251, a215
    v_ldexp_f32 v248, v248, v213
    v_ldexp_f32 v249, v249, v213
    v_ldexp_f32 v250, v250, v213
    v_ldexp_f32 v251, v251, v213
    v_accvgpr_write_b32 a212, v248
    v_accvgpr_write_b32 a213, v249
    v_accvgpr_write_b32 a214, v250
    v_accvgpr_write_b32 a215, v251
    v_accvgpr_read_b32 v248, a216
    v_accvgpr_read_b32 v249, a217
    v_accvgpr_read_b32 v250, a218
    v_accvgpr_read_b32 v251, a219
    v_ldexp_f32 v248, v248, v214
    v_ldexp_f32 v249, v249, v214
    v_ldexp_f32 v250, v250, v214
    v_ldexp_f32 v251, v251, v214
    v_accvgpr_write_b32 a216, v248
    v_accvgpr_write_b32 a217, v249
    v_accvgpr_write_b32 a218, v250
    v_accvgpr_write_b32 a219, v251
    v_accvgpr_read_b32 v248, a220
    v_accvgpr_read_b32 v249, a221
    v_accvgpr_read_b32 v250, a222
    v_accvgpr_read_b32 v251, a223
    v_ldexp_f32 v248, v248, v215
    v_ldexp_f32 v249, v249, v215
    v_ldexp_f32 v250, v250, v215
    v_ldexp_f32 v251, v251, v215
    v_accvgpr_write_b32 a220, v248
    v_accvgpr_write_b32 a221, v249
    v_accvgpr_write_b32 a222, v250
    v_accvgpr_write_b32 a223, v251
    v_accvgpr_read_b32 v248, a224
    v_accvgpr_read_b32 v249, a225
    v_accvgpr_read_b32 v250, a226
    v_accvgpr_read_b32 v251, a227
    v_ldexp_f32 v248, v248, v212
    v_ldexp_f32 v249, v249, v212
    v_ldexp_f32 v250, v250, v212
    v_ldexp_f32 v251, v251, v212
    v_accvgpr_write_b32 a224, v248
    v_accvgpr_write_b32 a225, v249
    v_accvgpr_write_b32 a226, v250
    v_accvgpr_write_b32 a227, v251
    v_accvgpr_read_b32 v248, a228
    v_accvgpr_read_b32 v249, a229
    v_accvgpr_read_b32 v250, a230
    v_accvgpr_read_b32 v251, a231
    v_ldexp_f32 v248, v248, v213
    v_ldexp_f32 v249, v249, v213
    v_ldexp_f32 v250, v250, v213
    v_ldexp_f32 v251, v251, v213
    v_accvgpr_write_b32 a228, v248
    v_accvgpr_write_b32 a229, v249
    v_accvgpr_write_b32 a230, v250
    v_accvgpr_write_b32 a231, v251
    v_accvgpr_read_b32 v248, a232
    v_accvgpr_read_b32 v249, a233
    v_accvgpr_read_b32 v250, a234
    v_accvgpr_read_b32 v251, a235
    v_ldexp_f32 v248, v248, v214
    v_ldexp_f32 v249, v249, v214
    v_ldexp_f32 v250, v250, v214
    v_ldexp_f32 v251, v251, v214
    v_accvgpr_write_b32 a232, v248
    v_accvgpr_write_b32 a233, v249
    v_accvgpr_write_b32 a234, v250
    v_accvgpr_write_b32 a235, v251
    v_accvgpr_read_b32 v248, a236
    v_accvgpr_read_b32 v249, a237
    v_accvgpr_read_b32 v250, a238
    v_accvgpr_read_b32 v251, a239
    v_ldexp_f32 v248, v248, v215
    v_ldexp_f32 v249, v249, v215
    v_ldexp_f32 v250, v250, v215
    v_ldexp_f32 v251, v251, v215
    v_accvgpr_write_b32 a236, v248
    v_accvgpr_write_b32 a237, v249
    v_accvgpr_write_b32 a238, v250
    v_accvgpr_write_b32 a239, v251
    v_accvgpr_read_b32 v248, a240
    v_accvgpr_read_b32 v249, a241
    v_accvgpr_read_b32 v250, a242
    v_accvgpr_read_b32 v251, a243
    v_ldexp_f32 v248, v248, v212
    v_ldexp_f32 v249, v249, v212
    v_ldexp_f32 v250, v250, v212
    v_ldexp_f32 v251, v251, v212
    v_accvgpr_write_b32 a240, v248
    v_accvgpr_write_b32 a241, v249
    v_accvgpr_write_b32 a242, v250
    v_accvgpr_write_b32 a243, v251
    v_accvgpr_read_b32 v248, a244
    v_accvgpr_read_b32 v249, a245
    v_accvgpr_read_b32 v250, a246
    v_accvgpr_read_b32 v251, a247
    v_ldexp_f32 v248, v248, v213
    v_ldexp_f32 v249, v249, v213
    v_ldexp_f32 v250, v250, v213
    v_ldexp_f32 v251, v251, v213
    v_accvgpr_write_b32 a244, v248
    v_accvgpr_write_b32 a245, v249
    v_accvgpr_write_b32 a246, v250
    v_accvgpr_write_b32 a247, v251
    v_accvgpr_read_b32 v248, a248
    v_accvgpr_read_b32 v249, a249
    v_accvgpr_read_b32 v250, a250
    v_accvgpr_read_b32 v251, a251
    v_ldexp_f32 v248, v248, v214
    v_ldexp_f32 v249, v249, v214
    v_ldexp_f32 v250, v250, v214
    v_ldexp_f32 v251, v251, v214
    v_accvgpr_write_b32 a248, v248
    v_accvgpr_write_b32 a249, v249
    v_accvgpr_write_b32 a250, v250
    v_accvgpr_write_b32 a251, v251
    v_accvgpr_read_b32 v248, a252
    v_accvgpr_read_b32 v249, a253
    v_accvgpr_read_b32 v250, a254
    v_accvgpr_read_b32 v251, a255
    v_ldexp_f32 v248, v248, v215
    v_ldexp_f32 v249, v249, v215
    v_ldexp_f32 v250, v250, v215
    v_ldexp_f32 v251, v251, v215
    v_accvgpr_write_b32 a252, v248
    v_accvgpr_write_b32 a253, v249
    v_accvgpr_write_b32 a254, v250
    v_accvgpr_write_b32 a255, v251
    s_setreg_imm32_b32 hwreg(HW_REG_MODE, 4, 2), 0
    s_nop 1
    v_sub_f32 v248, v128, v208
    v_sub_f32 v249, v129, v208
    v_sub_f32 v250, v130, v208
    v_sub_f32 v251, v131, v208
    v_exp_f32 v248, v248
    v_exp_f32 v249, v249
    v_exp_f32 v250, v250
    v_exp_f32 v251, v251
    s_nop 0
    v_cvt_pk_bf16_f32 v176, v248, v249
    v_cvt_pk_bf16_f32 v177, v250, v251
    v_add_f32 v244, v248, v249
    v_add_f32 v244, v244, v250
    v_add_f32 v244, v244, v251
    v_sub_f32 v248, v144, v208
    v_sub_f32 v249, v145, v208
    v_sub_f32 v250, v146, v208
    v_sub_f32 v251, v147, v208
    v_exp_f32 v248, v248
    v_exp_f32 v249, v249
    v_exp_f32 v250, v250
    v_exp_f32 v251, v251
    s_nop 0
    v_cvt_pk_bf16_f32 v178, v248, v249
    v_cvt_pk_bf16_f32 v179, v250, v251
    v_add_f32 v244, v244, v248
    v_add_f32 v244, v244, v249
    v_add_f32 v244, v244, v250
    v_add_f32 v244, v244, v251
    v_sub_f32 v248, v132, v209
    v_sub_f32 v249, v133, v209
    v_sub_f32 v250, v134, v209
    v_sub_f32 v251, v135, v209
    v_exp_f32 v248, v248
    v_exp_f32 v249, v249
    v_exp_f32 v250, v250
    v_exp_f32 v251, v251
    s_nop 0
    v_cvt_pk_bf16_f32 v180, v248, v249
    v_cvt_pk_bf16_f32 v181, v250, v251
    v_add_f32 v245, v248, v249
    v_add_f32 v245, v245, v250
    v_add_f32 v245, v245, v251
    v_sub_f32 v248, v148, v209
    v_sub_f32 v249, v149, v209
    v_sub_f32 v250, v150, v209
    v_sub_f32 v251, v151, v209
    v_exp_f32 v248, v248
    v_exp_f32 v249, v249
    v_exp_f32 v250, v250
    v_exp_f32 v251, v251
    s_nop 0
    v_cvt_pk_bf16_f32 v182, v248, v249
    v_cvt_pk_bf16_f32 v183, v250, v251
    v_add_f32 v245, v245, v248
    v_add_f32 v245, v245, v249
    v_add_f32 v245, v245, v250
    v_add_f32 v245, v245, v251
    v_sub_f32 v248, v136, v210
    v_sub_f32 v249, v137, v210
    v_sub_f32 v250, v138, v210
    v_sub_f32 v251, v139, v210
    v_exp_f32 v248, v248
    v_exp_f32 v249, v249
    v_exp_f32 v250, v250
    v_exp_f32 v251, v251
    s_nop 0
    v_cvt_pk_bf16_f32 v184, v248, v249
    v_cvt_pk_bf16_f32 v185, v250, v251
    v_add_f32 v246, v248, v249
    v_add_f32 v246, v246, v250
    v_add_f32 v246, v246, v251
    v_sub_f32 v248, v152, v210
    v_sub_f32 v249, v153, v210
    v_sub_f32 v250, v154, v210
    v_sub_f32 v251, v155, v210
    v_exp_f32 v248, v248
    v_exp_f32 v249, v249
    v_exp_f32 v250, v250
    v_exp_f32 v251, v251
    s_nop 0
    v_cvt_pk_bf16_f32 v186, v248, v249
    v_cvt_pk_bf16_f32 v187, v250, v251
    v_add_f32 v246, v246, v248
    v_add_f32 v246, v246, v249
    v_add_f32 v246, v246, v250
    v_add_f32 v246, v246, v251
    v_sub_f32 v248, v140, v211
    v_sub_f32 v249, v141, v211
    v_sub_f32 v250, v142, v211
    v_sub_f32 v251, v143, v211
    v_exp_f32 v248, v248
    v_exp_f32 v249, v249
    v_exp_f32 v250, v250
    v_exp_f32 v251, v251
    s_nop 0
    v_cvt_pk_bf16_f32 v188, v248, v249
    v_cvt_pk_bf16_f32 v189, v250, v251
    v_add_f32 v247, v248, v249
    v_add_f32 v247, v247, v250
    v_add_f32 v247, v247, v251
    v_sub_f32 v248, v156, v211
    v_sub_f32 v249, v157, v211
    v_sub_f32 v250, v158, v211
    v_sub_f32 v251, v159, v211
    v_exp_f32 v248, v248
    v_exp_f32 v249, v249
    v_exp_f32 v250, v250
    v_exp_f32 v251, v251
    s_nop 0
    v_cvt_pk_bf16_f32 v190, v248, v249
    v_cvt_pk_bf16_f32 v191, v250, v251
    v_add_f32 v247, v247, v248
    v_add_f32 v247, v247, v249
    v_add_f32 v247, v247, v250
    v_add_f32 v247, v247, v251
    s_nop 1
    s_setpc_b64 s[72:73]
.section .rodata,"a"
.p2align 6
.amdhsa_kernel adaLN_cond__gqa_block_cached__mixer_s_mlp__prompt_kernel
  .amdhsa_next_free_vgpr 512
  .amdhsa_next_free_sgpr 102
  .amdhsa_accum_offset 256
  .amdhsa_group_segment_fixed_size 0
  .amdhsa_kernarg_size 120
  .amdhsa_user_sgpr_count 2
  .amdhsa_user_sgpr_kernarg_segment_ptr 1
  .amdhsa_system_sgpr_workgroup_id_x 1
.end_amdhsa_kernel
```
